```python
import torch

def _softmax(x, axis=-1):
    return torch.softmax(x, dim=axis)

def _gelu(x):
    return torch.nn.functional.gelu(x, approximate='tanh')

def _silu(x):
    return torch.nn.functional.silu(x)

def _sigmoid(x):
    return torch.sigmoid(x)

def _layernorm(x, axis=-1, eps=1e-05):
    m = x.mean(dim=axis, keepdim=True)
    v = x.var(dim=axis, keepdim=True, unbiased=False)
    return (x - m) / torch.sqrt(v + eps)

def _scatter_add(tgt, idx, src, axis=0):
    return tgt.clone().index_add_(axis, idx, src)

def _segment_sum(src, seg, n):
    out = torch.zeros((n,) + src.shape[1:], dtype=src.dtype)
    return out.index_add_(0, seg, src)

def _pad(x, pw):
    flat = tuple((v for pair in reversed(pw) for v in pair))
    return torch.nn.functional.pad(x, flat)
kernel_name = 'parallel_sum__ssm_conv_s4__mixer_gmlp__prompt'

def setup_inputs():

    _w = lambda a: (lambda t: t.to(torch.bfloat16) if t.is_floating_point() else t)(torch.as_tensor(a))

    def _A_setup():
        B, L, D, N = (1, 2048, 576, 128)
        A_re = -(lambda _x: torch.exp(torch.as_tensor(_x)))((lambda *s: torch.randn(*s, dtype=torch.bfloat16) * 3.2)(D, N))
        A_im = torch.pi * (lambda *s: torch.randn(*s, dtype=torch.bfloat16) * 0.2)(D, N)
        B_re = (lambda *s: torch.randn(*s, dtype=torch.bfloat16) * 0.8)(D, N)
        B_im = (lambda *s: torch.randn(*s, dtype=torch.bfloat16) * 0.8)(D, N)
        C_re = (lambda *s: torch.randn(*s, dtype=torch.bfloat16) * 0.8)(D, N)
        C_im = (lambda *s: torch.randn(*s, dtype=torch.bfloat16) * 0.8)(D, N)
        log_dt = (lambda *s: torch.randn(*s, dtype=torch.bfloat16) * 0.2)(D) * 0.5 - 4.0
        Dskip = (lambda *s: torch.randn(*s, dtype=torch.bfloat16) * 1.6)(D)
        return {'u': _w((lambda *s: torch.randn(*s, dtype=torch.bfloat16) * 0.05)(B, L, D)), 'A_re': _w(A_re), 'A_im': _w(A_im), 'B_re': _w(B_re), 'B_im': _w(B_im), 'C_re': _w(C_re), 'C_im': _w(C_im), 'log_dt': _w(log_dt), 'Dskip': _w(Dskip)}
    _A_in = _A_setup()

    def _B_setup():
        B, S, D, F = (1, 2048, 576, 4608)
        Fh = F // 2
        return {'x': _w((lambda *s: torch.randn(*s, dtype=torch.bfloat16) * 0.05)(B, S, D)), 'w_in': _w((lambda *s: torch.randn(*s, dtype=torch.bfloat16) * 0.4)(D, 2 * Fh)), 'w_sp': _w(0.01 * (lambda *s: torch.randn(*s, dtype=torch.bfloat16) * 0.4)(S, S)), 'b_sp': _w(1.0 + 0.01 * (lambda *s: torch.randn(*s, dtype=torch.bfloat16) * 0.05)(S)), 'w_out': _w((lambda *s: torch.randn(*s, dtype=torch.bfloat16) * 0.05)(Fh, D))}
    _B_in = _B_setup()
    return {'A_u': _A_in['u'], 'A_A_re': _A_in['A_re'], 'A_A_im': _A_in['A_im'], 'A_B_re': _A_in['B_re'], 'A_B_im': _A_in['B_im'], 'A_C_re': _A_in['C_re'], 'A_C_im': _A_in['C_im'], 'A_log_dt': _A_in['log_dt'], 'A_Dskip': _A_in['Dskip'], 'B_x': _B_in['x'], 'B_w_in': _B_in['w_in'], 'B_w_sp': _B_in['w_sp'], 'B_b_sp': _B_in['b_sp'], 'B_w_out': _B_in['w_out']}

def reference(A_u, A_A_re, A_A_im, A_B_re, A_B_im, A_C_re, A_C_im, A_log_dt, A_Dskip, B_x, B_w_in, B_w_sp, B_b_sp, B_w_out):

    def _A_ref(u, A_re, A_im, B_re, B_im, C_re, C_im, log_dt, Dskip):
        Bsz, L, D = u.shape
        dt = torch.exp(log_dt)[:, None]
        A = A_re + 1j * A_im
        Bc = B_re + 1j * B_im
        Cc = C_re + 1j * C_im
        logdA = dt * A
        dB = dt * Bc
        l = (lambda x, dt: x.to(dt))(torch.arange(L), A_re.dtype)
        P = torch.exp(logdA[:, :, None] * l[None, None, :])
        K = torch.einsum('dn,dnl,dn->dl', Cc, P, dB).real
        L2 = 2 * L
        Kp = _pad(K, ((0, 0), (0, L)))
        up = (lambda x, *d: x.permute(*d))(u, 0, 2, 1)
        up = _pad(up, ((0, 0), (0, 0), (0, L)))
        Kf = (lambda x, axes=(-2, -1): torch.fft.rfft2(x.float(), dim=axes))(Kp[:, None, :], axes=(-2, -1))
        Uf = (lambda x, axes=(-2, -1): torch.fft.rfft2(x.float(), dim=axes))(up[:, :, None, :], axes=(-2, -1))
        Yf = Uf * Kf[None, :, :, :]
        y = (lambda x, s, axes=(-2, -1): torch.fft.irfft2(x, s=s, dim=axes).to(torch.bfloat16))(Yf, (1, L2), axes=(-2, -1))[:, :, 0, :L]
        y = (lambda x, *d: x.permute(*d))(y, 0, 2, 1) + u * Dskip[None, None, :]
        return y

    def _B_ref(x, w_in, w_sp, b_sp, w_out):
        B, S, D = x.shape
        F = w_in.shape[-1]
        Fh = F // 2
        z = _gelu(torch.einsum('bsd,df->bsf', x, w_in))
        z1 = z[..., :Fh].clone()
        z2 = _layernorm(z[..., Fh:], axis=-1)
        g = torch.einsum('ts,bsf->btf', w_sp, z2) + b_sp[None, :, None]
        return torch.einsum('bsf,fd->bsd', z1 * g, w_out)
    x = A_u
    xn = _layernorm(x, axis=-1)
    return x + _A_ref(xn, A_A_re, A_A_im, A_B_re, A_B_im, A_C_re, A_C_im, A_log_dt, A_Dskip) + _B_ref(xn, B_w_in, B_w_sp, B_b_sp, B_w_out)
```

```asm
; @launch kernel=mega_kernel grid=(256,1,1) block=(512,1,1) lds=162048
.amdgcn_target "amdgcn-amd-amdhsa--gfx950"
.text
.globl mega_kernel
.p2align 8
.type mega_kernel,@function
mega_kernel:
s_cmp_ge_u32 s2, 256
s_cbranch_scc1 mega_end
s_load_dwordx16 s[68:83], s[0:1], 0
s_load_dwordx2 s[4:5], s[0:1], 80
s_load_dwordx2 s[6:7], s[0:1], 104
s_load_dwordx2 s[10:11], s[0:1], 120
s_load_dwordx2 s[8:9], s[0:1], 128
s_getpc_b64 s[30:31]
mega_pc:
s_lshr_b32 s25, s2, 3
s_lshl_b32 s32, s25, 12
v_lshlrev_b32 v234, 7, v0
v_add_u32 v234, s32, v234
v_min_u32 v234, mega_end-mega_pc, v234
v_cmp_gt_u32 vcc, 32, v0
s_nop 3
s_and_saveexec_b64 s[62:63], vcc
s_cbranch_execz mega_cpf
global_load_dword v249, v234, s[30:31]
mega_cpf:
s_mov_b64 exec, s[62:63]
s_and_b32 s24, s2, 7
s_lshr_b32 s25, s2, 3
s_and_b32 s26, s24, 1
s_lshl_b32 s26, s26, 3
s_and_b32 s27, s25, 7
s_add_u32 s26, s26, s27
s_lshr_b32 s27, s24, 1
s_lshl_b32 s27, s27, 2
s_lshr_b32 s25, s25, 3
s_add_u32 s27, s27, s25
v_mov_b32 v255, v0
v_lshrrev_b32 v235, 6, v0
v_and_b32 v250, 63, v0
v_and_b32 v251, 15, v0
v_bfe_u32 v252, v0, 4, 2
v_readfirstlane_b32 s29, v235
v_lshlrev_b32 v253, 4, v250
s_mov_b32 s61, 2146435072
s_nop 1
s_and_b32 s28, s29, 3
s_lshl_b32 s38, s26, 5
s_add_u32 s38, s38, s27
s_lshl_b32 s38, s38, 2
s_add_u32 s38, s38, 262144
s_mul_i32 s58, s27, 5
s_add_u32 s58, s58, s26
s_and_b32 s58, s58, 15
s_sub_u32 s59, s58, 9
s_cmp_lt_u32 s58, 9
s_cselect_b32 s59, s58, s59
s_mov_b32 s3, s59
v_lshrrev_b32 v234, 3, v250
v_and_b32 v235, 7, v250
v_bfe_u32 v236, v250, 4, 1
v_xor_b32 v235, v235, v236
s_lshl_b32 s30, s26, 7
s_lshl_b32 s31, s28, 4
s_add_u32 s30, s30, s31
v_add_u32 v234, s30, v234
v_mul_u32_u24 v234, 1152, v234
s_and_b32 s31, s29, 1
s_lshl_b32 s31, s31, 2
s_add_u32 s30, s31, 0
v_xor_b32 v236, s30, v235
v_lshl_add_u32 v46, v236, 4, v234
s_add_u32 s30, s31, 2
v_xor_b32 v236, s30, v235
v_lshl_add_u32 v47, v236, 4, v234
v_add_u32 v47, 9216, v47
s_mul_i32 s32, s27, 288
s_mul_i32 s30, s28, 73728
s_add_u32 s32, s32, s30
s_lshr_b32 s30, s29, 2
s_mul_i32 s49, s30, 73728
s_mul_i32 s50, s30, 294912
s_mov_b32 s33, 238609295
v_add_u32 v234, 0, v250
v_mul_hi_u32 v235, v234, s33
v_mul_u32_u24 v236, 18, v235
v_sub_u32 v236, v234, v236
v_mul_u32_u24 v235, 9216, v235
v_lshl_add_u32 v236, v236, 4, s32
v_add_u32 v48, v235, v236
v_add_u32 v234, 64, v250
v_mul_hi_u32 v235, v234, s33
v_mul_u32_u24 v236, 18, v235
v_sub_u32 v236, v234, v236
v_mul_u32_u24 v235, 9216, v235
v_lshl_add_u32 v236, v236, 4, s32
v_add_u32 v49, v235, v236
v_add_u32 v234, 128, v250
v_mul_hi_u32 v235, v234, s33
v_mul_u32_u24 v236, 18, v235
v_sub_u32 v236, v234, v236
v_mul_u32_u24 v235, 9216, v235
v_lshl_add_u32 v236, v236, 4, s32
v_add_u32 v50, v235, v236
s_lshl_b32 s36, s29, 11
s_mul_i32 s37, s29, 2432
s_add_u32 s37, s37, 84224
s_mov_b32 s64, 0xffff
s_mov_b32 s65, 0
s_mov_b32 s66, -1
s_mov_b32 s67, 0
s_waitcnt lgkmcnt(0)
s_mov_b32 s12, s68
s_and_b32 s13, s69, 0xffff
s_mov_b32 s14, 2359296
s_mov_b32 s15, 0x20000
s_mov_b32 s16, s4
s_and_b32 s17, s5, 0xffff
s_mov_b32 s18, 5308416
s_mov_b32 s19, 0x20000
s_add_u32 m0, s36, 18688
s_lshl_b32 s32, s59, 7
s_add_u32 s35, s32, s49
buffer_load_dwordx4 v46, s[12:15], s35 offen lds
s_add_u32 m0, s36, 19712
s_add_u32 s59, s59, 1
buffer_load_dwordx4 v47, s[12:15], s35 offen lds
s_cmp_eq_u32 s59, 9
s_cselect_b32 s59, 0, s59
s_add_u32 m0, s37, 0
s_mul_i32 s33, s3, 589824
s_add_u32 s33, s33, 4608
s_add_u32 s34, s33, s50
buffer_load_dwordx4 v48, s[16:19], s34 offen lds
s_add_u32 m0, s37, 1024
s_add_u32 s3, s3, 1
buffer_load_dwordx4 v49, s[16:19], s34 offen lds
s_add_u32 m0, s37, 2048
s_mov_b64 exec, s[64:65]
buffer_load_dwordx4 v50, s[16:19], s34 offen lds
s_mov_b64 exec, s[62:63]
s_cmp_eq_u32 s3, 9
s_cselect_b32 s3, 0, s3
s_add_u32 s44, s8, 42991616
s_addc_u32 s45, s9, 0
s_and_b32 s45, s45, 0xffff
s_mov_b32 s46, 1214464
s_mov_b32 s47, 0x20000
s_mul_i32 s30, s26, 9
s_add_u32 s30, s30, s58
s_lshl_b32 s30, s30, 10
s_mul_i32 s31, s27, 9
s_add_u32 s31, s31, s58
s_mul_i32 s31, s31, 1152
s_add_u32 s31, s31, 1048576
s_cmp_lt_u32 s58, 9
s_cselect_b32 s56, s30, s61
s_cselect_b32 s57, s31, s61
s_lshl_b32 s34, s26, 4
s_add_u32 s34, s34, s27
s_lshl_b32 s34, s34, 10
s_add_u32 s48, s34, 327680
s_add_u32 s35, s57, 128
s_cmp_eq_u32 s29, 0
s_cselect_b32 s34, s56, s61
s_cmp_eq_u32 s29, 1
s_cselect_b32 s34, s57, s34
s_cmp_eq_u32 s29, 2
s_cselect_b32 s34, s48, s34
s_cmp_eq_u32 s29, 3
s_cselect_b32 s34, s35, s34
v_mov_b32 v238, -1
v_mov_b32 v239, -1
v_mov_b32 v240, -1
v_mov_b32 v241, -1
buffer_store_dwordx4 v[238:241], v253, s[44:47], s34 offen sc1
s_cmp_eq_u32 s29, 4
s_cbranch_scc0 mega_ow_1
s_lshl_b32 s30, s27, 4
s_add_u32 s30, s30, s26
s_lshl_b32 s30, s30, 7
s_add_u32 s30, s30, 266236
s_lshl_b32 s31, s26, 9
s_lshl_b32 s34, s27, 2
s_add_u32 s31, s31, s34
s_add_u32 s31, s31, 297856
s_lshl_b32 s34, s2, 3
s_add_u32 s34, s34, 280576
v_lshl_add_u32 v242, v250, 2, s30
v_lshl_add_u32 v243, v250, 7, s31
v_lshl_add_u32 v244, v250, 11, s34
v_mov_b32 v245, s38
v_cmp_lt_u32 vcc, 0, v250
s_nop 1
v_cndmask_b32 v245, v245, v242, vcc
v_cmp_lt_u32 vcc, 8, v250
s_nop 1
v_cndmask_b32 v245, v245, v243, vcc
v_cmp_lt_u32 vcc, 12, v250
s_nop 1
v_cndmask_b32 v245, v245, v244, vcc
v_mov_b32 v242, 0
s_mov_b64 exec, 0x7ffff
buffer_store_dword v242, v245, s[44:47], 0 offen sc1
s_mov_b64 exec, s[62:63]
mega_ow_1:
s_add_u32 m0, s36, 35072
s_lshl_b32 s32, s59, 7
s_add_u32 s35, s32, s49
buffer_load_dwordx4 v46, s[12:15], s35 offen lds
s_add_u32 m0, s36, 36096
s_add_u32 s59, s59, 1
buffer_load_dwordx4 v47, s[12:15], s35 offen lds
s_cmp_eq_u32 s59, 9
s_cselect_b32 s59, 0, s59
s_add_u32 m0, s37, 19456
s_mul_i32 s33, s3, 589824
s_add_u32 s33, s33, 4608
s_add_u32 s34, s33, s50
buffer_load_dwordx4 v48, s[16:19], s34 offen lds
s_add_u32 m0, s37, 20480
s_add_u32 s3, s3, 1
buffer_load_dwordx4 v49, s[16:19], s34 offen lds
s_add_u32 m0, s37, 21504
s_mov_b64 exec, s[64:65]
buffer_load_dwordx4 v50, s[16:19], s34 offen lds
s_mov_b64 exec, s[62:63]
s_cmp_eq_u32 s3, 9
s_cselect_b32 s3, 0, s3
s_mov_b32 s20, s6
s_and_b32 s21, s7, 0xffff
s_mov_b32 s22, 2654208
s_mov_b32 s23, 0x20000
s_mov_b32 s40, s10
s_and_b32 s41, s11, 0xffff
s_mov_b32 s42, 256
s_mov_b32 s43, 0x20000
s_add_u32 s52, s8, 28311552
s_addc_u32 s53, s9, 0
s_and_b32 s53, s53, 0xffff
s_mov_b32 s54, 2359296
s_mov_b32 s55, 0x20000
s_mov_b32 s92, s82
s_and_b32 s93, s83, 0xffff
s_mov_b32 s94, 1152
s_mov_b32 s95, 0x20000
s_mov_b32 s88, s80
s_and_b32 s89, s81, 0xffff
s_mov_b32 s90, 147456
s_mov_b32 s91, 0x20000
s_mov_b32 s84, s78
s_and_b32 s85, s79, 0xffff
s_mov_b32 s86, 147456
s_mov_b32 s87, 0x20000
s_mov_b32 s80, s76
s_and_b32 s81, s77, 0xffff
s_mov_b32 s82, 147456
s_mov_b32 s83, 0x20000
s_mov_b32 s76, s74
s_and_b32 s77, s75, 0xffff
s_mov_b32 s78, 147456
s_mov_b32 s79, 0x20000
s_mov_b32 s72, s72
s_and_b32 s73, s73, 0xffff
s_mov_b32 s74, 147456
s_mov_b32 s75, 0x20000
s_mov_b32 s68, s70
s_and_b32 s69, s71, 0xffff
s_mov_b32 s70, 147456
s_mov_b32 s71, 0x20000
v_lshrrev_b32 v234, 2, v251
v_and_b32 v235, 3, v251
v_lshl_add_u32 v236, v234, 3, v235
s_lshl_b32 s30, s28, 5
v_add_u32 v236, s30, v236
v_bfe_u32 v237, v251, 1, 1
v_lshl_add_u32 v237, v234, 1, v237
v_xor_b32 v237, v237, v252
v_lshlrev_b32 v237, 4, v237
v_lshlrev_b32 v44, 3, v236
v_lshl_add_u32 v40, v236, 7, v237
v_add_u32 v40, 18688, v40
v_xor_b32 v41, 64, v40
v_mul_u32_u24 v236, 288, v234
v_mul_u32_u24 v237, 2432, v252
v_lshl_add_u32 v236, v235, 3, v236
v_add_u32 v236, v236, v237
v_add_u32 v42, 84224, v236
v_add_u32 v43, 123136, v236
v_mov_b32 v238, s61
v_cmp_eq_u32 vcc, v234, v252
s_lshr_b32 s30, s29, 2
s_lshl_b32 s30, s30, 5
s_add_u32 s30, s30, s56
v_add_u32 v51, s30, v44
v_cndmask_b32 v51, v238, v51, vcc
v_cmp_eq_u32 vcc, 0, v252
v_lshl_add_u32 v52, v251, 2, s57
s_nop 0
v_cndmask_b32 v52, v238, v52, vcc
v_mov_b32 v0, 0
v_mov_b32 v1, 0
v_mov_b32 v2, 0
v_mov_b32 v3, 0
v_mov_b32 v4, 0
v_mov_b32 v5, 0
v_mov_b32 v6, 0
v_mov_b32 v7, 0
v_mov_b32 v8, 0
v_mov_b32 v9, 0
v_mov_b32 v10, 0
v_mov_b32 v11, 0
v_mov_b32 v12, 0
v_mov_b32 v13, 0
v_mov_b32 v14, 0
v_mov_b32 v15, 0
v_mov_b32 v16, 0
v_mov_b32 v17, 0
v_mov_b32 v18, 0
v_mov_b32 v19, 0
v_mov_b32 v20, 0
v_mov_b32 v21, 0
v_mov_b32 v22, 0
v_mov_b32 v23, 0
v_mov_b32 v24, 0
v_mov_b32 v25, 0
v_mov_b32 v26, 0
v_mov_b32 v27, 0
v_mov_b32 v28, 0
v_mov_b32 v29, 0
v_mov_b32 v30, 0
v_mov_b32 v31, 0
v_mov_b32 v32, 0
v_mov_b32 v33, 0
v_mov_b32 v34, 0
v_mov_b32 v35, 0
v_mov_b32 v36, 0
v_mov_b32 v37, 0
v_mov_b32 v38, 0
v_mov_b32 v39, 0
v_mov_b32 v54, 0x3f803f80
v_mov_b32 v55, 0x3f803f80
v_mov_b32 v56, 0x3f803f80
v_mov_b32 v57, 0x3f803f80
v_mov_b32 v160, 0
v_mov_b32 v58, 0
v_mov_b32 v161, 0
v_mov_b32 v59, 0
v_mov_b32 v162, 0
v_mov_b32 v60, 0
v_mov_b32 v163, 0
v_mov_b32 v61, 0
v_mov_b32 v164, 0
v_mov_b32 v62, 0
v_mov_b32 v165, 0
v_mov_b32 v63, 0
v_mov_b32 v166, 0
v_mov_b32 v64, 0
v_mov_b32 v167, 0
v_mov_b32 v65, 0
v_mov_b32 v254, 0xc0135761
s_mov_b32 s60, 0xbdd2d3e8
v_lshlrev_b32 v245, 4, v251
s_waitcnt vmcnt(6)
s_barrier
s_cmp_ge_u32 s29, 4
s_cbranch_scc1 mega_hf1
ds_read_b128 v[72:75], v40 offset:0
ds_read_b128 v[76:79], v40 offset:512
ds_read_b64_tr_b16 v[80:81], v42 offset:0
ds_read_b64_tr_b16 v[82:83], v42 offset:1152
ds_read_b64_tr_b16 v[84:85], v42 offset:32
ds_read_b64_tr_b16 v[86:87], v42 offset:1184
ds_read_b64_tr_b16 v[88:89], v42 offset:64
ds_read_b64_tr_b16 v[90:91], v42 offset:1216
ds_read_b64_tr_b16 v[92:93], v42 offset:96
ds_read_b64_tr_b16 v[94:95], v42 offset:1248
s_waitcnt lgkmcnt(0)
v_mfma_f32_16x16x32_bf16 v[0:3], v[72:75], v[80:83], v[0:3]
ds_read_b128 v[100:103], v41 offset:0
ds_read_b128 v[104:107], v41 offset:512
v_mfma_f32_16x16x32_bf16 v[4:7], v[76:79], v[80:83], v[4:7]
ds_read_b64_tr_b16 v[108:109], v42 offset:9728
ds_read_b64_tr_b16 v[110:111], v42 offset:10880
s_add_u32 m0, s36, 51456
s_lshl_b32 s32, s59, 7
s_add_u32 s35, s32, s49
buffer_load_dwordx4 v46, s[12:15], s35 offen lds
v_mfma_f32_16x16x32_bf16 v[8:11], v[72:75], v[84:87], v[8:11]
ds_read_b64_tr_b16 v[112:113], v42 offset:9760
s_add_u32 m0, s36, 52480
s_add_u32 s59, s59, 1
buffer_load_dwordx4 v47, s[12:15], s35 offen lds
s_cmp_eq_u32 s59, 9
s_cselect_b32 s59, 0, s59
v_mfma_f32_16x16x32_bf16 v[12:15], v[76:79], v[84:87], v[12:15]
ds_read_b64_tr_b16 v[114:115], v42 offset:10912
ds_read_b64_tr_b16 v[116:117], v42 offset:9792
s_add_u32 m0, s37, 38912
s_mul_i32 s33, s3, 589824
s_add_u32 s33, s33, 4608
s_add_u32 s34, s33, s50
buffer_load_dwordx4 v48, s[16:19], s34 offen lds
v_mfma_f32_16x16x32_bf16 v[16:19], v[72:75], v[88:91], v[16:19]
ds_read_b64_tr_b16 v[118:119], v42 offset:10944
ds_read_b64_tr_b16 v[120:121], v42 offset:9824
v_mfma_f32_16x16x32_bf16 v[20:23], v[76:79], v[88:91], v[20:23]
ds_read_b64_tr_b16 v[122:123], v42 offset:10976
s_add_u32 m0, s37, 39936
s_add_u32 s3, s3, 1
buffer_load_dwordx4 v49, s[16:19], s34 offen lds
v_mfma_f32_16x16x32_bf16 v[24:27], v[72:75], v[92:95], v[24:27]
s_add_u32 m0, s37, 40960
s_mov_b64 exec, s[64:65]
buffer_load_dwordx4 v50, s[16:19], s34 offen lds
s_mov_b64 exec, s[62:63]
s_cmp_eq_u32 s3, 9
s_cselect_b32 s3, 0, s3
v_mfma_f32_16x16x32_bf16 v[28:31], v[76:79], v[92:95], v[28:31]
v_mfma_f32_16x16x32_bf16 v[160:163], v[54:57], v[72:75], v[160:163]
v_mfma_f32_16x16x32_bf16 v[164:167], v[72:75], v[72:75], v[164:167]
s_cmp_eq_u32 s28, 1
s_cbranch_scc1 mega_cs_3
s_cmp_eq_u32 s28, 2
s_cbranch_scc1 mega_cs_4
s_cmp_eq_u32 s28, 3
s_cbranch_scc1 mega_cs_5
v_mfma_f32_16x16x32_bf16 v[58:61], v[54:57], v[80:83], v[58:61]
s_branch mega_cse_2
mega_cs_3:
v_mfma_f32_16x16x32_bf16 v[58:61], v[54:57], v[84:87], v[58:61]
s_branch mega_cse_2
mega_cs_4:
v_mfma_f32_16x16x32_bf16 v[58:61], v[54:57], v[88:91], v[58:61]
s_branch mega_cse_2
mega_cs_5:
v_mfma_f32_16x16x32_bf16 v[58:61], v[54:57], v[92:95], v[58:61]
mega_cse_2:
s_waitcnt vmcnt(5) lgkmcnt(0)
s_barrier
v_mfma_f32_16x16x32_bf16 v[0:3], v[100:103], v[108:111], v[0:3]
ds_read_b128 v[72:75], v40 offset:16384
ds_read_b128 v[76:79], v40 offset:16896
v_mfma_f32_16x16x32_bf16 v[4:7], v[104:107], v[108:111], v[4:7]
ds_read_b64_tr_b16 v[80:81], v42 offset:19456
ds_read_b64_tr_b16 v[82:83], v42 offset:20608
s_add_u32 m0, s36, 67840
s_lshl_b32 s32, s59, 7
s_add_u32 s35, s32, s49
buffer_load_dwordx4 v46, s[12:15], s35 offen lds
s_add_u32 m0, s36, 68864
s_add_u32 s59, s59, 1
buffer_load_dwordx4 v47, s[12:15], s35 offen lds
s_cmp_eq_u32 s59, 9
s_cselect_b32 s59, 0, s59
v_mfma_f32_16x16x32_bf16 v[8:11], v[100:103], v[112:115], v[8:11]
ds_read_b64_tr_b16 v[84:85], v42 offset:19488
s_add_u32 m0, s37, 58368
s_mul_i32 s33, s3, 589824
s_add_u32 s33, s33, 4608
s_add_u32 s34, s33, s50
buffer_load_dwordx4 v48, s[16:19], s34 offen lds
v_mfma_f32_16x16x32_bf16 v[12:15], v[104:107], v[112:115], v[12:15]
ds_read_b64_tr_b16 v[86:87], v42 offset:20640
ds_read_b64_tr_b16 v[88:89], v42 offset:19520
s_add_u32 m0, s37, 59392
s_add_u32 s3, s3, 1
buffer_load_dwordx4 v49, s[16:19], s34 offen lds
s_add_u32 m0, s37, 60416
s_mov_b64 exec, s[64:65]
buffer_load_dwordx4 v50, s[16:19], s34 offen lds
s_mov_b64 exec, s[62:63]
s_cmp_eq_u32 s3, 9
s_cselect_b32 s3, 0, s3
v_mfma_f32_16x16x32_bf16 v[16:19], v[100:103], v[116:119], v[16:19]
ds_read_b64_tr_b16 v[90:91], v42 offset:20672
ds_read_b64_tr_b16 v[92:93], v42 offset:19552
s_add_u32 m0, s36, 18688
s_lshl_b32 s32, s59, 7
s_add_u32 s35, s32, s49
buffer_load_dwordx4 v46, s[12:15], s35 offen lds
v_mfma_f32_16x16x32_bf16 v[20:23], v[104:107], v[116:119], v[20:23]
ds_read_b64_tr_b16 v[94:95], v42 offset:20704
s_add_u32 m0, s36, 19712
s_add_u32 s59, s59, 1
buffer_load_dwordx4 v47, s[12:15], s35 offen lds
s_cmp_eq_u32 s59, 9
s_cselect_b32 s59, 0, s59
s_add_u32 m0, s37, 0
s_mul_i32 s33, s3, 589824
s_add_u32 s33, s33, 4608
s_add_u32 s34, s33, s50
buffer_load_dwordx4 v48, s[16:19], s34 offen lds
v_mfma_f32_16x16x32_bf16 v[24:27], v[100:103], v[120:123], v[24:27]
s_add_u32 m0, s37, 1024
s_add_u32 s3, s3, 1
buffer_load_dwordx4 v49, s[16:19], s34 offen lds
v_mfma_f32_16x16x32_bf16 v[28:31], v[104:107], v[120:123], v[28:31]
s_add_u32 m0, s37, 2048
s_mov_b64 exec, s[64:65]
buffer_load_dwordx4 v50, s[16:19], s34 offen lds
s_mov_b64 exec, s[62:63]
s_cmp_eq_u32 s3, 9
s_cselect_b32 s3, 0, s3
v_mfma_f32_16x16x32_bf16 v[160:163], v[54:57], v[100:103], v[160:163]
v_mfma_f32_16x16x32_bf16 v[164:167], v[100:103], v[100:103], v[164:167]
s_cmp_eq_u32 s28, 1
s_cbranch_scc1 mega_cs_7
s_cmp_eq_u32 s28, 2
s_cbranch_scc1 mega_cs_8
s_cmp_eq_u32 s28, 3
s_cbranch_scc1 mega_cs_9
v_mfma_f32_16x16x32_bf16 v[58:61], v[54:57], v[108:111], v[58:61]
s_branch mega_cse_6
mega_cs_7:
v_mfma_f32_16x16x32_bf16 v[58:61], v[54:57], v[112:115], v[58:61]
s_branch mega_cse_6
mega_cs_8:
v_mfma_f32_16x16x32_bf16 v[58:61], v[54:57], v[116:119], v[58:61]
s_branch mega_cse_6
mega_cs_9:
v_mfma_f32_16x16x32_bf16 v[58:61], v[54:57], v[120:123], v[58:61]
mega_cse_6:
s_waitcnt lgkmcnt(0)
v_mfma_f32_16x16x32_bf16 v[0:3], v[72:75], v[80:83], v[0:3]
ds_read_b128 v[100:103], v41 offset:16384
ds_read_b128 v[104:107], v41 offset:16896
v_and_b32 v234, 3, v251
v_cmp_eq_u32 vcc, 1, v234
v_mfma_f32_16x16x32_bf16 v[4:7], v[76:79], v[80:83], v[4:7]
ds_read_b64_tr_b16 v[108:109], v42 offset:29184
ds_read_b64_tr_b16 v[110:111], v42 offset:30336
v_cndmask_b32 v164, v164, v165, vcc
v_and_b32 v234, 3, v251
v_mfma_f32_16x16x32_bf16 v[8:11], v[72:75], v[84:87], v[8:11]
ds_read_b64_tr_b16 v[112:113], v42 offset:29216
v_cmp_eq_u32 vcc, 2, v234
s_nop 1
v_cndmask_b32 v164, v164, v166, vcc
v_mfma_f32_16x16x32_bf16 v[12:15], v[76:79], v[84:87], v[12:15]
ds_read_b64_tr_b16 v[114:115], v42 offset:30368
ds_read_b64_tr_b16 v[116:117], v42 offset:29248
v_and_b32 v234, 3, v251
v_mfma_f32_16x16x32_bf16 v[16:19], v[72:75], v[88:91], v[16:19]
ds_read_b64_tr_b16 v[118:119], v42 offset:30400
ds_read_b64_tr_b16 v[120:121], v42 offset:29280
v_cmp_eq_u32 vcc, 3, v234
s_nop 1
v_cndmask_b32 v164, v164, v167, vcc
v_mfma_f32_16x16x32_bf16 v[20:23], v[76:79], v[88:91], v[20:23]
ds_read_b64_tr_b16 v[122:123], v42 offset:30432
v_mov_b32 v161, v164
buffer_store_dwordx2 v[160:161], v51, s[44:47], 0 offen sc1
v_mfma_f32_16x16x32_bf16 v[24:27], v[72:75], v[92:95], v[24:27]
s_add_u32 s31, s28, 0
s_lshl_b32 s31, s31, 6
v_mfma_f32_16x16x32_bf16 v[28:31], v[76:79], v[92:95], v[28:31]
buffer_store_dword v58, v52, s[44:47], s31 offen sc1
s_waitcnt vmcnt(12) lgkmcnt(0)
s_barrier
v_mfma_f32_16x16x32_bf16 v[0:3], v[100:103], v[108:111], v[0:3]
ds_read_b128 v[72:75], v40 offset:32768
ds_read_b128 v[76:79], v40 offset:33280
v_mfma_f32_16x16x32_bf16 v[4:7], v[104:107], v[108:111], v[4:7]
ds_read_b64_tr_b16 v[80:81], v43 offset:0
ds_read_b64_tr_b16 v[82:83], v43 offset:1152
s_add_u32 m0, s36, 35072
s_lshl_b32 s32, s59, 7
s_add_u32 s35, s32, s49
buffer_load_dwordx4 v46, s[12:15], s35 offen lds
v_mfma_f32_16x16x32_bf16 v[8:11], v[100:103], v[112:115], v[8:11]
ds_read_b64_tr_b16 v[84:85], v43 offset:32
s_add_u32 m0, s36, 36096
s_add_u32 s59, s59, 1
buffer_load_dwordx4 v47, s[12:15], s35 offen lds
s_cmp_eq_u32 s59, 9
s_cselect_b32 s59, 0, s59
v_mfma_f32_16x16x32_bf16 v[12:15], v[104:107], v[112:115], v[12:15]
ds_read_b64_tr_b16 v[86:87], v43 offset:1184
ds_read_b64_tr_b16 v[88:89], v43 offset:64
s_add_u32 m0, s37, 19456
s_mul_i32 s33, s3, 589824
s_add_u32 s33, s33, 4608
s_add_u32 s34, s33, s50
buffer_load_dwordx4 v48, s[16:19], s34 offen lds
v_mfma_f32_16x16x32_bf16 v[16:19], v[100:103], v[116:119], v[16:19]
ds_read_b64_tr_b16 v[90:91], v43 offset:1216
ds_read_b64_tr_b16 v[92:93], v43 offset:96
v_mfma_f32_16x16x32_bf16 v[20:23], v[104:107], v[116:119], v[20:23]
ds_read_b64_tr_b16 v[94:95], v43 offset:1248
s_add_u32 m0, s37, 20480
s_add_u32 s3, s3, 1
buffer_load_dwordx4 v49, s[16:19], s34 offen lds
v_mfma_f32_16x16x32_bf16 v[24:27], v[100:103], v[120:123], v[24:27]
s_add_u32 m0, s37, 21504
s_mov_b64 exec, s[64:65]
buffer_load_dwordx4 v50, s[16:19], s34 offen lds
s_mov_b64 exec, s[62:63]
s_cmp_eq_u32 s3, 9
s_cselect_b32 s3, 0, s3
v_mfma_f32_16x16x32_bf16 v[28:31], v[104:107], v[120:123], v[28:31]
s_waitcnt lgkmcnt(0)
v_mfma_f32_16x16x32_bf16 v[0:3], v[72:75], v[80:83], v[0:3]
ds_read_b128 v[100:103], v41 offset:32768
ds_read_b128 v[104:107], v41 offset:33280
s_mul_hi_u32 s24, s2, 0x55555556
s_mul_i32 s25, s24, 3
s_sub_u32 s25, s2, s25
s_mul_hi_u32 s10, s24, 0x1c71c71d
s_mul_i32 s11, s10, 9
v_mfma_f32_16x16x32_bf16 v[4:7], v[76:79], v[80:83], v[4:7]
ds_read_b64_tr_b16 v[108:109], v43 offset:9728
ds_read_b64_tr_b16 v[110:111], v43 offset:10880
s_sub_u32 s11, s24, s11
s_mul_i32 s10, s10, 288
s_lshl_b32 s39, s11, 5
s_cmp_ge_u32 s11, 4
s_cselect_b32 s35, 16, 0
v_mfma_f32_16x16x32_bf16 v[8:11], v[72:75], v[84:87], v[8:11]
ds_read_b64_tr_b16 v[112:113], v43 offset:9760
s_add_u32 s39, s39, s35
s_cmp_eq_u32 s11, 8
s_cselect_b32 s39, 128, s39
s_lshl_b32 s35, s29, 2
s_add_u32 s39, s39, s10
s_add_u32 s39, s39, s35
v_mfma_f32_16x16x32_bf16 v[12:15], v[76:79], v[84:87], v[12:15]
ds_read_b64_tr_b16 v[114:115], v43 offset:10912
ds_read_b64_tr_b16 v[116:117], v43 offset:9792
s_mul_i32 s39, s39, 1152
s_mul_i32 s35, s25, 384
s_add_u32 s39, s39, s35
s_cmp_lt_u32 s2, 216
s_cselect_b32 s39, s39, s61
v_mfma_f32_16x16x32_bf16 v[16:19], v[72:75], v[88:91], v[16:19]
ds_read_b64_tr_b16 v[118:119], v43 offset:10944
ds_read_b64_tr_b16 v[120:121], v43 offset:9824
s_mov_b32 s35, 178956971
s_mul_i32 s34, s29, 1536
v_add_u32 v234, 0, v250
v_mul_hi_u32 v235, v234, s35
v_mfma_f32_16x16x32_bf16 v[20:23], v[76:79], v[88:91], v[20:23]
ds_read_b64_tr_b16 v[122:123], v43 offset:10976
v_mul_u32_u24 v236, 24, v235
v_sub_u32 v236, v234, v236
v_mul_u32_u24 v235, 1152, v235
v_lshl_add_u32 v235, v236, 4, v235
s_add_u32 m0, s34, 6272
s_nop 0
buffer_load_dwordx4 v235, s[20:23], s39 offen lds
v_mfma_f32_16x16x32_bf16 v[24:27], v[72:75], v[92:95], v[24:27]
v_add_u32 v234, 64, v250
v_mul_hi_u32 v235, v234, s35
v_mul_u32_u24 v236, 24, v235
v_sub_u32 v236, v234, v236
v_mfma_f32_16x16x32_bf16 v[28:31], v[76:79], v[92:95], v[28:31]
v_mul_u32_u24 v235, 1152, v235
v_lshl_add_u32 v235, v236, 4, v235
s_add_u32 m0, s34, 7296
s_mov_b64 exec, s[66:67]
buffer_load_dwordx4 v235, s[20:23], s39 offen lds
s_mov_b64 exec, s[62:63]
s_waitcnt vmcnt(14) lgkmcnt(0)
s_barrier
v_mfma_f32_16x16x32_bf16 v[0:3], v[100:103], v[108:111], v[0:3]
ds_read_b128 v[72:75], v40 offset:49152
ds_read_b128 v[76:79], v40 offset:49664
v_mfma_f32_16x16x32_bf16 v[4:7], v[104:107], v[108:111], v[4:7]
ds_read_b64_tr_b16 v[80:81], v43 offset:19456
ds_read_b64_tr_b16 v[82:83], v43 offset:20608
s_add_u32 m0, s36, 51456
s_lshl_b32 s32, s59, 7
s_add_u32 s35, s32, s49
buffer_load_dwordx4 v46, s[12:15], s35 offen lds
v_mfma_f32_16x16x32_bf16 v[8:11], v[100:103], v[112:115], v[8:11]
ds_read_b64_tr_b16 v[84:85], v43 offset:19488
s_add_u32 m0, s36, 52480
s_add_u32 s59, s59, 1
buffer_load_dwordx4 v47, s[12:15], s35 offen lds
s_cmp_eq_u32 s59, 9
s_cselect_b32 s59, 0, s59
v_mfma_f32_16x16x32_bf16 v[12:15], v[104:107], v[112:115], v[12:15]
ds_read_b64_tr_b16 v[86:87], v43 offset:20640
ds_read_b64_tr_b16 v[88:89], v43 offset:19520
s_add_u32 m0, s37, 38912
s_mul_i32 s33, s3, 589824
s_add_u32 s33, s33, 4608
s_add_u32 s34, s33, s50
buffer_load_dwordx4 v48, s[16:19], s34 offen lds
v_mfma_f32_16x16x32_bf16 v[16:19], v[100:103], v[116:119], v[16:19]
ds_read_b64_tr_b16 v[90:91], v43 offset:20672
ds_read_b64_tr_b16 v[92:93], v43 offset:19552
v_mfma_f32_16x16x32_bf16 v[20:23], v[104:107], v[116:119], v[20:23]
ds_read_b64_tr_b16 v[94:95], v43 offset:20704
s_add_u32 m0, s37, 39936
s_add_u32 s3, s3, 1
buffer_load_dwordx4 v49, s[16:19], s34 offen lds
v_mfma_f32_16x16x32_bf16 v[24:27], v[100:103], v[120:123], v[24:27]
s_add_u32 m0, s37, 40960
s_mov_b64 exec, s[64:65]
buffer_load_dwordx4 v50, s[16:19], s34 offen lds
s_mov_b64 exec, s[62:63]
s_cmp_eq_u32 s3, 9
s_cselect_b32 s3, 0, s3
v_mfma_f32_16x16x32_bf16 v[28:31], v[104:107], v[120:123], v[28:31]
s_waitcnt lgkmcnt(0)
v_mfma_f32_16x16x32_bf16 v[0:3], v[72:75], v[80:83], v[0:3]
ds_read_b128 v[100:103], v41 offset:49152
ds_read_b128 v[104:107], v41 offset:49664
v_mfma_f32_16x16x32_bf16 v[4:7], v[76:79], v[80:83], v[4:7]
ds_read_b64_tr_b16 v[108:109], v43 offset:29184
ds_read_b64_tr_b16 v[110:111], v43 offset:30336
v_mfma_f32_16x16x32_bf16 v[8:11], v[72:75], v[84:87], v[8:11]
ds_read_b64_tr_b16 v[112:113], v43 offset:29216
v_mfma_f32_16x16x32_bf16 v[12:15], v[76:79], v[84:87], v[12:15]
ds_read_b64_tr_b16 v[114:115], v43 offset:30368
ds_read_b64_tr_b16 v[116:117], v43 offset:29248
v_mfma_f32_16x16x32_bf16 v[16:19], v[72:75], v[88:91], v[16:19]
ds_read_b64_tr_b16 v[118:119], v43 offset:30400
ds_read_b64_tr_b16 v[120:121], v43 offset:29280
v_mfma_f32_16x16x32_bf16 v[20:23], v[76:79], v[88:91], v[20:23]
ds_read_b64_tr_b16 v[122:123], v43 offset:30432
v_mfma_f32_16x16x32_bf16 v[24:27], v[72:75], v[92:95], v[24:27]
v_mfma_f32_16x16x32_bf16 v[28:31], v[76:79], v[92:95], v[28:31]
s_waitcnt vmcnt(14) lgkmcnt(0)
s_barrier
v_mfma_f32_16x16x32_bf16 v[0:3], v[100:103], v[108:111], v[0:3]
ds_read_b128 v[72:75], v40 offset:0
ds_read_b128 v[76:79], v40 offset:512
v_mfma_f32_16x16x32_bf16 v[4:7], v[104:107], v[108:111], v[4:7]
ds_read_b64_tr_b16 v[80:81], v42 offset:0
ds_read_b64_tr_b16 v[82:83], v42 offset:1152
s_add_u32 m0, s36, 67840
s_lshl_b32 s32, s59, 7
s_add_u32 s35, s32, s49
buffer_load_dwordx4 v46, s[12:15], s35 offen lds
v_mfma_f32_16x16x32_bf16 v[8:11], v[100:103], v[112:115], v[8:11]
ds_read_b64_tr_b16 v[84:85], v42 offset:32
s_add_u32 m0, s36, 68864
s_add_u32 s59, s59, 1
buffer_load_dwordx4 v47, s[12:15], s35 offen lds
s_cmp_eq_u32 s59, 9
s_cselect_b32 s59, 0, s59
v_mfma_f32_16x16x32_bf16 v[12:15], v[104:107], v[112:115], v[12:15]
ds_read_b64_tr_b16 v[86:87], v42 offset:1184
ds_read_b64_tr_b16 v[88:89], v42 offset:64
s_add_u32 m0, s37, 58368
s_mul_i32 s33, s3, 589824
s_add_u32 s33, s33, 4608
s_add_u32 s34, s33, s50
buffer_load_dwordx4 v48, s[16:19], s34 offen lds
v_mfma_f32_16x16x32_bf16 v[16:19], v[100:103], v[116:119], v[16:19]
ds_read_b64_tr_b16 v[90:91], v42 offset:1216
ds_read_b64_tr_b16 v[92:93], v42 offset:96
v_mfma_f32_16x16x32_bf16 v[20:23], v[104:107], v[116:119], v[20:23]
ds_read_b64_tr_b16 v[94:95], v42 offset:1248
s_add_u32 m0, s37, 59392
s_add_u32 s3, s3, 1
buffer_load_dwordx4 v49, s[16:19], s34 offen lds
v_mfma_f32_16x16x32_bf16 v[24:27], v[100:103], v[120:123], v[24:27]
s_add_u32 m0, s37, 60416
s_mov_b64 exec, s[64:65]
buffer_load_dwordx4 v50, s[16:19], s34 offen lds
s_mov_b64 exec, s[62:63]
s_cmp_eq_u32 s3, 9
s_cselect_b32 s3, 0, s3
v_mfma_f32_16x16x32_bf16 v[28:31], v[104:107], v[120:123], v[28:31]
s_waitcnt lgkmcnt(0)
v_mfma_f32_16x16x32_bf16 v[0:3], v[72:75], v[80:83], v[0:3]
ds_read_b128 v[100:103], v41 offset:0
ds_read_b128 v[104:107], v41 offset:512
v_mfma_f32_16x16x32_bf16 v[4:7], v[76:79], v[80:83], v[4:7]
ds_read_b64_tr_b16 v[108:109], v42 offset:9728
ds_read_b64_tr_b16 v[110:111], v42 offset:10880
v_mfma_f32_16x16x32_bf16 v[8:11], v[72:75], v[84:87], v[8:11]
ds_read_b64_tr_b16 v[112:113], v42 offset:9760
v_mfma_f32_16x16x32_bf16 v[12:15], v[76:79], v[84:87], v[12:15]
ds_read_b64_tr_b16 v[114:115], v42 offset:10912
ds_read_b64_tr_b16 v[116:117], v42 offset:9792
v_mfma_f32_16x16x32_bf16 v[16:19], v[72:75], v[88:91], v[16:19]
ds_read_b64_tr_b16 v[118:119], v42 offset:10944
ds_read_b64_tr_b16 v[120:121], v42 offset:9824
v_mfma_f32_16x16x32_bf16 v[20:23], v[76:79], v[88:91], v[20:23]
ds_read_b64_tr_b16 v[122:123], v42 offset:10976
v_mfma_f32_16x16x32_bf16 v[24:27], v[72:75], v[92:95], v[24:27]
v_mfma_f32_16x16x32_bf16 v[28:31], v[76:79], v[92:95], v[28:31]
s_waitcnt vmcnt(12) lgkmcnt(0)
s_barrier
v_mfma_f32_16x16x32_bf16 v[0:3], v[100:103], v[108:111], v[0:3]
ds_read_b128 v[72:75], v40 offset:16384
ds_read_b128 v[76:79], v40 offset:16896
v_mfma_f32_16x16x32_bf16 v[4:7], v[104:107], v[108:111], v[4:7]
ds_read_b64_tr_b16 v[80:81], v42 offset:19456
ds_read_b64_tr_b16 v[82:83], v42 offset:20608
s_add_u32 m0, s36, 18688
s_lshl_b32 s32, s59, 7
s_add_u32 s35, s32, s49
buffer_load_dwordx4 v46, s[12:15], s35 offen lds
v_mfma_f32_16x16x32_bf16 v[8:11], v[100:103], v[112:115], v[8:11]
ds_read_b64_tr_b16 v[84:85], v42 offset:19488
s_add_u32 m0, s36, 19712
s_add_u32 s59, s59, 1
buffer_load_dwordx4 v47, s[12:15], s35 offen lds
s_cmp_eq_u32 s59, 9
s_cselect_b32 s59, 0, s59
v_mfma_f32_16x16x32_bf16 v[12:15], v[104:107], v[112:115], v[12:15]
ds_read_b64_tr_b16 v[86:87], v42 offset:20640
ds_read_b64_tr_b16 v[88:89], v42 offset:19520
s_add_u32 m0, s37, 0
s_mul_i32 s33, s3, 589824
s_add_u32 s33, s33, 4608
s_add_u32 s34, s33, s50
buffer_load_dwordx4 v48, s[16:19], s34 offen lds
v_mfma_f32_16x16x32_bf16 v[16:19], v[100:103], v[116:119], v[16:19]
ds_read_b64_tr_b16 v[90:91], v42 offset:20672
ds_read_b64_tr_b16 v[92:93], v42 offset:19552
v_mfma_f32_16x16x32_bf16 v[20:23], v[104:107], v[116:119], v[20:23]
ds_read_b64_tr_b16 v[94:95], v42 offset:20704
s_add_u32 m0, s37, 1024
s_add_u32 s3, s3, 1
buffer_load_dwordx4 v49, s[16:19], s34 offen lds
v_mfma_f32_16x16x32_bf16 v[24:27], v[100:103], v[120:123], v[24:27]
s_add_u32 m0, s37, 2048
s_mov_b64 exec, s[64:65]
buffer_load_dwordx4 v50, s[16:19], s34 offen lds
s_mov_b64 exec, s[62:63]
s_cmp_eq_u32 s3, 9
s_cselect_b32 s3, 0, s3
v_mfma_f32_16x16x32_bf16 v[28:31], v[104:107], v[120:123], v[28:31]
s_waitcnt lgkmcnt(0)
v_mfma_f32_16x16x32_bf16 v[0:3], v[72:75], v[80:83], v[0:3]
ds_read_b128 v[100:103], v41 offset:16384
ds_read_b128 v[104:107], v41 offset:16896
v_mfma_f32_16x16x32_bf16 v[4:7], v[76:79], v[80:83], v[4:7]
ds_read_b64_tr_b16 v[108:109], v42 offset:29184
ds_read_b64_tr_b16 v[110:111], v42 offset:30336
v_mfma_f32_16x16x32_bf16 v[8:11], v[72:75], v[84:87], v[8:11]
ds_read_b64_tr_b16 v[112:113], v42 offset:29216
v_mfma_f32_16x16x32_bf16 v[12:15], v[76:79], v[84:87], v[12:15]
ds_read_b64_tr_b16 v[114:115], v42 offset:30368
ds_read_b64_tr_b16 v[116:117], v42 offset:29248
v_mfma_f32_16x16x32_bf16 v[16:19], v[72:75], v[88:91], v[16:19]
ds_read_b64_tr_b16 v[118:119], v42 offset:30400
ds_read_b64_tr_b16 v[120:121], v42 offset:29280
v_mfma_f32_16x16x32_bf16 v[20:23], v[76:79], v[88:91], v[20:23]
ds_read_b64_tr_b16 v[122:123], v42 offset:30432
v_mfma_f32_16x16x32_bf16 v[24:27], v[72:75], v[92:95], v[24:27]
v_mfma_f32_16x16x32_bf16 v[28:31], v[76:79], v[92:95], v[28:31]
s_waitcnt vmcnt(10) lgkmcnt(0)
s_barrier
v_mfma_f32_16x16x32_bf16 v[0:3], v[100:103], v[108:111], v[0:3]
ds_read_b128 v[72:75], v40 offset:32768
ds_read_b128 v[76:79], v40 offset:33280
v_mfma_f32_16x16x32_bf16 v[4:7], v[104:107], v[108:111], v[4:7]
ds_read_b64_tr_b16 v[80:81], v43 offset:0
ds_read_b64_tr_b16 v[82:83], v43 offset:1152
s_add_u32 s3, s3, 5
s_cmp_ge_u32 s3, 9
s_cselect_b32 s33, 9, 0
s_sub_u32 s3, s3, s33
s_add_u32 m0, s37, 19456
s_mul_i32 s33, s3, 589824
s_add_u32 s34, s33, s50
buffer_load_dwordx4 v48, s[16:19], s34 offen lds
v_mfma_f32_16x16x32_bf16 v[8:11], v[100:103], v[112:115], v[8:11]
ds_read_b64_tr_b16 v[84:85], v43 offset:32
v_mfma_f32_16x16x32_bf16 v[12:15], v[104:107], v[112:115], v[12:15]
ds_read_b64_tr_b16 v[86:87], v43 offset:1184
ds_read_b64_tr_b16 v[88:89], v43 offset:64
s_add_u32 m0, s37, 20480
s_add_u32 s3, s3, 1
buffer_load_dwordx4 v49, s[16:19], s34 offen lds
v_mfma_f32_16x16x32_bf16 v[16:19], v[100:103], v[116:119], v[16:19]
ds_read_b64_tr_b16 v[90:91], v43 offset:1216
ds_read_b64_tr_b16 v[92:93], v43 offset:96
v_mfma_f32_16x16x32_bf16 v[20:23], v[104:107], v[116:119], v[20:23]
ds_read_b64_tr_b16 v[94:95], v43 offset:1248
s_add_u32 m0, s37, 21504
s_mov_b64 exec, s[64:65]
buffer_load_dwordx4 v50, s[16:19], s34 offen lds
s_mov_b64 exec, s[62:63]
s_cmp_eq_u32 s3, 9
s_cselect_b32 s3, 0, s3
v_mfma_f32_16x16x32_bf16 v[24:27], v[100:103], v[120:123], v[24:27]
v_mfma_f32_16x16x32_bf16 v[28:31], v[104:107], v[120:123], v[28:31]
s_waitcnt lgkmcnt(0)
v_mfma_f32_16x16x32_bf16 v[0:3], v[72:75], v[80:83], v[0:3]
ds_read_b128 v[100:103], v41 offset:32768
ds_read_b128 v[104:107], v41 offset:33280
v_mfma_f32_16x16x32_bf16 v[4:7], v[76:79], v[80:83], v[4:7]
ds_read_b64_tr_b16 v[108:109], v43 offset:9728
ds_read_b64_tr_b16 v[110:111], v43 offset:10880
v_mfma_f32_16x16x32_bf16 v[8:11], v[72:75], v[84:87], v[8:11]
ds_read_b64_tr_b16 v[112:113], v43 offset:9760
v_mfma_f32_16x16x32_bf16 v[12:15], v[76:79], v[84:87], v[12:15]
ds_read_b64_tr_b16 v[114:115], v43 offset:10912
ds_read_b64_tr_b16 v[116:117], v43 offset:9792
v_mfma_f32_16x16x32_bf16 v[16:19], v[72:75], v[88:91], v[16:19]
ds_read_b64_tr_b16 v[118:119], v43 offset:10944
ds_read_b64_tr_b16 v[120:121], v43 offset:9824
v_mfma_f32_16x16x32_bf16 v[20:23], v[76:79], v[88:91], v[20:23]
ds_read_b64_tr_b16 v[122:123], v43 offset:10976
v_mfma_f32_16x16x32_bf16 v[24:27], v[72:75], v[92:95], v[24:27]
v_mfma_f32_16x16x32_bf16 v[28:31], v[76:79], v[92:95], v[28:31]
s_waitcnt vmcnt(8) lgkmcnt(0)
s_barrier
v_mfma_f32_16x16x32_bf16 v[0:3], v[100:103], v[108:111], v[0:3]
ds_read_b128 v[72:75], v40 offset:49152
ds_read_b128 v[76:79], v40 offset:49664
v_mfma_f32_16x16x32_bf16 v[4:7], v[104:107], v[108:111], v[4:7]
ds_read_b64_tr_b16 v[80:81], v43 offset:19456
ds_read_b64_tr_b16 v[82:83], v43 offset:20608
s_add_u32 m0, s37, 38912
s_mul_i32 s33, s3, 589824
s_add_u32 s34, s33, s50
buffer_load_dwordx4 v48, s[16:19], s34 offen lds
v_mfma_f32_16x16x32_bf16 v[8:11], v[100:103], v[112:115], v[8:11]
ds_read_b64_tr_b16 v[84:85], v43 offset:19488
v_mfma_f32_16x16x32_bf16 v[12:15], v[104:107], v[112:115], v[12:15]
ds_read_b64_tr_b16 v[86:87], v43 offset:20640
ds_read_b64_tr_b16 v[88:89], v43 offset:19520
s_add_u32 m0, s37, 39936
s_add_u32 s3, s3, 1
buffer_load_dwordx4 v49, s[16:19], s34 offen lds
v_mfma_f32_16x16x32_bf16 v[16:19], v[100:103], v[116:119], v[16:19]
ds_read_b64_tr_b16 v[90:91], v43 offset:20672
ds_read_b64_tr_b16 v[92:93], v43 offset:19552
v_mfma_f32_16x16x32_bf16 v[20:23], v[104:107], v[116:119], v[20:23]
ds_read_b64_tr_b16 v[94:95], v43 offset:20704
s_add_u32 m0, s37, 40960
s_mov_b64 exec, s[64:65]
buffer_load_dwordx4 v50, s[16:19], s34 offen lds
s_mov_b64 exec, s[62:63]
s_cmp_eq_u32 s3, 9
s_cselect_b32 s3, 0, s3
v_mfma_f32_16x16x32_bf16 v[24:27], v[100:103], v[120:123], v[24:27]
v_mfma_f32_16x16x32_bf16 v[28:31], v[104:107], v[120:123], v[28:31]
s_mul_i32 s30, s26, 9216
s_mul_i32 s31, s27, 10368
s_add_u32 s31, s31, 1047552
v_mov_b32 v234, s30
v_mov_b32 v235, s31
v_cmp_gt_u32 vcc, 128, v255
s_nop 1
v_cndmask_b32 v53, v235, v234, vcc
v_mov_b32 v234, 1024
v_mov_b32 v235, 1152
v_cndmask_b32 v45, v235, v234, vcc
v_lshl_add_u32 v53, v255, 3, v53
v_mov_b32 v235, s61
v_cmp_gt_u32 vcc, 200, v255
s_nop 1
v_cndmask_b32 v53, v235, v53, vcc
s_waitcnt lgkmcnt(0)
v_mfma_f32_16x16x32_bf16 v[0:3], v[72:75], v[80:83], v[0:3]
ds_read_b128 v[100:103], v41 offset:49152
ds_read_b128 v[104:107], v41 offset:49664
v_mfma_f32_16x16x32_bf16 v[4:7], v[76:79], v[80:83], v[4:7]
ds_read_b64_tr_b16 v[108:109], v43 offset:29184
ds_read_b64_tr_b16 v[110:111], v43 offset:30336
v_mad_u32_u24 v235, v45, 0, v53
buffer_load_dwordx2 v[128:129], v235, s[44:47], 0 offen sc1
v_mfma_f32_16x16x32_bf16 v[8:11], v[72:75], v[84:87], v[8:11]
ds_read_b64_tr_b16 v[112:113], v43 offset:29216
v_mfma_f32_16x16x32_bf16 v[12:15], v[76:79], v[84:87], v[12:15]
ds_read_b64_tr_b16 v[114:115], v43 offset:30368
ds_read_b64_tr_b16 v[116:117], v43 offset:29248
v_mfma_f32_16x16x32_bf16 v[16:19], v[72:75], v[88:91], v[16:19]
ds_read_b64_tr_b16 v[118:119], v43 offset:30400
ds_read_b64_tr_b16 v[120:121], v43 offset:29280
v_mad_u32_u24 v235, v45, 1, v53
buffer_load_dwordx2 v[130:131], v235, s[44:47], 0 offen sc1
v_mfma_f32_16x16x32_bf16 v[20:23], v[76:79], v[88:91], v[20:23]
ds_read_b64_tr_b16 v[122:123], v43 offset:30432
v_mfma_f32_16x16x32_bf16 v[24:27], v[72:75], v[92:95], v[24:27]
v_mfma_f32_16x16x32_bf16 v[28:31], v[76:79], v[92:95], v[28:31]
v_mad_u32_u24 v235, v45, 2, v53
buffer_load_dwordx2 v[132:133], v235, s[44:47], 0 offen sc1
s_waitcnt vmcnt(9) lgkmcnt(0)
s_barrier
v_mfma_f32_16x16x32_bf16 v[0:3], v[100:103], v[108:111], v[0:3]
ds_read_b128 v[72:75], v40 offset:0
ds_read_b128 v[76:79], v40 offset:512
v_mad_u32_u24 v235, v45, 3, v53
buffer_load_dwordx2 v[134:135], v235, s[44:47], 0 offen sc1
v_mfma_f32_16x16x32_bf16 v[4:7], v[104:107], v[108:111], v[4:7]
ds_read_b64_tr_b16 v[80:81], v42 offset:0
ds_read_b64_tr_b16 v[82:83], v42 offset:1152
s_add_u32 m0, s37, 58368
s_mul_i32 s33, s3, 589824
s_add_u32 s34, s33, s50
buffer_load_dwordx4 v48, s[16:19], s34 offen lds
v_mfma_f32_16x16x32_bf16 v[8:11], v[100:103], v[112:115], v[8:11]
ds_read_b64_tr_b16 v[84:85], v42 offset:32
v_mfma_f32_16x16x32_bf16 v[12:15], v[104:107], v[112:115], v[12:15]
ds_read_b64_tr_b16 v[86:87], v42 offset:1184
ds_read_b64_tr_b16 v[88:89], v42 offset:64
s_add_u32 m0, s37, 59392
s_add_u32 s3, s3, 1
buffer_load_dwordx4 v49, s[16:19], s34 offen lds
v_mad_u32_u24 v235, v45, 4, v53
buffer_load_dwordx2 v[136:137], v235, s[44:47], 0 offen sc1
v_mfma_f32_16x16x32_bf16 v[16:19], v[100:103], v[116:119], v[16:19]
ds_read_b64_tr_b16 v[90:91], v42 offset:1216
ds_read_b64_tr_b16 v[92:93], v42 offset:96
v_mfma_f32_16x16x32_bf16 v[20:23], v[104:107], v[116:119], v[20:23]
ds_read_b64_tr_b16 v[94:95], v42 offset:1248
s_add_u32 m0, s37, 60416
s_mov_b64 exec, s[64:65]
buffer_load_dwordx4 v50, s[16:19], s34 offen lds
s_mov_b64 exec, s[62:63]
s_cmp_eq_u32 s3, 9
s_cselect_b32 s3, 0, s3
v_mfma_f32_16x16x32_bf16 v[24:27], v[100:103], v[120:123], v[24:27]
v_mad_u32_u24 v235, v45, 5, v53
buffer_load_dwordx2 v[138:139], v235, s[44:47], 0 offen sc1
v_mfma_f32_16x16x32_bf16 v[28:31], v[104:107], v[120:123], v[28:31]
v_lshrrev_b32 v241, 2, v251
v_lshl_add_u32 v241, v252, 2, v241
v_mul_u32_u24 v241, 384, v241
v_and_b32 v242, 3, v251
v_lshl_add_u32 v241, v242, 3, v241
s_lshl_b32 s30, s28, 5
v_add_u32 v241, s30, v241
ds_read_b64_tr_b16 v[160:161], v241 offset:6272
ds_read_b64_tr_b16 v[162:163], v241 offset:12416
ds_read_b64_tr_b16 v[164:165], v241 offset:6400
ds_read_b64_tr_b16 v[166:167], v241 offset:12544
ds_read_b64_tr_b16 v[168:169], v241 offset:6528
ds_read_b64_tr_b16 v[170:171], v241 offset:12672
s_waitcnt lgkmcnt(0)
v_mfma_f32_16x16x32_bf16 v[0:3], v[72:75], v[80:83], v[0:3]
ds_read_b128 v[100:103], v41 offset:0
ds_read_b128 v[104:107], v41 offset:512
s_mul_i32 s31, s24, 36
s_mul_i32 s34, s25, 12
v_mfma_f32_16x16x32_bf16 v[4:7], v[76:79], v[80:83], v[4:7]
ds_read_b64_tr_b16 v[108:109], v42 offset:9728
ds_read_b64_tr_b16 v[110:111], v42 offset:10880
v_mad_u32_u24 v235, v45, 6, v53
buffer_load_dwordx2 v[140:141], v235, s[44:47], 0 offen sc1
s_add_u32 s31, s31, s34
s_add_u32 s31, s31, s28
v_mfma_f32_16x16x32_bf16 v[8:11], v[72:75], v[84:87], v[8:11]
ds_read_b64_tr_b16 v[112:113], v42 offset:9760
s_lshl_b32 s31, s31, 10
s_cmp_lt_u32 s2, 216
s_cselect_b32 s31, s31, s61
v_mfma_f32_16x16x32_bf16 v[12:15], v[76:79], v[84:87], v[12:15]
ds_read_b64_tr_b16 v[114:115], v42 offset:10912
ds_read_b64_tr_b16 v[116:117], v42 offset:9792
s_add_u32 s20, s8, 33554432
s_addc_u32 s21, s9, 0
v_mfma_f32_16x16x32_bf16 v[16:19], v[72:75], v[88:91], v[16:19]
ds_read_b64_tr_b16 v[118:119], v42 offset:10944
ds_read_b64_tr_b16 v[120:121], v42 offset:9824
v_mad_u32_u24 v235, v45, 7, v53
buffer_load_dwordx2 v[142:143], v235, s[44:47], 0 offen sc1
s_and_b32 s21, s21, 0xffff
s_mov_b32 s22, 2654208
v_mfma_f32_16x16x32_bf16 v[20:23], v[76:79], v[88:91], v[20:23]
ds_read_b64_tr_b16 v[122:123], v42 offset:10976
s_mov_b32 s23, 0x20000
buffer_store_dwordx4 v[160:163], v253, s[20:23], s31 offen sc1
v_mfma_f32_16x16x32_bf16 v[24:27], v[72:75], v[92:95], v[24:27]
s_add_u32 s31, s31, 4096
buffer_store_dwordx4 v[164:167], v253, s[20:23], s31 offen sc1
v_mfma_f32_16x16x32_bf16 v[28:31], v[76:79], v[92:95], v[28:31]
v_mad_u32_u24 v235, v45, 8, v53
buffer_load_dwordx2 v[144:145], v235, s[44:47], 0 offen sc1
s_add_u32 s31, s31, 4096
buffer_store_dwordx4 v[168:171], v253, s[20:23], s31 offen sc1
s_waitcnt vmcnt(18) lgkmcnt(0)
s_barrier
v_mfma_f32_16x16x32_bf16 v[0:3], v[100:103], v[108:111], v[0:3]
v_mfma_f32_16x16x32_bf16 v[4:7], v[104:107], v[108:111], v[4:7]
s_add_u32 m0, s37, 0
s_mul_i32 s33, s3, 589824
s_add_u32 s34, s33, s50
buffer_load_dwordx4 v48, s[16:19], s34 offen lds
v_mfma_f32_16x16x32_bf16 v[8:11], v[100:103], v[112:115], v[8:11]
v_mfma_f32_16x16x32_bf16 v[12:15], v[104:107], v[112:115], v[12:15]
s_add_u32 m0, s37, 1024
s_add_u32 s3, s3, 1
buffer_load_dwordx4 v49, s[16:19], s34 offen lds
v_mfma_f32_16x16x32_bf16 v[16:19], v[100:103], v[116:119], v[16:19]
v_mfma_f32_16x16x32_bf16 v[20:23], v[104:107], v[116:119], v[20:23]
s_add_u32 m0, s37, 2048
s_mov_b64 exec, s[64:65]
buffer_load_dwordx4 v50, s[16:19], s34 offen lds
s_mov_b64 exec, s[62:63]
s_cmp_eq_u32 s3, 9
s_cselect_b32 s3, 0, s3
v_mfma_f32_16x16x32_bf16 v[24:27], v[100:103], v[120:123], v[24:27]
v_mfma_f32_16x16x32_bf16 v[28:31], v[104:107], v[120:123], v[28:31]
s_load_dwordx2 s[4:5], s[0:1], 88
s_mov_b32 s39, 100000
s_waitcnt vmcnt(4)
mega_pl_10:
v_max3_u32 v234, v128, v129, v130
v_max3_u32 v234, v234, v131, v132
v_max3_u32 v234, v234, v133, v134
v_max3_u32 v234, v234, v135, v136
v_max3_u32 v234, v234, v137, v138
v_max3_u32 v234, v234, v139, v140
v_max3_u32 v234, v234, v141, v142
v_max3_u32 v234, v234, v143, v144
v_max_u32 v234, v234, v145
v_cmp_eq_u32 vcc, -1, v234
s_nop 4
s_cbranch_vccz mega_pe_11
s_sub_u32 s39, s39, 1
s_cmp_eq_u32 s39, 0
s_cbranch_scc1 mega_pe_11
s_sleep 8
v_mad_u32_u24 v235, v45, 0, v53
buffer_load_dwordx2 v[128:129], v235, s[44:47], 0 offen sc1
v_mad_u32_u24 v235, v45, 1, v53
buffer_load_dwordx2 v[130:131], v235, s[44:47], 0 offen sc1
v_mad_u32_u24 v235, v45, 2, v53
buffer_load_dwordx2 v[132:133], v235, s[44:47], 0 offen sc1
v_mad_u32_u24 v235, v45, 3, v53
buffer_load_dwordx2 v[134:135], v235, s[44:47], 0 offen sc1
v_mad_u32_u24 v235, v45, 4, v53
buffer_load_dwordx2 v[136:137], v235, s[44:47], 0 offen sc1
v_mad_u32_u24 v235, v45, 5, v53
buffer_load_dwordx2 v[138:139], v235, s[44:47], 0 offen sc1
v_mad_u32_u24 v235, v45, 6, v53
buffer_load_dwordx2 v[140:141], v235, s[44:47], 0 offen sc1
v_mad_u32_u24 v235, v45, 7, v53
buffer_load_dwordx2 v[142:143], v235, s[44:47], 0 offen sc1
v_mad_u32_u24 v235, v45, 8, v53
buffer_load_dwordx2 v[144:145], v235, s[44:47], 0 offen sc1
s_waitcnt vmcnt(0)
s_branch mega_pl_10
mega_pe_11:
v_add_f32 v128, v128, v130
v_add_f32 v129, v129, v131
v_add_f32 v128, v128, v132
v_add_f32 v129, v129, v133
v_add_f32 v128, v128, v134
v_add_f32 v129, v129, v135
v_add_f32 v128, v128, v136
v_add_f32 v129, v129, v137
v_add_f32 v128, v128, v138
v_add_f32 v129, v129, v139
v_add_f32 v128, v128, v140
v_add_f32 v129, v129, v141
v_add_f32 v128, v128, v142
v_add_f32 v129, v129, v143
v_add_f32 v128, v128, v144
v_add_f32 v129, v129, v145
v_mov_b32 v130, v128
v_mov_b32 v131, v129
v_mul_f32 v128, 0x3ae38e39, v128
v_mul_f32 v129, 0x3ae38e39, v129
v_fma_f32 v129, -v128, v128, v129
v_max_f32 v129, 0, v129
v_cvt_pk_bf16_f32 v234, v128, v129
v_and_b32 v235, 0xffff0000, v234
v_lshlrev_b32 v129, 16, v234
v_add_f32 v235, 0x3727c5ac, v235
v_cvt_pk_bf16_f32 v235, v235, v235
v_lshlrev_b32 v235, 16, v235
v_sqrt_f32 v235, v235
s_nop 0
v_cvt_pk_bf16_f32 v235, v235, v235
v_lshlrev_b32 v235, 16, v235
v_rcp_f32 v128, v235
v_cmp_gt_u32 vcc, 128, v255
v_lshlrev_b32 v236, 3, v255
s_nop 0
v_cndmask_b32 v128, v130, v128, vcc
v_cndmask_b32 v129, v131, v129, vcc
v_cmp_gt_u32 vcc, 200, v255
s_nop 3
s_and_saveexec_b64 s[56:57], vcc
s_cbranch_execz mega_e0_12
ds_write_b64 v236, v[128:129]
mega_e0_12:
s_mov_b64 exec, s[62:63]
s_waitcnt lgkmcnt(0)
s_barrier
s_lshl_b32 s30, s28, 8
v_lshl_add_u32 v238, v252, 6, s30
ds_read_b128 v[72:75], v238 offset:0
ds_read_b128 v[76:79], v238 offset:16
ds_read_b128 v[80:83], v238 offset:32
ds_read_b128 v[84:87], v238 offset:48
v_lshlrev_b32 v239, 2, v251
ds_read_b32 v88, v239 offset:1024
ds_read_b32 v89, v239 offset:1088
ds_read_b32 v90, v239 offset:1152
ds_read_b32 v91, v239 offset:1216
s_mov_b32 s20, s4
s_and_b32 s21, s5, 0xffff
s_mov_b32 s22, 8388608
s_mov_b32 s23, 0x20000
s_lshl_b32 s30, s2, 15
s_lshl_b32 s31, s29, 12
s_add_u32 s30, s30, s31
buffer_load_dwordx4 v[112:115], v253, s[20:23], s30 offen offset:0
buffer_load_dwordx4 v[116:119], v253, s[20:23], s30 offen offset:1024
buffer_load_dwordx4 v[120:123], v253, s[20:23], s30 offen offset:2048
buffer_load_dwordx4 v[124:127], v253, s[20:23], s30 offen offset:3072
v_mov_b32 v96, 0
v_mov_b32 v97, 0
v_mov_b32 v98, 0
v_mov_b32 v99, 0
v_mov_b32 v100, 0
v_mov_b32 v101, 0
v_mov_b32 v102, 0
v_mov_b32 v103, 0
v_mov_b32 v104, 0
v_mov_b32 v105, 0
v_mov_b32 v106, 0
v_mov_b32 v107, 0
v_mov_b32 v108, 0
v_mov_b32 v109, 0
v_mov_b32 v110, 0
v_mov_b32 v111, 0
v_mov_b32 v58, 0
v_mov_b32 v59, 0
v_mov_b32 v60, 0
v_mov_b32 v61, 0
v_mov_b32 v62, 0
v_mov_b32 v63, 0
v_mov_b32 v64, 0
v_mov_b32 v65, 0
v_mov_b32 v66, 0
v_mov_b32 v67, 0
v_mov_b32 v68, 0
v_mov_b32 v69, 0
s_waitcnt lgkmcnt(0)
v_fma_f32 v0, -v73, v88, v0
v_fma_f32 v1, -v75, v88, v1
v_fma_f32 v2, -v77, v88, v2
v_fma_f32 v3, -v79, v88, v3
v_fma_f32 v4, -v81, v88, v4
v_fma_f32 v5, -v83, v88, v5
v_fma_f32 v6, -v85, v88, v6
v_fma_f32 v7, -v87, v88, v7
v_fma_f32 v8, -v73, v89, v8
v_fma_f32 v9, -v75, v89, v9
v_fma_f32 v10, -v77, v89, v10
v_fma_f32 v11, -v79, v89, v11
v_fma_f32 v12, -v81, v89, v12
v_fma_f32 v13, -v83, v89, v13
v_fma_f32 v14, -v85, v89, v14
v_fma_f32 v15, -v87, v89, v15
v_fma_f32 v16, -v73, v90, v16
v_fma_f32 v17, -v75, v90, v17
v_fma_f32 v18, -v77, v90, v18
v_fma_f32 v19, -v79, v90, v19
v_fma_f32 v20, -v81, v90, v20
v_fma_f32 v21, -v83, v90, v21
v_fma_f32 v22, -v85, v90, v22
v_fma_f32 v23, -v87, v90, v23
v_fma_f32 v24, -v73, v91, v24
v_fma_f32 v25, -v75, v91, v25
v_fma_f32 v26, -v77, v91, v26
v_fma_f32 v27, -v79, v91, v27
v_fma_f32 v28, -v81, v91, v28
v_fma_f32 v29, -v83, v91, v29
v_fma_f32 v30, -v85, v91, v30
v_fma_f32 v31, -v87, v91, v31
v_mul_f32 v0, v0, v72
v_mul_f32 v1, v1, v74
v_mul_f32 v2, v2, v76
v_mul_f32 v3, v3, v78
v_mul_f32 v4, v4, v80
v_mul_f32 v5, v5, v82
v_mul_f32 v6, v6, v84
v_mul_f32 v7, v7, v86
v_mul_f32 v8, v8, v72
v_mul_f32 v9, v9, v74
v_mul_f32 v10, v10, v76
v_mul_f32 v11, v11, v78
v_mul_f32 v12, v12, v80
v_mul_f32 v13, v13, v82
v_mul_f32 v14, v14, v84
v_mul_f32 v15, v15, v86
v_mul_f32 v16, v16, v72
v_mul_f32 v17, v17, v74
v_mul_f32 v18, v18, v76
v_mul_f32 v19, v19, v78
v_mul_f32 v20, v20, v80
v_mul_f32 v21, v21, v82
v_mul_f32 v22, v22, v84
v_mul_f32 v23, v23, v86
v_mul_f32 v24, v24, v72
v_mul_f32 v25, v25, v74
v_mul_f32 v26, v26, v76
v_mul_f32 v27, v27, v78
v_mul_f32 v28, v28, v80
v_mul_f32 v29, v29, v82
v_mul_f32 v30, v30, v84
v_mul_f32 v31, v31, v86
v_mul_f32 v128, v0, v0
v_mul_f32 v129, v1, v1
v_mul_f32 v130, v2, v2
v_mul_f32 v131, v3, v3
v_mul_f32 v132, v4, v4
v_mul_f32 v133, v5, v5
v_mul_f32 v134, v6, v6
v_mul_f32 v135, v7, v7
v_mul_f32 v136, v8, v8
v_mul_f32 v137, v9, v9
v_mul_f32 v138, v10, v10
v_mul_f32 v139, v11, v11
v_mul_f32 v140, v12, v12
v_mul_f32 v141, v13, v13
v_mul_f32 v142, v14, v14
v_mul_f32 v143, v15, v15
v_mul_f32 v144, v16, v16
v_mul_f32 v145, v17, v17
v_mul_f32 v146, v18, v18
v_mul_f32 v147, v19, v19
v_mul_f32 v148, v20, v20
v_mul_f32 v149, v21, v21
v_mul_f32 v150, v22, v22
v_mul_f32 v151, v23, v23
v_mul_f32 v152, v24, v24
v_mul_f32 v153, v25, v25
v_mul_f32 v154, v26, v26
v_mul_f32 v155, v27, v27
v_mul_f32 v156, v28, v28
v_mul_f32 v157, v29, v29
v_mul_f32 v158, v30, v30
v_mul_f32 v159, v31, v31
v_fma_f32 v128, v128, s60, v254
v_fma_f32 v129, v129, s60, v254
v_fma_f32 v130, v130, s60, v254
v_fma_f32 v131, v131, s60, v254
v_fma_f32 v132, v132, s60, v254
v_fma_f32 v133, v133, s60, v254
v_fma_f32 v134, v134, s60, v254
v_fma_f32 v135, v135, s60, v254
v_fma_f32 v136, v136, s60, v254
v_fma_f32 v137, v137, s60, v254
v_fma_f32 v138, v138, s60, v254
v_fma_f32 v139, v139, s60, v254
v_fma_f32 v140, v140, s60, v254
v_fma_f32 v141, v141, s60, v254
v_fma_f32 v142, v142, s60, v254
v_fma_f32 v143, v143, s60, v254
v_fma_f32 v144, v144, s60, v254
v_fma_f32 v145, v145, s60, v254
v_fma_f32 v146, v146, s60, v254
v_fma_f32 v147, v147, s60, v254
v_fma_f32 v148, v148, s60, v254
v_fma_f32 v149, v149, s60, v254
v_fma_f32 v150, v150, s60, v254
v_fma_f32 v151, v151, s60, v254
v_fma_f32 v152, v152, s60, v254
v_fma_f32 v153, v153, s60, v254
v_fma_f32 v154, v154, s60, v254
v_fma_f32 v155, v155, s60, v254
v_fma_f32 v156, v156, s60, v254
v_fma_f32 v157, v157, s60, v254
v_fma_f32 v158, v158, s60, v254
v_fma_f32 v159, v159, s60, v254
v_mul_f32 v128, v128, v0
v_mul_f32 v129, v129, v1
v_mul_f32 v130, v130, v2
v_mul_f32 v131, v131, v3
v_mul_f32 v132, v132, v4
v_mul_f32 v133, v133, v5
v_mul_f32 v134, v134, v6
v_mul_f32 v135, v135, v7
v_mul_f32 v136, v136, v8
v_mul_f32 v137, v137, v9
v_mul_f32 v138, v138, v10
v_mul_f32 v139, v139, v11
v_mul_f32 v140, v140, v12
v_mul_f32 v141, v141, v13
v_mul_f32 v142, v142, v14
v_mul_f32 v143, v143, v15
v_mul_f32 v144, v144, v16
v_mul_f32 v145, v145, v17
v_mul_f32 v146, v146, v18
v_mul_f32 v147, v147, v19
v_mul_f32 v148, v148, v20
v_mul_f32 v149, v149, v21
v_mul_f32 v150, v150, v22
v_mul_f32 v151, v151, v23
v_mul_f32 v152, v152, v24
v_mul_f32 v153, v153, v25
v_mul_f32 v154, v154, v26
v_mul_f32 v155, v155, v27
v_mul_f32 v156, v156, v28
v_mul_f32 v157, v157, v29
v_mul_f32 v158, v158, v30
v_mul_f32 v159, v159, v31
v_exp_f32 v128, v128
v_exp_f32 v129, v129
v_exp_f32 v130, v130
v_exp_f32 v131, v131
v_exp_f32 v132, v132
v_exp_f32 v133, v133
v_exp_f32 v134, v134
v_exp_f32 v135, v135
v_exp_f32 v136, v136
v_exp_f32 v137, v137
v_exp_f32 v138, v138
v_exp_f32 v139, v139
v_exp_f32 v140, v140
v_exp_f32 v141, v141
v_exp_f32 v142, v142
v_exp_f32 v143, v143
v_exp_f32 v144, v144
v_exp_f32 v145, v145
v_exp_f32 v146, v146
v_exp_f32 v147, v147
v_exp_f32 v148, v148
v_exp_f32 v149, v149
v_exp_f32 v150, v150
v_exp_f32 v151, v151
v_exp_f32 v152, v152
v_exp_f32 v153, v153
v_exp_f32 v154, v154
v_exp_f32 v155, v155
v_exp_f32 v156, v156
v_exp_f32 v157, v157
v_exp_f32 v158, v158
v_exp_f32 v159, v159
v_add_f32 v128, 1.0, v128
v_add_f32 v129, 1.0, v129
v_add_f32 v130, 1.0, v130
v_add_f32 v131, 1.0, v131
v_add_f32 v132, 1.0, v132
v_add_f32 v133, 1.0, v133
v_add_f32 v134, 1.0, v134
v_add_f32 v135, 1.0, v135
v_add_f32 v136, 1.0, v136
v_add_f32 v137, 1.0, v137
v_add_f32 v138, 1.0, v138
v_add_f32 v139, 1.0, v139
v_add_f32 v140, 1.0, v140
v_add_f32 v141, 1.0, v141
v_add_f32 v142, 1.0, v142
v_add_f32 v143, 1.0, v143
v_add_f32 v144, 1.0, v144
v_add_f32 v145, 1.0, v145
v_add_f32 v146, 1.0, v146
v_add_f32 v147, 1.0, v147
v_add_f32 v148, 1.0, v148
v_add_f32 v149, 1.0, v149
v_add_f32 v150, 1.0, v150
v_add_f32 v151, 1.0, v151
v_add_f32 v152, 1.0, v152
v_add_f32 v153, 1.0, v153
v_add_f32 v154, 1.0, v154
v_add_f32 v155, 1.0, v155
v_add_f32 v156, 1.0, v156
v_add_f32 v157, 1.0, v157
v_add_f32 v158, 1.0, v158
v_add_f32 v159, 1.0, v159
v_rcp_f32 v128, v128
v_rcp_f32 v129, v129
v_rcp_f32 v130, v130
v_rcp_f32 v131, v131
v_rcp_f32 v132, v132
v_rcp_f32 v133, v133
v_rcp_f32 v134, v134
v_rcp_f32 v135, v135
v_rcp_f32 v136, v136
v_rcp_f32 v137, v137
v_rcp_f32 v138, v138
v_rcp_f32 v139, v139
v_rcp_f32 v140, v140
v_rcp_f32 v141, v141
v_rcp_f32 v142, v142
v_rcp_f32 v143, v143
v_rcp_f32 v144, v144
v_rcp_f32 v145, v145
v_rcp_f32 v146, v146
v_rcp_f32 v147, v147
v_rcp_f32 v148, v148
v_rcp_f32 v149, v149
v_rcp_f32 v150, v150
v_rcp_f32 v151, v151
v_rcp_f32 v152, v152
v_rcp_f32 v153, v153
v_rcp_f32 v154, v154
v_rcp_f32 v155, v155
v_rcp_f32 v156, v156
v_rcp_f32 v157, v157
v_rcp_f32 v158, v158
v_rcp_f32 v159, v159
v_mul_f32 v0, v0, v128
v_mul_f32 v1, v1, v129
v_mul_f32 v2, v2, v130
v_mul_f32 v3, v3, v131
v_mul_f32 v4, v4, v132
v_mul_f32 v5, v5, v133
v_mul_f32 v6, v6, v134
v_mul_f32 v7, v7, v135
v_mul_f32 v8, v8, v136
v_mul_f32 v9, v9, v137
v_mul_f32 v10, v10, v138
v_mul_f32 v11, v11, v139
v_mul_f32 v12, v12, v140
v_mul_f32 v13, v13, v141
v_mul_f32 v14, v14, v142
v_mul_f32 v15, v15, v143
v_mul_f32 v16, v16, v144
v_mul_f32 v17, v17, v145
v_mul_f32 v18, v18, v146
v_mul_f32 v19, v19, v147
v_mul_f32 v20, v20, v148
v_mul_f32 v21, v21, v149
v_mul_f32 v22, v22, v150
v_mul_f32 v23, v23, v151
v_mul_f32 v24, v24, v152
v_mul_f32 v25, v25, v153
v_mul_f32 v26, v26, v154
v_mul_f32 v27, v27, v155
v_mul_f32 v28, v28, v156
v_mul_f32 v29, v29, v157
v_mul_f32 v30, v30, v158
v_mul_f32 v31, v31, v159
v_add_f32 v96, v96, v0
v_add_f32 v98, v98, v1
v_add_f32 v100, v100, v2
v_add_f32 v102, v102, v3
v_add_f32 v104, v104, v4
v_add_f32 v106, v106, v5
v_add_f32 v108, v108, v6
v_add_f32 v110, v110, v7
v_fmac_f32 v97, v0, v0
v_fmac_f32 v99, v1, v1
v_fmac_f32 v101, v2, v2
v_fmac_f32 v103, v3, v3
v_fmac_f32 v105, v4, v4
v_fmac_f32 v107, v5, v5
v_fmac_f32 v109, v6, v6
v_fmac_f32 v111, v7, v7
v_add_f32 v96, v96, v8
v_add_f32 v98, v98, v9
v_add_f32 v100, v100, v10
v_add_f32 v102, v102, v11
v_add_f32 v104, v104, v12
v_add_f32 v106, v106, v13
v_add_f32 v108, v108, v14
v_add_f32 v110, v110, v15
v_fmac_f32 v97, v8, v8
v_fmac_f32 v99, v9, v9
v_fmac_f32 v101, v10, v10
v_fmac_f32 v103, v11, v11
v_fmac_f32 v105, v12, v12
v_fmac_f32 v107, v13, v13
v_fmac_f32 v109, v14, v14
v_fmac_f32 v111, v15, v15
v_add_f32 v96, v96, v16
v_add_f32 v98, v98, v17
v_add_f32 v100, v100, v18
v_add_f32 v102, v102, v19
v_add_f32 v104, v104, v20
v_add_f32 v106, v106, v21
v_add_f32 v108, v108, v22
v_add_f32 v110, v110, v23
v_fmac_f32 v97, v16, v16
v_fmac_f32 v99, v17, v17
v_fmac_f32 v101, v18, v18
v_fmac_f32 v103, v19, v19
v_fmac_f32 v105, v20, v20
v_fmac_f32 v107, v21, v21
v_fmac_f32 v109, v22, v22
v_fmac_f32 v111, v23, v23
v_add_f32 v96, v96, v24
v_add_f32 v98, v98, v25
v_add_f32 v100, v100, v26
v_add_f32 v102, v102, v27
v_add_f32 v104, v104, v28
v_add_f32 v106, v106, v29
v_add_f32 v108, v108, v30
v_add_f32 v110, v110, v31
v_fmac_f32 v97, v24, v24
v_fmac_f32 v99, v25, v25
v_fmac_f32 v101, v26, v26
v_fmac_f32 v103, v27, v27
v_fmac_f32 v105, v28, v28
v_fmac_f32 v107, v29, v29
v_fmac_f32 v109, v30, v30
v_fmac_f32 v111, v31, v31
v_add_f32_dpp v96, v96, v96 row_ror:8 row_mask:0xf bank_mask:0x3
v_add_f32_dpp v97, v97, v97 row_ror:8 row_mask:0xf bank_mask:0x3
v_add_f32_dpp v98, v98, v98 row_ror:8 row_mask:0xf bank_mask:0x3
v_add_f32_dpp v99, v99, v99 row_ror:8 row_mask:0xf bank_mask:0x3
v_add_f32_dpp v100, v100, v100 row_ror:8 row_mask:0xf bank_mask:0x3
v_add_f32_dpp v101, v101, v101 row_ror:8 row_mask:0xf bank_mask:0x3
v_add_f32_dpp v102, v102, v102 row_ror:8 row_mask:0xf bank_mask:0x3
v_add_f32_dpp v103, v103, v103 row_ror:8 row_mask:0xf bank_mask:0x3
v_add_f32_dpp v96, v104, v104 row_ror:8 row_mask:0xf bank_mask:0xc
v_add_f32_dpp v97, v105, v105 row_ror:8 row_mask:0xf bank_mask:0xc
v_add_f32_dpp v98, v106, v106 row_ror:8 row_mask:0xf bank_mask:0xc
v_add_f32_dpp v99, v107, v107 row_ror:8 row_mask:0xf bank_mask:0xc
v_add_f32_dpp v100, v108, v108 row_ror:8 row_mask:0xf bank_mask:0xc
v_add_f32_dpp v101, v109, v109 row_ror:8 row_mask:0xf bank_mask:0xc
v_add_f32_dpp v102, v110, v110 row_ror:8 row_mask:0xf bank_mask:0xc
v_add_f32_dpp v103, v111, v111 row_ror:8 row_mask:0xf bank_mask:0xc
v_add_f32_dpp v104, v96, v96 row_shl:4 row_mask:0xf bank_mask:0x5
v_add_f32_dpp v105, v97, v97 row_shl:4 row_mask:0xf bank_mask:0x5
v_add_f32_dpp v106, v98, v98 row_shl:4 row_mask:0xf bank_mask:0x5
v_add_f32_dpp v107, v99, v99 row_shl:4 row_mask:0xf bank_mask:0x5
v_add_f32_dpp v104, v100, v100 row_shr:4 row_mask:0xf bank_mask:0xa
v_add_f32_dpp v105, v101, v101 row_shr:4 row_mask:0xf bank_mask:0xa
v_add_f32_dpp v106, v102, v102 row_shr:4 row_mask:0xf bank_mask:0xa
v_add_f32_dpp v107, v103, v103 row_shr:4 row_mask:0xf bank_mask:0xa
v_add_f32_dpp v104, v104, v104 quad_perm:[1,0,3,2] row_mask:0xf bank_mask:0xf
v_add_f32_dpp v105, v105, v105 quad_perm:[1,0,3,2] row_mask:0xf bank_mask:0xf
v_add_f32_dpp v106, v106, v106 quad_perm:[1,0,3,2] row_mask:0xf bank_mask:0xf
v_add_f32_dpp v107, v107, v107 quad_perm:[1,0,3,2] row_mask:0xf bank_mask:0xf
v_add_f32_dpp v104, v104, v104 quad_perm:[2,3,0,1] row_mask:0xf bank_mask:0xf
v_add_f32_dpp v105, v105, v105 quad_perm:[2,3,0,1] row_mask:0xf bank_mask:0xf
v_add_f32_dpp v106, v106, v106 quad_perm:[2,3,0,1] row_mask:0xf bank_mask:0xf
v_add_f32_dpp v107, v107, v107 quad_perm:[2,3,0,1] row_mask:0xf bank_mask:0xf
v_lshrrev_b32 v239, 2, v251
v_lshl_add_u32 v238, v239, 4, v238
ds_write_b128 v238, v[104:107] offset:2176
s_mov_b64 exec, s[62:63]
v_mov_b32 v160, 0
v_mov_b32 v161, 0
v_mov_b32 v162, 0
v_mov_b32 v163, 0
v_mov_b32 v164, 0
v_mov_b32 v165, 0
v_mov_b32 v166, 0
v_mov_b32 v167, 0
v_mov_b32 v168, 0
v_mov_b32 v169, 0
v_mov_b32 v170, 0
v_mov_b32 v171, 0
v_mov_b32 v172, 0
v_mov_b32 v173, 0
v_mov_b32 v174, 0
v_mov_b32 v175, 0
v_mov_b32 v176, 0
v_mov_b32 v177, 0
v_mov_b32 v178, 0
v_mov_b32 v179, 0
v_mov_b32 v180, 0
v_mov_b32 v181, 0
v_mov_b32 v182, 0
v_mov_b32 v183, 0
v_mov_b32 v184, 0
v_mov_b32 v185, 0
v_mov_b32 v186, 0
v_mov_b32 v187, 0
v_mov_b32 v188, 0
v_mov_b32 v189, 0
v_mov_b32 v190, 0
v_mov_b32 v191, 0
v_mov_b32 v192, 0
v_mov_b32 v193, 0
v_mov_b32 v194, 0
v_mov_b32 v195, 0
v_mov_b32 v196, 0
v_mov_b32 v197, 0
v_mov_b32 v198, 0
v_mov_b32 v199, 0
v_mov_b32 v200, 0
v_mov_b32 v201, 0
v_mov_b32 v202, 0
v_mov_b32 v203, 0
v_mov_b32 v204, 0
v_mov_b32 v205, 0
v_mov_b32 v206, 0
v_mov_b32 v207, 0
v_mov_b32 v208, 0
v_mov_b32 v209, 0
v_mov_b32 v210, 0
v_mov_b32 v211, 0
v_mov_b32 v212, 0
v_mov_b32 v213, 0
v_mov_b32 v214, 0
v_mov_b32 v215, 0
v_mov_b32 v216, 0
v_mov_b32 v217, 0
v_mov_b32 v218, 0
v_mov_b32 v219, 0
v_mov_b32 v220, 0
v_mov_b32 v221, 0
v_mov_b32 v222, 0
v_mov_b32 v223, 0
v_mov_b32 v224, 0
v_mov_b32 v225, 0
v_mov_b32 v226, 0
v_mov_b32 v227, 0
v_mov_b32 v228, 0
v_mov_b32 v229, 0
v_mov_b32 v230, 0
v_mov_b32 v231, 0
s_waitcnt vmcnt(0) lgkmcnt(0)
ds_read_b128 v[72:75], v40 offset:16384
ds_read_b128 v[76:79], v40 offset:16896
ds_read_b64_tr_b16 v[80:81], v42 offset:19456
ds_read_b64_tr_b16 v[82:83], v42 offset:20608
ds_read_b64_tr_b16 v[84:85], v42 offset:19488
ds_read_b64_tr_b16 v[86:87], v42 offset:20640
ds_read_b64_tr_b16 v[88:89], v42 offset:19520
ds_read_b64_tr_b16 v[90:91], v42 offset:20672
ds_read_b64_tr_b16 v[92:93], v42 offset:19552
ds_read_b64_tr_b16 v[94:95], v42 offset:20704
ds_read_b64_tr_b16 v[96:97], v42 offset:19584
ds_read_b64_tr_b16 v[98:99], v42 offset:20736
ds_read_b64_tr_b16 v[100:101], v42 offset:19616
ds_read_b64_tr_b16 v[102:103], v42 offset:20768
ds_read_b64_tr_b16 v[104:105], v42 offset:19648
ds_read_b64_tr_b16 v[106:107], v42 offset:20800
ds_read_b64_tr_b16 v[108:109], v42 offset:19680
ds_read_b64_tr_b16 v[110:111], v42 offset:20832
ds_read_b64_tr_b16 v[112:113], v42 offset:19712
ds_read_b64_tr_b16 v[114:115], v42 offset:20864
s_barrier
s_setprio 2
s_waitcnt lgkmcnt(0)
v_mfma_f32_16x16x32_bf16 v[160:163], v[80:83], v[72:75], v[160:163]
ds_read_b128 v[116:119], v41 offset:16384
ds_read_b128 v[120:123], v41 offset:16896
v_mfma_f32_16x16x32_bf16 v[164:167], v[80:83], v[76:79], v[164:167]
ds_read_b64_tr_b16 v[124:125], v42 offset:29184
ds_read_b64_tr_b16 v[126:127], v42 offset:30336
v_mfma_f32_16x16x32_bf16 v[168:171], v[84:87], v[72:75], v[168:171]
ds_read_b64_tr_b16 v[128:129], v42 offset:29216
v_mfma_f32_16x16x32_bf16 v[172:175], v[84:87], v[76:79], v[172:175]
ds_read_b64_tr_b16 v[130:131], v42 offset:30368
ds_read_b64_tr_b16 v[132:133], v42 offset:29248
v_mfma_f32_16x16x32_bf16 v[176:179], v[88:91], v[72:75], v[176:179]
ds_read_b64_tr_b16 v[134:135], v42 offset:30400
ds_read_b64_tr_b16 v[136:137], v42 offset:29280
v_mfma_f32_16x16x32_bf16 v[180:183], v[88:91], v[76:79], v[180:183]
ds_read_b64_tr_b16 v[138:139], v42 offset:30432
v_mfma_f32_16x16x32_bf16 v[184:187], v[92:95], v[72:75], v[184:187]
ds_read_b64_tr_b16 v[140:141], v42 offset:29312
ds_read_b64_tr_b16 v[142:143], v42 offset:30464
v_mfma_f32_16x16x32_bf16 v[188:191], v[92:95], v[76:79], v[188:191]
ds_read_b64_tr_b16 v[144:145], v42 offset:29344
ds_read_b64_tr_b16 v[146:147], v42 offset:30496
v_mfma_f32_16x16x32_bf16 v[192:195], v[96:99], v[72:75], v[192:195]
ds_read_b64_tr_b16 v[148:149], v42 offset:29376
v_mfma_f32_16x16x32_bf16 v[196:199], v[96:99], v[76:79], v[196:199]
ds_read_b64_tr_b16 v[150:151], v42 offset:30528
ds_read_b64_tr_b16 v[152:153], v42 offset:29408
v_mfma_f32_16x16x32_bf16 v[200:203], v[100:103], v[72:75], v[200:203]
ds_read_b64_tr_b16 v[154:155], v42 offset:30560
ds_read_b64_tr_b16 v[156:157], v42 offset:29440
v_mfma_f32_16x16x32_bf16 v[204:207], v[100:103], v[76:79], v[204:207]
ds_read_b64_tr_b16 v[158:159], v42 offset:30592
v_mfma_f32_16x16x32_bf16 v[208:211], v[104:107], v[72:75], v[208:211]
v_mfma_f32_16x16x32_bf16 v[212:215], v[104:107], v[76:79], v[212:215]
v_mfma_f32_16x16x32_bf16 v[216:219], v[108:111], v[72:75], v[216:219]
v_mfma_f32_16x16x32_bf16 v[220:223], v[108:111], v[76:79], v[220:223]
v_mfma_f32_16x16x32_bf16 v[224:227], v[112:115], v[72:75], v[224:227]
v_mfma_f32_16x16x32_bf16 v[228:231], v[112:115], v[76:79], v[228:231]
s_cmp_eq_u32 s28, 1
s_cbranch_scc1 mega_cs_14
s_cmp_eq_u32 s28, 2
s_cbranch_scc1 mega_cs_15
s_cmp_eq_u32 s28, 3
s_cbranch_scc1 mega_cs_16
v_mfma_f32_16x16x32_bf16 v[58:61], v[54:57], v[80:83], v[58:61]
v_mfma_f32_16x16x32_bf16 v[62:65], v[54:57], v[96:99], v[62:65]
v_mfma_f32_16x16x32_bf16 v[66:69], v[54:57], v[112:115], v[66:69]
s_branch mega_cse_13
mega_cs_14:
v_mfma_f32_16x16x32_bf16 v[58:61], v[54:57], v[84:87], v[58:61]
v_mfma_f32_16x16x32_bf16 v[62:65], v[54:57], v[100:103], v[62:65]
s_branch mega_cse_13
mega_cs_15:
v_mfma_f32_16x16x32_bf16 v[58:61], v[54:57], v[88:91], v[58:61]
v_mfma_f32_16x16x32_bf16 v[62:65], v[54:57], v[104:107], v[62:65]
s_branch mega_cse_13
mega_cs_16:
v_mfma_f32_16x16x32_bf16 v[58:61], v[54:57], v[92:95], v[58:61]
v_mfma_f32_16x16x32_bf16 v[62:65], v[54:57], v[108:111], v[62:65]
mega_cse_13:
s_waitcnt vmcnt(0) lgkmcnt(0)
s_barrier
v_mfma_f32_16x16x32_bf16 v[160:163], v[124:127], v[116:119], v[160:163]
ds_read_b128 v[72:75], v40 offset:32768
ds_read_b128 v[76:79], v40 offset:33280
v_mfma_f32_16x16x32_bf16 v[164:167], v[124:127], v[120:123], v[164:167]
ds_read_b64_tr_b16 v[80:81], v43 offset:0
ds_read_b64_tr_b16 v[82:83], v43 offset:1152
v_mfma_f32_16x16x32_bf16 v[168:171], v[128:131], v[116:119], v[168:171]
ds_read_b64_tr_b16 v[84:85], v43 offset:32
v_mfma_f32_16x16x32_bf16 v[172:175], v[128:131], v[120:123], v[172:175]
ds_read_b64_tr_b16 v[86:87], v43 offset:1184
ds_read_b64_tr_b16 v[88:89], v43 offset:64
v_mfma_f32_16x16x32_bf16 v[176:179], v[132:135], v[116:119], v[176:179]
ds_read_b64_tr_b16 v[90:91], v43 offset:1216
ds_read_b64_tr_b16 v[92:93], v43 offset:96
v_mfma_f32_16x16x32_bf16 v[180:183], v[132:135], v[120:123], v[180:183]
ds_read_b64_tr_b16 v[94:95], v43 offset:1248
v_mfma_f32_16x16x32_bf16 v[184:187], v[136:139], v[116:119], v[184:187]
ds_read_b64_tr_b16 v[96:97], v43 offset:128
ds_read_b64_tr_b16 v[98:99], v43 offset:1280
v_mfma_f32_16x16x32_bf16 v[188:191], v[136:139], v[120:123], v[188:191]
ds_read_b64_tr_b16 v[100:101], v43 offset:160
ds_read_b64_tr_b16 v[102:103], v43 offset:1312
v_mfma_f32_16x16x32_bf16 v[192:195], v[140:143], v[116:119], v[192:195]
ds_read_b64_tr_b16 v[104:105], v43 offset:192
v_mfma_f32_16x16x32_bf16 v[196:199], v[140:143], v[120:123], v[196:199]
ds_read_b64_tr_b16 v[106:107], v43 offset:1344
ds_read_b64_tr_b16 v[108:109], v43 offset:224
v_mfma_f32_16x16x32_bf16 v[200:203], v[144:147], v[116:119], v[200:203]
ds_read_b64_tr_b16 v[110:111], v43 offset:1376
ds_read_b64_tr_b16 v[112:113], v43 offset:256
v_mfma_f32_16x16x32_bf16 v[204:207], v[144:147], v[120:123], v[204:207]
ds_read_b64_tr_b16 v[114:115], v43 offset:1408
v_mfma_f32_16x16x32_bf16 v[208:211], v[148:151], v[116:119], v[208:211]
v_mfma_f32_16x16x32_bf16 v[212:215], v[148:151], v[120:123], v[212:215]
v_mfma_f32_16x16x32_bf16 v[216:219], v[152:155], v[116:119], v[216:219]
v_mfma_f32_16x16x32_bf16 v[220:223], v[152:155], v[120:123], v[220:223]
v_mfma_f32_16x16x32_bf16 v[224:227], v[156:159], v[116:119], v[224:227]
v_mfma_f32_16x16x32_bf16 v[228:231], v[156:159], v[120:123], v[228:231]
s_cmp_eq_u32 s28, 1
s_cbranch_scc1 mega_cs_18
s_cmp_eq_u32 s28, 2
s_cbranch_scc1 mega_cs_19
s_cmp_eq_u32 s28, 3
s_cbranch_scc1 mega_cs_20
v_mfma_f32_16x16x32_bf16 v[58:61], v[54:57], v[124:127], v[58:61]
v_mfma_f32_16x16x32_bf16 v[62:65], v[54:57], v[140:143], v[62:65]
v_mfma_f32_16x16x32_bf16 v[66:69], v[54:57], v[156:159], v[66:69]
s_branch mega_cse_17
mega_cs_18:
v_mfma_f32_16x16x32_bf16 v[58:61], v[54:57], v[128:131], v[58:61]
v_mfma_f32_16x16x32_bf16 v[62:65], v[54:57], v[144:147], v[62:65]
s_branch mega_cse_17
mega_cs_19:
v_mfma_f32_16x16x32_bf16 v[58:61], v[54:57], v[132:135], v[58:61]
v_mfma_f32_16x16x32_bf16 v[62:65], v[54:57], v[148:151], v[62:65]
s_branch mega_cse_17
mega_cs_20:
v_mfma_f32_16x16x32_bf16 v[58:61], v[54:57], v[136:139], v[58:61]
v_mfma_f32_16x16x32_bf16 v[62:65], v[54:57], v[152:155], v[62:65]
mega_cse_17:
s_waitcnt lgkmcnt(0)
v_mfma_f32_16x16x32_bf16 v[160:163], v[80:83], v[72:75], v[160:163]
ds_read_b128 v[116:119], v41 offset:32768
ds_read_b128 v[120:123], v41 offset:33280
s_add_u32 s31, s28, 9
v_mfma_f32_16x16x32_bf16 v[164:167], v[80:83], v[76:79], v[164:167]
ds_read_b64_tr_b16 v[124:125], v43 offset:9728
ds_read_b64_tr_b16 v[126:127], v43 offset:10880
v_mfma_f32_16x16x32_bf16 v[168:171], v[84:87], v[72:75], v[168:171]
ds_read_b64_tr_b16 v[128:129], v43 offset:9760
s_lshl_b32 s31, s31, 6
v_mfma_f32_16x16x32_bf16 v[172:175], v[84:87], v[76:79], v[172:175]
ds_read_b64_tr_b16 v[130:131], v43 offset:10912
ds_read_b64_tr_b16 v[132:133], v43 offset:9792
v_mfma_f32_16x16x32_bf16 v[176:179], v[88:91], v[72:75], v[176:179]
ds_read_b64_tr_b16 v[134:135], v43 offset:10944
ds_read_b64_tr_b16 v[136:137], v43 offset:9824
buffer_store_dword v58, v52, s[44:47], s31 offen sc1
v_mfma_f32_16x16x32_bf16 v[180:183], v[88:91], v[76:79], v[180:183]
ds_read_b64_tr_b16 v[138:139], v43 offset:10976
v_mfma_f32_16x16x32_bf16 v[184:187], v[92:95], v[72:75], v[184:187]
ds_read_b64_tr_b16 v[140:141], v43 offset:9856
ds_read_b64_tr_b16 v[142:143], v43 offset:11008
s_add_u32 s31, s28, 13
v_mfma_f32_16x16x32_bf16 v[188:191], v[92:95], v[76:79], v[188:191]
ds_read_b64_tr_b16 v[144:145], v43 offset:9888
ds_read_b64_tr_b16 v[146:147], v43 offset:11040
v_mfma_f32_16x16x32_bf16 v[192:195], v[96:99], v[72:75], v[192:195]
ds_read_b64_tr_b16 v[148:149], v43 offset:9920
v_mfma_f32_16x16x32_bf16 v[196:199], v[96:99], v[76:79], v[196:199]
ds_read_b64_tr_b16 v[150:151], v43 offset:11072
ds_read_b64_tr_b16 v[152:153], v43 offset:9952
s_lshl_b32 s31, s31, 6
v_mfma_f32_16x16x32_bf16 v[200:203], v[100:103], v[72:75], v[200:203]
ds_read_b64_tr_b16 v[154:155], v43 offset:11104
ds_read_b64_tr_b16 v[156:157], v43 offset:9984
v_mfma_f32_16x16x32_bf16 v[204:207], v[100:103], v[76:79], v[204:207]
ds_read_b64_tr_b16 v[158:159], v43 offset:11136
buffer_store_dword v62, v52, s[44:47], s31 offen sc1
v_mfma_f32_16x16x32_bf16 v[208:211], v[104:107], v[72:75], v[208:211]
v_mfma_f32_16x16x32_bf16 v[212:215], v[104:107], v[76:79], v[212:215]
s_cmp_eq_u32 s28, 0
s_cselect_b32 s31, 1088, s61
v_mfma_f32_16x16x32_bf16 v[216:219], v[108:111], v[72:75], v[216:219]
v_mfma_f32_16x16x32_bf16 v[220:223], v[108:111], v[76:79], v[220:223]
buffer_store_dword v66, v52, s[44:47], s31 offen sc1
v_mfma_f32_16x16x32_bf16 v[224:227], v[112:115], v[72:75], v[224:227]
v_mfma_f32_16x16x32_bf16 v[228:231], v[112:115], v[76:79], v[228:231]
s_waitcnt vmcnt(3) lgkmcnt(0)
s_barrier
v_mfma_f32_16x16x32_bf16 v[160:163], v[124:127], v[116:119], v[160:163]
ds_read_b128 v[72:75], v40 offset:49152
ds_read_b128 v[76:79], v40 offset:49664
v_mfma_f32_16x16x32_bf16 v[164:167], v[124:127], v[120:123], v[164:167]
ds_read_b64_tr_b16 v[80:81], v43 offset:19456
ds_read_b64_tr_b16 v[82:83], v43 offset:20608
v_mfma_f32_16x16x32_bf16 v[168:171], v[128:131], v[116:119], v[168:171]
ds_read_b64_tr_b16 v[84:85], v43 offset:19488
v_mfma_f32_16x16x32_bf16 v[172:175], v[128:131], v[120:123], v[172:175]
ds_read_b64_tr_b16 v[86:87], v43 offset:20640
ds_read_b64_tr_b16 v[88:89], v43 offset:19520
v_mfma_f32_16x16x32_bf16 v[176:179], v[132:135], v[116:119], v[176:179]
ds_read_b64_tr_b16 v[90:91], v43 offset:20672
ds_read_b64_tr_b16 v[92:93], v43 offset:19552
v_mfma_f32_16x16x32_bf16 v[180:183], v[132:135], v[120:123], v[180:183]
ds_read_b64_tr_b16 v[94:95], v43 offset:20704
v_mfma_f32_16x16x32_bf16 v[184:187], v[136:139], v[116:119], v[184:187]
ds_read_b64_tr_b16 v[96:97], v43 offset:19584
ds_read_b64_tr_b16 v[98:99], v43 offset:20736
v_mfma_f32_16x16x32_bf16 v[188:191], v[136:139], v[120:123], v[188:191]
ds_read_b64_tr_b16 v[100:101], v43 offset:19616
ds_read_b64_tr_b16 v[102:103], v43 offset:20768
v_mfma_f32_16x16x32_bf16 v[192:195], v[140:143], v[116:119], v[192:195]
ds_read_b64_tr_b16 v[104:105], v43 offset:19648
v_mfma_f32_16x16x32_bf16 v[196:199], v[140:143], v[120:123], v[196:199]
ds_read_b64_tr_b16 v[106:107], v43 offset:20800
ds_read_b64_tr_b16 v[108:109], v43 offset:19680
v_mfma_f32_16x16x32_bf16 v[200:203], v[144:147], v[116:119], v[200:203]
ds_read_b64_tr_b16 v[110:111], v43 offset:20832
ds_read_b64_tr_b16 v[112:113], v43 offset:19712
v_mfma_f32_16x16x32_bf16 v[204:207], v[144:147], v[120:123], v[204:207]
ds_read_b64_tr_b16 v[114:115], v43 offset:20864
v_mfma_f32_16x16x32_bf16 v[208:211], v[148:151], v[116:119], v[208:211]
v_mfma_f32_16x16x32_bf16 v[212:215], v[148:151], v[120:123], v[212:215]
v_mfma_f32_16x16x32_bf16 v[216:219], v[152:155], v[116:119], v[216:219]
v_mfma_f32_16x16x32_bf16 v[220:223], v[152:155], v[120:123], v[220:223]
v_mfma_f32_16x16x32_bf16 v[224:227], v[156:159], v[116:119], v[224:227]
v_mfma_f32_16x16x32_bf16 v[228:231], v[156:159], v[120:123], v[228:231]
s_waitcnt lgkmcnt(0)
v_mfma_f32_16x16x32_bf16 v[160:163], v[80:83], v[72:75], v[160:163]
ds_read_b128 v[116:119], v41 offset:49152
ds_read_b128 v[120:123], v41 offset:49664
v_mfma_f32_16x16x32_bf16 v[164:167], v[80:83], v[76:79], v[164:167]
ds_read_b64_tr_b16 v[124:125], v43 offset:29184
ds_read_b64_tr_b16 v[126:127], v43 offset:30336
v_mfma_f32_16x16x32_bf16 v[168:171], v[84:87], v[72:75], v[168:171]
ds_read_b64_tr_b16 v[128:129], v43 offset:29216
v_mfma_f32_16x16x32_bf16 v[172:175], v[84:87], v[76:79], v[172:175]
ds_read_b64_tr_b16 v[130:131], v43 offset:30368
ds_read_b64_tr_b16 v[132:133], v43 offset:29248
v_mfma_f32_16x16x32_bf16 v[176:179], v[88:91], v[72:75], v[176:179]
ds_read_b64_tr_b16 v[134:135], v43 offset:30400
ds_read_b64_tr_b16 v[136:137], v43 offset:29280
v_mfma_f32_16x16x32_bf16 v[180:183], v[88:91], v[76:79], v[180:183]
ds_read_b64_tr_b16 v[138:139], v43 offset:30432
v_mfma_f32_16x16x32_bf16 v[184:187], v[92:95], v[72:75], v[184:187]
ds_read_b64_tr_b16 v[140:141], v43 offset:29312
ds_read_b64_tr_b16 v[142:143], v43 offset:30464
v_mfma_f32_16x16x32_bf16 v[188:191], v[92:95], v[76:79], v[188:191]
ds_read_b64_tr_b16 v[144:145], v43 offset:29344
ds_read_b64_tr_b16 v[146:147], v43 offset:30496
v_mfma_f32_16x16x32_bf16 v[192:195], v[96:99], v[72:75], v[192:195]
ds_read_b64_tr_b16 v[148:149], v43 offset:29376
v_mfma_f32_16x16x32_bf16 v[196:199], v[96:99], v[76:79], v[196:199]
ds_read_b64_tr_b16 v[150:151], v43 offset:30528
ds_read_b64_tr_b16 v[152:153], v43 offset:29408
v_mfma_f32_16x16x32_bf16 v[200:203], v[100:103], v[72:75], v[200:203]
ds_read_b64_tr_b16 v[154:155], v43 offset:30560
ds_read_b64_tr_b16 v[156:157], v43 offset:29440
v_mfma_f32_16x16x32_bf16 v[204:207], v[100:103], v[76:79], v[204:207]
ds_read_b64_tr_b16 v[158:159], v43 offset:30592
v_mfma_f32_16x16x32_bf16 v[208:211], v[104:107], v[72:75], v[208:211]
v_mfma_f32_16x16x32_bf16 v[212:215], v[104:107], v[76:79], v[212:215]
v_mfma_f32_16x16x32_bf16 v[216:219], v[108:111], v[72:75], v[216:219]
v_mfma_f32_16x16x32_bf16 v[220:223], v[108:111], v[76:79], v[220:223]
v_mfma_f32_16x16x32_bf16 v[224:227], v[112:115], v[72:75], v[224:227]
v_mfma_f32_16x16x32_bf16 v[228:231], v[112:115], v[76:79], v[228:231]
s_waitcnt vmcnt(3) lgkmcnt(0)
s_barrier
v_mfma_f32_16x16x32_bf16 v[160:163], v[124:127], v[116:119], v[160:163]
ds_read_b128 v[72:75], v40 offset:0
ds_read_b128 v[76:79], v40 offset:512
v_mfma_f32_16x16x32_bf16 v[164:167], v[124:127], v[120:123], v[164:167]
ds_read_b64_tr_b16 v[80:81], v42 offset:0
ds_read_b64_tr_b16 v[82:83], v42 offset:1152
v_mfma_f32_16x16x32_bf16 v[168:171], v[128:131], v[116:119], v[168:171]
ds_read_b64_tr_b16 v[84:85], v42 offset:32
v_mfma_f32_16x16x32_bf16 v[172:175], v[128:131], v[120:123], v[172:175]
ds_read_b64_tr_b16 v[86:87], v42 offset:1184
ds_read_b64_tr_b16 v[88:89], v42 offset:64
v_mfma_f32_16x16x32_bf16 v[176:179], v[132:135], v[116:119], v[176:179]
ds_read_b64_tr_b16 v[90:91], v42 offset:1216
ds_read_b64_tr_b16 v[92:93], v42 offset:96
v_mfma_f32_16x16x32_bf16 v[180:183], v[132:135], v[120:123], v[180:183]
ds_read_b64_tr_b16 v[94:95], v42 offset:1248
v_mfma_f32_16x16x32_bf16 v[184:187], v[136:139], v[116:119], v[184:187]
ds_read_b64_tr_b16 v[96:97], v42 offset:128
ds_read_b64_tr_b16 v[98:99], v42 offset:1280
v_mfma_f32_16x16x32_bf16 v[188:191], v[136:139], v[120:123], v[188:191]
ds_read_b64_tr_b16 v[100:101], v42 offset:160
ds_read_b64_tr_b16 v[102:103], v42 offset:1312
v_mfma_f32_16x16x32_bf16 v[192:195], v[140:143], v[116:119], v[192:195]
ds_read_b64_tr_b16 v[104:105], v42 offset:192
v_mfma_f32_16x16x32_bf16 v[196:199], v[140:143], v[120:123], v[196:199]
ds_read_b64_tr_b16 v[106:107], v42 offset:1344
ds_read_b64_tr_b16 v[108:109], v42 offset:224
v_mfma_f32_16x16x32_bf16 v[200:203], v[144:147], v[116:119], v[200:203]
ds_read_b64_tr_b16 v[110:111], v42 offset:1376
ds_read_b64_tr_b16 v[112:113], v42 offset:256
v_mfma_f32_16x16x32_bf16 v[204:207], v[144:147], v[120:123], v[204:207]
ds_read_b64_tr_b16 v[114:115], v42 offset:1408
v_mfma_f32_16x16x32_bf16 v[208:211], v[148:151], v[116:119], v[208:211]
v_mfma_f32_16x16x32_bf16 v[212:215], v[148:151], v[120:123], v[212:215]
v_mfma_f32_16x16x32_bf16 v[216:219], v[152:155], v[116:119], v[216:219]
v_mfma_f32_16x16x32_bf16 v[220:223], v[152:155], v[120:123], v[220:223]
v_mfma_f32_16x16x32_bf16 v[224:227], v[156:159], v[116:119], v[224:227]
v_mfma_f32_16x16x32_bf16 v[228:231], v[156:159], v[120:123], v[228:231]
s_waitcnt lgkmcnt(0)
v_mfma_f32_16x16x32_bf16 v[160:163], v[80:83], v[72:75], v[160:163]
ds_read_b128 v[116:119], v41 offset:0
ds_read_b128 v[120:123], v41 offset:512
v_mfma_f32_16x16x32_bf16 v[164:167], v[80:83], v[76:79], v[164:167]
ds_read_b64_tr_b16 v[124:125], v42 offset:9728
ds_read_b64_tr_b16 v[126:127], v42 offset:10880
v_mfma_f32_16x16x32_bf16 v[168:171], v[84:87], v[72:75], v[168:171]
ds_read_b64_tr_b16 v[128:129], v42 offset:9760
v_mfma_f32_16x16x32_bf16 v[172:175], v[84:87], v[76:79], v[172:175]
ds_read_b64_tr_b16 v[130:131], v42 offset:10912
ds_read_b64_tr_b16 v[132:133], v42 offset:9792
v_mfma_f32_16x16x32_bf16 v[176:179], v[88:91], v[72:75], v[176:179]
ds_read_b64_tr_b16 v[134:135], v42 offset:10944
ds_read_b64_tr_b16 v[136:137], v42 offset:9824
v_mfma_f32_16x16x32_bf16 v[180:183], v[88:91], v[76:79], v[180:183]
ds_read_b64_tr_b16 v[138:139], v42 offset:10976
v_mfma_f32_16x16x32_bf16 v[184:187], v[92:95], v[72:75], v[184:187]
ds_read_b64_tr_b16 v[140:141], v42 offset:9856
ds_read_b64_tr_b16 v[142:143], v42 offset:11008
v_mfma_f32_16x16x32_bf16 v[188:191], v[92:95], v[76:79], v[188:191]
ds_read_b64_tr_b16 v[144:145], v42 offset:9888
ds_read_b64_tr_b16 v[146:147], v42 offset:11040
v_mfma_f32_16x16x32_bf16 v[192:195], v[96:99], v[72:75], v[192:195]
ds_read_b64_tr_b16 v[148:149], v42 offset:9920
v_mfma_f32_16x16x32_bf16 v[196:199], v[96:99], v[76:79], v[196:199]
ds_read_b64_tr_b16 v[150:151], v42 offset:11072
ds_read_b64_tr_b16 v[152:153], v42 offset:9952
v_mfma_f32_16x16x32_bf16 v[200:203], v[100:103], v[72:75], v[200:203]
ds_read_b64_tr_b16 v[154:155], v42 offset:11104
ds_read_b64_tr_b16 v[156:157], v42 offset:9984
v_mfma_f32_16x16x32_bf16 v[204:207], v[100:103], v[76:79], v[204:207]
ds_read_b64_tr_b16 v[158:159], v42 offset:11136
v_mfma_f32_16x16x32_bf16 v[208:211], v[104:107], v[72:75], v[208:211]
v_mfma_f32_16x16x32_bf16 v[212:215], v[104:107], v[76:79], v[212:215]
v_mfma_f32_16x16x32_bf16 v[216:219], v[108:111], v[72:75], v[216:219]
v_mfma_f32_16x16x32_bf16 v[220:223], v[108:111], v[76:79], v[220:223]
v_mfma_f32_16x16x32_bf16 v[224:227], v[112:115], v[72:75], v[224:227]
v_mfma_f32_16x16x32_bf16 v[228:231], v[112:115], v[76:79], v[228:231]
s_waitcnt lgkmcnt(0)
s_barrier
s_lshl_b32 s30, s28, 8
v_lshl_add_u32 v241, v252, 6, s30
s_waitcnt lgkmcnt(0)
ds_read_b128 v[72:75], v241 offset:4224
ds_read_b128 v[76:79], v241 offset:4240
ds_read_b128 v[80:83], v241 offset:4256
ds_read_b128 v[84:87], v241 offset:4272
s_lshl_b32 s30, s27, 6
s_lshl_b32 s31, s26, 2
s_add_u32 s30, s30, s31
s_add_u32 s30, s30, s28
s_mul_i32 s30, s30, 9216
s_add_u32 s20, s8, 9437184
s_addc_u32 s21, s9, 0
s_and_b32 s21, s21, 0xffff
s_mov_b32 s22, 9437184
s_mov_b32 s23, 0x20000
s_waitcnt lgkmcnt(0)
v_fma_f32 v0, v0, v72, v73
v_fma_f32 v1, v1, v74, v75
v_fma_f32 v2, v2, v76, v77
v_fma_f32 v3, v3, v78, v79
v_fma_f32 v4, v4, v80, v81
v_fma_f32 v5, v5, v82, v83
v_fma_f32 v6, v6, v84, v85
v_fma_f32 v7, v7, v86, v87
v_cvt_pk_bf16_f32 v88, v0, v1
v_cvt_pk_bf16_f32 v89, v2, v3
v_cvt_pk_bf16_f32 v90, v4, v5
v_cvt_pk_bf16_f32 v91, v6, v7
s_add_u32 s34, s30, 0
buffer_store_dwordx4 v[88:91], v253, s[20:23], s34 offen sc1
v_fma_f32 v8, v8, v72, v73
v_fma_f32 v9, v9, v74, v75
v_fma_f32 v10, v10, v76, v77
v_fma_f32 v11, v11, v78, v79
v_fma_f32 v12, v12, v80, v81
v_fma_f32 v13, v13, v82, v83
v_fma_f32 v14, v14, v84, v85
v_fma_f32 v15, v15, v86, v87
v_cvt_pk_bf16_f32 v92, v8, v9
v_cvt_pk_bf16_f32 v93, v10, v11
v_cvt_pk_bf16_f32 v94, v12, v13
v_cvt_pk_bf16_f32 v95, v14, v15
s_add_u32 s34, s30, 1024
buffer_store_dwordx4 v[92:95], v253, s[20:23], s34 offen sc1
v_fma_f32 v16, v16, v72, v73
v_fma_f32 v17, v17, v74, v75
v_fma_f32 v18, v18, v76, v77
v_fma_f32 v19, v19, v78, v79
v_fma_f32 v20, v20, v80, v81
v_fma_f32 v21, v21, v82, v83
v_fma_f32 v22, v22, v84, v85
v_fma_f32 v23, v23, v86, v87
v_cvt_pk_bf16_f32 v88, v16, v17
v_cvt_pk_bf16_f32 v89, v18, v19
v_cvt_pk_bf16_f32 v90, v20, v21
v_cvt_pk_bf16_f32 v91, v22, v23
s_add_u32 s34, s30, 2048
buffer_store_dwordx4 v[88:91], v253, s[20:23], s34 offen sc1
v_fma_f32 v24, v24, v72, v73
v_fma_f32 v25, v25, v74, v75
v_fma_f32 v26, v26, v76, v77
v_fma_f32 v27, v27, v78, v79
v_fma_f32 v28, v28, v80, v81
v_fma_f32 v29, v29, v82, v83
v_fma_f32 v30, v30, v84, v85
v_fma_f32 v31, v31, v86, v87
v_cvt_pk_bf16_f32 v92, v24, v25
v_cvt_pk_bf16_f32 v93, v26, v27
v_cvt_pk_bf16_f32 v94, v28, v29
v_cvt_pk_bf16_f32 v95, v30, v31
s_add_u32 s34, s30, 3072
buffer_store_dwordx4 v[92:95], v253, s[20:23], s34 offen sc1
v_mfma_f32_16x16x32_bf16 v[160:163], v[124:127], v[116:119], v[160:163]
ds_read_b128 v[72:75], v40 offset:16384
ds_read_b128 v[76:79], v40 offset:16896
v_mfma_f32_16x16x32_bf16 v[164:167], v[124:127], v[120:123], v[164:167]
ds_read_b64_tr_b16 v[80:81], v42 offset:19456
ds_read_b64_tr_b16 v[82:83], v42 offset:20608
v_mfma_f32_16x16x32_bf16 v[168:171], v[128:131], v[116:119], v[168:171]
ds_read_b64_tr_b16 v[84:85], v42 offset:19488
v_mfma_f32_16x16x32_bf16 v[172:175], v[128:131], v[120:123], v[172:175]
ds_read_b64_tr_b16 v[86:87], v42 offset:20640
ds_read_b64_tr_b16 v[88:89], v42 offset:19520
v_mfma_f32_16x16x32_bf16 v[176:179], v[132:135], v[116:119], v[176:179]
ds_read_b64_tr_b16 v[90:91], v42 offset:20672
ds_read_b64_tr_b16 v[92:93], v42 offset:19552
v_mfma_f32_16x16x32_bf16 v[180:183], v[132:135], v[120:123], v[180:183]
ds_read_b64_tr_b16 v[94:95], v42 offset:20704
v_mfma_f32_16x16x32_bf16 v[184:187], v[136:139], v[116:119], v[184:187]
ds_read_b64_tr_b16 v[96:97], v42 offset:19584
ds_read_b64_tr_b16 v[98:99], v42 offset:20736
v_mfma_f32_16x16x32_bf16 v[188:191], v[136:139], v[120:123], v[188:191]
ds_read_b64_tr_b16 v[100:101], v42 offset:19616
ds_read_b64_tr_b16 v[102:103], v42 offset:20768
v_mfma_f32_16x16x32_bf16 v[192:195], v[140:143], v[116:119], v[192:195]
ds_read_b64_tr_b16 v[104:105], v42 offset:19648
v_mfma_f32_16x16x32_bf16 v[196:199], v[140:143], v[120:123], v[196:199]
ds_read_b64_tr_b16 v[106:107], v42 offset:20800
ds_read_b64_tr_b16 v[108:109], v42 offset:19680
v_mfma_f32_16x16x32_bf16 v[200:203], v[144:147], v[116:119], v[200:203]
ds_read_b64_tr_b16 v[110:111], v42 offset:20832
ds_read_b64_tr_b16 v[112:113], v42 offset:19712
v_mfma_f32_16x16x32_bf16 v[204:207], v[144:147], v[120:123], v[204:207]
ds_read_b64_tr_b16 v[114:115], v42 offset:20864
v_mfma_f32_16x16x32_bf16 v[208:211], v[148:151], v[116:119], v[208:211]
v_mfma_f32_16x16x32_bf16 v[212:215], v[148:151], v[120:123], v[212:215]
v_mfma_f32_16x16x32_bf16 v[216:219], v[152:155], v[116:119], v[216:219]
v_mfma_f32_16x16x32_bf16 v[220:223], v[152:155], v[120:123], v[220:223]
v_mfma_f32_16x16x32_bf16 v[224:227], v[156:159], v[116:119], v[224:227]
v_mfma_f32_16x16x32_bf16 v[228:231], v[156:159], v[120:123], v[228:231]
s_waitcnt lgkmcnt(0)
v_mfma_f32_16x16x32_bf16 v[160:163], v[80:83], v[72:75], v[160:163]
ds_read_b128 v[116:119], v41 offset:16384
ds_read_b128 v[120:123], v41 offset:16896
v_mfma_f32_16x16x32_bf16 v[164:167], v[80:83], v[76:79], v[164:167]
ds_read_b64_tr_b16 v[124:125], v42 offset:29184
ds_read_b64_tr_b16 v[126:127], v42 offset:30336
v_mfma_f32_16x16x32_bf16 v[168:171], v[84:87], v[72:75], v[168:171]
ds_read_b64_tr_b16 v[128:129], v42 offset:29216
v_mfma_f32_16x16x32_bf16 v[172:175], v[84:87], v[76:79], v[172:175]
ds_read_b64_tr_b16 v[130:131], v42 offset:30368
ds_read_b64_tr_b16 v[132:133], v42 offset:29248
v_mfma_f32_16x16x32_bf16 v[176:179], v[88:91], v[72:75], v[176:179]
ds_read_b64_tr_b16 v[134:135], v42 offset:30400
ds_read_b64_tr_b16 v[136:137], v42 offset:29280
v_mfma_f32_16x16x32_bf16 v[180:183], v[88:91], v[76:79], v[180:183]
ds_read_b64_tr_b16 v[138:139], v42 offset:30432
v_mfma_f32_16x16x32_bf16 v[184:187], v[92:95], v[72:75], v[184:187]
ds_read_b64_tr_b16 v[140:141], v42 offset:29312
ds_read_b64_tr_b16 v[142:143], v42 offset:30464
v_mfma_f32_16x16x32_bf16 v[188:191], v[92:95], v[76:79], v[188:191]
ds_read_b64_tr_b16 v[144:145], v42 offset:29344
ds_read_b64_tr_b16 v[146:147], v42 offset:30496
v_mfma_f32_16x16x32_bf16 v[192:195], v[96:99], v[72:75], v[192:195]
ds_read_b64_tr_b16 v[148:149], v42 offset:29376
v_mfma_f32_16x16x32_bf16 v[196:199], v[96:99], v[76:79], v[196:199]
ds_read_b64_tr_b16 v[150:151], v42 offset:30528
ds_read_b64_tr_b16 v[152:153], v42 offset:29408
v_mfma_f32_16x16x32_bf16 v[200:203], v[100:103], v[72:75], v[200:203]
ds_read_b64_tr_b16 v[154:155], v42 offset:30560
ds_read_b64_tr_b16 v[156:157], v42 offset:29440
v_mfma_f32_16x16x32_bf16 v[204:207], v[100:103], v[76:79], v[204:207]
ds_read_b64_tr_b16 v[158:159], v42 offset:30592
v_mfma_f32_16x16x32_bf16 v[208:211], v[104:107], v[72:75], v[208:211]
v_mfma_f32_16x16x32_bf16 v[212:215], v[104:107], v[76:79], v[212:215]
v_mfma_f32_16x16x32_bf16 v[216:219], v[108:111], v[72:75], v[216:219]
v_mfma_f32_16x16x32_bf16 v[220:223], v[108:111], v[76:79], v[220:223]
v_mfma_f32_16x16x32_bf16 v[224:227], v[112:115], v[72:75], v[224:227]
v_mfma_f32_16x16x32_bf16 v[228:231], v[112:115], v[76:79], v[228:231]
s_waitcnt lgkmcnt(0)
s_barrier
v_mfma_f32_16x16x32_bf16 v[160:163], v[124:127], v[116:119], v[160:163]
ds_read_b128 v[72:75], v40 offset:32768
ds_read_b128 v[76:79], v40 offset:33280
v_mfma_f32_16x16x32_bf16 v[164:167], v[124:127], v[120:123], v[164:167]
ds_read_b64_tr_b16 v[80:81], v43 offset:0
ds_read_b64_tr_b16 v[82:83], v43 offset:1152
v_mfma_f32_16x16x32_bf16 v[168:171], v[128:131], v[116:119], v[168:171]
ds_read_b64_tr_b16 v[84:85], v43 offset:32
v_mfma_f32_16x16x32_bf16 v[172:175], v[128:131], v[120:123], v[172:175]
ds_read_b64_tr_b16 v[86:87], v43 offset:1184
ds_read_b64_tr_b16 v[88:89], v43 offset:64
v_mfma_f32_16x16x32_bf16 v[176:179], v[132:135], v[116:119], v[176:179]
ds_read_b64_tr_b16 v[90:91], v43 offset:1216
ds_read_b64_tr_b16 v[92:93], v43 offset:96
v_mfma_f32_16x16x32_bf16 v[180:183], v[132:135], v[120:123], v[180:183]
ds_read_b64_tr_b16 v[94:95], v43 offset:1248
v_mfma_f32_16x16x32_bf16 v[184:187], v[136:139], v[116:119], v[184:187]
ds_read_b64_tr_b16 v[96:97], v43 offset:128
ds_read_b64_tr_b16 v[98:99], v43 offset:1280
v_mfma_f32_16x16x32_bf16 v[188:191], v[136:139], v[120:123], v[188:191]
ds_read_b64_tr_b16 v[100:101], v43 offset:160
ds_read_b64_tr_b16 v[102:103], v43 offset:1312
v_mfma_f32_16x16x32_bf16 v[192:195], v[140:143], v[116:119], v[192:195]
ds_read_b64_tr_b16 v[104:105], v43 offset:192
v_mfma_f32_16x16x32_bf16 v[196:199], v[140:143], v[120:123], v[196:199]
ds_read_b64_tr_b16 v[106:107], v43 offset:1344
ds_read_b64_tr_b16 v[108:109], v43 offset:224
v_mfma_f32_16x16x32_bf16 v[200:203], v[144:147], v[116:119], v[200:203]
ds_read_b64_tr_b16 v[110:111], v43 offset:1376
ds_read_b64_tr_b16 v[112:113], v43 offset:256
v_mfma_f32_16x16x32_bf16 v[204:207], v[144:147], v[120:123], v[204:207]
ds_read_b64_tr_b16 v[114:115], v43 offset:1408
v_mfma_f32_16x16x32_bf16 v[208:211], v[148:151], v[116:119], v[208:211]
v_mfma_f32_16x16x32_bf16 v[212:215], v[148:151], v[120:123], v[212:215]
v_mfma_f32_16x16x32_bf16 v[216:219], v[152:155], v[116:119], v[216:219]
v_mfma_f32_16x16x32_bf16 v[220:223], v[152:155], v[120:123], v[220:223]
v_mfma_f32_16x16x32_bf16 v[224:227], v[156:159], v[116:119], v[224:227]
v_mfma_f32_16x16x32_bf16 v[228:231], v[156:159], v[120:123], v[228:231]
s_waitcnt lgkmcnt(0)
v_mfma_f32_16x16x32_bf16 v[160:163], v[80:83], v[72:75], v[160:163]
ds_read_b128 v[116:119], v41 offset:32768
ds_read_b128 v[120:123], v41 offset:33280
v_mfma_f32_16x16x32_bf16 v[164:167], v[80:83], v[76:79], v[164:167]
ds_read_b64_tr_b16 v[124:125], v43 offset:9728
ds_read_b64_tr_b16 v[126:127], v43 offset:10880
v_mfma_f32_16x16x32_bf16 v[168:171], v[84:87], v[72:75], v[168:171]
ds_read_b64_tr_b16 v[128:129], v43 offset:9760
v_mfma_f32_16x16x32_bf16 v[172:175], v[84:87], v[76:79], v[172:175]
ds_read_b64_tr_b16 v[130:131], v43 offset:10912
ds_read_b64_tr_b16 v[132:133], v43 offset:9792
v_mfma_f32_16x16x32_bf16 v[176:179], v[88:91], v[72:75], v[176:179]
ds_read_b64_tr_b16 v[134:135], v43 offset:10944
ds_read_b64_tr_b16 v[136:137], v43 offset:9824
v_mfma_f32_16x16x32_bf16 v[180:183], v[88:91], v[76:79], v[180:183]
ds_read_b64_tr_b16 v[138:139], v43 offset:10976
v_mfma_f32_16x16x32_bf16 v[184:187], v[92:95], v[72:75], v[184:187]
ds_read_b64_tr_b16 v[140:141], v43 offset:9856
ds_read_b64_tr_b16 v[142:143], v43 offset:11008
v_mfma_f32_16x16x32_bf16 v[188:191], v[92:95], v[76:79], v[188:191]
ds_read_b64_tr_b16 v[144:145], v43 offset:9888
ds_read_b64_tr_b16 v[146:147], v43 offset:11040
v_mfma_f32_16x16x32_bf16 v[192:195], v[96:99], v[72:75], v[192:195]
ds_read_b64_tr_b16 v[148:149], v43 offset:9920
v_mfma_f32_16x16x32_bf16 v[196:199], v[96:99], v[76:79], v[196:199]
ds_read_b64_tr_b16 v[150:151], v43 offset:11072
ds_read_b64_tr_b16 v[152:153], v43 offset:9952
v_mfma_f32_16x16x32_bf16 v[200:203], v[100:103], v[72:75], v[200:203]
ds_read_b64_tr_b16 v[154:155], v43 offset:11104
ds_read_b64_tr_b16 v[156:157], v43 offset:9984
v_mfma_f32_16x16x32_bf16 v[204:207], v[100:103], v[76:79], v[204:207]
ds_read_b64_tr_b16 v[158:159], v43 offset:11136
v_mfma_f32_16x16x32_bf16 v[208:211], v[104:107], v[72:75], v[208:211]
v_mfma_f32_16x16x32_bf16 v[212:215], v[104:107], v[76:79], v[212:215]
v_mfma_f32_16x16x32_bf16 v[216:219], v[108:111], v[72:75], v[216:219]
v_mfma_f32_16x16x32_bf16 v[220:223], v[108:111], v[76:79], v[220:223]
v_mfma_f32_16x16x32_bf16 v[224:227], v[112:115], v[72:75], v[224:227]
v_mfma_f32_16x16x32_bf16 v[228:231], v[112:115], v[76:79], v[228:231]
s_lshl_b32 s30, s27, 4
s_add_u32 s30, s30, s26
s_lshl_b32 s30, s30, 5
s_add_u32 s30, s30, s29
s_lshl_b32 s30, s30, 2
s_add_u32 s30, s30, 266240
s_waitcnt vmcnt(0)
v_mov_b32 v248, 1
v_mov_b32 v249, s30
s_mov_b64 exec, 1
buffer_store_dword v248, v249, s[44:47], 0 offen sc1
s_mov_b64 exec, s[62:63]
s_waitcnt lgkmcnt(0)
s_barrier
v_mfma_f32_16x16x32_bf16 v[160:163], v[124:127], v[116:119], v[160:163]
ds_read_b128 v[72:75], v40 offset:49152
ds_read_b128 v[76:79], v40 offset:49664
v_mfma_f32_16x16x32_bf16 v[164:167], v[124:127], v[120:123], v[164:167]
ds_read_b64_tr_b16 v[80:81], v43 offset:19456
ds_read_b64_tr_b16 v[82:83], v43 offset:20608
v_mfma_f32_16x16x32_bf16 v[168:171], v[128:131], v[116:119], v[168:171]
ds_read_b64_tr_b16 v[84:85], v43 offset:19488
v_mfma_f32_16x16x32_bf16 v[172:175], v[128:131], v[120:123], v[172:175]
ds_read_b64_tr_b16 v[86:87], v43 offset:20640
ds_read_b64_tr_b16 v[88:89], v43 offset:19520
v_mfma_f32_16x16x32_bf16 v[176:179], v[132:135], v[116:119], v[176:179]
ds_read_b64_tr_b16 v[90:91], v43 offset:20672
ds_read_b64_tr_b16 v[92:93], v43 offset:19552
v_mfma_f32_16x16x32_bf16 v[180:183], v[132:135], v[120:123], v[180:183]
ds_read_b64_tr_b16 v[94:95], v43 offset:20704
v_mfma_f32_16x16x32_bf16 v[184:187], v[136:139], v[116:119], v[184:187]
ds_read_b64_tr_b16 v[96:97], v43 offset:19584
ds_read_b64_tr_b16 v[98:99], v43 offset:20736
v_mfma_f32_16x16x32_bf16 v[188:191], v[136:139], v[120:123], v[188:191]
ds_read_b64_tr_b16 v[100:101], v43 offset:19616
ds_read_b64_tr_b16 v[102:103], v43 offset:20768
v_mfma_f32_16x16x32_bf16 v[192:195], v[140:143], v[116:119], v[192:195]
ds_read_b64_tr_b16 v[104:105], v43 offset:19648
v_mfma_f32_16x16x32_bf16 v[196:199], v[140:143], v[120:123], v[196:199]
ds_read_b64_tr_b16 v[106:107], v43 offset:20800
ds_read_b64_tr_b16 v[108:109], v43 offset:19680
v_mfma_f32_16x16x32_bf16 v[200:203], v[144:147], v[116:119], v[200:203]
ds_read_b64_tr_b16 v[110:111], v43 offset:20832
ds_read_b64_tr_b16 v[112:113], v43 offset:19712
v_mfma_f32_16x16x32_bf16 v[204:207], v[144:147], v[120:123], v[204:207]
ds_read_b64_tr_b16 v[114:115], v43 offset:20864
v_mfma_f32_16x16x32_bf16 v[208:211], v[148:151], v[116:119], v[208:211]
v_mfma_f32_16x16x32_bf16 v[212:215], v[148:151], v[120:123], v[212:215]
v_mfma_f32_16x16x32_bf16 v[216:219], v[152:155], v[116:119], v[216:219]
v_mfma_f32_16x16x32_bf16 v[220:223], v[152:155], v[120:123], v[220:223]
v_mfma_f32_16x16x32_bf16 v[224:227], v[156:159], v[116:119], v[224:227]
v_mfma_f32_16x16x32_bf16 v[228:231], v[156:159], v[120:123], v[228:231]
s_waitcnt lgkmcnt(0)
v_mfma_f32_16x16x32_bf16 v[160:163], v[80:83], v[72:75], v[160:163]
ds_read_b128 v[116:119], v41 offset:49152
ds_read_b128 v[120:123], v41 offset:49664
v_mfma_f32_16x16x32_bf16 v[164:167], v[80:83], v[76:79], v[164:167]
ds_read_b64_tr_b16 v[124:125], v43 offset:29184
ds_read_b64_tr_b16 v[126:127], v43 offset:30336
v_mfma_f32_16x16x32_bf16 v[168:171], v[84:87], v[72:75], v[168:171]
ds_read_b64_tr_b16 v[128:129], v43 offset:29216
v_mfma_f32_16x16x32_bf16 v[172:175], v[84:87], v[76:79], v[172:175]
ds_read_b64_tr_b16 v[130:131], v43 offset:30368
ds_read_b64_tr_b16 v[132:133], v43 offset:29248
v_mfma_f32_16x16x32_bf16 v[176:179], v[88:91], v[72:75], v[176:179]
ds_read_b64_tr_b16 v[134:135], v43 offset:30400
ds_read_b64_tr_b16 v[136:137], v43 offset:29280
v_mfma_f32_16x16x32_bf16 v[180:183], v[88:91], v[76:79], v[180:183]
ds_read_b64_tr_b16 v[138:139], v43 offset:30432
v_mfma_f32_16x16x32_bf16 v[184:187], v[92:95], v[72:75], v[184:187]
ds_read_b64_tr_b16 v[140:141], v43 offset:29312
ds_read_b64_tr_b16 v[142:143], v43 offset:30464
v_mfma_f32_16x16x32_bf16 v[188:191], v[92:95], v[76:79], v[188:191]
ds_read_b64_tr_b16 v[144:145], v43 offset:29344
ds_read_b64_tr_b16 v[146:147], v43 offset:30496
v_mfma_f32_16x16x32_bf16 v[192:195], v[96:99], v[72:75], v[192:195]
ds_read_b64_tr_b16 v[148:149], v43 offset:29376
v_mfma_f32_16x16x32_bf16 v[196:199], v[96:99], v[76:79], v[196:199]
ds_read_b64_tr_b16 v[150:151], v43 offset:30528
ds_read_b64_tr_b16 v[152:153], v43 offset:29408
v_mfma_f32_16x16x32_bf16 v[200:203], v[100:103], v[72:75], v[200:203]
ds_read_b64_tr_b16 v[154:155], v43 offset:30560
ds_read_b64_tr_b16 v[156:157], v43 offset:29440
v_mfma_f32_16x16x32_bf16 v[204:207], v[100:103], v[76:79], v[204:207]
ds_read_b64_tr_b16 v[158:159], v43 offset:30592
v_mfma_f32_16x16x32_bf16 v[208:211], v[104:107], v[72:75], v[208:211]
v_mfma_f32_16x16x32_bf16 v[212:215], v[104:107], v[76:79], v[212:215]
v_mfma_f32_16x16x32_bf16 v[216:219], v[108:111], v[72:75], v[216:219]
v_mfma_f32_16x16x32_bf16 v[220:223], v[108:111], v[76:79], v[220:223]
v_mfma_f32_16x16x32_bf16 v[224:227], v[112:115], v[72:75], v[224:227]
v_mfma_f32_16x16x32_bf16 v[228:231], v[112:115], v[76:79], v[228:231]
s_waitcnt lgkmcnt(0)
v_mfma_f32_16x16x32_bf16 v[160:163], v[124:127], v[116:119], v[160:163]
ds_read_b128 v[72:75], v40 offset:0
ds_read_b128 v[76:79], v40 offset:512
v_mfma_f32_16x16x32_bf16 v[164:167], v[124:127], v[120:123], v[164:167]
ds_read_b64_tr_b16 v[80:81], v42 offset:0
ds_read_b64_tr_b16 v[82:83], v42 offset:1152
v_mfma_f32_16x16x32_bf16 v[168:171], v[128:131], v[116:119], v[168:171]
ds_read_b64_tr_b16 v[84:85], v42 offset:32
v_mfma_f32_16x16x32_bf16 v[172:175], v[128:131], v[120:123], v[172:175]
ds_read_b64_tr_b16 v[86:87], v42 offset:1184
ds_read_b64_tr_b16 v[88:89], v42 offset:64
v_mfma_f32_16x16x32_bf16 v[176:179], v[132:135], v[116:119], v[176:179]
ds_read_b64_tr_b16 v[90:91], v42 offset:1216
ds_read_b64_tr_b16 v[92:93], v42 offset:96
v_mfma_f32_16x16x32_bf16 v[180:183], v[132:135], v[120:123], v[180:183]
ds_read_b64_tr_b16 v[94:95], v42 offset:1248
v_mfma_f32_16x16x32_bf16 v[184:187], v[136:139], v[116:119], v[184:187]
ds_read_b64_tr_b16 v[96:97], v42 offset:128
ds_read_b64_tr_b16 v[98:99], v42 offset:1280
v_mfma_f32_16x16x32_bf16 v[188:191], v[136:139], v[120:123], v[188:191]
ds_read_b64_tr_b16 v[100:101], v42 offset:160
ds_read_b64_tr_b16 v[102:103], v42 offset:1312
v_mfma_f32_16x16x32_bf16 v[192:195], v[140:143], v[116:119], v[192:195]
ds_read_b64_tr_b16 v[104:105], v42 offset:192
v_mfma_f32_16x16x32_bf16 v[196:199], v[140:143], v[120:123], v[196:199]
ds_read_b64_tr_b16 v[106:107], v42 offset:1344
ds_read_b64_tr_b16 v[108:109], v42 offset:224
v_mfma_f32_16x16x32_bf16 v[200:203], v[144:147], v[116:119], v[200:203]
ds_read_b64_tr_b16 v[110:111], v42 offset:1376
ds_read_b64_tr_b16 v[112:113], v42 offset:256
v_mfma_f32_16x16x32_bf16 v[204:207], v[144:147], v[120:123], v[204:207]
ds_read_b64_tr_b16 v[114:115], v42 offset:1408
v_mfma_f32_16x16x32_bf16 v[208:211], v[148:151], v[116:119], v[208:211]
v_mfma_f32_16x16x32_bf16 v[212:215], v[148:151], v[120:123], v[212:215]
v_mfma_f32_16x16x32_bf16 v[216:219], v[152:155], v[116:119], v[216:219]
v_mfma_f32_16x16x32_bf16 v[220:223], v[152:155], v[120:123], v[220:223]
v_mfma_f32_16x16x32_bf16 v[224:227], v[156:159], v[116:119], v[224:227]
v_mfma_f32_16x16x32_bf16 v[228:231], v[156:159], v[120:123], v[228:231]
s_waitcnt lgkmcnt(0)
v_mfma_f32_16x16x32_bf16 v[160:163], v[80:83], v[72:75], v[160:163]
ds_read_b128 v[116:119], v41 offset:0
ds_read_b128 v[120:123], v41 offset:512
v_mfma_f32_16x16x32_bf16 v[164:167], v[80:83], v[76:79], v[164:167]
ds_read_b64_tr_b16 v[124:125], v42 offset:9728
ds_read_b64_tr_b16 v[126:127], v42 offset:10880
v_mfma_f32_16x16x32_bf16 v[168:171], v[84:87], v[72:75], v[168:171]
ds_read_b64_tr_b16 v[128:129], v42 offset:9760
v_mfma_f32_16x16x32_bf16 v[172:175], v[84:87], v[76:79], v[172:175]
ds_read_b64_tr_b16 v[130:131], v42 offset:10912
ds_read_b64_tr_b16 v[132:133], v42 offset:9792
v_mfma_f32_16x16x32_bf16 v[176:179], v[88:91], v[72:75], v[176:179]
ds_read_b64_tr_b16 v[134:135], v42 offset:10944
ds_read_b64_tr_b16 v[136:137], v42 offset:9824
v_mfma_f32_16x16x32_bf16 v[180:183], v[88:91], v[76:79], v[180:183]
ds_read_b64_tr_b16 v[138:139], v42 offset:10976
v_mfma_f32_16x16x32_bf16 v[184:187], v[92:95], v[72:75], v[184:187]
ds_read_b64_tr_b16 v[140:141], v42 offset:9856
ds_read_b64_tr_b16 v[142:143], v42 offset:11008
v_mfma_f32_16x16x32_bf16 v[188:191], v[92:95], v[76:79], v[188:191]
ds_read_b64_tr_b16 v[144:145], v42 offset:9888
ds_read_b64_tr_b16 v[146:147], v42 offset:11040
v_mfma_f32_16x16x32_bf16 v[192:195], v[96:99], v[72:75], v[192:195]
ds_read_b64_tr_b16 v[148:149], v42 offset:9920
v_mfma_f32_16x16x32_bf16 v[196:199], v[96:99], v[76:79], v[196:199]
ds_read_b64_tr_b16 v[150:151], v42 offset:11072
ds_read_b64_tr_b16 v[152:153], v42 offset:9952
v_mfma_f32_16x16x32_bf16 v[200:203], v[100:103], v[72:75], v[200:203]
ds_read_b64_tr_b16 v[154:155], v42 offset:11104
ds_read_b64_tr_b16 v[156:157], v42 offset:9984
v_mfma_f32_16x16x32_bf16 v[204:207], v[100:103], v[76:79], v[204:207]
ds_read_b64_tr_b16 v[158:159], v42 offset:11136
v_mfma_f32_16x16x32_bf16 v[208:211], v[104:107], v[72:75], v[208:211]
v_mfma_f32_16x16x32_bf16 v[212:215], v[104:107], v[76:79], v[212:215]
v_mfma_f32_16x16x32_bf16 v[216:219], v[108:111], v[72:75], v[216:219]
v_mfma_f32_16x16x32_bf16 v[220:223], v[108:111], v[76:79], v[220:223]
v_mfma_f32_16x16x32_bf16 v[224:227], v[112:115], v[72:75], v[224:227]
v_mfma_f32_16x16x32_bf16 v[228:231], v[112:115], v[76:79], v[228:231]
s_waitcnt lgkmcnt(0)
v_mfma_f32_16x16x32_bf16 v[160:163], v[124:127], v[116:119], v[160:163]
ds_read_b128 v[72:75], v40 offset:16384
ds_read_b128 v[76:79], v40 offset:16896
v_mfma_f32_16x16x32_bf16 v[164:167], v[124:127], v[120:123], v[164:167]
ds_read_b64_tr_b16 v[80:81], v42 offset:19456
ds_read_b64_tr_b16 v[82:83], v42 offset:20608
v_mfma_f32_16x16x32_bf16 v[168:171], v[128:131], v[116:119], v[168:171]
ds_read_b64_tr_b16 v[84:85], v42 offset:19488
v_mfma_f32_16x16x32_bf16 v[172:175], v[128:131], v[120:123], v[172:175]
ds_read_b64_tr_b16 v[86:87], v42 offset:20640
ds_read_b64_tr_b16 v[88:89], v42 offset:19520
v_mfma_f32_16x16x32_bf16 v[176:179], v[132:135], v[116:119], v[176:179]
ds_read_b64_tr_b16 v[90:91], v42 offset:20672
ds_read_b64_tr_b16 v[92:93], v42 offset:19552
v_mfma_f32_16x16x32_bf16 v[180:183], v[132:135], v[120:123], v[180:183]
ds_read_b64_tr_b16 v[94:95], v42 offset:20704
v_mfma_f32_16x16x32_bf16 v[184:187], v[136:139], v[116:119], v[184:187]
ds_read_b64_tr_b16 v[96:97], v42 offset:19584
ds_read_b64_tr_b16 v[98:99], v42 offset:20736
v_mfma_f32_16x16x32_bf16 v[188:191], v[136:139], v[120:123], v[188:191]
ds_read_b64_tr_b16 v[100:101], v42 offset:19616
ds_read_b64_tr_b16 v[102:103], v42 offset:20768
v_mfma_f32_16x16x32_bf16 v[192:195], v[140:143], v[116:119], v[192:195]
ds_read_b64_tr_b16 v[104:105], v42 offset:19648
v_mfma_f32_16x16x32_bf16 v[196:199], v[140:143], v[120:123], v[196:199]
ds_read_b64_tr_b16 v[106:107], v42 offset:20800
ds_read_b64_tr_b16 v[108:109], v42 offset:19680
v_mfma_f32_16x16x32_bf16 v[200:203], v[144:147], v[116:119], v[200:203]
ds_read_b64_tr_b16 v[110:111], v42 offset:20832
ds_read_b64_tr_b16 v[112:113], v42 offset:19712
v_mfma_f32_16x16x32_bf16 v[204:207], v[144:147], v[120:123], v[204:207]
ds_read_b64_tr_b16 v[114:115], v42 offset:20864
v_mfma_f32_16x16x32_bf16 v[208:211], v[148:151], v[116:119], v[208:211]
v_mfma_f32_16x16x32_bf16 v[212:215], v[148:151], v[120:123], v[212:215]
v_mfma_f32_16x16x32_bf16 v[216:219], v[152:155], v[116:119], v[216:219]
v_mfma_f32_16x16x32_bf16 v[220:223], v[152:155], v[120:123], v[220:223]
v_mfma_f32_16x16x32_bf16 v[224:227], v[156:159], v[116:119], v[224:227]
v_mfma_f32_16x16x32_bf16 v[228:231], v[156:159], v[120:123], v[228:231]
s_load_dwordx2 s[6:7], s[0:1], 96
s_waitcnt lgkmcnt(0)
v_mfma_f32_16x16x32_bf16 v[160:163], v[80:83], v[72:75], v[160:163]
ds_read_b128 v[116:119], v41 offset:16384
ds_read_b128 v[120:123], v41 offset:16896
v_mfma_f32_16x16x32_bf16 v[164:167], v[80:83], v[76:79], v[164:167]
ds_read_b64_tr_b16 v[124:125], v42 offset:29184
ds_read_b64_tr_b16 v[126:127], v42 offset:30336
v_mfma_f32_16x16x32_bf16 v[168:171], v[84:87], v[72:75], v[168:171]
ds_read_b64_tr_b16 v[128:129], v42 offset:29216
v_mfma_f32_16x16x32_bf16 v[172:175], v[84:87], v[76:79], v[172:175]
ds_read_b64_tr_b16 v[130:131], v42 offset:30368
ds_read_b64_tr_b16 v[132:133], v42 offset:29248
v_mfma_f32_16x16x32_bf16 v[176:179], v[88:91], v[72:75], v[176:179]
ds_read_b64_tr_b16 v[134:135], v42 offset:30400
ds_read_b64_tr_b16 v[136:137], v42 offset:29280
v_mfma_f32_16x16x32_bf16 v[180:183], v[88:91], v[76:79], v[180:183]
ds_read_b64_tr_b16 v[138:139], v42 offset:30432
v_mfma_f32_16x16x32_bf16 v[184:187], v[92:95], v[72:75], v[184:187]
ds_read_b64_tr_b16 v[140:141], v42 offset:29312
ds_read_b64_tr_b16 v[142:143], v42 offset:30464
v_mfma_f32_16x16x32_bf16 v[188:191], v[92:95], v[76:79], v[188:191]
ds_read_b64_tr_b16 v[144:145], v42 offset:29344
ds_read_b64_tr_b16 v[146:147], v42 offset:30496
v_mfma_f32_16x16x32_bf16 v[192:195], v[96:99], v[72:75], v[192:195]
ds_read_b64_tr_b16 v[148:149], v42 offset:29376
v_mfma_f32_16x16x32_bf16 v[196:199], v[96:99], v[76:79], v[196:199]
ds_read_b64_tr_b16 v[150:151], v42 offset:30528
ds_read_b64_tr_b16 v[152:153], v42 offset:29408
v_mfma_f32_16x16x32_bf16 v[200:203], v[100:103], v[72:75], v[200:203]
ds_read_b64_tr_b16 v[154:155], v42 offset:30560
ds_read_b64_tr_b16 v[156:157], v42 offset:29440
v_mfma_f32_16x16x32_bf16 v[204:207], v[100:103], v[76:79], v[204:207]
ds_read_b64_tr_b16 v[158:159], v42 offset:30592
v_mfma_f32_16x16x32_bf16 v[208:211], v[104:107], v[72:75], v[208:211]
v_mfma_f32_16x16x32_bf16 v[212:215], v[104:107], v[76:79], v[212:215]
v_mfma_f32_16x16x32_bf16 v[216:219], v[108:111], v[72:75], v[216:219]
v_mfma_f32_16x16x32_bf16 v[220:223], v[108:111], v[76:79], v[220:223]
v_mfma_f32_16x16x32_bf16 v[224:227], v[112:115], v[72:75], v[224:227]
v_mfma_f32_16x16x32_bf16 v[228:231], v[112:115], v[76:79], v[228:231]
s_waitcnt lgkmcnt(0)
s_barrier
v_mfma_f32_16x16x32_bf16 v[160:163], v[124:127], v[116:119], v[160:163]
v_mfma_f32_16x16x32_bf16 v[164:167], v[124:127], v[120:123], v[164:167]
v_mfma_f32_16x16x32_bf16 v[168:171], v[128:131], v[116:119], v[168:171]
v_mfma_f32_16x16x32_bf16 v[172:175], v[128:131], v[120:123], v[172:175]
v_mfma_f32_16x16x32_bf16 v[176:179], v[132:135], v[116:119], v[176:179]
v_mfma_f32_16x16x32_bf16 v[180:183], v[132:135], v[120:123], v[180:183]
v_mfma_f32_16x16x32_bf16 v[184:187], v[136:139], v[116:119], v[184:187]
v_mfma_f32_16x16x32_bf16 v[188:191], v[136:139], v[120:123], v[188:191]
v_mfma_f32_16x16x32_bf16 v[192:195], v[140:143], v[116:119], v[192:195]
v_mfma_f32_16x16x32_bf16 v[196:199], v[140:143], v[120:123], v[196:199]
v_mfma_f32_16x16x32_bf16 v[200:203], v[144:147], v[116:119], v[200:203]
v_mfma_f32_16x16x32_bf16 v[204:207], v[144:147], v[120:123], v[204:207]
v_mfma_f32_16x16x32_bf16 v[208:211], v[148:151], v[116:119], v[208:211]
v_mfma_f32_16x16x32_bf16 v[212:215], v[148:151], v[120:123], v[212:215]
v_mfma_f32_16x16x32_bf16 v[216:219], v[152:155], v[116:119], v[216:219]
v_mfma_f32_16x16x32_bf16 v[220:223], v[152:155], v[120:123], v[220:223]
v_mfma_f32_16x16x32_bf16 v[224:227], v[156:159], v[116:119], v[224:227]
v_mfma_f32_16x16x32_bf16 v[228:231], v[156:159], v[120:123], v[228:231]
s_mov_b32 s20, s6
s_and_b32 s21, s7, 0xffff
s_mov_b32 s22, 4096
s_mov_b32 s23, 0x20000
ds_read_b64 v[246:247], v44 offset:0
ds_read_b64 v[248:249], v44 offset:32
v_mov_b32 v73, v251
v_mov_b32 v74, v252
v_mov_b32 v75, v253
v_lshrrev_b32 v77, 2, v73
v_lshrrev_b32 v78, 3, v44
s_lshl_b32 s31, s26, 7
v_add_lshl_u32 v79, v78, s31, 1
v_mov_b32 v252, v254
buffer_load_ushort v253, v79, s[20:23], 0 offen
buffer_load_ushort v254, v79, s[20:23], 0 offen offset:8
v_bfe_u32 v80, v73, 1, 1
v_lshl_add_u32 v80, v77, 1, v80
v_xor_b32 v80, v80, v74
v_lshlrev_b32 v80, 4, v80
v_lshl_add_u32 v240, v78, 7, v80
v_add_u32 v240, 18688, v240
v_xor_b32 v241, 64, v240
v_add_u32 v242, 35072, v75
v_add_u32 v243, 69632, v240
v_add_u32 v244, 69632, v241
v_add_u32 v245, 69632, v242
v_lshlrev_b32 v250, 4, v74
s_add_u32 s12, s8, 18874368
s_addc_u32 s13, s9, 0
s_and_b32 s13, s13, 0xffff
s_mov_b32 s14, 9437184
s_mov_b32 s15, 0x20000
ds_read_b128 v[236:239], v250 offset:1600
s_waitcnt lgkmcnt(0)
v_fma_f32 v160, -v247, v236, v160
v_fma_f32 v161, -v247, v237, v161
v_fma_f32 v162, -v247, v238, v162
v_fma_f32 v163, -v247, v239, v163
v_fma_f32 v164, -v249, v236, v164
v_fma_f32 v165, -v249, v237, v165
v_fma_f32 v166, -v249, v238, v166
v_fma_f32 v167, -v249, v239, v167
v_mul_f32 v160, v160, v246
v_mul_f32 v161, v161, v246
v_mul_f32 v162, v162, v246
v_mul_f32 v163, v163, v246
v_mul_f32 v232, v160, v160
v_mul_f32 v233, v161, v161
v_mul_f32 v234, v162, v162
v_mul_f32 v235, v163, v163
v_fma_f32 v232, v232, s60, v252
v_fma_f32 v233, v233, s60, v252
v_fma_f32 v234, v234, s60, v252
v_fma_f32 v235, v235, s60, v252
v_mul_f32 v232, v232, v160
v_mul_f32 v233, v233, v161
v_mul_f32 v234, v234, v162
v_mul_f32 v235, v235, v163
v_exp_f32 v232, v232
v_exp_f32 v233, v233
v_exp_f32 v234, v234
v_exp_f32 v235, v235
v_add_f32 v232, 1.0, v232
v_add_f32 v233, 1.0, v233
v_add_f32 v234, 1.0, v234
v_add_f32 v235, 1.0, v235
v_rcp_f32 v232, v232
v_rcp_f32 v233, v233
v_rcp_f32 v234, v234
v_rcp_f32 v235, v235
v_mul_f32 v160, v160, v232
v_mul_f32 v161, v161, v233
v_mul_f32 v162, v162, v234
v_mul_f32 v163, v163, v235
v_mul_f32 v164, v164, v248
v_mul_f32 v165, v165, v248
v_mul_f32 v166, v166, v248
v_mul_f32 v167, v167, v248
v_mul_f32 v232, v164, v164
v_mul_f32 v233, v165, v165
v_mul_f32 v234, v166, v166
v_mul_f32 v235, v167, v167
v_fma_f32 v232, v232, s60, v252
v_fma_f32 v233, v233, s60, v252
v_fma_f32 v234, v234, s60, v252
v_fma_f32 v235, v235, s60, v252
v_mul_f32 v232, v232, v164
v_mul_f32 v233, v233, v165
v_mul_f32 v234, v234, v166
v_mul_f32 v235, v235, v167
v_exp_f32 v232, v232
v_exp_f32 v233, v233
v_exp_f32 v234, v234
v_exp_f32 v235, v235
v_add_f32 v232, 1.0, v232
v_add_f32 v233, 1.0, v233
v_add_f32 v234, 1.0, v234
v_add_f32 v235, 1.0, v235
v_rcp_f32 v232, v232
v_rcp_f32 v233, v233
v_rcp_f32 v234, v234
v_rcp_f32 v235, v235
v_mul_f32 v164, v164, v232
v_mul_f32 v165, v165, v233
v_mul_f32 v166, v166, v234
v_mul_f32 v167, v167, v235
ds_read_b128 v[236:239], v250 offset:1664
s_waitcnt lgkmcnt(0)
v_fma_f32 v168, -v247, v236, v168
v_fma_f32 v169, -v247, v237, v169
v_fma_f32 v170, -v247, v238, v170
v_fma_f32 v171, -v247, v239, v171
v_fma_f32 v172, -v249, v236, v172
v_fma_f32 v173, -v249, v237, v173
v_fma_f32 v174, -v249, v238, v174
v_fma_f32 v175, -v249, v239, v175
v_mul_f32 v168, v168, v246
v_mul_f32 v169, v169, v246
v_mul_f32 v170, v170, v246
v_mul_f32 v171, v171, v246
v_mul_f32 v232, v168, v168
v_mul_f32 v233, v169, v169
v_mul_f32 v234, v170, v170
v_mul_f32 v235, v171, v171
v_fma_f32 v232, v232, s60, v252
v_fma_f32 v233, v233, s60, v252
v_fma_f32 v234, v234, s60, v252
v_fma_f32 v235, v235, s60, v252
v_mul_f32 v232, v232, v168
v_mul_f32 v233, v233, v169
v_mul_f32 v234, v234, v170
v_mul_f32 v235, v235, v171
v_exp_f32 v232, v232
v_exp_f32 v233, v233
v_exp_f32 v234, v234
v_exp_f32 v235, v235
v_add_f32 v232, 1.0, v232
v_add_f32 v233, 1.0, v233
v_add_f32 v234, 1.0, v234
v_add_f32 v235, 1.0, v235
v_rcp_f32 v232, v232
v_rcp_f32 v233, v233
v_rcp_f32 v234, v234
v_rcp_f32 v235, v235
v_mul_f32 v168, v168, v232
v_mul_f32 v169, v169, v233
v_mul_f32 v170, v170, v234
v_mul_f32 v171, v171, v235
v_mul_f32 v172, v172, v248
v_mul_f32 v173, v173, v248
v_mul_f32 v174, v174, v248
v_mul_f32 v175, v175, v248
v_mul_f32 v232, v172, v172
v_mul_f32 v233, v173, v173
v_mul_f32 v234, v174, v174
v_mul_f32 v235, v175, v175
v_fma_f32 v232, v232, s60, v252
v_fma_f32 v233, v233, s60, v252
v_fma_f32 v234, v234, s60, v252
v_fma_f32 v235, v235, s60, v252
v_mul_f32 v232, v232, v172
v_mul_f32 v233, v233, v173
v_mul_f32 v234, v234, v174
v_mul_f32 v235, v235, v175
v_exp_f32 v232, v232
v_exp_f32 v233, v233
v_exp_f32 v234, v234
v_exp_f32 v235, v235
v_add_f32 v232, 1.0, v232
v_add_f32 v233, 1.0, v233
v_add_f32 v234, 1.0, v234
v_add_f32 v235, 1.0, v235
v_rcp_f32 v232, v232
v_rcp_f32 v233, v233
v_rcp_f32 v234, v234
v_rcp_f32 v235, v235
v_mul_f32 v172, v172, v232
v_mul_f32 v173, v173, v233
v_mul_f32 v174, v174, v234
v_mul_f32 v175, v175, v235
s_barrier
s_waitcnt vmcnt(0)
v_lshlrev_b32 v253, 16, v253
v_lshlrev_b32 v254, 16, v254
v_mov_b32 v0, v253
v_mov_b32 v1, v253
v_mov_b32 v2, v253
v_mov_b32 v3, v253
v_mov_b32 v4, v253
v_mov_b32 v5, v253
v_mov_b32 v6, v253
v_mov_b32 v7, v253
v_mov_b32 v8, v253
v_mov_b32 v9, v253
v_mov_b32 v10, v253
v_mov_b32 v11, v253
v_mov_b32 v12, v253
v_mov_b32 v13, v253
v_mov_b32 v14, v253
v_mov_b32 v15, v253
v_mov_b32 v16, v253
v_mov_b32 v17, v253
v_mov_b32 v18, v253
v_mov_b32 v19, v253
v_mov_b32 v20, v253
v_mov_b32 v21, v253
v_mov_b32 v22, v253
v_mov_b32 v23, v253
v_mov_b32 v24, v253
v_mov_b32 v25, v253
v_mov_b32 v26, v253
v_mov_b32 v27, v253
v_mov_b32 v28, v253
v_mov_b32 v29, v253
v_mov_b32 v30, v253
v_mov_b32 v31, v253
v_mov_b32 v32, v253
v_mov_b32 v33, v253
v_mov_b32 v34, v253
v_mov_b32 v35, v253
v_mov_b32 v36, v254
v_mov_b32 v37, v254
v_mov_b32 v38, v254
v_mov_b32 v39, v254
v_mov_b32 v40, v254
v_mov_b32 v41, v254
v_mov_b32 v42, v254
v_mov_b32 v43, v254
v_mov_b32 v44, v254
v_mov_b32 v45, v254
v_mov_b32 v46, v254
v_mov_b32 v47, v254
v_mov_b32 v48, v254
v_mov_b32 v49, v254
v_mov_b32 v50, v254
v_mov_b32 v51, v254
v_mov_b32 v52, v254
v_mov_b32 v53, v254
v_mov_b32 v54, v254
v_mov_b32 v55, v254
v_mov_b32 v56, v254
v_mov_b32 v57, v254
v_mov_b32 v58, v254
v_mov_b32 v59, v254
v_mov_b32 v60, v254
v_mov_b32 v61, v254
v_mov_b32 v62, v254
v_mov_b32 v63, v254
v_mov_b32 v64, v254
v_mov_b32 v65, v254
v_mov_b32 v66, v254
v_mov_b32 v67, v254
v_mov_b32 v68, v254
v_mov_b32 v69, v254
v_mov_b32 v70, v254
v_mov_b32 v71, v254
ds_read_b128 v[236:239], v250 offset:1728
s_waitcnt lgkmcnt(0)
v_fma_f32 v176, -v247, v236, v176
v_fma_f32 v177, -v247, v237, v177
v_fma_f32 v178, -v247, v238, v178
v_fma_f32 v179, -v247, v239, v179
v_fma_f32 v180, -v249, v236, v180
v_fma_f32 v181, -v249, v237, v181
v_fma_f32 v182, -v249, v238, v182
v_fma_f32 v183, -v249, v239, v183
v_mul_f32 v176, v176, v246
v_mul_f32 v177, v177, v246
v_mul_f32 v178, v178, v246
v_mul_f32 v179, v179, v246
v_mul_f32 v232, v176, v176
v_mul_f32 v233, v177, v177
v_mul_f32 v234, v178, v178
v_mul_f32 v235, v179, v179
v_fma_f32 v232, v232, s60, v252
v_fma_f32 v233, v233, s60, v252
v_fma_f32 v234, v234, s60, v252
v_fma_f32 v235, v235, s60, v252
v_mul_f32 v232, v232, v176
v_mul_f32 v233, v233, v177
v_mul_f32 v234, v234, v178
v_mul_f32 v235, v235, v179
v_exp_f32 v232, v232
v_exp_f32 v233, v233
v_exp_f32 v234, v234
v_exp_f32 v235, v235
v_add_f32 v232, 1.0, v232
v_add_f32 v233, 1.0, v233
v_add_f32 v234, 1.0, v234
v_add_f32 v235, 1.0, v235
v_rcp_f32 v232, v232
v_rcp_f32 v233, v233
v_rcp_f32 v234, v234
v_rcp_f32 v235, v235
v_mul_f32 v176, v176, v232
v_mul_f32 v177, v177, v233
v_mul_f32 v178, v178, v234
v_mul_f32 v179, v179, v235
v_mul_f32 v180, v180, v248
v_mul_f32 v181, v181, v248
v_mul_f32 v182, v182, v248
v_mul_f32 v183, v183, v248
v_mul_f32 v232, v180, v180
v_mul_f32 v233, v181, v181
v_mul_f32 v234, v182, v182
v_mul_f32 v235, v183, v183
v_fma_f32 v232, v232, s60, v252
v_fma_f32 v233, v233, s60, v252
v_fma_f32 v234, v234, s60, v252
v_fma_f32 v235, v235, s60, v252
v_mul_f32 v232, v232, v180
v_mul_f32 v233, v233, v181
v_mul_f32 v234, v234, v182
v_mul_f32 v235, v235, v183
v_exp_f32 v232, v232
v_exp_f32 v233, v233
v_exp_f32 v234, v234
v_exp_f32 v235, v235
v_add_f32 v232, 1.0, v232
v_add_f32 v233, 1.0, v233
v_add_f32 v234, 1.0, v234
v_add_f32 v235, 1.0, v235
v_rcp_f32 v232, v232
v_rcp_f32 v233, v233
v_rcp_f32 v234, v234
v_rcp_f32 v235, v235
v_mul_f32 v180, v180, v232
v_mul_f32 v181, v181, v233
v_mul_f32 v182, v182, v234
v_mul_f32 v183, v183, v235
s_setprio 2
s_barrier
s_barrier
ds_read_b128 v[72:75], v240 offset:0
ds_read_b128 v[76:79], v240 offset:512
ds_read_b128 v[80:83], v242 offset:0
ds_read_b128 v[84:87], v242 offset:1024
ds_read_b128 v[88:91], v242 offset:2048
ds_read_b128 v[92:95], v242 offset:3072
ds_read_b128 v[96:99], v242 offset:4096
ds_read_b128 v[100:103], v242 offset:5120
ds_read_b128 v[104:107], v242 offset:6144
ds_read_b128 v[108:111], v242 offset:7168
ds_read_b128 v[112:115], v242 offset:8192
s_waitcnt lgkmcnt(0)
v_mfma_f32_16x16x32_bf16 v[0:3], v[80:83], v[72:75], v[0:3]
ds_read_b128 v[124:127], v242 offset:9216
v_mfma_f32_16x16x32_bf16 v[36:39], v[80:83], v[76:79], v[36:39]
ds_read_b128 v[116:119], v241 offset:0
v_mfma_f32_16x16x32_bf16 v[4:7], v[84:87], v[72:75], v[4:7]
ds_read_b128 v[128:131], v242 offset:10240
v_mfma_f32_16x16x32_bf16 v[40:43], v[84:87], v[76:79], v[40:43]
ds_read_b128 v[120:123], v241 offset:512
v_mfma_f32_16x16x32_bf16 v[8:11], v[88:91], v[72:75], v[8:11]
ds_read_b128 v[132:135], v242 offset:11264
v_mfma_f32_16x16x32_bf16 v[44:47], v[88:91], v[76:79], v[44:47]
ds_read_b128 v[136:139], v242 offset:12288
v_mfma_f32_16x16x32_bf16 v[12:15], v[92:95], v[72:75], v[12:15]
ds_read_b128 v[140:143], v242 offset:13312
v_mfma_f32_16x16x32_bf16 v[48:51], v[92:95], v[76:79], v[48:51]
ds_read_b128 v[144:147], v242 offset:14336
v_mfma_f32_16x16x32_bf16 v[16:19], v[96:99], v[72:75], v[16:19]
ds_read_b128 v[148:151], v242 offset:15360
v_mfma_f32_16x16x32_bf16 v[52:55], v[96:99], v[76:79], v[52:55]
ds_read_b128 v[152:155], v242 offset:16384
v_mfma_f32_16x16x32_bf16 v[20:23], v[100:103], v[72:75], v[20:23]
ds_read_b128 v[156:159], v242 offset:17408
v_mfma_f32_16x16x32_bf16 v[56:59], v[100:103], v[76:79], v[56:59]
v_mfma_f32_16x16x32_bf16 v[24:27], v[104:107], v[72:75], v[24:27]
v_mfma_f32_16x16x32_bf16 v[60:63], v[104:107], v[76:79], v[60:63]
v_mfma_f32_16x16x32_bf16 v[28:31], v[108:111], v[72:75], v[28:31]
v_mfma_f32_16x16x32_bf16 v[64:67], v[108:111], v[76:79], v[64:67]
v_mfma_f32_16x16x32_bf16 v[32:35], v[112:115], v[72:75], v[32:35]
v_mfma_f32_16x16x32_bf16 v[68:71], v[112:115], v[76:79], v[68:71]
s_waitcnt lgkmcnt(0)
s_barrier
v_mfma_f32_16x16x32_bf16 v[0:3], v[124:127], v[116:119], v[0:3]
ds_read_b128 v[80:83], v242 offset:34816
v_mfma_f32_16x16x32_bf16 v[36:39], v[124:127], v[120:123], v[36:39]
ds_read_b128 v[72:75], v240 offset:34816
v_mfma_f32_16x16x32_bf16 v[4:7], v[128:131], v[116:119], v[4:7]
ds_read_b128 v[84:87], v242 offset:35840
v_mfma_f32_16x16x32_bf16 v[40:43], v[128:131], v[120:123], v[40:43]
ds_read_b128 v[76:79], v240 offset:35328
v_mfma_f32_16x16x32_bf16 v[8:11], v[132:135], v[116:119], v[8:11]
ds_read_b128 v[88:91], v242 offset:36864
v_mfma_f32_16x16x32_bf16 v[44:47], v[132:135], v[120:123], v[44:47]
ds_read_b128 v[92:95], v242 offset:37888
v_mfma_f32_16x16x32_bf16 v[12:15], v[136:139], v[116:119], v[12:15]
ds_read_b128 v[96:99], v242 offset:38912
ds_read_b128 v[236:239], v250 offset:1792
v_mfma_f32_16x16x32_bf16 v[48:51], v[136:139], v[120:123], v[48:51]
ds_read_b128 v[100:103], v242 offset:39936
v_mfma_f32_16x16x32_bf16 v[16:19], v[140:143], v[116:119], v[16:19]
ds_read_b128 v[104:107], v242 offset:40960
v_mfma_f32_16x16x32_bf16 v[52:55], v[140:143], v[120:123], v[52:55]
ds_read_b128 v[108:111], v242 offset:41984
v_mfma_f32_16x16x32_bf16 v[20:23], v[144:147], v[116:119], v[20:23]
ds_read_b128 v[112:115], v242 offset:43008
v_mfma_f32_16x16x32_bf16 v[56:59], v[144:147], v[120:123], v[56:59]
v_mfma_f32_16x16x32_bf16 v[24:27], v[148:151], v[116:119], v[24:27]
v_mfma_f32_16x16x32_bf16 v[60:63], v[148:151], v[120:123], v[60:63]
v_mfma_f32_16x16x32_bf16 v[28:31], v[152:155], v[116:119], v[28:31]
v_mfma_f32_16x16x32_bf16 v[64:67], v[152:155], v[120:123], v[64:67]
v_mfma_f32_16x16x32_bf16 v[32:35], v[156:159], v[116:119], v[32:35]
v_mfma_f32_16x16x32_bf16 v[68:71], v[156:159], v[120:123], v[68:71]
s_waitcnt lgkmcnt(0)
v_mfma_f32_16x16x32_bf16 v[0:3], v[80:83], v[72:75], v[0:3]
ds_read_b128 v[124:127], v242 offset:44032
v_mfma_f32_16x16x32_bf16 v[36:39], v[80:83], v[76:79], v[36:39]
ds_read_b128 v[116:119], v241 offset:34816
v_mfma_f32_16x16x32_bf16 v[4:7], v[84:87], v[72:75], v[4:7]
ds_read_b128 v[128:131], v242 offset:45056
v_mfma_f32_16x16x32_bf16 v[40:43], v[84:87], v[76:79], v[40:43]
ds_read_b128 v[120:123], v241 offset:35328
v_mfma_f32_16x16x32_bf16 v[8:11], v[88:91], v[72:75], v[8:11]
ds_read_b128 v[132:135], v242 offset:46080
v_mfma_f32_16x16x32_bf16 v[44:47], v[88:91], v[76:79], v[44:47]
ds_read_b128 v[136:139], v242 offset:47104
v_mfma_f32_16x16x32_bf16 v[12:15], v[92:95], v[72:75], v[12:15]
ds_read_b128 v[140:143], v242 offset:48128
v_fma_f32 v184, -v247, v236, v184
v_mfma_f32_16x16x32_bf16 v[48:51], v[92:95], v[76:79], v[48:51]
ds_read_b128 v[144:147], v242 offset:49152
v_fma_f32 v185, -v247, v237, v185
v_mfma_f32_16x16x32_bf16 v[16:19], v[96:99], v[72:75], v[16:19]
ds_read_b128 v[148:151], v242 offset:50176
v_fma_f32 v186, -v247, v238, v186
v_mfma_f32_16x16x32_bf16 v[52:55], v[96:99], v[76:79], v[52:55]
ds_read_b128 v[152:155], v242 offset:51200
v_mfma_f32_16x16x32_bf16 v[20:23], v[100:103], v[72:75], v[20:23]
ds_read_b128 v[156:159], v242 offset:52224
v_fma_f32 v187, -v247, v239, v187
v_mfma_f32_16x16x32_bf16 v[56:59], v[100:103], v[76:79], v[56:59]
v_fma_f32 v188, -v249, v236, v188
v_mfma_f32_16x16x32_bf16 v[24:27], v[104:107], v[72:75], v[24:27]
v_fma_f32 v189, -v249, v237, v189
v_mfma_f32_16x16x32_bf16 v[60:63], v[104:107], v[76:79], v[60:63]
v_mfma_f32_16x16x32_bf16 v[28:31], v[108:111], v[72:75], v[28:31]
v_fma_f32 v190, -v249, v238, v190
v_mfma_f32_16x16x32_bf16 v[64:67], v[108:111], v[76:79], v[64:67]
v_fma_f32 v191, -v249, v239, v191
v_mfma_f32_16x16x32_bf16 v[32:35], v[112:115], v[72:75], v[32:35]
v_mul_f32 v184, v184, v246
v_mfma_f32_16x16x32_bf16 v[68:71], v[112:115], v[76:79], v[68:71]
s_waitcnt lgkmcnt(0)
s_barrier
v_mfma_f32_16x16x32_bf16 v[0:3], v[124:127], v[116:119], v[0:3]
ds_read_b128 v[80:83], v245 offset:0
v_mfma_f32_16x16x32_bf16 v[36:39], v[124:127], v[120:123], v[36:39]
ds_read_b128 v[72:75], v243 offset:0
v_mfma_f32_16x16x32_bf16 v[4:7], v[128:131], v[116:119], v[4:7]
ds_read_b128 v[84:87], v245 offset:1024
v_mfma_f32_16x16x32_bf16 v[40:43], v[128:131], v[120:123], v[40:43]
ds_read_b128 v[76:79], v243 offset:512
v_mfma_f32_16x16x32_bf16 v[8:11], v[132:135], v[116:119], v[8:11]
ds_read_b128 v[88:91], v245 offset:2048
v_mfma_f32_16x16x32_bf16 v[44:47], v[132:135], v[120:123], v[44:47]
ds_read_b128 v[92:95], v245 offset:3072
v_mfma_f32_16x16x32_bf16 v[12:15], v[136:139], v[116:119], v[12:15]
ds_read_b128 v[96:99], v245 offset:4096
v_mul_f32 v185, v185, v246
v_mfma_f32_16x16x32_bf16 v[48:51], v[136:139], v[120:123], v[48:51]
ds_read_b128 v[100:103], v245 offset:5120
v_mul_f32 v186, v186, v246
v_mfma_f32_16x16x32_bf16 v[16:19], v[140:143], v[116:119], v[16:19]
ds_read_b128 v[104:107], v245 offset:6144
v_mul_f32 v187, v187, v246
v_mfma_f32_16x16x32_bf16 v[52:55], v[140:143], v[120:123], v[52:55]
ds_read_b128 v[108:111], v245 offset:7168
v_mfma_f32_16x16x32_bf16 v[20:23], v[144:147], v[116:119], v[20:23]
ds_read_b128 v[112:115], v245 offset:8192
v_mul_f32 v232, v184, v184
v_mfma_f32_16x16x32_bf16 v[56:59], v[144:147], v[120:123], v[56:59]
v_mul_f32 v233, v185, v185
v_mfma_f32_16x16x32_bf16 v[24:27], v[148:151], v[116:119], v[24:27]
v_mul_f32 v234, v186, v186
v_mfma_f32_16x16x32_bf16 v[60:63], v[148:151], v[120:123], v[60:63]
v_mfma_f32_16x16x32_bf16 v[28:31], v[152:155], v[116:119], v[28:31]
v_mul_f32 v235, v187, v187
v_mfma_f32_16x16x32_bf16 v[64:67], v[152:155], v[120:123], v[64:67]
v_fma_f32 v232, v232, s60, v252
v_mfma_f32_16x16x32_bf16 v[32:35], v[156:159], v[116:119], v[32:35]
v_fma_f32 v233, v233, s60, v252
v_mfma_f32_16x16x32_bf16 v[68:71], v[156:159], v[120:123], v[68:71]
s_waitcnt lgkmcnt(0)
v_mfma_f32_16x16x32_bf16 v[0:3], v[80:83], v[72:75], v[0:3]
ds_read_b128 v[124:127], v245 offset:9216
v_mfma_f32_16x16x32_bf16 v[36:39], v[80:83], v[76:79], v[36:39]
ds_read_b128 v[116:119], v244 offset:0
v_mfma_f32_16x16x32_bf16 v[4:7], v[84:87], v[72:75], v[4:7]
ds_read_b128 v[128:131], v245 offset:10240
v_mfma_f32_16x16x32_bf16 v[40:43], v[84:87], v[76:79], v[40:43]
ds_read_b128 v[120:123], v244 offset:512
v_mfma_f32_16x16x32_bf16 v[8:11], v[88:91], v[72:75], v[8:11]
ds_read_b128 v[132:135], v245 offset:11264
v_mfma_f32_16x16x32_bf16 v[44:47], v[88:91], v[76:79], v[44:47]
ds_read_b128 v[136:139], v245 offset:12288
v_mfma_f32_16x16x32_bf16 v[12:15], v[92:95], v[72:75], v[12:15]
ds_read_b128 v[140:143], v245 offset:13312
v_fma_f32 v234, v234, s60, v252
v_mfma_f32_16x16x32_bf16 v[48:51], v[92:95], v[76:79], v[48:51]
ds_read_b128 v[144:147], v245 offset:14336
v_fma_f32 v235, v235, s60, v252
v_mfma_f32_16x16x32_bf16 v[16:19], v[96:99], v[72:75], v[16:19]
ds_read_b128 v[148:151], v245 offset:15360
v_mul_f32 v232, v232, v184
v_mfma_f32_16x16x32_bf16 v[52:55], v[96:99], v[76:79], v[52:55]
ds_read_b128 v[152:155], v245 offset:16384
v_mfma_f32_16x16x32_bf16 v[20:23], v[100:103], v[72:75], v[20:23]
ds_read_b128 v[156:159], v245 offset:17408
v_mul_f32 v233, v233, v185
v_mfma_f32_16x16x32_bf16 v[56:59], v[100:103], v[76:79], v[56:59]
v_mul_f32 v234, v234, v186
v_mfma_f32_16x16x32_bf16 v[24:27], v[104:107], v[72:75], v[24:27]
v_mul_f32 v235, v235, v187
v_mfma_f32_16x16x32_bf16 v[60:63], v[104:107], v[76:79], v[60:63]
v_mfma_f32_16x16x32_bf16 v[28:31], v[108:111], v[72:75], v[28:31]
v_exp_f32 v232, v232
v_mfma_f32_16x16x32_bf16 v[64:67], v[108:111], v[76:79], v[64:67]
v_exp_f32 v233, v233
v_mfma_f32_16x16x32_bf16 v[32:35], v[112:115], v[72:75], v[32:35]
v_exp_f32 v234, v234
v_mfma_f32_16x16x32_bf16 v[68:71], v[112:115], v[76:79], v[68:71]
s_waitcnt lgkmcnt(0)
s_barrier
v_mfma_f32_16x16x32_bf16 v[0:3], v[124:127], v[116:119], v[0:3]
ds_read_b128 v[80:83], v245 offset:34816
v_mfma_f32_16x16x32_bf16 v[36:39], v[124:127], v[120:123], v[36:39]
ds_read_b128 v[72:75], v243 offset:34816
v_mfma_f32_16x16x32_bf16 v[4:7], v[128:131], v[116:119], v[4:7]
ds_read_b128 v[84:87], v245 offset:35840
v_mfma_f32_16x16x32_bf16 v[40:43], v[128:131], v[120:123], v[40:43]
ds_read_b128 v[76:79], v243 offset:35328
v_mfma_f32_16x16x32_bf16 v[8:11], v[132:135], v[116:119], v[8:11]
ds_read_b128 v[88:91], v245 offset:36864
v_mfma_f32_16x16x32_bf16 v[44:47], v[132:135], v[120:123], v[44:47]
ds_read_b128 v[92:95], v245 offset:37888
v_mfma_f32_16x16x32_bf16 v[12:15], v[136:139], v[116:119], v[12:15]
ds_read_b128 v[96:99], v245 offset:38912
v_exp_f32 v235, v235
v_mfma_f32_16x16x32_bf16 v[48:51], v[136:139], v[120:123], v[48:51]
ds_read_b128 v[100:103], v245 offset:39936
v_add_f32 v232, 1.0, v232
v_mfma_f32_16x16x32_bf16 v[16:19], v[140:143], v[116:119], v[16:19]
ds_read_b128 v[104:107], v245 offset:40960
v_add_f32 v233, 1.0, v233
v_mfma_f32_16x16x32_bf16 v[52:55], v[140:143], v[120:123], v[52:55]
ds_read_b128 v[108:111], v245 offset:41984
v_mfma_f32_16x16x32_bf16 v[20:23], v[144:147], v[116:119], v[20:23]
ds_read_b128 v[112:115], v245 offset:43008
v_add_f32 v234, 1.0, v234
v_mfma_f32_16x16x32_bf16 v[56:59], v[144:147], v[120:123], v[56:59]
v_add_f32 v235, 1.0, v235
v_mfma_f32_16x16x32_bf16 v[24:27], v[148:151], v[116:119], v[24:27]
v_rcp_f32 v232, v232
v_mfma_f32_16x16x32_bf16 v[60:63], v[148:151], v[120:123], v[60:63]
v_mfma_f32_16x16x32_bf16 v[28:31], v[152:155], v[116:119], v[28:31]
v_rcp_f32 v233, v233
v_mfma_f32_16x16x32_bf16 v[64:67], v[152:155], v[120:123], v[64:67]
v_rcp_f32 v234, v234
v_mfma_f32_16x16x32_bf16 v[32:35], v[156:159], v[116:119], v[32:35]
v_rcp_f32 v235, v235
v_mfma_f32_16x16x32_bf16 v[68:71], v[156:159], v[120:123], v[68:71]
s_waitcnt lgkmcnt(0)
v_mfma_f32_16x16x32_bf16 v[0:3], v[80:83], v[72:75], v[0:3]
ds_read_b128 v[124:127], v245 offset:44032
v_mfma_f32_16x16x32_bf16 v[36:39], v[80:83], v[76:79], v[36:39]
ds_read_b128 v[116:119], v244 offset:34816
v_mfma_f32_16x16x32_bf16 v[4:7], v[84:87], v[72:75], v[4:7]
ds_read_b128 v[128:131], v245 offset:45056
v_mfma_f32_16x16x32_bf16 v[40:43], v[84:87], v[76:79], v[40:43]
ds_read_b128 v[120:123], v244 offset:35328
v_mfma_f32_16x16x32_bf16 v[8:11], v[88:91], v[72:75], v[8:11]
ds_read_b128 v[132:135], v245 offset:46080
v_mfma_f32_16x16x32_bf16 v[44:47], v[88:91], v[76:79], v[44:47]
ds_read_b128 v[136:139], v245 offset:47104
v_mfma_f32_16x16x32_bf16 v[12:15], v[92:95], v[72:75], v[12:15]
ds_read_b128 v[140:143], v245 offset:48128
v_mul_f32 v184, v184, v232
v_mfma_f32_16x16x32_bf16 v[48:51], v[92:95], v[76:79], v[48:51]
ds_read_b128 v[144:147], v245 offset:49152
v_mul_f32 v185, v185, v233
v_mfma_f32_16x16x32_bf16 v[16:19], v[96:99], v[72:75], v[16:19]
ds_read_b128 v[148:151], v245 offset:50176
v_mul_f32 v186, v186, v234
v_mfma_f32_16x16x32_bf16 v[52:55], v[96:99], v[76:79], v[52:55]
ds_read_b128 v[152:155], v245 offset:51200
v_mfma_f32_16x16x32_bf16 v[20:23], v[100:103], v[72:75], v[20:23]
ds_read_b128 v[156:159], v245 offset:52224
v_mul_f32 v187, v187, v235
v_mfma_f32_16x16x32_bf16 v[56:59], v[100:103], v[76:79], v[56:59]
v_mul_f32 v188, v188, v248
v_mfma_f32_16x16x32_bf16 v[24:27], v[104:107], v[72:75], v[24:27]
v_mul_f32 v189, v189, v248
v_mfma_f32_16x16x32_bf16 v[60:63], v[104:107], v[76:79], v[60:63]
v_mfma_f32_16x16x32_bf16 v[28:31], v[108:111], v[72:75], v[28:31]
v_mul_f32 v190, v190, v248
v_mfma_f32_16x16x32_bf16 v[64:67], v[108:111], v[76:79], v[64:67]
v_mul_f32 v191, v191, v248
v_mfma_f32_16x16x32_bf16 v[32:35], v[112:115], v[72:75], v[32:35]
v_mul_f32 v232, v188, v188
v_mfma_f32_16x16x32_bf16 v[68:71], v[112:115], v[76:79], v[68:71]
s_waitcnt lgkmcnt(0)
s_barrier
v_mfma_f32_16x16x32_bf16 v[0:3], v[124:127], v[116:119], v[0:3]
ds_read_b128 v[80:83], v242 offset:0
v_mfma_f32_16x16x32_bf16 v[36:39], v[124:127], v[120:123], v[36:39]
ds_read_b128 v[72:75], v240 offset:0
v_mfma_f32_16x16x32_bf16 v[4:7], v[128:131], v[116:119], v[4:7]
ds_read_b128 v[84:87], v242 offset:1024
v_mfma_f32_16x16x32_bf16 v[40:43], v[128:131], v[120:123], v[40:43]
ds_read_b128 v[76:79], v240 offset:512
v_mfma_f32_16x16x32_bf16 v[8:11], v[132:135], v[116:119], v[8:11]
ds_read_b128 v[88:91], v242 offset:2048
v_mfma_f32_16x16x32_bf16 v[44:47], v[132:135], v[120:123], v[44:47]
ds_read_b128 v[92:95], v242 offset:3072
v_mfma_f32_16x16x32_bf16 v[12:15], v[136:139], v[116:119], v[12:15]
ds_read_b128 v[96:99], v242 offset:4096
v_mul_f32 v233, v189, v189
v_mfma_f32_16x16x32_bf16 v[48:51], v[136:139], v[120:123], v[48:51]
ds_read_b128 v[100:103], v242 offset:5120
v_mul_f32 v234, v190, v190
v_mfma_f32_16x16x32_bf16 v[16:19], v[140:143], v[116:119], v[16:19]
ds_read_b128 v[104:107], v242 offset:6144
v_mul_f32 v235, v191, v191
v_mfma_f32_16x16x32_bf16 v[52:55], v[140:143], v[120:123], v[52:55]
ds_read_b128 v[108:111], v242 offset:7168
v_mfma_f32_16x16x32_bf16 v[20:23], v[144:147], v[116:119], v[20:23]
ds_read_b128 v[112:115], v242 offset:8192
v_fma_f32 v232, v232, s60, v252
v_mfma_f32_16x16x32_bf16 v[56:59], v[144:147], v[120:123], v[56:59]
v_fma_f32 v233, v233, s60, v252
v_mfma_f32_16x16x32_bf16 v[24:27], v[148:151], v[116:119], v[24:27]
v_fma_f32 v234, v234, s60, v252
v_mfma_f32_16x16x32_bf16 v[60:63], v[148:151], v[120:123], v[60:63]
v_mfma_f32_16x16x32_bf16 v[28:31], v[152:155], v[116:119], v[28:31]
v_fma_f32 v235, v235, s60, v252
v_mfma_f32_16x16x32_bf16 v[64:67], v[152:155], v[120:123], v[64:67]
v_mul_f32 v232, v232, v188
v_mfma_f32_16x16x32_bf16 v[32:35], v[156:159], v[116:119], v[32:35]
v_mul_f32 v233, v233, v189
v_mfma_f32_16x16x32_bf16 v[68:71], v[156:159], v[120:123], v[68:71]
s_waitcnt lgkmcnt(0)
v_mfma_f32_16x16x32_bf16 v[0:3], v[80:83], v[72:75], v[0:3]
ds_read_b128 v[124:127], v242 offset:9216
v_mfma_f32_16x16x32_bf16 v[36:39], v[80:83], v[76:79], v[36:39]
ds_read_b128 v[116:119], v241 offset:0
v_mfma_f32_16x16x32_bf16 v[4:7], v[84:87], v[72:75], v[4:7]
ds_read_b128 v[128:131], v242 offset:10240
v_mfma_f32_16x16x32_bf16 v[40:43], v[84:87], v[76:79], v[40:43]
ds_read_b128 v[120:123], v241 offset:512
v_mfma_f32_16x16x32_bf16 v[8:11], v[88:91], v[72:75], v[8:11]
ds_read_b128 v[132:135], v242 offset:11264
v_mfma_f32_16x16x32_bf16 v[44:47], v[88:91], v[76:79], v[44:47]
ds_read_b128 v[136:139], v242 offset:12288
v_mfma_f32_16x16x32_bf16 v[12:15], v[92:95], v[72:75], v[12:15]
ds_read_b128 v[140:143], v242 offset:13312
v_mul_f32 v234, v234, v190
v_mfma_f32_16x16x32_bf16 v[48:51], v[92:95], v[76:79], v[48:51]
ds_read_b128 v[144:147], v242 offset:14336
v_mul_f32 v235, v235, v191
v_mfma_f32_16x16x32_bf16 v[16:19], v[96:99], v[72:75], v[16:19]
ds_read_b128 v[148:151], v242 offset:15360
v_exp_f32 v232, v232
v_mfma_f32_16x16x32_bf16 v[52:55], v[96:99], v[76:79], v[52:55]
ds_read_b128 v[152:155], v242 offset:16384
v_mfma_f32_16x16x32_bf16 v[20:23], v[100:103], v[72:75], v[20:23]
ds_read_b128 v[156:159], v242 offset:17408
v_exp_f32 v233, v233
v_mfma_f32_16x16x32_bf16 v[56:59], v[100:103], v[76:79], v[56:59]
v_exp_f32 v234, v234
v_mfma_f32_16x16x32_bf16 v[24:27], v[104:107], v[72:75], v[24:27]
v_exp_f32 v235, v235
v_mfma_f32_16x16x32_bf16 v[60:63], v[104:107], v[76:79], v[60:63]
v_mfma_f32_16x16x32_bf16 v[28:31], v[108:111], v[72:75], v[28:31]
v_add_f32 v232, 1.0, v232
v_mfma_f32_16x16x32_bf16 v[64:67], v[108:111], v[76:79], v[64:67]
v_add_f32 v233, 1.0, v233
v_mfma_f32_16x16x32_bf16 v[32:35], v[112:115], v[72:75], v[32:35]
v_add_f32 v234, 1.0, v234
v_mfma_f32_16x16x32_bf16 v[68:71], v[112:115], v[76:79], v[68:71]
s_waitcnt lgkmcnt(0)
s_barrier
v_mfma_f32_16x16x32_bf16 v[0:3], v[124:127], v[116:119], v[0:3]
ds_read_b128 v[80:83], v242 offset:34816
v_mfma_f32_16x16x32_bf16 v[36:39], v[124:127], v[120:123], v[36:39]
ds_read_b128 v[72:75], v240 offset:34816
v_mfma_f32_16x16x32_bf16 v[4:7], v[128:131], v[116:119], v[4:7]
ds_read_b128 v[84:87], v242 offset:35840
v_mfma_f32_16x16x32_bf16 v[40:43], v[128:131], v[120:123], v[40:43]
ds_read_b128 v[76:79], v240 offset:35328
v_mfma_f32_16x16x32_bf16 v[8:11], v[132:135], v[116:119], v[8:11]
ds_read_b128 v[88:91], v242 offset:36864
v_mfma_f32_16x16x32_bf16 v[44:47], v[132:135], v[120:123], v[44:47]
ds_read_b128 v[92:95], v242 offset:37888
v_mfma_f32_16x16x32_bf16 v[12:15], v[136:139], v[116:119], v[12:15]
ds_read_b128 v[96:99], v242 offset:38912
v_add_f32 v235, 1.0, v235
v_mfma_f32_16x16x32_bf16 v[48:51], v[136:139], v[120:123], v[48:51]
ds_read_b128 v[100:103], v242 offset:39936
v_rcp_f32 v232, v232
v_mfma_f32_16x16x32_bf16 v[16:19], v[140:143], v[116:119], v[16:19]
ds_read_b128 v[104:107], v242 offset:40960
v_rcp_f32 v233, v233
v_mfma_f32_16x16x32_bf16 v[52:55], v[140:143], v[120:123], v[52:55]
ds_read_b128 v[108:111], v242 offset:41984
v_mfma_f32_16x16x32_bf16 v[20:23], v[144:147], v[116:119], v[20:23]
ds_read_b128 v[112:115], v242 offset:43008
v_rcp_f32 v234, v234
v_mfma_f32_16x16x32_bf16 v[56:59], v[144:147], v[120:123], v[56:59]
v_rcp_f32 v235, v235
v_mfma_f32_16x16x32_bf16 v[24:27], v[148:151], v[116:119], v[24:27]
v_mul_f32 v188, v188, v232
v_mfma_f32_16x16x32_bf16 v[60:63], v[148:151], v[120:123], v[60:63]
v_mfma_f32_16x16x32_bf16 v[28:31], v[152:155], v[116:119], v[28:31]
v_mul_f32 v189, v189, v233
v_mfma_f32_16x16x32_bf16 v[64:67], v[152:155], v[120:123], v[64:67]
v_mul_f32 v190, v190, v234
v_mfma_f32_16x16x32_bf16 v[32:35], v[156:159], v[116:119], v[32:35]
v_mul_f32 v191, v191, v235
v_mfma_f32_16x16x32_bf16 v[68:71], v[156:159], v[120:123], v[68:71]
s_waitcnt lgkmcnt(0)
v_mfma_f32_16x16x32_bf16 v[0:3], v[80:83], v[72:75], v[0:3]
ds_read_b128 v[124:127], v242 offset:44032
v_mfma_f32_16x16x32_bf16 v[36:39], v[80:83], v[76:79], v[36:39]
ds_read_b128 v[116:119], v241 offset:34816
v_mfma_f32_16x16x32_bf16 v[4:7], v[84:87], v[72:75], v[4:7]
ds_read_b128 v[128:131], v242 offset:45056
v_mfma_f32_16x16x32_bf16 v[40:43], v[84:87], v[76:79], v[40:43]
ds_read_b128 v[120:123], v241 offset:35328
v_mfma_f32_16x16x32_bf16 v[8:11], v[88:91], v[72:75], v[8:11]
ds_read_b128 v[132:135], v242 offset:46080
v_mfma_f32_16x16x32_bf16 v[44:47], v[88:91], v[76:79], v[44:47]
ds_read_b128 v[136:139], v242 offset:47104
v_mfma_f32_16x16x32_bf16 v[12:15], v[92:95], v[72:75], v[12:15]
ds_read_b128 v[140:143], v242 offset:48128
ds_read_b128 v[236:239], v250 offset:1856
v_mfma_f32_16x16x32_bf16 v[48:51], v[92:95], v[76:79], v[48:51]
ds_read_b128 v[144:147], v242 offset:49152
v_mfma_f32_16x16x32_bf16 v[16:19], v[96:99], v[72:75], v[16:19]
ds_read_b128 v[148:151], v242 offset:50176
v_mfma_f32_16x16x32_bf16 v[52:55], v[96:99], v[76:79], v[52:55]
ds_read_b128 v[152:155], v242 offset:51200
v_mfma_f32_16x16x32_bf16 v[20:23], v[100:103], v[72:75], v[20:23]
ds_read_b128 v[156:159], v242 offset:52224
v_mfma_f32_16x16x32_bf16 v[56:59], v[100:103], v[76:79], v[56:59]
v_mfma_f32_16x16x32_bf16 v[24:27], v[104:107], v[72:75], v[24:27]
v_mfma_f32_16x16x32_bf16 v[60:63], v[104:107], v[76:79], v[60:63]
v_mfma_f32_16x16x32_bf16 v[28:31], v[108:111], v[72:75], v[28:31]
v_mfma_f32_16x16x32_bf16 v[64:67], v[108:111], v[76:79], v[64:67]
v_mfma_f32_16x16x32_bf16 v[32:35], v[112:115], v[72:75], v[32:35]
v_mfma_f32_16x16x32_bf16 v[68:71], v[112:115], v[76:79], v[68:71]
s_waitcnt lgkmcnt(0)
s_barrier
v_mfma_f32_16x16x32_bf16 v[0:3], v[124:127], v[116:119], v[0:3]
ds_read_b128 v[80:83], v245 offset:0
v_mfma_f32_16x16x32_bf16 v[36:39], v[124:127], v[120:123], v[36:39]
ds_read_b128 v[72:75], v243 offset:0
v_mfma_f32_16x16x32_bf16 v[4:7], v[128:131], v[116:119], v[4:7]
ds_read_b128 v[84:87], v245 offset:1024
v_mfma_f32_16x16x32_bf16 v[40:43], v[128:131], v[120:123], v[40:43]
ds_read_b128 v[76:79], v243 offset:512
v_mfma_f32_16x16x32_bf16 v[8:11], v[132:135], v[116:119], v[8:11]
ds_read_b128 v[88:91], v245 offset:2048
v_mfma_f32_16x16x32_bf16 v[44:47], v[132:135], v[120:123], v[44:47]
ds_read_b128 v[92:95], v245 offset:3072
v_mfma_f32_16x16x32_bf16 v[12:15], v[136:139], v[116:119], v[12:15]
ds_read_b128 v[96:99], v245 offset:4096
v_fma_f32 v192, -v247, v236, v192
v_mfma_f32_16x16x32_bf16 v[48:51], v[136:139], v[120:123], v[48:51]
ds_read_b128 v[100:103], v245 offset:5120
v_fma_f32 v193, -v247, v237, v193
v_mfma_f32_16x16x32_bf16 v[16:19], v[140:143], v[116:119], v[16:19]
ds_read_b128 v[104:107], v245 offset:6144
v_fma_f32 v194, -v247, v238, v194
v_mfma_f32_16x16x32_bf16 v[52:55], v[140:143], v[120:123], v[52:55]
ds_read_b128 v[108:111], v245 offset:7168
v_mfma_f32_16x16x32_bf16 v[20:23], v[144:147], v[116:119], v[20:23]
ds_read_b128 v[112:115], v245 offset:8192
v_fma_f32 v195, -v247, v239, v195
v_mfma_f32_16x16x32_bf16 v[56:59], v[144:147], v[120:123], v[56:59]
v_fma_f32 v196, -v249, v236, v196
v_mfma_f32_16x16x32_bf16 v[24:27], v[148:151], v[116:119], v[24:27]
v_fma_f32 v197, -v249, v237, v197
v_mfma_f32_16x16x32_bf16 v[60:63], v[148:151], v[120:123], v[60:63]
v_mfma_f32_16x16x32_bf16 v[28:31], v[152:155], v[116:119], v[28:31]
v_fma_f32 v198, -v249, v238, v198
v_mfma_f32_16x16x32_bf16 v[64:67], v[152:155], v[120:123], v[64:67]
v_fma_f32 v199, -v249, v239, v199
v_mfma_f32_16x16x32_bf16 v[32:35], v[156:159], v[116:119], v[32:35]
v_mul_f32 v192, v192, v246
v_mfma_f32_16x16x32_bf16 v[68:71], v[156:159], v[120:123], v[68:71]
s_waitcnt lgkmcnt(0)
v_mfma_f32_16x16x32_bf16 v[0:3], v[80:83], v[72:75], v[0:3]
ds_read_b128 v[124:127], v245 offset:9216
v_mfma_f32_16x16x32_bf16 v[36:39], v[80:83], v[76:79], v[36:39]
ds_read_b128 v[116:119], v244 offset:0
v_mfma_f32_16x16x32_bf16 v[4:7], v[84:87], v[72:75], v[4:7]
ds_read_b128 v[128:131], v245 offset:10240
v_mfma_f32_16x16x32_bf16 v[40:43], v[84:87], v[76:79], v[40:43]
ds_read_b128 v[120:123], v244 offset:512
v_mfma_f32_16x16x32_bf16 v[8:11], v[88:91], v[72:75], v[8:11]
ds_read_b128 v[132:135], v245 offset:11264
v_mfma_f32_16x16x32_bf16 v[44:47], v[88:91], v[76:79], v[44:47]
ds_read_b128 v[136:139], v245 offset:12288
v_mfma_f32_16x16x32_bf16 v[12:15], v[92:95], v[72:75], v[12:15]
ds_read_b128 v[140:143], v245 offset:13312
v_mul_f32 v193, v193, v246
v_mfma_f32_16x16x32_bf16 v[48:51], v[92:95], v[76:79], v[48:51]
ds_read_b128 v[144:147], v245 offset:14336
v_mul_f32 v194, v194, v246
v_mfma_f32_16x16x32_bf16 v[16:19], v[96:99], v[72:75], v[16:19]
ds_read_b128 v[148:151], v245 offset:15360
v_mul_f32 v195, v195, v246
v_mfma_f32_16x16x32_bf16 v[52:55], v[96:99], v[76:79], v[52:55]
ds_read_b128 v[152:155], v245 offset:16384
v_mfma_f32_16x16x32_bf16 v[20:23], v[100:103], v[72:75], v[20:23]
ds_read_b128 v[156:159], v245 offset:17408
v_mul_f32 v232, v192, v192
v_mfma_f32_16x16x32_bf16 v[56:59], v[100:103], v[76:79], v[56:59]
v_mul_f32 v233, v193, v193
v_mfma_f32_16x16x32_bf16 v[24:27], v[104:107], v[72:75], v[24:27]
v_mul_f32 v234, v194, v194
v_mfma_f32_16x16x32_bf16 v[60:63], v[104:107], v[76:79], v[60:63]
v_mfma_f32_16x16x32_bf16 v[28:31], v[108:111], v[72:75], v[28:31]
v_mul_f32 v235, v195, v195
v_mfma_f32_16x16x32_bf16 v[64:67], v[108:111], v[76:79], v[64:67]
v_fma_f32 v232, v232, s60, v252
v_mfma_f32_16x16x32_bf16 v[32:35], v[112:115], v[72:75], v[32:35]
v_fma_f32 v233, v233, s60, v252
v_mfma_f32_16x16x32_bf16 v[68:71], v[112:115], v[76:79], v[68:71]
s_waitcnt lgkmcnt(0)
s_barrier
v_mfma_f32_16x16x32_bf16 v[0:3], v[124:127], v[116:119], v[0:3]
ds_read_b128 v[80:83], v245 offset:34816
v_mfma_f32_16x16x32_bf16 v[36:39], v[124:127], v[120:123], v[36:39]
ds_read_b128 v[72:75], v243 offset:34816
v_mfma_f32_16x16x32_bf16 v[4:7], v[128:131], v[116:119], v[4:7]
ds_read_b128 v[84:87], v245 offset:35840
v_mfma_f32_16x16x32_bf16 v[40:43], v[128:131], v[120:123], v[40:43]
ds_read_b128 v[76:79], v243 offset:35328
v_mfma_f32_16x16x32_bf16 v[8:11], v[132:135], v[116:119], v[8:11]
ds_read_b128 v[88:91], v245 offset:36864
v_mfma_f32_16x16x32_bf16 v[44:47], v[132:135], v[120:123], v[44:47]
ds_read_b128 v[92:95], v245 offset:37888
v_mfma_f32_16x16x32_bf16 v[12:15], v[136:139], v[116:119], v[12:15]
ds_read_b128 v[96:99], v245 offset:38912
v_fma_f32 v234, v234, s60, v252
v_mfma_f32_16x16x32_bf16 v[48:51], v[136:139], v[120:123], v[48:51]
ds_read_b128 v[100:103], v245 offset:39936
v_fma_f32 v235, v235, s60, v252
v_mfma_f32_16x16x32_bf16 v[16:19], v[140:143], v[116:119], v[16:19]
ds_read_b128 v[104:107], v245 offset:40960
v_mul_f32 v232, v232, v192
v_mfma_f32_16x16x32_bf16 v[52:55], v[140:143], v[120:123], v[52:55]
ds_read_b128 v[108:111], v245 offset:41984
v_mfma_f32_16x16x32_bf16 v[20:23], v[144:147], v[116:119], v[20:23]
ds_read_b128 v[112:115], v245 offset:43008
v_mul_f32 v233, v233, v193
v_mfma_f32_16x16x32_bf16 v[56:59], v[144:147], v[120:123], v[56:59]
v_mul_f32 v234, v234, v194
v_mfma_f32_16x16x32_bf16 v[24:27], v[148:151], v[116:119], v[24:27]
v_mul_f32 v235, v235, v195
v_mfma_f32_16x16x32_bf16 v[60:63], v[148:151], v[120:123], v[60:63]
v_mfma_f32_16x16x32_bf16 v[28:31], v[152:155], v[116:119], v[28:31]
v_exp_f32 v232, v232
v_mfma_f32_16x16x32_bf16 v[64:67], v[152:155], v[120:123], v[64:67]
v_exp_f32 v233, v233
v_mfma_f32_16x16x32_bf16 v[32:35], v[156:159], v[116:119], v[32:35]
v_exp_f32 v234, v234
v_mfma_f32_16x16x32_bf16 v[68:71], v[156:159], v[120:123], v[68:71]
s_waitcnt lgkmcnt(0)
v_mfma_f32_16x16x32_bf16 v[0:3], v[80:83], v[72:75], v[0:3]
ds_read_b128 v[124:127], v245 offset:44032
v_mfma_f32_16x16x32_bf16 v[36:39], v[80:83], v[76:79], v[36:39]
ds_read_b128 v[116:119], v244 offset:34816
v_mfma_f32_16x16x32_bf16 v[4:7], v[84:87], v[72:75], v[4:7]
ds_read_b128 v[128:131], v245 offset:45056
v_mfma_f32_16x16x32_bf16 v[40:43], v[84:87], v[76:79], v[40:43]
ds_read_b128 v[120:123], v244 offset:35328
v_mfma_f32_16x16x32_bf16 v[8:11], v[88:91], v[72:75], v[8:11]
ds_read_b128 v[132:135], v245 offset:46080
v_mfma_f32_16x16x32_bf16 v[44:47], v[88:91], v[76:79], v[44:47]
ds_read_b128 v[136:139], v245 offset:47104
v_mfma_f32_16x16x32_bf16 v[12:15], v[92:95], v[72:75], v[12:15]
ds_read_b128 v[140:143], v245 offset:48128
v_exp_f32 v235, v235
v_mfma_f32_16x16x32_bf16 v[48:51], v[92:95], v[76:79], v[48:51]
ds_read_b128 v[144:147], v245 offset:49152
v_add_f32 v232, 1.0, v232
v_mfma_f32_16x16x32_bf16 v[16:19], v[96:99], v[72:75], v[16:19]
ds_read_b128 v[148:151], v245 offset:50176
v_add_f32 v233, 1.0, v233
v_mfma_f32_16x16x32_bf16 v[52:55], v[96:99], v[76:79], v[52:55]
ds_read_b128 v[152:155], v245 offset:51200
v_mfma_f32_16x16x32_bf16 v[20:23], v[100:103], v[72:75], v[20:23]
ds_read_b128 v[156:159], v245 offset:52224
v_add_f32 v234, 1.0, v234
v_mfma_f32_16x16x32_bf16 v[56:59], v[100:103], v[76:79], v[56:59]
v_add_f32 v235, 1.0, v235
v_mfma_f32_16x16x32_bf16 v[24:27], v[104:107], v[72:75], v[24:27]
v_rcp_f32 v232, v232
v_mfma_f32_16x16x32_bf16 v[60:63], v[104:107], v[76:79], v[60:63]
v_mfma_f32_16x16x32_bf16 v[28:31], v[108:111], v[72:75], v[28:31]
v_rcp_f32 v233, v233
v_mfma_f32_16x16x32_bf16 v[64:67], v[108:111], v[76:79], v[64:67]
v_rcp_f32 v234, v234
v_mfma_f32_16x16x32_bf16 v[32:35], v[112:115], v[72:75], v[32:35]
v_rcp_f32 v235, v235
v_mfma_f32_16x16x32_bf16 v[68:71], v[112:115], v[76:79], v[68:71]
s_waitcnt lgkmcnt(0)
s_barrier
v_mfma_f32_16x16x32_bf16 v[0:3], v[124:127], v[116:119], v[0:3]
ds_read_b128 v[80:83], v242 offset:0
v_mfma_f32_16x16x32_bf16 v[36:39], v[124:127], v[120:123], v[36:39]
ds_read_b128 v[72:75], v240 offset:0
v_mfma_f32_16x16x32_bf16 v[4:7], v[128:131], v[116:119], v[4:7]
ds_read_b128 v[84:87], v242 offset:1024
v_mfma_f32_16x16x32_bf16 v[40:43], v[128:131], v[120:123], v[40:43]
ds_read_b128 v[76:79], v240 offset:512
v_mfma_f32_16x16x32_bf16 v[8:11], v[132:135], v[116:119], v[8:11]
ds_read_b128 v[88:91], v242 offset:2048
v_mfma_f32_16x16x32_bf16 v[44:47], v[132:135], v[120:123], v[44:47]
ds_read_b128 v[92:95], v242 offset:3072
v_mfma_f32_16x16x32_bf16 v[12:15], v[136:139], v[116:119], v[12:15]
ds_read_b128 v[96:99], v242 offset:4096
v_mul_f32 v192, v192, v232
v_mfma_f32_16x16x32_bf16 v[48:51], v[136:139], v[120:123], v[48:51]
ds_read_b128 v[100:103], v242 offset:5120
v_mul_f32 v193, v193, v233
v_mfma_f32_16x16x32_bf16 v[16:19], v[140:143], v[116:119], v[16:19]
ds_read_b128 v[104:107], v242 offset:6144
v_mul_f32 v194, v194, v234
v_mfma_f32_16x16x32_bf16 v[52:55], v[140:143], v[120:123], v[52:55]
ds_read_b128 v[108:111], v242 offset:7168
v_mfma_f32_16x16x32_bf16 v[20:23], v[144:147], v[116:119], v[20:23]
ds_read_b128 v[112:115], v242 offset:8192
v_mul_f32 v195, v195, v235
v_mfma_f32_16x16x32_bf16 v[56:59], v[144:147], v[120:123], v[56:59]
v_mul_f32 v196, v196, v248
v_mfma_f32_16x16x32_bf16 v[24:27], v[148:151], v[116:119], v[24:27]
v_mul_f32 v197, v197, v248
v_mfma_f32_16x16x32_bf16 v[60:63], v[148:151], v[120:123], v[60:63]
v_mfma_f32_16x16x32_bf16 v[28:31], v[152:155], v[116:119], v[28:31]
v_mul_f32 v198, v198, v248
v_mfma_f32_16x16x32_bf16 v[64:67], v[152:155], v[120:123], v[64:67]
v_mul_f32 v199, v199, v248
v_mfma_f32_16x16x32_bf16 v[32:35], v[156:159], v[116:119], v[32:35]
v_mul_f32 v232, v196, v196
v_mfma_f32_16x16x32_bf16 v[68:71], v[156:159], v[120:123], v[68:71]
s_waitcnt lgkmcnt(0)
v_mfma_f32_16x16x32_bf16 v[0:3], v[80:83], v[72:75], v[0:3]
ds_read_b128 v[124:127], v242 offset:9216
v_mfma_f32_16x16x32_bf16 v[36:39], v[80:83], v[76:79], v[36:39]
ds_read_b128 v[116:119], v241 offset:0
v_mfma_f32_16x16x32_bf16 v[4:7], v[84:87], v[72:75], v[4:7]
ds_read_b128 v[128:131], v242 offset:10240
v_mfma_f32_16x16x32_bf16 v[40:43], v[84:87], v[76:79], v[40:43]
ds_read_b128 v[120:123], v241 offset:512
v_mfma_f32_16x16x32_bf16 v[8:11], v[88:91], v[72:75], v[8:11]
ds_read_b128 v[132:135], v242 offset:11264
v_mfma_f32_16x16x32_bf16 v[44:47], v[88:91], v[76:79], v[44:47]
ds_read_b128 v[136:139], v242 offset:12288
v_mfma_f32_16x16x32_bf16 v[12:15], v[92:95], v[72:75], v[12:15]
ds_read_b128 v[140:143], v242 offset:13312
v_mul_f32 v233, v197, v197
v_mfma_f32_16x16x32_bf16 v[48:51], v[92:95], v[76:79], v[48:51]
ds_read_b128 v[144:147], v242 offset:14336
v_mul_f32 v234, v198, v198
v_mfma_f32_16x16x32_bf16 v[16:19], v[96:99], v[72:75], v[16:19]
ds_read_b128 v[148:151], v242 offset:15360
v_mul_f32 v235, v199, v199
v_mfma_f32_16x16x32_bf16 v[52:55], v[96:99], v[76:79], v[52:55]
ds_read_b128 v[152:155], v242 offset:16384
v_mfma_f32_16x16x32_bf16 v[20:23], v[100:103], v[72:75], v[20:23]
ds_read_b128 v[156:159], v242 offset:17408
v_fma_f32 v232, v232, s60, v252
v_mfma_f32_16x16x32_bf16 v[56:59], v[100:103], v[76:79], v[56:59]
v_fma_f32 v233, v233, s60, v252
v_mfma_f32_16x16x32_bf16 v[24:27], v[104:107], v[72:75], v[24:27]
v_fma_f32 v234, v234, s60, v252
v_mfma_f32_16x16x32_bf16 v[60:63], v[104:107], v[76:79], v[60:63]
v_mfma_f32_16x16x32_bf16 v[28:31], v[108:111], v[72:75], v[28:31]
v_fma_f32 v235, v235, s60, v252
v_mfma_f32_16x16x32_bf16 v[64:67], v[108:111], v[76:79], v[64:67]
v_mul_f32 v232, v232, v196
v_mfma_f32_16x16x32_bf16 v[32:35], v[112:115], v[72:75], v[32:35]
v_mul_f32 v233, v233, v197
v_mfma_f32_16x16x32_bf16 v[68:71], v[112:115], v[76:79], v[68:71]
s_waitcnt lgkmcnt(0)
s_barrier
v_mfma_f32_16x16x32_bf16 v[0:3], v[124:127], v[116:119], v[0:3]
ds_read_b128 v[80:83], v242 offset:34816
v_mfma_f32_16x16x32_bf16 v[36:39], v[124:127], v[120:123], v[36:39]
ds_read_b128 v[72:75], v240 offset:34816
v_mfma_f32_16x16x32_bf16 v[4:7], v[128:131], v[116:119], v[4:7]
ds_read_b128 v[84:87], v242 offset:35840
v_mfma_f32_16x16x32_bf16 v[40:43], v[128:131], v[120:123], v[40:43]
ds_read_b128 v[76:79], v240 offset:35328
v_mfma_f32_16x16x32_bf16 v[8:11], v[132:135], v[116:119], v[8:11]
ds_read_b128 v[88:91], v242 offset:36864
v_mfma_f32_16x16x32_bf16 v[44:47], v[132:135], v[120:123], v[44:47]
ds_read_b128 v[92:95], v242 offset:37888
v_mfma_f32_16x16x32_bf16 v[12:15], v[136:139], v[116:119], v[12:15]
ds_read_b128 v[96:99], v242 offset:38912
v_mul_f32 v234, v234, v198
v_mfma_f32_16x16x32_bf16 v[48:51], v[136:139], v[120:123], v[48:51]
ds_read_b128 v[100:103], v242 offset:39936
v_mul_f32 v235, v235, v199
v_mfma_f32_16x16x32_bf16 v[16:19], v[140:143], v[116:119], v[16:19]
ds_read_b128 v[104:107], v242 offset:40960
v_exp_f32 v232, v232
v_mfma_f32_16x16x32_bf16 v[52:55], v[140:143], v[120:123], v[52:55]
ds_read_b128 v[108:111], v242 offset:41984
v_mfma_f32_16x16x32_bf16 v[20:23], v[144:147], v[116:119], v[20:23]
ds_read_b128 v[112:115], v242 offset:43008
v_exp_f32 v233, v233
v_mfma_f32_16x16x32_bf16 v[56:59], v[144:147], v[120:123], v[56:59]
v_exp_f32 v234, v234
v_mfma_f32_16x16x32_bf16 v[24:27], v[148:151], v[116:119], v[24:27]
v_exp_f32 v235, v235
v_mfma_f32_16x16x32_bf16 v[60:63], v[148:151], v[120:123], v[60:63]
v_mfma_f32_16x16x32_bf16 v[28:31], v[152:155], v[116:119], v[28:31]
v_add_f32 v232, 1.0, v232
v_mfma_f32_16x16x32_bf16 v[64:67], v[152:155], v[120:123], v[64:67]
v_add_f32 v233, 1.0, v233
v_mfma_f32_16x16x32_bf16 v[32:35], v[156:159], v[116:119], v[32:35]
v_add_f32 v234, 1.0, v234
v_mfma_f32_16x16x32_bf16 v[68:71], v[156:159], v[120:123], v[68:71]
s_waitcnt lgkmcnt(0)
v_mfma_f32_16x16x32_bf16 v[0:3], v[80:83], v[72:75], v[0:3]
ds_read_b128 v[124:127], v242 offset:44032
v_mfma_f32_16x16x32_bf16 v[36:39], v[80:83], v[76:79], v[36:39]
ds_read_b128 v[116:119], v241 offset:34816
v_mfma_f32_16x16x32_bf16 v[4:7], v[84:87], v[72:75], v[4:7]
ds_read_b128 v[128:131], v242 offset:45056
v_mfma_f32_16x16x32_bf16 v[40:43], v[84:87], v[76:79], v[40:43]
ds_read_b128 v[120:123], v241 offset:35328
v_mfma_f32_16x16x32_bf16 v[8:11], v[88:91], v[72:75], v[8:11]
ds_read_b128 v[132:135], v242 offset:46080
v_mfma_f32_16x16x32_bf16 v[44:47], v[88:91], v[76:79], v[44:47]
ds_read_b128 v[136:139], v242 offset:47104
v_mfma_f32_16x16x32_bf16 v[12:15], v[92:95], v[72:75], v[12:15]
ds_read_b128 v[140:143], v242 offset:48128
v_add_f32 v235, 1.0, v235
v_mfma_f32_16x16x32_bf16 v[48:51], v[92:95], v[76:79], v[48:51]
ds_read_b128 v[144:147], v242 offset:49152
v_rcp_f32 v232, v232
v_mfma_f32_16x16x32_bf16 v[16:19], v[96:99], v[72:75], v[16:19]
ds_read_b128 v[148:151], v242 offset:50176
v_rcp_f32 v233, v233
v_mfma_f32_16x16x32_bf16 v[52:55], v[96:99], v[76:79], v[52:55]
ds_read_b128 v[152:155], v242 offset:51200
v_mfma_f32_16x16x32_bf16 v[20:23], v[100:103], v[72:75], v[20:23]
ds_read_b128 v[156:159], v242 offset:52224
v_rcp_f32 v234, v234
v_mfma_f32_16x16x32_bf16 v[56:59], v[100:103], v[76:79], v[56:59]
v_rcp_f32 v235, v235
v_mfma_f32_16x16x32_bf16 v[24:27], v[104:107], v[72:75], v[24:27]
v_mul_f32 v196, v196, v232
v_mfma_f32_16x16x32_bf16 v[60:63], v[104:107], v[76:79], v[60:63]
v_mfma_f32_16x16x32_bf16 v[28:31], v[108:111], v[72:75], v[28:31]
v_mul_f32 v197, v197, v233
v_mfma_f32_16x16x32_bf16 v[64:67], v[108:111], v[76:79], v[64:67]
v_mul_f32 v198, v198, v234
v_mfma_f32_16x16x32_bf16 v[32:35], v[112:115], v[72:75], v[32:35]
v_mul_f32 v199, v199, v235
v_mfma_f32_16x16x32_bf16 v[68:71], v[112:115], v[76:79], v[68:71]
s_waitcnt lgkmcnt(0)
s_barrier
v_mfma_f32_16x16x32_bf16 v[0:3], v[124:127], v[116:119], v[0:3]
ds_read_b128 v[80:83], v245 offset:0
v_mfma_f32_16x16x32_bf16 v[36:39], v[124:127], v[120:123], v[36:39]
ds_read_b128 v[72:75], v243 offset:0
v_mfma_f32_16x16x32_bf16 v[4:7], v[128:131], v[116:119], v[4:7]
ds_read_b128 v[84:87], v245 offset:1024
v_mfma_f32_16x16x32_bf16 v[40:43], v[128:131], v[120:123], v[40:43]
ds_read_b128 v[76:79], v243 offset:512
v_mfma_f32_16x16x32_bf16 v[8:11], v[132:135], v[116:119], v[8:11]
ds_read_b128 v[88:91], v245 offset:2048
v_mfma_f32_16x16x32_bf16 v[44:47], v[132:135], v[120:123], v[44:47]
ds_read_b128 v[92:95], v245 offset:3072
v_mfma_f32_16x16x32_bf16 v[12:15], v[136:139], v[116:119], v[12:15]
ds_read_b128 v[96:99], v245 offset:4096
ds_read_b128 v[236:239], v250 offset:1920
v_mfma_f32_16x16x32_bf16 v[48:51], v[136:139], v[120:123], v[48:51]
ds_read_b128 v[100:103], v245 offset:5120
v_mfma_f32_16x16x32_bf16 v[16:19], v[140:143], v[116:119], v[16:19]
ds_read_b128 v[104:107], v245 offset:6144
v_mfma_f32_16x16x32_bf16 v[52:55], v[140:143], v[120:123], v[52:55]
ds_read_b128 v[108:111], v245 offset:7168
v_mfma_f32_16x16x32_bf16 v[20:23], v[144:147], v[116:119], v[20:23]
ds_read_b128 v[112:115], v245 offset:8192
v_mfma_f32_16x16x32_bf16 v[56:59], v[144:147], v[120:123], v[56:59]
v_mfma_f32_16x16x32_bf16 v[24:27], v[148:151], v[116:119], v[24:27]
v_mfma_f32_16x16x32_bf16 v[60:63], v[148:151], v[120:123], v[60:63]
v_mfma_f32_16x16x32_bf16 v[28:31], v[152:155], v[116:119], v[28:31]
v_mfma_f32_16x16x32_bf16 v[64:67], v[152:155], v[120:123], v[64:67]
v_mfma_f32_16x16x32_bf16 v[32:35], v[156:159], v[116:119], v[32:35]
v_mfma_f32_16x16x32_bf16 v[68:71], v[156:159], v[120:123], v[68:71]
s_waitcnt lgkmcnt(0)
v_mfma_f32_16x16x32_bf16 v[0:3], v[80:83], v[72:75], v[0:3]
ds_read_b128 v[124:127], v245 offset:9216
v_mfma_f32_16x16x32_bf16 v[36:39], v[80:83], v[76:79], v[36:39]
ds_read_b128 v[116:119], v244 offset:0
v_mfma_f32_16x16x32_bf16 v[4:7], v[84:87], v[72:75], v[4:7]
ds_read_b128 v[128:131], v245 offset:10240
v_mfma_f32_16x16x32_bf16 v[40:43], v[84:87], v[76:79], v[40:43]
ds_read_b128 v[120:123], v244 offset:512
v_mfma_f32_16x16x32_bf16 v[8:11], v[88:91], v[72:75], v[8:11]
ds_read_b128 v[132:135], v245 offset:11264
v_mfma_f32_16x16x32_bf16 v[44:47], v[88:91], v[76:79], v[44:47]
ds_read_b128 v[136:139], v245 offset:12288
v_mfma_f32_16x16x32_bf16 v[12:15], v[92:95], v[72:75], v[12:15]
ds_read_b128 v[140:143], v245 offset:13312
v_fma_f32 v200, -v247, v236, v200
v_mfma_f32_16x16x32_bf16 v[48:51], v[92:95], v[76:79], v[48:51]
ds_read_b128 v[144:147], v245 offset:14336
v_fma_f32 v201, -v247, v237, v201
v_mfma_f32_16x16x32_bf16 v[16:19], v[96:99], v[72:75], v[16:19]
ds_read_b128 v[148:151], v245 offset:15360
v_fma_f32 v202, -v247, v238, v202
v_mfma_f32_16x16x32_bf16 v[52:55], v[96:99], v[76:79], v[52:55]
ds_read_b128 v[152:155], v245 offset:16384
v_mfma_f32_16x16x32_bf16 v[20:23], v[100:103], v[72:75], v[20:23]
ds_read_b128 v[156:159], v245 offset:17408
v_fma_f32 v203, -v247, v239, v203
v_mfma_f32_16x16x32_bf16 v[56:59], v[100:103], v[76:79], v[56:59]
v_fma_f32 v204, -v249, v236, v204
v_mfma_f32_16x16x32_bf16 v[24:27], v[104:107], v[72:75], v[24:27]
v_fma_f32 v205, -v249, v237, v205
v_mfma_f32_16x16x32_bf16 v[60:63], v[104:107], v[76:79], v[60:63]
v_mfma_f32_16x16x32_bf16 v[28:31], v[108:111], v[72:75], v[28:31]
v_fma_f32 v206, -v249, v238, v206
v_mfma_f32_16x16x32_bf16 v[64:67], v[108:111], v[76:79], v[64:67]
v_fma_f32 v207, -v249, v239, v207
v_mfma_f32_16x16x32_bf16 v[32:35], v[112:115], v[72:75], v[32:35]
v_mul_f32 v200, v200, v246
v_mfma_f32_16x16x32_bf16 v[68:71], v[112:115], v[76:79], v[68:71]
s_waitcnt lgkmcnt(0)
s_barrier
v_mfma_f32_16x16x32_bf16 v[0:3], v[124:127], v[116:119], v[0:3]
ds_read_b128 v[80:83], v245 offset:34816
v_mfma_f32_16x16x32_bf16 v[36:39], v[124:127], v[120:123], v[36:39]
ds_read_b128 v[72:75], v243 offset:34816
v_mfma_f32_16x16x32_bf16 v[4:7], v[128:131], v[116:119], v[4:7]
ds_read_b128 v[84:87], v245 offset:35840
v_mfma_f32_16x16x32_bf16 v[40:43], v[128:131], v[120:123], v[40:43]
ds_read_b128 v[76:79], v243 offset:35328
v_mfma_f32_16x16x32_bf16 v[8:11], v[132:135], v[116:119], v[8:11]
ds_read_b128 v[88:91], v245 offset:36864
v_mfma_f32_16x16x32_bf16 v[44:47], v[132:135], v[120:123], v[44:47]
ds_read_b128 v[92:95], v245 offset:37888
v_mfma_f32_16x16x32_bf16 v[12:15], v[136:139], v[116:119], v[12:15]
ds_read_b128 v[96:99], v245 offset:38912
v_mul_f32 v201, v201, v246
v_mfma_f32_16x16x32_bf16 v[48:51], v[136:139], v[120:123], v[48:51]
ds_read_b128 v[100:103], v245 offset:39936
v_mul_f32 v202, v202, v246
v_mfma_f32_16x16x32_bf16 v[16:19], v[140:143], v[116:119], v[16:19]
ds_read_b128 v[104:107], v245 offset:40960
v_mul_f32 v203, v203, v246
v_mfma_f32_16x16x32_bf16 v[52:55], v[140:143], v[120:123], v[52:55]
ds_read_b128 v[108:111], v245 offset:41984
v_mfma_f32_16x16x32_bf16 v[20:23], v[144:147], v[116:119], v[20:23]
ds_read_b128 v[112:115], v245 offset:43008
v_mul_f32 v232, v200, v200
v_mfma_f32_16x16x32_bf16 v[56:59], v[144:147], v[120:123], v[56:59]
v_mul_f32 v233, v201, v201
v_mfma_f32_16x16x32_bf16 v[24:27], v[148:151], v[116:119], v[24:27]
v_mul_f32 v234, v202, v202
v_mfma_f32_16x16x32_bf16 v[60:63], v[148:151], v[120:123], v[60:63]
v_mfma_f32_16x16x32_bf16 v[28:31], v[152:155], v[116:119], v[28:31]
v_mul_f32 v235, v203, v203
v_mfma_f32_16x16x32_bf16 v[64:67], v[152:155], v[120:123], v[64:67]
v_fma_f32 v232, v232, s60, v252
v_mfma_f32_16x16x32_bf16 v[32:35], v[156:159], v[116:119], v[32:35]
v_fma_f32 v233, v233, s60, v252
v_mfma_f32_16x16x32_bf16 v[68:71], v[156:159], v[120:123], v[68:71]
s_waitcnt lgkmcnt(0)
v_mfma_f32_16x16x32_bf16 v[0:3], v[80:83], v[72:75], v[0:3]
ds_read_b128 v[124:127], v245 offset:44032
v_mfma_f32_16x16x32_bf16 v[36:39], v[80:83], v[76:79], v[36:39]
ds_read_b128 v[116:119], v244 offset:34816
v_mfma_f32_16x16x32_bf16 v[4:7], v[84:87], v[72:75], v[4:7]
ds_read_b128 v[128:131], v245 offset:45056
v_mfma_f32_16x16x32_bf16 v[40:43], v[84:87], v[76:79], v[40:43]
ds_read_b128 v[120:123], v244 offset:35328
v_mfma_f32_16x16x32_bf16 v[8:11], v[88:91], v[72:75], v[8:11]
ds_read_b128 v[132:135], v245 offset:46080
v_mfma_f32_16x16x32_bf16 v[44:47], v[88:91], v[76:79], v[44:47]
ds_read_b128 v[136:139], v245 offset:47104
v_mfma_f32_16x16x32_bf16 v[12:15], v[92:95], v[72:75], v[12:15]
ds_read_b128 v[140:143], v245 offset:48128
v_fma_f32 v234, v234, s60, v252
v_mfma_f32_16x16x32_bf16 v[48:51], v[92:95], v[76:79], v[48:51]
ds_read_b128 v[144:147], v245 offset:49152
v_fma_f32 v235, v235, s60, v252
v_mfma_f32_16x16x32_bf16 v[16:19], v[96:99], v[72:75], v[16:19]
ds_read_b128 v[148:151], v245 offset:50176
v_mul_f32 v232, v232, v200
v_mfma_f32_16x16x32_bf16 v[52:55], v[96:99], v[76:79], v[52:55]
ds_read_b128 v[152:155], v245 offset:51200
v_mfma_f32_16x16x32_bf16 v[20:23], v[100:103], v[72:75], v[20:23]
ds_read_b128 v[156:159], v245 offset:52224
v_mul_f32 v233, v233, v201
v_mfma_f32_16x16x32_bf16 v[56:59], v[100:103], v[76:79], v[56:59]
v_mul_f32 v234, v234, v202
v_mfma_f32_16x16x32_bf16 v[24:27], v[104:107], v[72:75], v[24:27]
v_mul_f32 v235, v235, v203
v_mfma_f32_16x16x32_bf16 v[60:63], v[104:107], v[76:79], v[60:63]
v_mfma_f32_16x16x32_bf16 v[28:31], v[108:111], v[72:75], v[28:31]
v_exp_f32 v232, v232
v_mfma_f32_16x16x32_bf16 v[64:67], v[108:111], v[76:79], v[64:67]
v_exp_f32 v233, v233
v_mfma_f32_16x16x32_bf16 v[32:35], v[112:115], v[72:75], v[32:35]
v_exp_f32 v234, v234
v_mfma_f32_16x16x32_bf16 v[68:71], v[112:115], v[76:79], v[68:71]
s_waitcnt lgkmcnt(0)
s_barrier
v_mfma_f32_16x16x32_bf16 v[0:3], v[124:127], v[116:119], v[0:3]
ds_read_b128 v[80:83], v242 offset:0
v_mfma_f32_16x16x32_bf16 v[36:39], v[124:127], v[120:123], v[36:39]
ds_read_b128 v[72:75], v240 offset:0
v_mfma_f32_16x16x32_bf16 v[4:7], v[128:131], v[116:119], v[4:7]
ds_read_b128 v[84:87], v242 offset:1024
v_mfma_f32_16x16x32_bf16 v[40:43], v[128:131], v[120:123], v[40:43]
ds_read_b128 v[76:79], v240 offset:512
v_mfma_f32_16x16x32_bf16 v[8:11], v[132:135], v[116:119], v[8:11]
ds_read_b128 v[88:91], v242 offset:2048
v_mfma_f32_16x16x32_bf16 v[44:47], v[132:135], v[120:123], v[44:47]
ds_read_b128 v[92:95], v242 offset:3072
v_mfma_f32_16x16x32_bf16 v[12:15], v[136:139], v[116:119], v[12:15]
ds_read_b128 v[96:99], v242 offset:4096
v_exp_f32 v235, v235
v_mfma_f32_16x16x32_bf16 v[48:51], v[136:139], v[120:123], v[48:51]
ds_read_b128 v[100:103], v242 offset:5120
v_add_f32 v232, 1.0, v232
v_mfma_f32_16x16x32_bf16 v[16:19], v[140:143], v[116:119], v[16:19]
ds_read_b128 v[104:107], v242 offset:6144
v_add_f32 v233, 1.0, v233
v_mfma_f32_16x16x32_bf16 v[52:55], v[140:143], v[120:123], v[52:55]
ds_read_b128 v[108:111], v242 offset:7168
v_mfma_f32_16x16x32_bf16 v[20:23], v[144:147], v[116:119], v[20:23]
ds_read_b128 v[112:115], v242 offset:8192
v_add_f32 v234, 1.0, v234
v_mfma_f32_16x16x32_bf16 v[56:59], v[144:147], v[120:123], v[56:59]
v_add_f32 v235, 1.0, v235
v_mfma_f32_16x16x32_bf16 v[24:27], v[148:151], v[116:119], v[24:27]
v_rcp_f32 v232, v232
v_mfma_f32_16x16x32_bf16 v[60:63], v[148:151], v[120:123], v[60:63]
v_mfma_f32_16x16x32_bf16 v[28:31], v[152:155], v[116:119], v[28:31]
v_rcp_f32 v233, v233
v_mfma_f32_16x16x32_bf16 v[64:67], v[152:155], v[120:123], v[64:67]
v_rcp_f32 v234, v234
v_mfma_f32_16x16x32_bf16 v[32:35], v[156:159], v[116:119], v[32:35]
v_rcp_f32 v235, v235
v_mfma_f32_16x16x32_bf16 v[68:71], v[156:159], v[120:123], v[68:71]
s_waitcnt lgkmcnt(0)
v_mfma_f32_16x16x32_bf16 v[0:3], v[80:83], v[72:75], v[0:3]
ds_read_b128 v[124:127], v242 offset:9216
v_mfma_f32_16x16x32_bf16 v[36:39], v[80:83], v[76:79], v[36:39]
ds_read_b128 v[116:119], v241 offset:0
v_mfma_f32_16x16x32_bf16 v[4:7], v[84:87], v[72:75], v[4:7]
ds_read_b128 v[128:131], v242 offset:10240
v_mfma_f32_16x16x32_bf16 v[40:43], v[84:87], v[76:79], v[40:43]
ds_read_b128 v[120:123], v241 offset:512
v_mfma_f32_16x16x32_bf16 v[8:11], v[88:91], v[72:75], v[8:11]
ds_read_b128 v[132:135], v242 offset:11264
v_mfma_f32_16x16x32_bf16 v[44:47], v[88:91], v[76:79], v[44:47]
ds_read_b128 v[136:139], v242 offset:12288
v_mfma_f32_16x16x32_bf16 v[12:15], v[92:95], v[72:75], v[12:15]
ds_read_b128 v[140:143], v242 offset:13312
v_mul_f32 v200, v200, v232
v_mfma_f32_16x16x32_bf16 v[48:51], v[92:95], v[76:79], v[48:51]
ds_read_b128 v[144:147], v242 offset:14336
v_mul_f32 v201, v201, v233
v_mfma_f32_16x16x32_bf16 v[16:19], v[96:99], v[72:75], v[16:19]
ds_read_b128 v[148:151], v242 offset:15360
v_mul_f32 v202, v202, v234
v_mfma_f32_16x16x32_bf16 v[52:55], v[96:99], v[76:79], v[52:55]
ds_read_b128 v[152:155], v242 offset:16384
v_mfma_f32_16x16x32_bf16 v[20:23], v[100:103], v[72:75], v[20:23]
ds_read_b128 v[156:159], v242 offset:17408
v_mul_f32 v203, v203, v235
v_mfma_f32_16x16x32_bf16 v[56:59], v[100:103], v[76:79], v[56:59]
v_mul_f32 v204, v204, v248
v_mfma_f32_16x16x32_bf16 v[24:27], v[104:107], v[72:75], v[24:27]
v_mul_f32 v205, v205, v248
v_mfma_f32_16x16x32_bf16 v[60:63], v[104:107], v[76:79], v[60:63]
v_mfma_f32_16x16x32_bf16 v[28:31], v[108:111], v[72:75], v[28:31]
v_mul_f32 v206, v206, v248
v_mfma_f32_16x16x32_bf16 v[64:67], v[108:111], v[76:79], v[64:67]
v_mul_f32 v207, v207, v248
v_mfma_f32_16x16x32_bf16 v[32:35], v[112:115], v[72:75], v[32:35]
v_mul_f32 v232, v204, v204
v_mfma_f32_16x16x32_bf16 v[68:71], v[112:115], v[76:79], v[68:71]
s_waitcnt lgkmcnt(0)
s_barrier
v_mfma_f32_16x16x32_bf16 v[0:3], v[124:127], v[116:119], v[0:3]
ds_read_b128 v[80:83], v242 offset:34816
v_mfma_f32_16x16x32_bf16 v[36:39], v[124:127], v[120:123], v[36:39]
ds_read_b128 v[72:75], v240 offset:34816
v_mfma_f32_16x16x32_bf16 v[4:7], v[128:131], v[116:119], v[4:7]
ds_read_b128 v[84:87], v242 offset:35840
v_mfma_f32_16x16x32_bf16 v[40:43], v[128:131], v[120:123], v[40:43]
ds_read_b128 v[76:79], v240 offset:35328
v_mfma_f32_16x16x32_bf16 v[8:11], v[132:135], v[116:119], v[8:11]
ds_read_b128 v[88:91], v242 offset:36864
v_mfma_f32_16x16x32_bf16 v[44:47], v[132:135], v[120:123], v[44:47]
ds_read_b128 v[92:95], v242 offset:37888
v_mfma_f32_16x16x32_bf16 v[12:15], v[136:139], v[116:119], v[12:15]
ds_read_b128 v[96:99], v242 offset:38912
v_mul_f32 v233, v205, v205
v_mfma_f32_16x16x32_bf16 v[48:51], v[136:139], v[120:123], v[48:51]
ds_read_b128 v[100:103], v242 offset:39936
v_mul_f32 v234, v206, v206
v_mfma_f32_16x16x32_bf16 v[16:19], v[140:143], v[116:119], v[16:19]
ds_read_b128 v[104:107], v242 offset:40960
v_mul_f32 v235, v207, v207
v_mfma_f32_16x16x32_bf16 v[52:55], v[140:143], v[120:123], v[52:55]
ds_read_b128 v[108:111], v242 offset:41984
v_mfma_f32_16x16x32_bf16 v[20:23], v[144:147], v[116:119], v[20:23]
ds_read_b128 v[112:115], v242 offset:43008
v_fma_f32 v232, v232, s60, v252
v_mfma_f32_16x16x32_bf16 v[56:59], v[144:147], v[120:123], v[56:59]
v_fma_f32 v233, v233, s60, v252
v_mfma_f32_16x16x32_bf16 v[24:27], v[148:151], v[116:119], v[24:27]
v_fma_f32 v234, v234, s60, v252
v_mfma_f32_16x16x32_bf16 v[60:63], v[148:151], v[120:123], v[60:63]
v_mfma_f32_16x16x32_bf16 v[28:31], v[152:155], v[116:119], v[28:31]
v_fma_f32 v235, v235, s60, v252
v_mfma_f32_16x16x32_bf16 v[64:67], v[152:155], v[120:123], v[64:67]
v_mul_f32 v232, v232, v204
v_mfma_f32_16x16x32_bf16 v[32:35], v[156:159], v[116:119], v[32:35]
v_mul_f32 v233, v233, v205
v_mfma_f32_16x16x32_bf16 v[68:71], v[156:159], v[120:123], v[68:71]
s_waitcnt lgkmcnt(0)
v_mfma_f32_16x16x32_bf16 v[0:3], v[80:83], v[72:75], v[0:3]
ds_read_b128 v[124:127], v242 offset:44032
v_mfma_f32_16x16x32_bf16 v[36:39], v[80:83], v[76:79], v[36:39]
ds_read_b128 v[116:119], v241 offset:34816
v_mfma_f32_16x16x32_bf16 v[4:7], v[84:87], v[72:75], v[4:7]
ds_read_b128 v[128:131], v242 offset:45056
v_mfma_f32_16x16x32_bf16 v[40:43], v[84:87], v[76:79], v[40:43]
ds_read_b128 v[120:123], v241 offset:35328
v_mfma_f32_16x16x32_bf16 v[8:11], v[88:91], v[72:75], v[8:11]
ds_read_b128 v[132:135], v242 offset:46080
v_mfma_f32_16x16x32_bf16 v[44:47], v[88:91], v[76:79], v[44:47]
ds_read_b128 v[136:139], v242 offset:47104
v_mfma_f32_16x16x32_bf16 v[12:15], v[92:95], v[72:75], v[12:15]
ds_read_b128 v[140:143], v242 offset:48128
v_mul_f32 v234, v234, v206
v_mfma_f32_16x16x32_bf16 v[48:51], v[92:95], v[76:79], v[48:51]
ds_read_b128 v[144:147], v242 offset:49152
v_mul_f32 v235, v235, v207
v_mfma_f32_16x16x32_bf16 v[16:19], v[96:99], v[72:75], v[16:19]
ds_read_b128 v[148:151], v242 offset:50176
v_exp_f32 v232, v232
v_mfma_f32_16x16x32_bf16 v[52:55], v[96:99], v[76:79], v[52:55]
ds_read_b128 v[152:155], v242 offset:51200
v_mfma_f32_16x16x32_bf16 v[20:23], v[100:103], v[72:75], v[20:23]
ds_read_b128 v[156:159], v242 offset:52224
v_exp_f32 v233, v233
v_mfma_f32_16x16x32_bf16 v[56:59], v[100:103], v[76:79], v[56:59]
v_exp_f32 v234, v234
v_mfma_f32_16x16x32_bf16 v[24:27], v[104:107], v[72:75], v[24:27]
v_exp_f32 v235, v235
v_mfma_f32_16x16x32_bf16 v[60:63], v[104:107], v[76:79], v[60:63]
v_mfma_f32_16x16x32_bf16 v[28:31], v[108:111], v[72:75], v[28:31]
v_add_f32 v232, 1.0, v232
v_mfma_f32_16x16x32_bf16 v[64:67], v[108:111], v[76:79], v[64:67]
v_add_f32 v233, 1.0, v233
v_mfma_f32_16x16x32_bf16 v[32:35], v[112:115], v[72:75], v[32:35]
v_add_f32 v234, 1.0, v234
v_mfma_f32_16x16x32_bf16 v[68:71], v[112:115], v[76:79], v[68:71]
s_waitcnt lgkmcnt(0)
s_barrier
v_mfma_f32_16x16x32_bf16 v[0:3], v[124:127], v[116:119], v[0:3]
ds_read_b128 v[80:83], v245 offset:0
v_mfma_f32_16x16x32_bf16 v[36:39], v[124:127], v[120:123], v[36:39]
ds_read_b128 v[72:75], v243 offset:0
v_mfma_f32_16x16x32_bf16 v[4:7], v[128:131], v[116:119], v[4:7]
ds_read_b128 v[84:87], v245 offset:1024
v_mfma_f32_16x16x32_bf16 v[40:43], v[128:131], v[120:123], v[40:43]
ds_read_b128 v[76:79], v243 offset:512
v_mfma_f32_16x16x32_bf16 v[8:11], v[132:135], v[116:119], v[8:11]
ds_read_b128 v[88:91], v245 offset:2048
v_mfma_f32_16x16x32_bf16 v[44:47], v[132:135], v[120:123], v[44:47]
ds_read_b128 v[92:95], v245 offset:3072
v_mfma_f32_16x16x32_bf16 v[12:15], v[136:139], v[116:119], v[12:15]
ds_read_b128 v[96:99], v245 offset:4096
v_add_f32 v235, 1.0, v235
v_mfma_f32_16x16x32_bf16 v[48:51], v[136:139], v[120:123], v[48:51]
ds_read_b128 v[100:103], v245 offset:5120
v_rcp_f32 v232, v232
v_mfma_f32_16x16x32_bf16 v[16:19], v[140:143], v[116:119], v[16:19]
ds_read_b128 v[104:107], v245 offset:6144
v_rcp_f32 v233, v233
v_mfma_f32_16x16x32_bf16 v[52:55], v[140:143], v[120:123], v[52:55]
ds_read_b128 v[108:111], v245 offset:7168
v_mfma_f32_16x16x32_bf16 v[20:23], v[144:147], v[116:119], v[20:23]
ds_read_b128 v[112:115], v245 offset:8192
v_rcp_f32 v234, v234
v_mfma_f32_16x16x32_bf16 v[56:59], v[144:147], v[120:123], v[56:59]
v_rcp_f32 v235, v235
v_mfma_f32_16x16x32_bf16 v[24:27], v[148:151], v[116:119], v[24:27]
v_mul_f32 v204, v204, v232
v_mfma_f32_16x16x32_bf16 v[60:63], v[148:151], v[120:123], v[60:63]
v_mfma_f32_16x16x32_bf16 v[28:31], v[152:155], v[116:119], v[28:31]
v_mul_f32 v205, v205, v233
v_mfma_f32_16x16x32_bf16 v[64:67], v[152:155], v[120:123], v[64:67]
v_mul_f32 v206, v206, v234
v_mfma_f32_16x16x32_bf16 v[32:35], v[156:159], v[116:119], v[32:35]
v_mul_f32 v207, v207, v235
v_mfma_f32_16x16x32_bf16 v[68:71], v[156:159], v[120:123], v[68:71]
s_waitcnt lgkmcnt(0)
v_mfma_f32_16x16x32_bf16 v[0:3], v[80:83], v[72:75], v[0:3]
ds_read_b128 v[124:127], v245 offset:9216
v_mfma_f32_16x16x32_bf16 v[36:39], v[80:83], v[76:79], v[36:39]
ds_read_b128 v[116:119], v244 offset:0
v_mfma_f32_16x16x32_bf16 v[4:7], v[84:87], v[72:75], v[4:7]
ds_read_b128 v[128:131], v245 offset:10240
v_mfma_f32_16x16x32_bf16 v[40:43], v[84:87], v[76:79], v[40:43]
ds_read_b128 v[120:123], v244 offset:512
v_mfma_f32_16x16x32_bf16 v[8:11], v[88:91], v[72:75], v[8:11]
ds_read_b128 v[132:135], v245 offset:11264
v_mfma_f32_16x16x32_bf16 v[44:47], v[88:91], v[76:79], v[44:47]
ds_read_b128 v[136:139], v245 offset:12288
v_mfma_f32_16x16x32_bf16 v[12:15], v[92:95], v[72:75], v[12:15]
ds_read_b128 v[140:143], v245 offset:13312
ds_read_b128 v[236:239], v250 offset:1984
v_mfma_f32_16x16x32_bf16 v[48:51], v[92:95], v[76:79], v[48:51]
ds_read_b128 v[144:147], v245 offset:14336
v_mfma_f32_16x16x32_bf16 v[16:19], v[96:99], v[72:75], v[16:19]
ds_read_b128 v[148:151], v245 offset:15360
v_mfma_f32_16x16x32_bf16 v[52:55], v[96:99], v[76:79], v[52:55]
ds_read_b128 v[152:155], v245 offset:16384
v_mfma_f32_16x16x32_bf16 v[20:23], v[100:103], v[72:75], v[20:23]
ds_read_b128 v[156:159], v245 offset:17408
v_mfma_f32_16x16x32_bf16 v[56:59], v[100:103], v[76:79], v[56:59]
v_mfma_f32_16x16x32_bf16 v[24:27], v[104:107], v[72:75], v[24:27]
v_mfma_f32_16x16x32_bf16 v[60:63], v[104:107], v[76:79], v[60:63]
v_mfma_f32_16x16x32_bf16 v[28:31], v[108:111], v[72:75], v[28:31]
v_mfma_f32_16x16x32_bf16 v[64:67], v[108:111], v[76:79], v[64:67]
v_mfma_f32_16x16x32_bf16 v[32:35], v[112:115], v[72:75], v[32:35]
v_mfma_f32_16x16x32_bf16 v[68:71], v[112:115], v[76:79], v[68:71]
s_waitcnt lgkmcnt(0)
s_barrier
v_mfma_f32_16x16x32_bf16 v[0:3], v[124:127], v[116:119], v[0:3]
ds_read_b128 v[80:83], v245 offset:34816
v_mfma_f32_16x16x32_bf16 v[36:39], v[124:127], v[120:123], v[36:39]
ds_read_b128 v[72:75], v243 offset:34816
v_mfma_f32_16x16x32_bf16 v[4:7], v[128:131], v[116:119], v[4:7]
ds_read_b128 v[84:87], v245 offset:35840
v_mfma_f32_16x16x32_bf16 v[40:43], v[128:131], v[120:123], v[40:43]
ds_read_b128 v[76:79], v243 offset:35328
v_mfma_f32_16x16x32_bf16 v[8:11], v[132:135], v[116:119], v[8:11]
ds_read_b128 v[88:91], v245 offset:36864
v_mfma_f32_16x16x32_bf16 v[44:47], v[132:135], v[120:123], v[44:47]
ds_read_b128 v[92:95], v245 offset:37888
v_mfma_f32_16x16x32_bf16 v[12:15], v[136:139], v[116:119], v[12:15]
ds_read_b128 v[96:99], v245 offset:38912
v_fma_f32 v208, -v247, v236, v208
v_mfma_f32_16x16x32_bf16 v[48:51], v[136:139], v[120:123], v[48:51]
ds_read_b128 v[100:103], v245 offset:39936
v_fma_f32 v209, -v247, v237, v209
v_mfma_f32_16x16x32_bf16 v[16:19], v[140:143], v[116:119], v[16:19]
ds_read_b128 v[104:107], v245 offset:40960
v_fma_f32 v210, -v247, v238, v210
v_mfma_f32_16x16x32_bf16 v[52:55], v[140:143], v[120:123], v[52:55]
ds_read_b128 v[108:111], v245 offset:41984
v_mfma_f32_16x16x32_bf16 v[20:23], v[144:147], v[116:119], v[20:23]
ds_read_b128 v[112:115], v245 offset:43008
v_fma_f32 v211, -v247, v239, v211
v_mfma_f32_16x16x32_bf16 v[56:59], v[144:147], v[120:123], v[56:59]
v_fma_f32 v212, -v249, v236, v212
v_mfma_f32_16x16x32_bf16 v[24:27], v[148:151], v[116:119], v[24:27]
v_fma_f32 v213, -v249, v237, v213
v_mfma_f32_16x16x32_bf16 v[60:63], v[148:151], v[120:123], v[60:63]
v_mfma_f32_16x16x32_bf16 v[28:31], v[152:155], v[116:119], v[28:31]
v_fma_f32 v214, -v249, v238, v214
v_mfma_f32_16x16x32_bf16 v[64:67], v[152:155], v[120:123], v[64:67]
v_fma_f32 v215, -v249, v239, v215
v_mfma_f32_16x16x32_bf16 v[32:35], v[156:159], v[116:119], v[32:35]
v_mul_f32 v208, v208, v246
v_mfma_f32_16x16x32_bf16 v[68:71], v[156:159], v[120:123], v[68:71]
s_waitcnt lgkmcnt(0)
v_mfma_f32_16x16x32_bf16 v[0:3], v[80:83], v[72:75], v[0:3]
ds_read_b128 v[124:127], v245 offset:44032
v_mfma_f32_16x16x32_bf16 v[36:39], v[80:83], v[76:79], v[36:39]
ds_read_b128 v[116:119], v244 offset:34816
v_mfma_f32_16x16x32_bf16 v[4:7], v[84:87], v[72:75], v[4:7]
ds_read_b128 v[128:131], v245 offset:45056
v_mfma_f32_16x16x32_bf16 v[40:43], v[84:87], v[76:79], v[40:43]
ds_read_b128 v[120:123], v244 offset:35328
v_mfma_f32_16x16x32_bf16 v[8:11], v[88:91], v[72:75], v[8:11]
ds_read_b128 v[132:135], v245 offset:46080
v_mfma_f32_16x16x32_bf16 v[44:47], v[88:91], v[76:79], v[44:47]
ds_read_b128 v[136:139], v245 offset:47104
v_mfma_f32_16x16x32_bf16 v[12:15], v[92:95], v[72:75], v[12:15]
ds_read_b128 v[140:143], v245 offset:48128
v_mul_f32 v209, v209, v246
v_mfma_f32_16x16x32_bf16 v[48:51], v[92:95], v[76:79], v[48:51]
ds_read_b128 v[144:147], v245 offset:49152
v_mul_f32 v210, v210, v246
v_mfma_f32_16x16x32_bf16 v[16:19], v[96:99], v[72:75], v[16:19]
ds_read_b128 v[148:151], v245 offset:50176
v_mul_f32 v211, v211, v246
v_mfma_f32_16x16x32_bf16 v[52:55], v[96:99], v[76:79], v[52:55]
ds_read_b128 v[152:155], v245 offset:51200
v_mfma_f32_16x16x32_bf16 v[20:23], v[100:103], v[72:75], v[20:23]
ds_read_b128 v[156:159], v245 offset:52224
v_mul_f32 v232, v208, v208
v_mfma_f32_16x16x32_bf16 v[56:59], v[100:103], v[76:79], v[56:59]
v_mul_f32 v233, v209, v209
v_mfma_f32_16x16x32_bf16 v[24:27], v[104:107], v[72:75], v[24:27]
v_mul_f32 v234, v210, v210
v_mfma_f32_16x16x32_bf16 v[60:63], v[104:107], v[76:79], v[60:63]
v_mfma_f32_16x16x32_bf16 v[28:31], v[108:111], v[72:75], v[28:31]
v_mul_f32 v235, v211, v211
v_mfma_f32_16x16x32_bf16 v[64:67], v[108:111], v[76:79], v[64:67]
v_fma_f32 v232, v232, s60, v252
v_mfma_f32_16x16x32_bf16 v[32:35], v[112:115], v[72:75], v[32:35]
v_fma_f32 v233, v233, s60, v252
v_mfma_f32_16x16x32_bf16 v[68:71], v[112:115], v[76:79], v[68:71]
s_waitcnt lgkmcnt(0)
s_barrier
v_mfma_f32_16x16x32_bf16 v[0:3], v[124:127], v[116:119], v[0:3]
ds_read_b128 v[80:83], v242 offset:0
v_mfma_f32_16x16x32_bf16 v[36:39], v[124:127], v[120:123], v[36:39]
ds_read_b128 v[72:75], v240 offset:0
v_mfma_f32_16x16x32_bf16 v[4:7], v[128:131], v[116:119], v[4:7]
ds_read_b128 v[84:87], v242 offset:1024
v_mfma_f32_16x16x32_bf16 v[40:43], v[128:131], v[120:123], v[40:43]
ds_read_b128 v[76:79], v240 offset:512
v_mfma_f32_16x16x32_bf16 v[8:11], v[132:135], v[116:119], v[8:11]
ds_read_b128 v[88:91], v242 offset:2048
v_mfma_f32_16x16x32_bf16 v[44:47], v[132:135], v[120:123], v[44:47]
ds_read_b128 v[92:95], v242 offset:3072
v_mfma_f32_16x16x32_bf16 v[12:15], v[136:139], v[116:119], v[12:15]
ds_read_b128 v[96:99], v242 offset:4096
v_fma_f32 v234, v234, s60, v252
v_mfma_f32_16x16x32_bf16 v[48:51], v[136:139], v[120:123], v[48:51]
ds_read_b128 v[100:103], v242 offset:5120
v_fma_f32 v235, v235, s60, v252
v_mfma_f32_16x16x32_bf16 v[16:19], v[140:143], v[116:119], v[16:19]
ds_read_b128 v[104:107], v242 offset:6144
v_mul_f32 v232, v232, v208
v_mfma_f32_16x16x32_bf16 v[52:55], v[140:143], v[120:123], v[52:55]
ds_read_b128 v[108:111], v242 offset:7168
v_mfma_f32_16x16x32_bf16 v[20:23], v[144:147], v[116:119], v[20:23]
ds_read_b128 v[112:115], v242 offset:8192
v_mul_f32 v233, v233, v209
v_mfma_f32_16x16x32_bf16 v[56:59], v[144:147], v[120:123], v[56:59]
v_mul_f32 v234, v234, v210
v_mfma_f32_16x16x32_bf16 v[24:27], v[148:151], v[116:119], v[24:27]
v_mul_f32 v235, v235, v211
v_mfma_f32_16x16x32_bf16 v[60:63], v[148:151], v[120:123], v[60:63]
v_mfma_f32_16x16x32_bf16 v[28:31], v[152:155], v[116:119], v[28:31]
v_exp_f32 v232, v232
v_mfma_f32_16x16x32_bf16 v[64:67], v[152:155], v[120:123], v[64:67]
v_exp_f32 v233, v233
v_mfma_f32_16x16x32_bf16 v[32:35], v[156:159], v[116:119], v[32:35]
v_exp_f32 v234, v234
v_mfma_f32_16x16x32_bf16 v[68:71], v[156:159], v[120:123], v[68:71]
s_waitcnt lgkmcnt(0)
v_mfma_f32_16x16x32_bf16 v[0:3], v[80:83], v[72:75], v[0:3]
ds_read_b128 v[124:127], v242 offset:9216
v_mfma_f32_16x16x32_bf16 v[36:39], v[80:83], v[76:79], v[36:39]
ds_read_b128 v[116:119], v241 offset:0
v_mfma_f32_16x16x32_bf16 v[4:7], v[84:87], v[72:75], v[4:7]
ds_read_b128 v[128:131], v242 offset:10240
v_mfma_f32_16x16x32_bf16 v[40:43], v[84:87], v[76:79], v[40:43]
ds_read_b128 v[120:123], v241 offset:512
v_mfma_f32_16x16x32_bf16 v[8:11], v[88:91], v[72:75], v[8:11]
ds_read_b128 v[132:135], v242 offset:11264
v_mfma_f32_16x16x32_bf16 v[44:47], v[88:91], v[76:79], v[44:47]
ds_read_b128 v[136:139], v242 offset:12288
v_mfma_f32_16x16x32_bf16 v[12:15], v[92:95], v[72:75], v[12:15]
ds_read_b128 v[140:143], v242 offset:13312
v_exp_f32 v235, v235
v_mfma_f32_16x16x32_bf16 v[48:51], v[92:95], v[76:79], v[48:51]
ds_read_b128 v[144:147], v242 offset:14336
v_add_f32 v232, 1.0, v232
v_mfma_f32_16x16x32_bf16 v[16:19], v[96:99], v[72:75], v[16:19]
ds_read_b128 v[148:151], v242 offset:15360
v_add_f32 v233, 1.0, v233
v_mfma_f32_16x16x32_bf16 v[52:55], v[96:99], v[76:79], v[52:55]
ds_read_b128 v[152:155], v242 offset:16384
v_mfma_f32_16x16x32_bf16 v[20:23], v[100:103], v[72:75], v[20:23]
ds_read_b128 v[156:159], v242 offset:17408
v_add_f32 v234, 1.0, v234
v_mfma_f32_16x16x32_bf16 v[56:59], v[100:103], v[76:79], v[56:59]
v_add_f32 v235, 1.0, v235
v_mfma_f32_16x16x32_bf16 v[24:27], v[104:107], v[72:75], v[24:27]
v_rcp_f32 v232, v232
v_mfma_f32_16x16x32_bf16 v[60:63], v[104:107], v[76:79], v[60:63]
v_mfma_f32_16x16x32_bf16 v[28:31], v[108:111], v[72:75], v[28:31]
v_rcp_f32 v233, v233
v_mfma_f32_16x16x32_bf16 v[64:67], v[108:111], v[76:79], v[64:67]
v_rcp_f32 v234, v234
v_mfma_f32_16x16x32_bf16 v[32:35], v[112:115], v[72:75], v[32:35]
v_rcp_f32 v235, v235
v_mfma_f32_16x16x32_bf16 v[68:71], v[112:115], v[76:79], v[68:71]
s_waitcnt lgkmcnt(0)
s_barrier
v_mfma_f32_16x16x32_bf16 v[0:3], v[124:127], v[116:119], v[0:3]
ds_read_b128 v[80:83], v242 offset:34816
v_mfma_f32_16x16x32_bf16 v[36:39], v[124:127], v[120:123], v[36:39]
ds_read_b128 v[72:75], v240 offset:34816
v_mfma_f32_16x16x32_bf16 v[4:7], v[128:131], v[116:119], v[4:7]
ds_read_b128 v[84:87], v242 offset:35840
v_mfma_f32_16x16x32_bf16 v[40:43], v[128:131], v[120:123], v[40:43]
ds_read_b128 v[76:79], v240 offset:35328
v_mfma_f32_16x16x32_bf16 v[8:11], v[132:135], v[116:119], v[8:11]
ds_read_b128 v[88:91], v242 offset:36864
v_mfma_f32_16x16x32_bf16 v[44:47], v[132:135], v[120:123], v[44:47]
ds_read_b128 v[92:95], v242 offset:37888
v_mfma_f32_16x16x32_bf16 v[12:15], v[136:139], v[116:119], v[12:15]
ds_read_b128 v[96:99], v242 offset:38912
v_mul_f32 v208, v208, v232
v_mfma_f32_16x16x32_bf16 v[48:51], v[136:139], v[120:123], v[48:51]
ds_read_b128 v[100:103], v242 offset:39936
v_mul_f32 v209, v209, v233
v_mfma_f32_16x16x32_bf16 v[16:19], v[140:143], v[116:119], v[16:19]
ds_read_b128 v[104:107], v242 offset:40960
v_mul_f32 v210, v210, v234
v_mfma_f32_16x16x32_bf16 v[52:55], v[140:143], v[120:123], v[52:55]
ds_read_b128 v[108:111], v242 offset:41984
v_mfma_f32_16x16x32_bf16 v[20:23], v[144:147], v[116:119], v[20:23]
ds_read_b128 v[112:115], v242 offset:43008
v_mul_f32 v211, v211, v235
v_mfma_f32_16x16x32_bf16 v[56:59], v[144:147], v[120:123], v[56:59]
v_mul_f32 v212, v212, v248
v_mfma_f32_16x16x32_bf16 v[24:27], v[148:151], v[116:119], v[24:27]
v_mul_f32 v213, v213, v248
v_mfma_f32_16x16x32_bf16 v[60:63], v[148:151], v[120:123], v[60:63]
v_mfma_f32_16x16x32_bf16 v[28:31], v[152:155], v[116:119], v[28:31]
v_mul_f32 v214, v214, v248
v_mfma_f32_16x16x32_bf16 v[64:67], v[152:155], v[120:123], v[64:67]
v_mul_f32 v215, v215, v248
v_mfma_f32_16x16x32_bf16 v[32:35], v[156:159], v[116:119], v[32:35]
v_mul_f32 v232, v212, v212
v_mfma_f32_16x16x32_bf16 v[68:71], v[156:159], v[120:123], v[68:71]
s_waitcnt lgkmcnt(0)
v_mfma_f32_16x16x32_bf16 v[0:3], v[80:83], v[72:75], v[0:3]
ds_read_b128 v[124:127], v242 offset:44032
v_mfma_f32_16x16x32_bf16 v[36:39], v[80:83], v[76:79], v[36:39]
ds_read_b128 v[116:119], v241 offset:34816
v_mfma_f32_16x16x32_bf16 v[4:7], v[84:87], v[72:75], v[4:7]
ds_read_b128 v[128:131], v242 offset:45056
v_mfma_f32_16x16x32_bf16 v[40:43], v[84:87], v[76:79], v[40:43]
ds_read_b128 v[120:123], v241 offset:35328
v_mfma_f32_16x16x32_bf16 v[8:11], v[88:91], v[72:75], v[8:11]
ds_read_b128 v[132:135], v242 offset:46080
v_mfma_f32_16x16x32_bf16 v[44:47], v[88:91], v[76:79], v[44:47]
ds_read_b128 v[136:139], v242 offset:47104
v_mfma_f32_16x16x32_bf16 v[12:15], v[92:95], v[72:75], v[12:15]
ds_read_b128 v[140:143], v242 offset:48128
v_mul_f32 v233, v213, v213
v_mfma_f32_16x16x32_bf16 v[48:51], v[92:95], v[76:79], v[48:51]
ds_read_b128 v[144:147], v242 offset:49152
v_mul_f32 v234, v214, v214
v_mfma_f32_16x16x32_bf16 v[16:19], v[96:99], v[72:75], v[16:19]
ds_read_b128 v[148:151], v242 offset:50176
v_mul_f32 v235, v215, v215
v_mfma_f32_16x16x32_bf16 v[52:55], v[96:99], v[76:79], v[52:55]
ds_read_b128 v[152:155], v242 offset:51200
v_mfma_f32_16x16x32_bf16 v[20:23], v[100:103], v[72:75], v[20:23]
ds_read_b128 v[156:159], v242 offset:52224
v_fma_f32 v232, v232, s60, v252
v_mfma_f32_16x16x32_bf16 v[56:59], v[100:103], v[76:79], v[56:59]
v_fma_f32 v233, v233, s60, v252
v_mfma_f32_16x16x32_bf16 v[24:27], v[104:107], v[72:75], v[24:27]
v_fma_f32 v234, v234, s60, v252
v_mfma_f32_16x16x32_bf16 v[60:63], v[104:107], v[76:79], v[60:63]
v_mfma_f32_16x16x32_bf16 v[28:31], v[108:111], v[72:75], v[28:31]
v_fma_f32 v235, v235, s60, v252
v_mfma_f32_16x16x32_bf16 v[64:67], v[108:111], v[76:79], v[64:67]
v_mul_f32 v232, v232, v212
v_mfma_f32_16x16x32_bf16 v[32:35], v[112:115], v[72:75], v[32:35]
v_mul_f32 v233, v233, v213
v_mfma_f32_16x16x32_bf16 v[68:71], v[112:115], v[76:79], v[68:71]
s_waitcnt lgkmcnt(0)
s_barrier
v_mfma_f32_16x16x32_bf16 v[0:3], v[124:127], v[116:119], v[0:3]
ds_read_b128 v[80:83], v245 offset:0
v_mfma_f32_16x16x32_bf16 v[36:39], v[124:127], v[120:123], v[36:39]
ds_read_b128 v[72:75], v243 offset:0
v_mfma_f32_16x16x32_bf16 v[4:7], v[128:131], v[116:119], v[4:7]
ds_read_b128 v[84:87], v245 offset:1024
v_mfma_f32_16x16x32_bf16 v[40:43], v[128:131], v[120:123], v[40:43]
ds_read_b128 v[76:79], v243 offset:512
v_mfma_f32_16x16x32_bf16 v[8:11], v[132:135], v[116:119], v[8:11]
ds_read_b128 v[88:91], v245 offset:2048
v_mfma_f32_16x16x32_bf16 v[44:47], v[132:135], v[120:123], v[44:47]
ds_read_b128 v[92:95], v245 offset:3072
v_mfma_f32_16x16x32_bf16 v[12:15], v[136:139], v[116:119], v[12:15]
ds_read_b128 v[96:99], v245 offset:4096
v_mul_f32 v234, v234, v214
v_mfma_f32_16x16x32_bf16 v[48:51], v[136:139], v[120:123], v[48:51]
ds_read_b128 v[100:103], v245 offset:5120
v_mul_f32 v235, v235, v215
v_mfma_f32_16x16x32_bf16 v[16:19], v[140:143], v[116:119], v[16:19]
ds_read_b128 v[104:107], v245 offset:6144
v_exp_f32 v232, v232
v_mfma_f32_16x16x32_bf16 v[52:55], v[140:143], v[120:123], v[52:55]
ds_read_b128 v[108:111], v245 offset:7168
v_mfma_f32_16x16x32_bf16 v[20:23], v[144:147], v[116:119], v[20:23]
ds_read_b128 v[112:115], v245 offset:8192
v_exp_f32 v233, v233
v_mfma_f32_16x16x32_bf16 v[56:59], v[144:147], v[120:123], v[56:59]
v_exp_f32 v234, v234
v_mfma_f32_16x16x32_bf16 v[24:27], v[148:151], v[116:119], v[24:27]
v_exp_f32 v235, v235
v_mfma_f32_16x16x32_bf16 v[60:63], v[148:151], v[120:123], v[60:63]
v_mfma_f32_16x16x32_bf16 v[28:31], v[152:155], v[116:119], v[28:31]
v_add_f32 v232, 1.0, v232
v_mfma_f32_16x16x32_bf16 v[64:67], v[152:155], v[120:123], v[64:67]
v_add_f32 v233, 1.0, v233
v_mfma_f32_16x16x32_bf16 v[32:35], v[156:159], v[116:119], v[32:35]
v_add_f32 v234, 1.0, v234
v_mfma_f32_16x16x32_bf16 v[68:71], v[156:159], v[120:123], v[68:71]
s_waitcnt lgkmcnt(0)
v_mfma_f32_16x16x32_bf16 v[0:3], v[80:83], v[72:75], v[0:3]
ds_read_b128 v[124:127], v245 offset:9216
v_mfma_f32_16x16x32_bf16 v[36:39], v[80:83], v[76:79], v[36:39]
ds_read_b128 v[116:119], v244 offset:0
v_mfma_f32_16x16x32_bf16 v[4:7], v[84:87], v[72:75], v[4:7]
ds_read_b128 v[128:131], v245 offset:10240
v_mfma_f32_16x16x32_bf16 v[40:43], v[84:87], v[76:79], v[40:43]
ds_read_b128 v[120:123], v244 offset:512
v_mfma_f32_16x16x32_bf16 v[8:11], v[88:91], v[72:75], v[8:11]
ds_read_b128 v[132:135], v245 offset:11264
v_mfma_f32_16x16x32_bf16 v[44:47], v[88:91], v[76:79], v[44:47]
ds_read_b128 v[136:139], v245 offset:12288
v_mfma_f32_16x16x32_bf16 v[12:15], v[92:95], v[72:75], v[12:15]
ds_read_b128 v[140:143], v245 offset:13312
v_add_f32 v235, 1.0, v235
v_mfma_f32_16x16x32_bf16 v[48:51], v[92:95], v[76:79], v[48:51]
ds_read_b128 v[144:147], v245 offset:14336
v_rcp_f32 v232, v232
v_mfma_f32_16x16x32_bf16 v[16:19], v[96:99], v[72:75], v[16:19]
ds_read_b128 v[148:151], v245 offset:15360
v_rcp_f32 v233, v233
v_mfma_f32_16x16x32_bf16 v[52:55], v[96:99], v[76:79], v[52:55]
ds_read_b128 v[152:155], v245 offset:16384
v_mfma_f32_16x16x32_bf16 v[20:23], v[100:103], v[72:75], v[20:23]
ds_read_b128 v[156:159], v245 offset:17408
v_rcp_f32 v234, v234
v_mfma_f32_16x16x32_bf16 v[56:59], v[100:103], v[76:79], v[56:59]
v_rcp_f32 v235, v235
v_mfma_f32_16x16x32_bf16 v[24:27], v[104:107], v[72:75], v[24:27]
v_mul_f32 v212, v212, v232
v_mfma_f32_16x16x32_bf16 v[60:63], v[104:107], v[76:79], v[60:63]
v_mfma_f32_16x16x32_bf16 v[28:31], v[108:111], v[72:75], v[28:31]
v_mul_f32 v213, v213, v233
v_mfma_f32_16x16x32_bf16 v[64:67], v[108:111], v[76:79], v[64:67]
v_mul_f32 v214, v214, v234
v_mfma_f32_16x16x32_bf16 v[32:35], v[112:115], v[72:75], v[32:35]
v_mul_f32 v215, v215, v235
v_mfma_f32_16x16x32_bf16 v[68:71], v[112:115], v[76:79], v[68:71]
s_waitcnt lgkmcnt(0)
s_barrier
v_mfma_f32_16x16x32_bf16 v[0:3], v[124:127], v[116:119], v[0:3]
ds_read_b128 v[80:83], v245 offset:34816
v_mfma_f32_16x16x32_bf16 v[36:39], v[124:127], v[120:123], v[36:39]
ds_read_b128 v[72:75], v243 offset:34816
v_mfma_f32_16x16x32_bf16 v[4:7], v[128:131], v[116:119], v[4:7]
ds_read_b128 v[84:87], v245 offset:35840
v_mfma_f32_16x16x32_bf16 v[40:43], v[128:131], v[120:123], v[40:43]
ds_read_b128 v[76:79], v243 offset:35328
v_mfma_f32_16x16x32_bf16 v[8:11], v[132:135], v[116:119], v[8:11]
ds_read_b128 v[88:91], v245 offset:36864
v_mfma_f32_16x16x32_bf16 v[44:47], v[132:135], v[120:123], v[44:47]
ds_read_b128 v[92:95], v245 offset:37888
v_mfma_f32_16x16x32_bf16 v[12:15], v[136:139], v[116:119], v[12:15]
ds_read_b128 v[96:99], v245 offset:38912
ds_read_b128 v[236:239], v250 offset:2048
v_mfma_f32_16x16x32_bf16 v[48:51], v[136:139], v[120:123], v[48:51]
ds_read_b128 v[100:103], v245 offset:39936
v_mfma_f32_16x16x32_bf16 v[16:19], v[140:143], v[116:119], v[16:19]
ds_read_b128 v[104:107], v245 offset:40960
v_mfma_f32_16x16x32_bf16 v[52:55], v[140:143], v[120:123], v[52:55]
ds_read_b128 v[108:111], v245 offset:41984
v_mfma_f32_16x16x32_bf16 v[20:23], v[144:147], v[116:119], v[20:23]
ds_read_b128 v[112:115], v245 offset:43008
v_mfma_f32_16x16x32_bf16 v[56:59], v[144:147], v[120:123], v[56:59]
v_mfma_f32_16x16x32_bf16 v[24:27], v[148:151], v[116:119], v[24:27]
v_mfma_f32_16x16x32_bf16 v[60:63], v[148:151], v[120:123], v[60:63]
v_mfma_f32_16x16x32_bf16 v[28:31], v[152:155], v[116:119], v[28:31]
v_mfma_f32_16x16x32_bf16 v[64:67], v[152:155], v[120:123], v[64:67]
v_mfma_f32_16x16x32_bf16 v[32:35], v[156:159], v[116:119], v[32:35]
v_mfma_f32_16x16x32_bf16 v[68:71], v[156:159], v[120:123], v[68:71]
s_waitcnt lgkmcnt(0)
v_mfma_f32_16x16x32_bf16 v[0:3], v[80:83], v[72:75], v[0:3]
ds_read_b128 v[124:127], v245 offset:44032
v_mfma_f32_16x16x32_bf16 v[36:39], v[80:83], v[76:79], v[36:39]
ds_read_b128 v[116:119], v244 offset:34816
v_mfma_f32_16x16x32_bf16 v[4:7], v[84:87], v[72:75], v[4:7]
ds_read_b128 v[128:131], v245 offset:45056
v_mfma_f32_16x16x32_bf16 v[40:43], v[84:87], v[76:79], v[40:43]
ds_read_b128 v[120:123], v244 offset:35328
v_mfma_f32_16x16x32_bf16 v[8:11], v[88:91], v[72:75], v[8:11]
ds_read_b128 v[132:135], v245 offset:46080
v_mfma_f32_16x16x32_bf16 v[44:47], v[88:91], v[76:79], v[44:47]
ds_read_b128 v[136:139], v245 offset:47104
v_mfma_f32_16x16x32_bf16 v[12:15], v[92:95], v[72:75], v[12:15]
ds_read_b128 v[140:143], v245 offset:48128
v_fma_f32 v216, -v247, v236, v216
v_mfma_f32_16x16x32_bf16 v[48:51], v[92:95], v[76:79], v[48:51]
ds_read_b128 v[144:147], v245 offset:49152
v_fma_f32 v217, -v247, v237, v217
v_mfma_f32_16x16x32_bf16 v[16:19], v[96:99], v[72:75], v[16:19]
ds_read_b128 v[148:151], v245 offset:50176
v_fma_f32 v218, -v247, v238, v218
v_mfma_f32_16x16x32_bf16 v[52:55], v[96:99], v[76:79], v[52:55]
ds_read_b128 v[152:155], v245 offset:51200
v_mfma_f32_16x16x32_bf16 v[20:23], v[100:103], v[72:75], v[20:23]
ds_read_b128 v[156:159], v245 offset:52224
v_fma_f32 v219, -v247, v239, v219
v_mfma_f32_16x16x32_bf16 v[56:59], v[100:103], v[76:79], v[56:59]
v_fma_f32 v220, -v249, v236, v220
v_mfma_f32_16x16x32_bf16 v[24:27], v[104:107], v[72:75], v[24:27]
v_fma_f32 v221, -v249, v237, v221
v_mfma_f32_16x16x32_bf16 v[60:63], v[104:107], v[76:79], v[60:63]
v_mfma_f32_16x16x32_bf16 v[28:31], v[108:111], v[72:75], v[28:31]
v_fma_f32 v222, -v249, v238, v222
v_mfma_f32_16x16x32_bf16 v[64:67], v[108:111], v[76:79], v[64:67]
v_fma_f32 v223, -v249, v239, v223
v_mfma_f32_16x16x32_bf16 v[32:35], v[112:115], v[72:75], v[32:35]
v_mul_f32 v216, v216, v246
v_mfma_f32_16x16x32_bf16 v[68:71], v[112:115], v[76:79], v[68:71]
s_waitcnt lgkmcnt(0)
s_barrier
v_mfma_f32_16x16x32_bf16 v[0:3], v[124:127], v[116:119], v[0:3]
ds_read_b128 v[80:83], v242 offset:0
v_mfma_f32_16x16x32_bf16 v[36:39], v[124:127], v[120:123], v[36:39]
ds_read_b128 v[72:75], v240 offset:0
v_mfma_f32_16x16x32_bf16 v[4:7], v[128:131], v[116:119], v[4:7]
ds_read_b128 v[84:87], v242 offset:1024
v_mfma_f32_16x16x32_bf16 v[40:43], v[128:131], v[120:123], v[40:43]
ds_read_b128 v[76:79], v240 offset:512
v_mfma_f32_16x16x32_bf16 v[8:11], v[132:135], v[116:119], v[8:11]
ds_read_b128 v[88:91], v242 offset:2048
v_mfma_f32_16x16x32_bf16 v[44:47], v[132:135], v[120:123], v[44:47]
ds_read_b128 v[92:95], v242 offset:3072
v_mfma_f32_16x16x32_bf16 v[12:15], v[136:139], v[116:119], v[12:15]
ds_read_b128 v[96:99], v242 offset:4096
v_mul_f32 v217, v217, v246
v_mfma_f32_16x16x32_bf16 v[48:51], v[136:139], v[120:123], v[48:51]
ds_read_b128 v[100:103], v242 offset:5120
v_mul_f32 v218, v218, v246
v_mfma_f32_16x16x32_bf16 v[16:19], v[140:143], v[116:119], v[16:19]
ds_read_b128 v[104:107], v242 offset:6144
v_mul_f32 v219, v219, v246
v_mfma_f32_16x16x32_bf16 v[52:55], v[140:143], v[120:123], v[52:55]
ds_read_b128 v[108:111], v242 offset:7168
v_mfma_f32_16x16x32_bf16 v[20:23], v[144:147], v[116:119], v[20:23]
ds_read_b128 v[112:115], v242 offset:8192
v_mul_f32 v232, v216, v216
v_mfma_f32_16x16x32_bf16 v[56:59], v[144:147], v[120:123], v[56:59]
v_mul_f32 v233, v217, v217
v_mfma_f32_16x16x32_bf16 v[24:27], v[148:151], v[116:119], v[24:27]
v_mul_f32 v234, v218, v218
v_mfma_f32_16x16x32_bf16 v[60:63], v[148:151], v[120:123], v[60:63]
v_mfma_f32_16x16x32_bf16 v[28:31], v[152:155], v[116:119], v[28:31]
v_mul_f32 v235, v219, v219
v_mfma_f32_16x16x32_bf16 v[64:67], v[152:155], v[120:123], v[64:67]
v_fma_f32 v232, v232, s60, v252
v_mfma_f32_16x16x32_bf16 v[32:35], v[156:159], v[116:119], v[32:35]
v_fma_f32 v233, v233, s60, v252
v_mfma_f32_16x16x32_bf16 v[68:71], v[156:159], v[120:123], v[68:71]
s_waitcnt lgkmcnt(0)
v_mfma_f32_16x16x32_bf16 v[0:3], v[80:83], v[72:75], v[0:3]
ds_read_b128 v[124:127], v242 offset:9216
v_mfma_f32_16x16x32_bf16 v[36:39], v[80:83], v[76:79], v[36:39]
ds_read_b128 v[116:119], v241 offset:0
v_mfma_f32_16x16x32_bf16 v[4:7], v[84:87], v[72:75], v[4:7]
ds_read_b128 v[128:131], v242 offset:10240
v_mfma_f32_16x16x32_bf16 v[40:43], v[84:87], v[76:79], v[40:43]
ds_read_b128 v[120:123], v241 offset:512
v_mfma_f32_16x16x32_bf16 v[8:11], v[88:91], v[72:75], v[8:11]
ds_read_b128 v[132:135], v242 offset:11264
v_mfma_f32_16x16x32_bf16 v[44:47], v[88:91], v[76:79], v[44:47]
ds_read_b128 v[136:139], v242 offset:12288
v_mfma_f32_16x16x32_bf16 v[12:15], v[92:95], v[72:75], v[12:15]
ds_read_b128 v[140:143], v242 offset:13312
v_fma_f32 v234, v234, s60, v252
v_mfma_f32_16x16x32_bf16 v[48:51], v[92:95], v[76:79], v[48:51]
ds_read_b128 v[144:147], v242 offset:14336
v_fma_f32 v235, v235, s60, v252
v_mfma_f32_16x16x32_bf16 v[16:19], v[96:99], v[72:75], v[16:19]
ds_read_b128 v[148:151], v242 offset:15360
v_mul_f32 v232, v232, v216
v_mfma_f32_16x16x32_bf16 v[52:55], v[96:99], v[76:79], v[52:55]
ds_read_b128 v[152:155], v242 offset:16384
v_mfma_f32_16x16x32_bf16 v[20:23], v[100:103], v[72:75], v[20:23]
ds_read_b128 v[156:159], v242 offset:17408
v_mul_f32 v233, v233, v217
v_mfma_f32_16x16x32_bf16 v[56:59], v[100:103], v[76:79], v[56:59]
v_mul_f32 v234, v234, v218
v_mfma_f32_16x16x32_bf16 v[24:27], v[104:107], v[72:75], v[24:27]
v_mul_f32 v235, v235, v219
v_mfma_f32_16x16x32_bf16 v[60:63], v[104:107], v[76:79], v[60:63]
v_mfma_f32_16x16x32_bf16 v[28:31], v[108:111], v[72:75], v[28:31]
v_exp_f32 v232, v232
v_mfma_f32_16x16x32_bf16 v[64:67], v[108:111], v[76:79], v[64:67]
v_exp_f32 v233, v233
v_mfma_f32_16x16x32_bf16 v[32:35], v[112:115], v[72:75], v[32:35]
v_exp_f32 v234, v234
v_mfma_f32_16x16x32_bf16 v[68:71], v[112:115], v[76:79], v[68:71]
s_waitcnt lgkmcnt(0)
s_barrier
v_mfma_f32_16x16x32_bf16 v[0:3], v[124:127], v[116:119], v[0:3]
ds_read_b128 v[80:83], v242 offset:34816
v_mfma_f32_16x16x32_bf16 v[36:39], v[124:127], v[120:123], v[36:39]
ds_read_b128 v[72:75], v240 offset:34816
v_mfma_f32_16x16x32_bf16 v[4:7], v[128:131], v[116:119], v[4:7]
ds_read_b128 v[84:87], v242 offset:35840
v_mfma_f32_16x16x32_bf16 v[40:43], v[128:131], v[120:123], v[40:43]
ds_read_b128 v[76:79], v240 offset:35328
v_mfma_f32_16x16x32_bf16 v[8:11], v[132:135], v[116:119], v[8:11]
ds_read_b128 v[88:91], v242 offset:36864
v_mfma_f32_16x16x32_bf16 v[44:47], v[132:135], v[120:123], v[44:47]
ds_read_b128 v[92:95], v242 offset:37888
v_mfma_f32_16x16x32_bf16 v[12:15], v[136:139], v[116:119], v[12:15]
ds_read_b128 v[96:99], v242 offset:38912
v_exp_f32 v235, v235
v_mfma_f32_16x16x32_bf16 v[48:51], v[136:139], v[120:123], v[48:51]
ds_read_b128 v[100:103], v242 offset:39936
v_add_f32 v232, 1.0, v232
v_mfma_f32_16x16x32_bf16 v[16:19], v[140:143], v[116:119], v[16:19]
ds_read_b128 v[104:107], v242 offset:40960
v_add_f32 v233, 1.0, v233
v_mfma_f32_16x16x32_bf16 v[52:55], v[140:143], v[120:123], v[52:55]
ds_read_b128 v[108:111], v242 offset:41984
v_mfma_f32_16x16x32_bf16 v[20:23], v[144:147], v[116:119], v[20:23]
ds_read_b128 v[112:115], v242 offset:43008
v_add_f32 v234, 1.0, v234
v_mfma_f32_16x16x32_bf16 v[56:59], v[144:147], v[120:123], v[56:59]
v_add_f32 v235, 1.0, v235
v_mfma_f32_16x16x32_bf16 v[24:27], v[148:151], v[116:119], v[24:27]
v_rcp_f32 v232, v232
v_mfma_f32_16x16x32_bf16 v[60:63], v[148:151], v[120:123], v[60:63]
v_mfma_f32_16x16x32_bf16 v[28:31], v[152:155], v[116:119], v[28:31]
v_rcp_f32 v233, v233
v_mfma_f32_16x16x32_bf16 v[64:67], v[152:155], v[120:123], v[64:67]
v_rcp_f32 v234, v234
v_mfma_f32_16x16x32_bf16 v[32:35], v[156:159], v[116:119], v[32:35]
v_rcp_f32 v235, v235
v_mfma_f32_16x16x32_bf16 v[68:71], v[156:159], v[120:123], v[68:71]
s_waitcnt lgkmcnt(0)
v_mfma_f32_16x16x32_bf16 v[0:3], v[80:83], v[72:75], v[0:3]
ds_read_b128 v[124:127], v242 offset:44032
v_mfma_f32_16x16x32_bf16 v[36:39], v[80:83], v[76:79], v[36:39]
ds_read_b128 v[116:119], v241 offset:34816
v_mfma_f32_16x16x32_bf16 v[4:7], v[84:87], v[72:75], v[4:7]
ds_read_b128 v[128:131], v242 offset:45056
v_mfma_f32_16x16x32_bf16 v[40:43], v[84:87], v[76:79], v[40:43]
ds_read_b128 v[120:123], v241 offset:35328
v_mfma_f32_16x16x32_bf16 v[8:11], v[88:91], v[72:75], v[8:11]
ds_read_b128 v[132:135], v242 offset:46080
v_mfma_f32_16x16x32_bf16 v[44:47], v[88:91], v[76:79], v[44:47]
ds_read_b128 v[136:139], v242 offset:47104
v_mfma_f32_16x16x32_bf16 v[12:15], v[92:95], v[72:75], v[12:15]
ds_read_b128 v[140:143], v242 offset:48128
v_mul_f32 v216, v216, v232
v_mfma_f32_16x16x32_bf16 v[48:51], v[92:95], v[76:79], v[48:51]
ds_read_b128 v[144:147], v242 offset:49152
v_mul_f32 v217, v217, v233
v_mfma_f32_16x16x32_bf16 v[16:19], v[96:99], v[72:75], v[16:19]
ds_read_b128 v[148:151], v242 offset:50176
v_mul_f32 v218, v218, v234
v_mfma_f32_16x16x32_bf16 v[52:55], v[96:99], v[76:79], v[52:55]
ds_read_b128 v[152:155], v242 offset:51200
v_mfma_f32_16x16x32_bf16 v[20:23], v[100:103], v[72:75], v[20:23]
ds_read_b128 v[156:159], v242 offset:52224
v_mul_f32 v219, v219, v235
v_mfma_f32_16x16x32_bf16 v[56:59], v[100:103], v[76:79], v[56:59]
v_mul_f32 v220, v220, v248
v_mfma_f32_16x16x32_bf16 v[24:27], v[104:107], v[72:75], v[24:27]
v_mul_f32 v221, v221, v248
v_mfma_f32_16x16x32_bf16 v[60:63], v[104:107], v[76:79], v[60:63]
v_mfma_f32_16x16x32_bf16 v[28:31], v[108:111], v[72:75], v[28:31]
v_mul_f32 v222, v222, v248
v_mfma_f32_16x16x32_bf16 v[64:67], v[108:111], v[76:79], v[64:67]
v_mul_f32 v223, v223, v248
v_mfma_f32_16x16x32_bf16 v[32:35], v[112:115], v[72:75], v[32:35]
v_mul_f32 v232, v220, v220
v_mfma_f32_16x16x32_bf16 v[68:71], v[112:115], v[76:79], v[68:71]
s_waitcnt lgkmcnt(0)
s_barrier
v_mfma_f32_16x16x32_bf16 v[0:3], v[124:127], v[116:119], v[0:3]
ds_read_b128 v[80:83], v245 offset:0
v_mfma_f32_16x16x32_bf16 v[36:39], v[124:127], v[120:123], v[36:39]
ds_read_b128 v[72:75], v243 offset:0
v_mfma_f32_16x16x32_bf16 v[4:7], v[128:131], v[116:119], v[4:7]
ds_read_b128 v[84:87], v245 offset:1024
v_mfma_f32_16x16x32_bf16 v[40:43], v[128:131], v[120:123], v[40:43]
ds_read_b128 v[76:79], v243 offset:512
v_mfma_f32_16x16x32_bf16 v[8:11], v[132:135], v[116:119], v[8:11]
ds_read_b128 v[88:91], v245 offset:2048
v_mfma_f32_16x16x32_bf16 v[44:47], v[132:135], v[120:123], v[44:47]
ds_read_b128 v[92:95], v245 offset:3072
v_mfma_f32_16x16x32_bf16 v[12:15], v[136:139], v[116:119], v[12:15]
ds_read_b128 v[96:99], v245 offset:4096
v_mul_f32 v233, v221, v221
v_mfma_f32_16x16x32_bf16 v[48:51], v[136:139], v[120:123], v[48:51]
ds_read_b128 v[100:103], v245 offset:5120
v_mul_f32 v234, v222, v222
v_mfma_f32_16x16x32_bf16 v[16:19], v[140:143], v[116:119], v[16:19]
ds_read_b128 v[104:107], v245 offset:6144
v_mul_f32 v235, v223, v223
v_mfma_f32_16x16x32_bf16 v[52:55], v[140:143], v[120:123], v[52:55]
ds_read_b128 v[108:111], v245 offset:7168
v_mfma_f32_16x16x32_bf16 v[20:23], v[144:147], v[116:119], v[20:23]
ds_read_b128 v[112:115], v245 offset:8192
v_fma_f32 v232, v232, s60, v252
v_mfma_f32_16x16x32_bf16 v[56:59], v[144:147], v[120:123], v[56:59]
v_fma_f32 v233, v233, s60, v252
v_mfma_f32_16x16x32_bf16 v[24:27], v[148:151], v[116:119], v[24:27]
v_fma_f32 v234, v234, s60, v252
v_mfma_f32_16x16x32_bf16 v[60:63], v[148:151], v[120:123], v[60:63]
v_mfma_f32_16x16x32_bf16 v[28:31], v[152:155], v[116:119], v[28:31]
v_fma_f32 v235, v235, s60, v252
v_mfma_f32_16x16x32_bf16 v[64:67], v[152:155], v[120:123], v[64:67]
v_mul_f32 v232, v232, v220
v_mfma_f32_16x16x32_bf16 v[32:35], v[156:159], v[116:119], v[32:35]
v_mul_f32 v233, v233, v221
v_mfma_f32_16x16x32_bf16 v[68:71], v[156:159], v[120:123], v[68:71]
s_waitcnt lgkmcnt(0)
v_mfma_f32_16x16x32_bf16 v[0:3], v[80:83], v[72:75], v[0:3]
ds_read_b128 v[124:127], v245 offset:9216
v_mfma_f32_16x16x32_bf16 v[36:39], v[80:83], v[76:79], v[36:39]
ds_read_b128 v[116:119], v244 offset:0
v_mfma_f32_16x16x32_bf16 v[4:7], v[84:87], v[72:75], v[4:7]
ds_read_b128 v[128:131], v245 offset:10240
v_mfma_f32_16x16x32_bf16 v[40:43], v[84:87], v[76:79], v[40:43]
ds_read_b128 v[120:123], v244 offset:512
v_mfma_f32_16x16x32_bf16 v[8:11], v[88:91], v[72:75], v[8:11]
ds_read_b128 v[132:135], v245 offset:11264
v_mfma_f32_16x16x32_bf16 v[44:47], v[88:91], v[76:79], v[44:47]
ds_read_b128 v[136:139], v245 offset:12288
v_mfma_f32_16x16x32_bf16 v[12:15], v[92:95], v[72:75], v[12:15]
ds_read_b128 v[140:143], v245 offset:13312
v_mul_f32 v234, v234, v222
v_mfma_f32_16x16x32_bf16 v[48:51], v[92:95], v[76:79], v[48:51]
ds_read_b128 v[144:147], v245 offset:14336
v_mul_f32 v235, v235, v223
v_mfma_f32_16x16x32_bf16 v[16:19], v[96:99], v[72:75], v[16:19]
ds_read_b128 v[148:151], v245 offset:15360
v_exp_f32 v232, v232
v_mfma_f32_16x16x32_bf16 v[52:55], v[96:99], v[76:79], v[52:55]
ds_read_b128 v[152:155], v245 offset:16384
v_mfma_f32_16x16x32_bf16 v[20:23], v[100:103], v[72:75], v[20:23]
ds_read_b128 v[156:159], v245 offset:17408
v_exp_f32 v233, v233
v_mfma_f32_16x16x32_bf16 v[56:59], v[100:103], v[76:79], v[56:59]
v_exp_f32 v234, v234
v_mfma_f32_16x16x32_bf16 v[24:27], v[104:107], v[72:75], v[24:27]
v_exp_f32 v235, v235
v_mfma_f32_16x16x32_bf16 v[60:63], v[104:107], v[76:79], v[60:63]
v_mfma_f32_16x16x32_bf16 v[28:31], v[108:111], v[72:75], v[28:31]
v_add_f32 v232, 1.0, v232
v_mfma_f32_16x16x32_bf16 v[64:67], v[108:111], v[76:79], v[64:67]
v_add_f32 v233, 1.0, v233
v_mfma_f32_16x16x32_bf16 v[32:35], v[112:115], v[72:75], v[32:35]
v_add_f32 v234, 1.0, v234
v_mfma_f32_16x16x32_bf16 v[68:71], v[112:115], v[76:79], v[68:71]
s_waitcnt lgkmcnt(0)
s_barrier
v_mfma_f32_16x16x32_bf16 v[0:3], v[124:127], v[116:119], v[0:3]
ds_read_b128 v[80:83], v245 offset:34816
v_mfma_f32_16x16x32_bf16 v[36:39], v[124:127], v[120:123], v[36:39]
ds_read_b128 v[72:75], v243 offset:34816
v_mfma_f32_16x16x32_bf16 v[4:7], v[128:131], v[116:119], v[4:7]
ds_read_b128 v[84:87], v245 offset:35840
v_mfma_f32_16x16x32_bf16 v[40:43], v[128:131], v[120:123], v[40:43]
ds_read_b128 v[76:79], v243 offset:35328
v_mfma_f32_16x16x32_bf16 v[8:11], v[132:135], v[116:119], v[8:11]
ds_read_b128 v[88:91], v245 offset:36864
v_mfma_f32_16x16x32_bf16 v[44:47], v[132:135], v[120:123], v[44:47]
ds_read_b128 v[92:95], v245 offset:37888
v_mfma_f32_16x16x32_bf16 v[12:15], v[136:139], v[116:119], v[12:15]
ds_read_b128 v[96:99], v245 offset:38912
v_add_f32 v235, 1.0, v235
v_mfma_f32_16x16x32_bf16 v[48:51], v[136:139], v[120:123], v[48:51]
ds_read_b128 v[100:103], v245 offset:39936
v_rcp_f32 v232, v232
v_mfma_f32_16x16x32_bf16 v[16:19], v[140:143], v[116:119], v[16:19]
ds_read_b128 v[104:107], v245 offset:40960
v_rcp_f32 v233, v233
v_mfma_f32_16x16x32_bf16 v[52:55], v[140:143], v[120:123], v[52:55]
ds_read_b128 v[108:111], v245 offset:41984
v_mfma_f32_16x16x32_bf16 v[20:23], v[144:147], v[116:119], v[20:23]
ds_read_b128 v[112:115], v245 offset:43008
v_rcp_f32 v234, v234
v_mfma_f32_16x16x32_bf16 v[56:59], v[144:147], v[120:123], v[56:59]
v_rcp_f32 v235, v235
v_mfma_f32_16x16x32_bf16 v[24:27], v[148:151], v[116:119], v[24:27]
v_mul_f32 v220, v220, v232
v_mfma_f32_16x16x32_bf16 v[60:63], v[148:151], v[120:123], v[60:63]
v_mfma_f32_16x16x32_bf16 v[28:31], v[152:155], v[116:119], v[28:31]
v_mul_f32 v221, v221, v233
v_mfma_f32_16x16x32_bf16 v[64:67], v[152:155], v[120:123], v[64:67]
v_mul_f32 v222, v222, v234
v_mfma_f32_16x16x32_bf16 v[32:35], v[156:159], v[116:119], v[32:35]
v_mul_f32 v223, v223, v235
v_mfma_f32_16x16x32_bf16 v[68:71], v[156:159], v[120:123], v[68:71]
s_waitcnt lgkmcnt(0)
v_mfma_f32_16x16x32_bf16 v[0:3], v[80:83], v[72:75], v[0:3]
ds_read_b128 v[124:127], v245 offset:44032
v_mfma_f32_16x16x32_bf16 v[36:39], v[80:83], v[76:79], v[36:39]
ds_read_b128 v[116:119], v244 offset:34816
v_mfma_f32_16x16x32_bf16 v[4:7], v[84:87], v[72:75], v[4:7]
ds_read_b128 v[128:131], v245 offset:45056
v_mfma_f32_16x16x32_bf16 v[40:43], v[84:87], v[76:79], v[40:43]
ds_read_b128 v[120:123], v244 offset:35328
v_mfma_f32_16x16x32_bf16 v[8:11], v[88:91], v[72:75], v[8:11]
ds_read_b128 v[132:135], v245 offset:46080
v_mfma_f32_16x16x32_bf16 v[44:47], v[88:91], v[76:79], v[44:47]
ds_read_b128 v[136:139], v245 offset:47104
v_mfma_f32_16x16x32_bf16 v[12:15], v[92:95], v[72:75], v[12:15]
ds_read_b128 v[140:143], v245 offset:48128
ds_read_b128 v[236:239], v250 offset:2112
v_mfma_f32_16x16x32_bf16 v[48:51], v[92:95], v[76:79], v[48:51]
ds_read_b128 v[144:147], v245 offset:49152
v_mfma_f32_16x16x32_bf16 v[16:19], v[96:99], v[72:75], v[16:19]
ds_read_b128 v[148:151], v245 offset:50176
v_mfma_f32_16x16x32_bf16 v[52:55], v[96:99], v[76:79], v[52:55]
ds_read_b128 v[152:155], v245 offset:51200
v_mfma_f32_16x16x32_bf16 v[20:23], v[100:103], v[72:75], v[20:23]
ds_read_b128 v[156:159], v245 offset:52224
v_mfma_f32_16x16x32_bf16 v[56:59], v[100:103], v[76:79], v[56:59]
v_mfma_f32_16x16x32_bf16 v[24:27], v[104:107], v[72:75], v[24:27]
v_mfma_f32_16x16x32_bf16 v[60:63], v[104:107], v[76:79], v[60:63]
v_mfma_f32_16x16x32_bf16 v[28:31], v[108:111], v[72:75], v[28:31]
v_mfma_f32_16x16x32_bf16 v[64:67], v[108:111], v[76:79], v[64:67]
v_mfma_f32_16x16x32_bf16 v[32:35], v[112:115], v[72:75], v[32:35]
v_mfma_f32_16x16x32_bf16 v[68:71], v[112:115], v[76:79], v[68:71]
s_waitcnt lgkmcnt(0)
s_barrier
v_mfma_f32_16x16x32_bf16 v[0:3], v[124:127], v[116:119], v[0:3]
ds_read_b128 v[80:83], v242 offset:0
v_mfma_f32_16x16x32_bf16 v[36:39], v[124:127], v[120:123], v[36:39]
ds_read_b128 v[72:75], v240 offset:0
v_mfma_f32_16x16x32_bf16 v[4:7], v[128:131], v[116:119], v[4:7]
ds_read_b128 v[84:87], v242 offset:1024
v_mfma_f32_16x16x32_bf16 v[40:43], v[128:131], v[120:123], v[40:43]
ds_read_b128 v[76:79], v240 offset:512
v_mfma_f32_16x16x32_bf16 v[8:11], v[132:135], v[116:119], v[8:11]
ds_read_b128 v[88:91], v242 offset:2048
v_mfma_f32_16x16x32_bf16 v[44:47], v[132:135], v[120:123], v[44:47]
ds_read_b128 v[92:95], v242 offset:3072
v_mfma_f32_16x16x32_bf16 v[12:15], v[136:139], v[116:119], v[12:15]
ds_read_b128 v[96:99], v242 offset:4096
v_fma_f32 v224, -v247, v236, v224
v_mfma_f32_16x16x32_bf16 v[48:51], v[136:139], v[120:123], v[48:51]
ds_read_b128 v[100:103], v242 offset:5120
v_fma_f32 v225, -v247, v237, v225
v_mfma_f32_16x16x32_bf16 v[16:19], v[140:143], v[116:119], v[16:19]
ds_read_b128 v[104:107], v242 offset:6144
v_fma_f32 v226, -v247, v238, v226
v_mfma_f32_16x16x32_bf16 v[52:55], v[140:143], v[120:123], v[52:55]
ds_read_b128 v[108:111], v242 offset:7168
v_mfma_f32_16x16x32_bf16 v[20:23], v[144:147], v[116:119], v[20:23]
ds_read_b128 v[112:115], v242 offset:8192
v_fma_f32 v227, -v247, v239, v227
v_mfma_f32_16x16x32_bf16 v[56:59], v[144:147], v[120:123], v[56:59]
v_fma_f32 v228, -v249, v236, v228
v_mfma_f32_16x16x32_bf16 v[24:27], v[148:151], v[116:119], v[24:27]
v_fma_f32 v229, -v249, v237, v229
v_mfma_f32_16x16x32_bf16 v[60:63], v[148:151], v[120:123], v[60:63]
v_mfma_f32_16x16x32_bf16 v[28:31], v[152:155], v[116:119], v[28:31]
v_fma_f32 v230, -v249, v238, v230
v_mfma_f32_16x16x32_bf16 v[64:67], v[152:155], v[120:123], v[64:67]
v_fma_f32 v231, -v249, v239, v231
v_mfma_f32_16x16x32_bf16 v[32:35], v[156:159], v[116:119], v[32:35]
v_mul_f32 v224, v224, v246
v_mfma_f32_16x16x32_bf16 v[68:71], v[156:159], v[120:123], v[68:71]
s_waitcnt lgkmcnt(0)
v_mfma_f32_16x16x32_bf16 v[0:3], v[80:83], v[72:75], v[0:3]
ds_read_b128 v[124:127], v242 offset:9216
v_mfma_f32_16x16x32_bf16 v[36:39], v[80:83], v[76:79], v[36:39]
ds_read_b128 v[116:119], v241 offset:0
v_mfma_f32_16x16x32_bf16 v[4:7], v[84:87], v[72:75], v[4:7]
ds_read_b128 v[128:131], v242 offset:10240
v_mfma_f32_16x16x32_bf16 v[40:43], v[84:87], v[76:79], v[40:43]
ds_read_b128 v[120:123], v241 offset:512
v_mfma_f32_16x16x32_bf16 v[8:11], v[88:91], v[72:75], v[8:11]
ds_read_b128 v[132:135], v242 offset:11264
v_mfma_f32_16x16x32_bf16 v[44:47], v[88:91], v[76:79], v[44:47]
ds_read_b128 v[136:139], v242 offset:12288
v_mfma_f32_16x16x32_bf16 v[12:15], v[92:95], v[72:75], v[12:15]
ds_read_b128 v[140:143], v242 offset:13312
v_mul_f32 v225, v225, v246
v_mfma_f32_16x16x32_bf16 v[48:51], v[92:95], v[76:79], v[48:51]
ds_read_b128 v[144:147], v242 offset:14336
v_mul_f32 v226, v226, v246
v_mfma_f32_16x16x32_bf16 v[16:19], v[96:99], v[72:75], v[16:19]
ds_read_b128 v[148:151], v242 offset:15360
v_mul_f32 v227, v227, v246
v_mfma_f32_16x16x32_bf16 v[52:55], v[96:99], v[76:79], v[52:55]
ds_read_b128 v[152:155], v242 offset:16384
v_mfma_f32_16x16x32_bf16 v[20:23], v[100:103], v[72:75], v[20:23]
ds_read_b128 v[156:159], v242 offset:17408
v_mul_f32 v232, v224, v224
v_mfma_f32_16x16x32_bf16 v[56:59], v[100:103], v[76:79], v[56:59]
v_mul_f32 v233, v225, v225
v_mfma_f32_16x16x32_bf16 v[24:27], v[104:107], v[72:75], v[24:27]
v_mul_f32 v234, v226, v226
v_mfma_f32_16x16x32_bf16 v[60:63], v[104:107], v[76:79], v[60:63]
v_mfma_f32_16x16x32_bf16 v[28:31], v[108:111], v[72:75], v[28:31]
v_mul_f32 v235, v227, v227
v_mfma_f32_16x16x32_bf16 v[64:67], v[108:111], v[76:79], v[64:67]
v_fma_f32 v232, v232, s60, v252
v_mfma_f32_16x16x32_bf16 v[32:35], v[112:115], v[72:75], v[32:35]
v_fma_f32 v233, v233, s60, v252
v_mfma_f32_16x16x32_bf16 v[68:71], v[112:115], v[76:79], v[68:71]
s_waitcnt lgkmcnt(0)
s_barrier
v_mfma_f32_16x16x32_bf16 v[0:3], v[124:127], v[116:119], v[0:3]
ds_read_b128 v[80:83], v242 offset:34816
v_mfma_f32_16x16x32_bf16 v[36:39], v[124:127], v[120:123], v[36:39]
ds_read_b128 v[72:75], v240 offset:34816
v_mfma_f32_16x16x32_bf16 v[4:7], v[128:131], v[116:119], v[4:7]
ds_read_b128 v[84:87], v242 offset:35840
v_mfma_f32_16x16x32_bf16 v[40:43], v[128:131], v[120:123], v[40:43]
ds_read_b128 v[76:79], v240 offset:35328
v_mfma_f32_16x16x32_bf16 v[8:11], v[132:135], v[116:119], v[8:11]
ds_read_b128 v[88:91], v242 offset:36864
v_mfma_f32_16x16x32_bf16 v[44:47], v[132:135], v[120:123], v[44:47]
ds_read_b128 v[92:95], v242 offset:37888
v_mfma_f32_16x16x32_bf16 v[12:15], v[136:139], v[116:119], v[12:15]
ds_read_b128 v[96:99], v242 offset:38912
v_fma_f32 v234, v234, s60, v252
v_mfma_f32_16x16x32_bf16 v[48:51], v[136:139], v[120:123], v[48:51]
ds_read_b128 v[100:103], v242 offset:39936
v_fma_f32 v235, v235, s60, v252
v_mfma_f32_16x16x32_bf16 v[16:19], v[140:143], v[116:119], v[16:19]
ds_read_b128 v[104:107], v242 offset:40960
v_mul_f32 v232, v232, v224
v_mfma_f32_16x16x32_bf16 v[52:55], v[140:143], v[120:123], v[52:55]
ds_read_b128 v[108:111], v242 offset:41984
v_mfma_f32_16x16x32_bf16 v[20:23], v[144:147], v[116:119], v[20:23]
ds_read_b128 v[112:115], v242 offset:43008
v_mul_f32 v233, v233, v225
v_mfma_f32_16x16x32_bf16 v[56:59], v[144:147], v[120:123], v[56:59]
v_mul_f32 v234, v234, v226
v_mfma_f32_16x16x32_bf16 v[24:27], v[148:151], v[116:119], v[24:27]
v_mul_f32 v235, v235, v227
v_mfma_f32_16x16x32_bf16 v[60:63], v[148:151], v[120:123], v[60:63]
v_mfma_f32_16x16x32_bf16 v[28:31], v[152:155], v[116:119], v[28:31]
v_exp_f32 v232, v232
v_mfma_f32_16x16x32_bf16 v[64:67], v[152:155], v[120:123], v[64:67]
v_exp_f32 v233, v233
v_mfma_f32_16x16x32_bf16 v[32:35], v[156:159], v[116:119], v[32:35]
v_exp_f32 v234, v234
v_mfma_f32_16x16x32_bf16 v[68:71], v[156:159], v[120:123], v[68:71]
s_waitcnt lgkmcnt(0)
v_mfma_f32_16x16x32_bf16 v[0:3], v[80:83], v[72:75], v[0:3]
ds_read_b128 v[124:127], v242 offset:44032
v_mfma_f32_16x16x32_bf16 v[36:39], v[80:83], v[76:79], v[36:39]
ds_read_b128 v[116:119], v241 offset:34816
v_mfma_f32_16x16x32_bf16 v[4:7], v[84:87], v[72:75], v[4:7]
ds_read_b128 v[128:131], v242 offset:45056
v_mfma_f32_16x16x32_bf16 v[40:43], v[84:87], v[76:79], v[40:43]
ds_read_b128 v[120:123], v241 offset:35328
v_mfma_f32_16x16x32_bf16 v[8:11], v[88:91], v[72:75], v[8:11]
ds_read_b128 v[132:135], v242 offset:46080
v_mfma_f32_16x16x32_bf16 v[44:47], v[88:91], v[76:79], v[44:47]
ds_read_b128 v[136:139], v242 offset:47104
v_mfma_f32_16x16x32_bf16 v[12:15], v[92:95], v[72:75], v[12:15]
ds_read_b128 v[140:143], v242 offset:48128
v_exp_f32 v235, v235
v_mfma_f32_16x16x32_bf16 v[48:51], v[92:95], v[76:79], v[48:51]
ds_read_b128 v[144:147], v242 offset:49152
v_add_f32 v232, 1.0, v232
v_mfma_f32_16x16x32_bf16 v[16:19], v[96:99], v[72:75], v[16:19]
ds_read_b128 v[148:151], v242 offset:50176
v_add_f32 v233, 1.0, v233
v_mfma_f32_16x16x32_bf16 v[52:55], v[96:99], v[76:79], v[52:55]
ds_read_b128 v[152:155], v242 offset:51200
v_mfma_f32_16x16x32_bf16 v[20:23], v[100:103], v[72:75], v[20:23]
ds_read_b128 v[156:159], v242 offset:52224
v_add_f32 v234, 1.0, v234
v_mfma_f32_16x16x32_bf16 v[56:59], v[100:103], v[76:79], v[56:59]
v_add_f32 v235, 1.0, v235
v_mfma_f32_16x16x32_bf16 v[24:27], v[104:107], v[72:75], v[24:27]
v_rcp_f32 v232, v232
v_mfma_f32_16x16x32_bf16 v[60:63], v[104:107], v[76:79], v[60:63]
v_mfma_f32_16x16x32_bf16 v[28:31], v[108:111], v[72:75], v[28:31]
v_rcp_f32 v233, v233
v_mfma_f32_16x16x32_bf16 v[64:67], v[108:111], v[76:79], v[64:67]
v_rcp_f32 v234, v234
v_mfma_f32_16x16x32_bf16 v[32:35], v[112:115], v[72:75], v[32:35]
v_rcp_f32 v235, v235
v_mfma_f32_16x16x32_bf16 v[68:71], v[112:115], v[76:79], v[68:71]
s_waitcnt lgkmcnt(0)
s_barrier
v_mfma_f32_16x16x32_bf16 v[0:3], v[124:127], v[116:119], v[0:3]
ds_read_b128 v[80:83], v245 offset:0
v_mfma_f32_16x16x32_bf16 v[36:39], v[124:127], v[120:123], v[36:39]
ds_read_b128 v[72:75], v243 offset:0
v_mfma_f32_16x16x32_bf16 v[4:7], v[128:131], v[116:119], v[4:7]
ds_read_b128 v[84:87], v245 offset:1024
v_mfma_f32_16x16x32_bf16 v[40:43], v[128:131], v[120:123], v[40:43]
ds_read_b128 v[76:79], v243 offset:512
v_mfma_f32_16x16x32_bf16 v[8:11], v[132:135], v[116:119], v[8:11]
ds_read_b128 v[88:91], v245 offset:2048
v_mfma_f32_16x16x32_bf16 v[44:47], v[132:135], v[120:123], v[44:47]
ds_read_b128 v[92:95], v245 offset:3072
v_mfma_f32_16x16x32_bf16 v[12:15], v[136:139], v[116:119], v[12:15]
ds_read_b128 v[96:99], v245 offset:4096
v_mul_f32 v224, v224, v232
v_mfma_f32_16x16x32_bf16 v[48:51], v[136:139], v[120:123], v[48:51]
ds_read_b128 v[100:103], v245 offset:5120
v_mul_f32 v225, v225, v233
v_mfma_f32_16x16x32_bf16 v[16:19], v[140:143], v[116:119], v[16:19]
ds_read_b128 v[104:107], v245 offset:6144
v_mul_f32 v226, v226, v234
v_mfma_f32_16x16x32_bf16 v[52:55], v[140:143], v[120:123], v[52:55]
ds_read_b128 v[108:111], v245 offset:7168
v_mfma_f32_16x16x32_bf16 v[20:23], v[144:147], v[116:119], v[20:23]
ds_read_b128 v[112:115], v245 offset:8192
v_mul_f32 v227, v227, v235
v_mfma_f32_16x16x32_bf16 v[56:59], v[144:147], v[120:123], v[56:59]
v_mul_f32 v228, v228, v248
v_mfma_f32_16x16x32_bf16 v[24:27], v[148:151], v[116:119], v[24:27]
v_mul_f32 v229, v229, v248
v_mfma_f32_16x16x32_bf16 v[60:63], v[148:151], v[120:123], v[60:63]
v_mfma_f32_16x16x32_bf16 v[28:31], v[152:155], v[116:119], v[28:31]
v_mul_f32 v230, v230, v248
v_mfma_f32_16x16x32_bf16 v[64:67], v[152:155], v[120:123], v[64:67]
v_mul_f32 v231, v231, v248
v_mfma_f32_16x16x32_bf16 v[32:35], v[156:159], v[116:119], v[32:35]
v_mul_f32 v232, v228, v228
v_mfma_f32_16x16x32_bf16 v[68:71], v[156:159], v[120:123], v[68:71]
s_waitcnt lgkmcnt(0)
v_mfma_f32_16x16x32_bf16 v[0:3], v[80:83], v[72:75], v[0:3]
ds_read_b128 v[124:127], v245 offset:9216
v_mfma_f32_16x16x32_bf16 v[36:39], v[80:83], v[76:79], v[36:39]
ds_read_b128 v[116:119], v244 offset:0
v_mfma_f32_16x16x32_bf16 v[4:7], v[84:87], v[72:75], v[4:7]
ds_read_b128 v[128:131], v245 offset:10240
v_mfma_f32_16x16x32_bf16 v[40:43], v[84:87], v[76:79], v[40:43]
ds_read_b128 v[120:123], v244 offset:512
v_mfma_f32_16x16x32_bf16 v[8:11], v[88:91], v[72:75], v[8:11]
ds_read_b128 v[132:135], v245 offset:11264
v_mfma_f32_16x16x32_bf16 v[44:47], v[88:91], v[76:79], v[44:47]
ds_read_b128 v[136:139], v245 offset:12288
v_mfma_f32_16x16x32_bf16 v[12:15], v[92:95], v[72:75], v[12:15]
ds_read_b128 v[140:143], v245 offset:13312
v_mul_f32 v233, v229, v229
v_mfma_f32_16x16x32_bf16 v[48:51], v[92:95], v[76:79], v[48:51]
ds_read_b128 v[144:147], v245 offset:14336
v_mul_f32 v234, v230, v230
v_mfma_f32_16x16x32_bf16 v[16:19], v[96:99], v[72:75], v[16:19]
ds_read_b128 v[148:151], v245 offset:15360
v_mul_f32 v235, v231, v231
v_mfma_f32_16x16x32_bf16 v[52:55], v[96:99], v[76:79], v[52:55]
ds_read_b128 v[152:155], v245 offset:16384
v_mfma_f32_16x16x32_bf16 v[20:23], v[100:103], v[72:75], v[20:23]
ds_read_b128 v[156:159], v245 offset:17408
v_fma_f32 v232, v232, s60, v252
v_mfma_f32_16x16x32_bf16 v[56:59], v[100:103], v[76:79], v[56:59]
v_fma_f32 v233, v233, s60, v252
v_mfma_f32_16x16x32_bf16 v[24:27], v[104:107], v[72:75], v[24:27]
v_fma_f32 v234, v234, s60, v252
v_mfma_f32_16x16x32_bf16 v[60:63], v[104:107], v[76:79], v[60:63]
v_mfma_f32_16x16x32_bf16 v[28:31], v[108:111], v[72:75], v[28:31]
v_fma_f32 v235, v235, s60, v252
v_mfma_f32_16x16x32_bf16 v[64:67], v[108:111], v[76:79], v[64:67]
v_mul_f32 v232, v232, v228
v_mfma_f32_16x16x32_bf16 v[32:35], v[112:115], v[72:75], v[32:35]
v_mul_f32 v233, v233, v229
v_mfma_f32_16x16x32_bf16 v[68:71], v[112:115], v[76:79], v[68:71]
s_waitcnt lgkmcnt(0)
s_barrier
v_mfma_f32_16x16x32_bf16 v[0:3], v[124:127], v[116:119], v[0:3]
ds_read_b128 v[80:83], v245 offset:34816
v_mfma_f32_16x16x32_bf16 v[36:39], v[124:127], v[120:123], v[36:39]
ds_read_b128 v[72:75], v243 offset:34816
v_mfma_f32_16x16x32_bf16 v[4:7], v[128:131], v[116:119], v[4:7]
ds_read_b128 v[84:87], v245 offset:35840
v_mfma_f32_16x16x32_bf16 v[40:43], v[128:131], v[120:123], v[40:43]
ds_read_b128 v[76:79], v243 offset:35328
v_mfma_f32_16x16x32_bf16 v[8:11], v[132:135], v[116:119], v[8:11]
ds_read_b128 v[88:91], v245 offset:36864
v_mfma_f32_16x16x32_bf16 v[44:47], v[132:135], v[120:123], v[44:47]
ds_read_b128 v[92:95], v245 offset:37888
v_mfma_f32_16x16x32_bf16 v[12:15], v[136:139], v[116:119], v[12:15]
ds_read_b128 v[96:99], v245 offset:38912
v_mul_f32 v234, v234, v230
v_mfma_f32_16x16x32_bf16 v[48:51], v[136:139], v[120:123], v[48:51]
ds_read_b128 v[100:103], v245 offset:39936
v_mul_f32 v235, v235, v231
v_mfma_f32_16x16x32_bf16 v[16:19], v[140:143], v[116:119], v[16:19]
ds_read_b128 v[104:107], v245 offset:40960
v_exp_f32 v232, v232
v_mfma_f32_16x16x32_bf16 v[52:55], v[140:143], v[120:123], v[52:55]
ds_read_b128 v[108:111], v245 offset:41984
v_mfma_f32_16x16x32_bf16 v[20:23], v[144:147], v[116:119], v[20:23]
ds_read_b128 v[112:115], v245 offset:43008
v_exp_f32 v233, v233
v_mfma_f32_16x16x32_bf16 v[56:59], v[144:147], v[120:123], v[56:59]
v_exp_f32 v234, v234
v_mfma_f32_16x16x32_bf16 v[24:27], v[148:151], v[116:119], v[24:27]
v_exp_f32 v235, v235
v_mfma_f32_16x16x32_bf16 v[60:63], v[148:151], v[120:123], v[60:63]
v_mfma_f32_16x16x32_bf16 v[28:31], v[152:155], v[116:119], v[28:31]
v_add_f32 v232, 1.0, v232
v_mfma_f32_16x16x32_bf16 v[64:67], v[152:155], v[120:123], v[64:67]
v_add_f32 v233, 1.0, v233
v_mfma_f32_16x16x32_bf16 v[32:35], v[156:159], v[116:119], v[32:35]
v_add_f32 v234, 1.0, v234
v_mfma_f32_16x16x32_bf16 v[68:71], v[156:159], v[120:123], v[68:71]
s_waitcnt lgkmcnt(0)
v_mfma_f32_16x16x32_bf16 v[0:3], v[80:83], v[72:75], v[0:3]
ds_read_b128 v[124:127], v245 offset:44032
v_mfma_f32_16x16x32_bf16 v[36:39], v[80:83], v[76:79], v[36:39]
ds_read_b128 v[116:119], v244 offset:34816
v_mfma_f32_16x16x32_bf16 v[4:7], v[84:87], v[72:75], v[4:7]
ds_read_b128 v[128:131], v245 offset:45056
v_mfma_f32_16x16x32_bf16 v[40:43], v[84:87], v[76:79], v[40:43]
ds_read_b128 v[120:123], v244 offset:35328
v_mfma_f32_16x16x32_bf16 v[8:11], v[88:91], v[72:75], v[8:11]
ds_read_b128 v[132:135], v245 offset:46080
v_mfma_f32_16x16x32_bf16 v[44:47], v[88:91], v[76:79], v[44:47]
ds_read_b128 v[136:139], v245 offset:47104
v_mfma_f32_16x16x32_bf16 v[12:15], v[92:95], v[72:75], v[12:15]
ds_read_b128 v[140:143], v245 offset:48128
v_add_f32 v235, 1.0, v235
v_mfma_f32_16x16x32_bf16 v[48:51], v[92:95], v[76:79], v[48:51]
ds_read_b128 v[144:147], v245 offset:49152
v_rcp_f32 v232, v232
v_mfma_f32_16x16x32_bf16 v[16:19], v[96:99], v[72:75], v[16:19]
ds_read_b128 v[148:151], v245 offset:50176
v_rcp_f32 v233, v233
v_mfma_f32_16x16x32_bf16 v[52:55], v[96:99], v[76:79], v[52:55]
ds_read_b128 v[152:155], v245 offset:51200
v_mfma_f32_16x16x32_bf16 v[20:23], v[100:103], v[72:75], v[20:23]
ds_read_b128 v[156:159], v245 offset:52224
v_rcp_f32 v234, v234
v_mfma_f32_16x16x32_bf16 v[56:59], v[100:103], v[76:79], v[56:59]
v_rcp_f32 v235, v235
v_mfma_f32_16x16x32_bf16 v[24:27], v[104:107], v[72:75], v[24:27]
v_mul_f32 v228, v228, v232
v_mfma_f32_16x16x32_bf16 v[60:63], v[104:107], v[76:79], v[60:63]
v_mfma_f32_16x16x32_bf16 v[28:31], v[108:111], v[72:75], v[28:31]
v_mul_f32 v229, v229, v233
v_mfma_f32_16x16x32_bf16 v[64:67], v[108:111], v[76:79], v[64:67]
v_mul_f32 v230, v230, v234
v_mfma_f32_16x16x32_bf16 v[32:35], v[112:115], v[72:75], v[32:35]
v_mul_f32 v231, v231, v235
v_mfma_f32_16x16x32_bf16 v[68:71], v[112:115], v[76:79], v[68:71]
s_waitcnt lgkmcnt(0)
s_barrier
v_mfma_f32_16x16x32_bf16 v[0:3], v[124:127], v[116:119], v[0:3]
ds_read_b128 v[80:83], v242 offset:0
v_mfma_f32_16x16x32_bf16 v[36:39], v[124:127], v[120:123], v[36:39]
ds_read_b128 v[72:75], v240 offset:0
v_mfma_f32_16x16x32_bf16 v[4:7], v[128:131], v[116:119], v[4:7]
ds_read_b128 v[84:87], v242 offset:1024
v_mfma_f32_16x16x32_bf16 v[40:43], v[128:131], v[120:123], v[40:43]
ds_read_b128 v[76:79], v240 offset:512
v_mfma_f32_16x16x32_bf16 v[8:11], v[132:135], v[116:119], v[8:11]
ds_read_b128 v[88:91], v242 offset:2048
v_mfma_f32_16x16x32_bf16 v[44:47], v[132:135], v[120:123], v[44:47]
ds_read_b128 v[92:95], v242 offset:3072
v_mfma_f32_16x16x32_bf16 v[12:15], v[136:139], v[116:119], v[12:15]
ds_read_b128 v[96:99], v242 offset:4096
v_mfma_f32_16x16x32_bf16 v[48:51], v[136:139], v[120:123], v[48:51]
ds_read_b128 v[100:103], v242 offset:5120
v_mfma_f32_16x16x32_bf16 v[16:19], v[140:143], v[116:119], v[16:19]
ds_read_b128 v[104:107], v242 offset:6144
v_mfma_f32_16x16x32_bf16 v[52:55], v[140:143], v[120:123], v[52:55]
ds_read_b128 v[108:111], v242 offset:7168
v_mfma_f32_16x16x32_bf16 v[20:23], v[144:147], v[116:119], v[20:23]
ds_read_b128 v[112:115], v242 offset:8192
v_mfma_f32_16x16x32_bf16 v[56:59], v[144:147], v[120:123], v[56:59]
v_mfma_f32_16x16x32_bf16 v[24:27], v[148:151], v[116:119], v[24:27]
v_mfma_f32_16x16x32_bf16 v[60:63], v[148:151], v[120:123], v[60:63]
v_mfma_f32_16x16x32_bf16 v[28:31], v[152:155], v[116:119], v[28:31]
v_mfma_f32_16x16x32_bf16 v[64:67], v[152:155], v[120:123], v[64:67]
v_mfma_f32_16x16x32_bf16 v[32:35], v[156:159], v[116:119], v[32:35]
v_mfma_f32_16x16x32_bf16 v[68:71], v[156:159], v[120:123], v[68:71]
s_waitcnt lgkmcnt(0)
s_setprio 3
v_mfma_f32_16x16x32_bf16 v[0:3], v[80:83], v[72:75], v[0:3]
ds_read_b128 v[124:127], v242 offset:9216
v_mfma_f32_16x16x32_bf16 v[36:39], v[80:83], v[76:79], v[36:39]
ds_read_b128 v[116:119], v241 offset:0
v_mfma_f32_16x16x32_bf16 v[4:7], v[84:87], v[72:75], v[4:7]
ds_read_b128 v[128:131], v242 offset:10240
v_mfma_f32_16x16x32_bf16 v[40:43], v[84:87], v[76:79], v[40:43]
ds_read_b128 v[120:123], v241 offset:512
v_mfma_f32_16x16x32_bf16 v[8:11], v[88:91], v[72:75], v[8:11]
ds_read_b128 v[132:135], v242 offset:11264
v_mfma_f32_16x16x32_bf16 v[44:47], v[88:91], v[76:79], v[44:47]
ds_read_b128 v[136:139], v242 offset:12288
v_mfma_f32_16x16x32_bf16 v[12:15], v[92:95], v[72:75], v[12:15]
ds_read_b128 v[140:143], v242 offset:13312
v_mfma_f32_16x16x32_bf16 v[48:51], v[92:95], v[76:79], v[48:51]
ds_read_b128 v[144:147], v242 offset:14336
v_mfma_f32_16x16x32_bf16 v[16:19], v[96:99], v[72:75], v[16:19]
ds_read_b128 v[148:151], v242 offset:15360
v_mfma_f32_16x16x32_bf16 v[52:55], v[96:99], v[76:79], v[52:55]
ds_read_b128 v[152:155], v242 offset:16384
v_mfma_f32_16x16x32_bf16 v[20:23], v[100:103], v[72:75], v[20:23]
ds_read_b128 v[156:159], v242 offset:17408
v_mfma_f32_16x16x32_bf16 v[56:59], v[100:103], v[76:79], v[56:59]
v_mfma_f32_16x16x32_bf16 v[24:27], v[104:107], v[72:75], v[24:27]
v_mfma_f32_16x16x32_bf16 v[60:63], v[104:107], v[76:79], v[60:63]
v_mfma_f32_16x16x32_bf16 v[28:31], v[108:111], v[72:75], v[28:31]
v_mfma_f32_16x16x32_bf16 v[64:67], v[108:111], v[76:79], v[64:67]
v_mfma_f32_16x16x32_bf16 v[32:35], v[112:115], v[72:75], v[32:35]
v_mfma_f32_16x16x32_bf16 v[68:71], v[112:115], v[76:79], v[68:71]
s_waitcnt lgkmcnt(0)
s_barrier
v_mfma_f32_16x16x32_bf16 v[0:3], v[124:127], v[116:119], v[0:3]
ds_read_b128 v[80:83], v242 offset:34816
v_mfma_f32_16x16x32_bf16 v[36:39], v[124:127], v[120:123], v[36:39]
ds_read_b128 v[72:75], v240 offset:34816
v_mfma_f32_16x16x32_bf16 v[4:7], v[128:131], v[116:119], v[4:7]
ds_read_b128 v[84:87], v242 offset:35840
v_mfma_f32_16x16x32_bf16 v[40:43], v[128:131], v[120:123], v[40:43]
ds_read_b128 v[76:79], v240 offset:35328
v_mfma_f32_16x16x32_bf16 v[8:11], v[132:135], v[116:119], v[8:11]
ds_read_b128 v[88:91], v242 offset:36864
v_mfma_f32_16x16x32_bf16 v[44:47], v[132:135], v[120:123], v[44:47]
ds_read_b128 v[92:95], v242 offset:37888
v_mfma_f32_16x16x32_bf16 v[12:15], v[136:139], v[116:119], v[12:15]
ds_read_b128 v[96:99], v242 offset:38912
v_mfma_f32_16x16x32_bf16 v[48:51], v[136:139], v[120:123], v[48:51]
ds_read_b128 v[100:103], v242 offset:39936
v_mfma_f32_16x16x32_bf16 v[16:19], v[140:143], v[116:119], v[16:19]
ds_read_b128 v[104:107], v242 offset:40960
v_mfma_f32_16x16x32_bf16 v[52:55], v[140:143], v[120:123], v[52:55]
ds_read_b128 v[108:111], v242 offset:41984
v_mfma_f32_16x16x32_bf16 v[20:23], v[144:147], v[116:119], v[20:23]
ds_read_b128 v[112:115], v242 offset:43008
v_mfma_f32_16x16x32_bf16 v[56:59], v[144:147], v[120:123], v[56:59]
v_mfma_f32_16x16x32_bf16 v[24:27], v[148:151], v[116:119], v[24:27]
v_mfma_f32_16x16x32_bf16 v[60:63], v[148:151], v[120:123], v[60:63]
v_mfma_f32_16x16x32_bf16 v[28:31], v[152:155], v[116:119], v[28:31]
v_mfma_f32_16x16x32_bf16 v[64:67], v[152:155], v[120:123], v[64:67]
v_mfma_f32_16x16x32_bf16 v[32:35], v[156:159], v[116:119], v[32:35]
v_mfma_f32_16x16x32_bf16 v[68:71], v[156:159], v[120:123], v[68:71]
s_waitcnt lgkmcnt(0)
v_mfma_f32_16x16x32_bf16 v[0:3], v[80:83], v[72:75], v[0:3]
ds_read_b128 v[124:127], v242 offset:44032
v_mfma_f32_16x16x32_bf16 v[36:39], v[80:83], v[76:79], v[36:39]
ds_read_b128 v[116:119], v241 offset:34816
v_mfma_f32_16x16x32_bf16 v[4:7], v[84:87], v[72:75], v[4:7]
ds_read_b128 v[128:131], v242 offset:45056
v_mfma_f32_16x16x32_bf16 v[40:43], v[84:87], v[76:79], v[40:43]
ds_read_b128 v[120:123], v241 offset:35328
v_mfma_f32_16x16x32_bf16 v[8:11], v[88:91], v[72:75], v[8:11]
ds_read_b128 v[132:135], v242 offset:46080
v_mfma_f32_16x16x32_bf16 v[44:47], v[88:91], v[76:79], v[44:47]
ds_read_b128 v[136:139], v242 offset:47104
v_mfma_f32_16x16x32_bf16 v[12:15], v[92:95], v[72:75], v[12:15]
ds_read_b128 v[140:143], v242 offset:48128
v_mfma_f32_16x16x32_bf16 v[48:51], v[92:95], v[76:79], v[48:51]
ds_read_b128 v[144:147], v242 offset:49152
v_mfma_f32_16x16x32_bf16 v[16:19], v[96:99], v[72:75], v[16:19]
ds_read_b128 v[148:151], v242 offset:50176
v_mfma_f32_16x16x32_bf16 v[52:55], v[96:99], v[76:79], v[52:55]
ds_read_b128 v[152:155], v242 offset:51200
v_mfma_f32_16x16x32_bf16 v[20:23], v[100:103], v[72:75], v[20:23]
ds_read_b128 v[156:159], v242 offset:52224
v_mfma_f32_16x16x32_bf16 v[56:59], v[100:103], v[76:79], v[56:59]
v_mfma_f32_16x16x32_bf16 v[24:27], v[104:107], v[72:75], v[24:27]
v_mfma_f32_16x16x32_bf16 v[60:63], v[104:107], v[76:79], v[60:63]
v_mfma_f32_16x16x32_bf16 v[28:31], v[108:111], v[72:75], v[28:31]
v_mfma_f32_16x16x32_bf16 v[64:67], v[108:111], v[76:79], v[64:67]
v_mfma_f32_16x16x32_bf16 v[32:35], v[112:115], v[72:75], v[32:35]
v_mfma_f32_16x16x32_bf16 v[68:71], v[112:115], v[76:79], v[68:71]
s_waitcnt lgkmcnt(0)
s_barrier
v_mfma_f32_16x16x32_bf16 v[0:3], v[124:127], v[116:119], v[0:3]
ds_read_b128 v[80:83], v245 offset:0
v_mfma_f32_16x16x32_bf16 v[36:39], v[124:127], v[120:123], v[36:39]
ds_read_b128 v[72:75], v243 offset:0
v_mfma_f32_16x16x32_bf16 v[4:7], v[128:131], v[116:119], v[4:7]
ds_read_b128 v[84:87], v245 offset:1024
v_mfma_f32_16x16x32_bf16 v[40:43], v[128:131], v[120:123], v[40:43]
ds_read_b128 v[76:79], v243 offset:512
v_mfma_f32_16x16x32_bf16 v[8:11], v[132:135], v[116:119], v[8:11]
ds_read_b128 v[88:91], v245 offset:2048
v_mfma_f32_16x16x32_bf16 v[44:47], v[132:135], v[120:123], v[44:47]
ds_read_b128 v[92:95], v245 offset:3072
v_mfma_f32_16x16x32_bf16 v[12:15], v[136:139], v[116:119], v[12:15]
ds_read_b128 v[96:99], v245 offset:4096
v_mfma_f32_16x16x32_bf16 v[48:51], v[136:139], v[120:123], v[48:51]
ds_read_b128 v[100:103], v245 offset:5120
v_mfma_f32_16x16x32_bf16 v[16:19], v[140:143], v[116:119], v[16:19]
ds_read_b128 v[104:107], v245 offset:6144
v_mfma_f32_16x16x32_bf16 v[52:55], v[140:143], v[120:123], v[52:55]
ds_read_b128 v[108:111], v245 offset:7168
v_mfma_f32_16x16x32_bf16 v[20:23], v[144:147], v[116:119], v[20:23]
ds_read_b128 v[112:115], v245 offset:8192
v_mfma_f32_16x16x32_bf16 v[56:59], v[144:147], v[120:123], v[56:59]
v_mfma_f32_16x16x32_bf16 v[24:27], v[148:151], v[116:119], v[24:27]
v_mfma_f32_16x16x32_bf16 v[60:63], v[148:151], v[120:123], v[60:63]
v_mfma_f32_16x16x32_bf16 v[28:31], v[152:155], v[116:119], v[28:31]
v_mfma_f32_16x16x32_bf16 v[64:67], v[152:155], v[120:123], v[64:67]
v_mfma_f32_16x16x32_bf16 v[32:35], v[156:159], v[116:119], v[32:35]
v_mfma_f32_16x16x32_bf16 v[68:71], v[156:159], v[120:123], v[68:71]
s_waitcnt lgkmcnt(0)
s_load_dwordx2 s[4:5], s[0:1], 0
s_load_dwordx2 s[6:7], s[0:1], 112
v_mbcnt_lo_u32_b32 v237, -1, 0
v_mbcnt_hi_u32_b32 v237, -1, v237
v_lshlrev_b32 v236, 4, v237
s_lshl_b32 s30, s26, 1
s_lshr_b32 s31, s28, 1
s_add_u32 s30, s30, s31
s_mul_i32 s30, s30, 72
s_lshr_b32 s31, s27, 1
s_mul_i32 s31, s31, 9
s_add_u32 s30, s30, s31
s_lshl_b32 s30, s30, 12
s_and_b32 s31, s28, 1
s_lshl_b32 s31, s31, 11
s_add_u32 s30, s30, s31
s_and_b32 s31, s27, 1
s_lshl_b32 s32, s31, 14
s_add_u32 s32, s32, s30
s_lshl_b32 s33, s31, 9
s_add_u32 s33, s33, s30
s_add_u32 s33, s33, 32768
v_lshlrev_b32 v238, 3, v237
v_mfma_f32_16x16x32_bf16 v[0:3], v[80:83], v[72:75], v[0:3]
ds_read_b128 v[124:127], v245 offset:9216
v_mfma_f32_16x16x32_bf16 v[36:39], v[80:83], v[76:79], v[36:39]
ds_read_b128 v[116:119], v244 offset:0
v_mfma_f32_16x16x32_bf16 v[4:7], v[84:87], v[72:75], v[4:7]
ds_read_b128 v[128:131], v245 offset:10240
v_mfma_f32_16x16x32_bf16 v[40:43], v[84:87], v[76:79], v[40:43]
ds_read_b128 v[120:123], v244 offset:512
v_mfma_f32_16x16x32_bf16 v[8:11], v[88:91], v[72:75], v[8:11]
ds_read_b128 v[132:135], v245 offset:11264
v_mfma_f32_16x16x32_bf16 v[44:47], v[88:91], v[76:79], v[44:47]
ds_read_b128 v[136:139], v245 offset:12288
v_mfma_f32_16x16x32_bf16 v[12:15], v[92:95], v[72:75], v[12:15]
ds_read_b128 v[140:143], v245 offset:13312
v_mfma_f32_16x16x32_bf16 v[48:51], v[92:95], v[76:79], v[48:51]
ds_read_b128 v[144:147], v245 offset:14336
v_mfma_f32_16x16x32_bf16 v[16:19], v[96:99], v[72:75], v[16:19]
ds_read_b128 v[148:151], v245 offset:15360
v_mfma_f32_16x16x32_bf16 v[52:55], v[96:99], v[76:79], v[52:55]
ds_read_b128 v[152:155], v245 offset:16384
v_mfma_f32_16x16x32_bf16 v[20:23], v[100:103], v[72:75], v[20:23]
ds_read_b128 v[156:159], v245 offset:17408
v_mfma_f32_16x16x32_bf16 v[56:59], v[100:103], v[76:79], v[56:59]
v_mfma_f32_16x16x32_bf16 v[24:27], v[104:107], v[72:75], v[24:27]
v_mfma_f32_16x16x32_bf16 v[60:63], v[104:107], v[76:79], v[60:63]
v_mfma_f32_16x16x32_bf16 v[28:31], v[108:111], v[72:75], v[28:31]
v_mfma_f32_16x16x32_bf16 v[64:67], v[108:111], v[76:79], v[64:67]
v_mfma_f32_16x16x32_bf16 v[32:35], v[112:115], v[72:75], v[32:35]
v_mfma_f32_16x16x32_bf16 v[68:71], v[112:115], v[76:79], v[68:71]
s_waitcnt lgkmcnt(0)
s_barrier
v_mfma_f32_16x16x32_bf16 v[0:3], v[124:127], v[116:119], v[0:3]
ds_read_b128 v[80:83], v245 offset:34816
v_mfma_f32_16x16x32_bf16 v[36:39], v[124:127], v[120:123], v[36:39]
ds_read_b128 v[72:75], v243 offset:34816
v_mfma_f32_16x16x32_bf16 v[4:7], v[128:131], v[116:119], v[4:7]
ds_read_b128 v[84:87], v245 offset:35840
v_mfma_f32_16x16x32_bf16 v[40:43], v[128:131], v[120:123], v[40:43]
ds_read_b128 v[76:79], v243 offset:35328
v_mfma_f32_16x16x32_bf16 v[8:11], v[132:135], v[116:119], v[8:11]
ds_read_b128 v[88:91], v245 offset:36864
v_mfma_f32_16x16x32_bf16 v[44:47], v[132:135], v[120:123], v[44:47]
ds_read_b128 v[92:95], v245 offset:37888
v_mfma_f32_16x16x32_bf16 v[12:15], v[136:139], v[116:119], v[12:15]
ds_read_b128 v[96:99], v245 offset:38912
v_mfma_f32_16x16x32_bf16 v[48:51], v[136:139], v[120:123], v[48:51]
ds_read_b128 v[100:103], v245 offset:39936
v_mfma_f32_16x16x32_bf16 v[16:19], v[140:143], v[116:119], v[16:19]
ds_read_b128 v[104:107], v245 offset:40960
v_mfma_f32_16x16x32_bf16 v[52:55], v[140:143], v[120:123], v[52:55]
ds_read_b128 v[108:111], v245 offset:41984
v_mfma_f32_16x16x32_bf16 v[20:23], v[144:147], v[116:119], v[20:23]
ds_read_b128 v[112:115], v245 offset:43008
v_mfma_f32_16x16x32_bf16 v[56:59], v[144:147], v[120:123], v[56:59]
v_mfma_f32_16x16x32_bf16 v[24:27], v[148:151], v[116:119], v[24:27]
v_mfma_f32_16x16x32_bf16 v[60:63], v[148:151], v[120:123], v[60:63]
v_mfma_f32_16x16x32_bf16 v[28:31], v[152:155], v[116:119], v[28:31]
v_mfma_f32_16x16x32_bf16 v[64:67], v[152:155], v[120:123], v[64:67]
v_mfma_f32_16x16x32_bf16 v[32:35], v[156:159], v[116:119], v[32:35]
v_mfma_f32_16x16x32_bf16 v[68:71], v[156:159], v[120:123], v[68:71]
s_waitcnt lgkmcnt(0)
ds_read_b128 v[116:119], v244 offset:34816
ds_read_b128 v[120:123], v244 offset:35328
ds_read_b128 v[124:127], v245 offset:44032
ds_read_b128 v[128:131], v245 offset:45056
ds_read_b128 v[132:135], v245 offset:46080
ds_read_b128 v[136:139], v245 offset:47104
ds_read_b128 v[140:143], v245 offset:48128
ds_read_b128 v[144:147], v245 offset:49152
ds_read_b128 v[148:151], v245 offset:50176
ds_read_b128 v[152:155], v245 offset:51200
ds_read_b128 v[156:159], v245 offset:52224
v_mfma_f32_16x16x32_bf16 v[0:3], v[80:83], v[72:75], v[0:3]
v_mfma_f32_16x16x32_bf16 v[36:39], v[80:83], v[76:79], v[36:39]
v_mfma_f32_16x16x32_bf16 v[4:7], v[84:87], v[72:75], v[4:7]
v_mfma_f32_16x16x32_bf16 v[40:43], v[84:87], v[76:79], v[40:43]
v_mfma_f32_16x16x32_bf16 v[8:11], v[88:91], v[72:75], v[8:11]
v_mfma_f32_16x16x32_bf16 v[44:47], v[88:91], v[76:79], v[44:47]
v_mfma_f32_16x16x32_bf16 v[12:15], v[92:95], v[72:75], v[12:15]
v_mfma_f32_16x16x32_bf16 v[48:51], v[92:95], v[76:79], v[48:51]
v_mfma_f32_16x16x32_bf16 v[16:19], v[96:99], v[72:75], v[16:19]
v_mfma_f32_16x16x32_bf16 v[52:55], v[96:99], v[76:79], v[52:55]
v_mfma_f32_16x16x32_bf16 v[20:23], v[100:103], v[72:75], v[20:23]
v_mfma_f32_16x16x32_bf16 v[56:59], v[100:103], v[76:79], v[56:59]
s_waitcnt lgkmcnt(0)
s_barrier
v_mfma_f32_16x16x32_bf16 v[0:3], v[124:127], v[116:119], v[0:3]
v_mfma_f32_16x16x32_bf16 v[36:39], v[124:127], v[120:123], v[36:39]
v_mfma_f32_16x16x32_bf16 v[4:7], v[128:131], v[116:119], v[4:7]
v_mfma_f32_16x16x32_bf16 v[40:43], v[128:131], v[120:123], v[40:43]
v_mfma_f32_16x16x32_bf16 v[8:11], v[132:135], v[116:119], v[8:11]
v_mfma_f32_16x16x32_bf16 v[44:47], v[132:135], v[120:123], v[44:47]
s_nop 2
v_mul_f32 v0, v0, v160
v_mul_f32 v1, v1, v161
v_mul_f32 v2, v2, v162
v_mul_f32 v3, v3, v163
v_mul_f32 v4, v4, v168
v_mfma_f32_16x16x32_bf16 v[12:15], v[136:139], v[116:119], v[12:15]
v_mul_f32 v5, v5, v169
v_mul_f32 v6, v6, v170
v_mul_f32 v7, v7, v171
v_mul_f32 v36, v36, v164
v_mul_f32 v37, v37, v165
v_mfma_f32_16x16x32_bf16 v[48:51], v[136:139], v[120:123], v[48:51]
v_mul_f32 v38, v38, v166
v_mul_f32 v39, v39, v167
v_mul_f32 v40, v40, v172
v_mul_f32 v41, v41, v173
v_mul_f32 v42, v42, v174
v_mfma_f32_16x16x32_bf16 v[24:27], v[104:107], v[72:75], v[24:27]
v_mul_f32 v43, v43, v175
v_cvt_pk_bf16_f32 v160, v0, v1
v_cvt_pk_bf16_f32 v161, v2, v3
v_cvt_pk_bf16_f32 v162, v4, v5
v_cvt_pk_bf16_f32 v163, v6, v7
v_mfma_f32_16x16x32_bf16 v[60:63], v[104:107], v[76:79], v[60:63]
s_add_u32 s34, s32, 0
buffer_store_dwordx4 v[160:163], v236, s[12:15], s34 offen offset:0 sc1
v_cvt_pk_bf16_f32 v164, v36, v37
v_cvt_pk_bf16_f32 v165, v38, v39
v_cvt_pk_bf16_f32 v166, v40, v41
v_cvt_pk_bf16_f32 v167, v42, v43
s_add_u32 s34, s32, 0
buffer_store_dwordx4 v[164:167], v236, s[12:15], s34 offen offset:1024 sc1
v_mfma_f32_16x16x32_bf16 v[16:19], v[140:143], v[116:119], v[16:19]
v_mul_f32 v8, v8, v176
v_mul_f32 v9, v9, v177
v_mul_f32 v10, v10, v178
v_mul_f32 v11, v11, v179
v_mfma_f32_16x16x32_bf16 v[52:55], v[140:143], v[120:123], v[52:55]
v_mul_f32 v12, v12, v184
v_mul_f32 v13, v13, v185
v_mul_f32 v14, v14, v186
v_mul_f32 v15, v15, v187
v_mfma_f32_16x16x32_bf16 v[20:23], v[144:147], v[116:119], v[20:23]
v_mul_f32 v44, v44, v180
v_mul_f32 v45, v45, v181
v_mul_f32 v46, v46, v182
v_mul_f32 v47, v47, v183
v_mfma_f32_16x16x32_bf16 v[56:59], v[144:147], v[120:123], v[56:59]
v_mul_f32 v48, v48, v188
v_mul_f32 v49, v49, v189
v_mul_f32 v50, v50, v190
v_mul_f32 v51, v51, v191
v_mfma_f32_16x16x32_bf16 v[28:31], v[108:111], v[72:75], v[28:31]
v_cvt_pk_bf16_f32 v176, v8, v9
v_cvt_pk_bf16_f32 v177, v10, v11
v_cvt_pk_bf16_f32 v178, v12, v13
v_cvt_pk_bf16_f32 v179, v14, v15
v_mfma_f32_16x16x32_bf16 v[64:67], v[108:111], v[76:79], v[64:67]
s_add_u32 s34, s32, 4096
buffer_store_dwordx4 v[176:179], v236, s[12:15], s34 offen offset:0 sc1
v_cvt_pk_bf16_f32 v180, v44, v45
v_cvt_pk_bf16_f32 v181, v46, v47
v_mfma_f32_16x16x32_bf16 v[32:35], v[112:115], v[72:75], v[32:35]
v_cvt_pk_bf16_f32 v182, v48, v49
v_cvt_pk_bf16_f32 v183, v50, v51
s_add_u32 s34, s32, 4096
buffer_store_dwordx4 v[180:183], v236, s[12:15], s34 offen offset:1024 sc1
v_mfma_f32_16x16x32_bf16 v[68:71], v[112:115], v[76:79], v[68:71]
v_mfma_f32_16x16x32_bf16 v[24:27], v[148:151], v[116:119], v[24:27]
v_mul_f32 v16, v16, v192
v_mul_f32 v17, v17, v193
v_mul_f32 v18, v18, v194
v_mul_f32 v19, v19, v195
v_mul_f32 v20, v20, v200
v_mul_f32 v21, v21, v201
v_mul_f32 v22, v22, v202
v_mfma_f32_16x16x32_bf16 v[60:63], v[148:151], v[120:123], v[60:63]
v_mul_f32 v23, v23, v203
v_mul_f32 v52, v52, v196
v_mul_f32 v53, v53, v197
v_mul_f32 v54, v54, v198
v_mul_f32 v55, v55, v199
v_mul_f32 v56, v56, v204
v_mul_f32 v57, v57, v205
v_mfma_f32_16x16x32_bf16 v[28:31], v[152:155], v[116:119], v[28:31]
v_mul_f32 v58, v58, v206
v_mul_f32 v59, v59, v207
v_cvt_pk_bf16_f32 v192, v16, v17
v_cvt_pk_bf16_f32 v193, v18, v19
v_cvt_pk_bf16_f32 v194, v20, v21
v_cvt_pk_bf16_f32 v195, v22, v23
s_add_u32 s34, s32, 8192
v_mfma_f32_16x16x32_bf16 v[64:67], v[152:155], v[120:123], v[64:67]
buffer_store_dwordx4 v[192:195], v236, s[12:15], s34 offen offset:0 sc1
v_cvt_pk_bf16_f32 v196, v52, v53
v_cvt_pk_bf16_f32 v197, v54, v55
v_cvt_pk_bf16_f32 v198, v56, v57
v_cvt_pk_bf16_f32 v199, v58, v59
s_add_u32 s34, s32, 8192
buffer_store_dwordx4 v[196:199], v236, s[12:15], s34 offen offset:1024 sc1
v_mfma_f32_16x16x32_bf16 v[32:35], v[156:159], v[116:119], v[32:35]
v_mul_f32 v24, v24, v208
v_mul_f32 v25, v25, v209
v_mul_f32 v26, v26, v210
v_mul_f32 v27, v27, v211
v_mul_f32 v28, v28, v216
v_mul_f32 v29, v29, v217
v_mul_f32 v30, v30, v218
v_mul_f32 v31, v31, v219
v_mul_f32 v60, v60, v212
v_mul_f32 v61, v61, v213
v_mul_f32 v62, v62, v214
v_mul_f32 v63, v63, v215
v_mul_f32 v64, v64, v220
v_mul_f32 v65, v65, v221
v_mfma_f32_16x16x32_bf16 v[68:71], v[156:159], v[120:123], v[68:71]
v_mul_f32 v66, v66, v222
v_mul_f32 v67, v67, v223
v_cvt_pk_bf16_f32 v208, v24, v25
v_cvt_pk_bf16_f32 v209, v26, v27
v_cvt_pk_bf16_f32 v210, v28, v29
v_cvt_pk_bf16_f32 v211, v30, v31
s_add_u32 s34, s32, 12288
buffer_store_dwordx4 v[208:211], v236, s[12:15], s34 offen offset:0 sc1
v_cvt_pk_bf16_f32 v212, v60, v61
v_cvt_pk_bf16_f32 v213, v62, v63
v_cvt_pk_bf16_f32 v214, v64, v65
v_cvt_pk_bf16_f32 v215, v66, v67
s_add_u32 s34, s32, 12288
buffer_store_dwordx4 v[212:215], v236, s[12:15], s34 offen offset:1024 sc1
v_mul_f32 v32, v32, v224
v_mul_f32 v33, v33, v225
v_mul_f32 v34, v34, v226
v_mul_f32 v35, v35, v227
v_mul_f32 v68, v68, v228
v_mul_f32 v69, v69, v229
v_mul_f32 v70, v70, v230
v_mul_f32 v71, v71, v231
v_cvt_pk_bf16_f32 v224, v32, v33
v_cvt_pk_bf16_f32 v225, v34, v35
buffer_store_dwordx2 v[224:225], v238, s[12:15], s33 offen offset:0 sc1
v_cvt_pk_bf16_f32 v228, v68, v69
v_cvt_pk_bf16_f32 v229, v70, v71
buffer_store_dwordx2 v[228:229], v238, s[12:15], s33 offen offset:1024 sc1
v_mov_b32 v72, v236
v_mov_b32 v73, v237
s_setprio 2
s_waitcnt vmcnt(0)
s_lshl_b32 s30, s26, 2
s_add_u32 s30, s30, s28
s_lshl_b32 s30, s30, 5
s_add_u32 s30, s30, s27
s_lshl_b32 s30, s30, 2
s_add_u32 s30, s30, 299008
v_mov_b32 v232, 1
v_mov_b32 v233, s30
s_mov_b64 exec, 1
buffer_store_dword v232, v233, s[44:47], 0 offen sc1
s_mov_b64 exec, s[62:63]
s_cmp_lt_u32 s29, 2
s_cselect_b32 s30, s2, 64
s_cmp_lt_u32 s30, 64
s_cbranch_scc0 mega_c3_21
s_load_dwordx2 s[10:11], s[0:1], 64
v_and_b32 v74, 15, v73
v_bfe_u32 v75, v73, 4, 2
s_add_u32 s52, s8, 30932992
s_addc_u32 s53, s9, 0
s_and_b32 s53, s53, 0xffff
s_mov_b32 s54, 2359296
s_mov_b32 s55, 0x20000
s_waitcnt lgkmcnt(0)
s_mov_b32 s48, s10
s_and_b32 s49, s11, 0xffff
s_mov_b32 s50, 1152
s_mov_b32 s51, 0x20000
s_add_u32 s70, s2, 512
s_mov_b32 s71, 53504
s_mov_b32 s74, 75008
s_mov_b32 s75, 83216
s_and_b32 s76, s29, 1
s_lshl_b32 s72, s70, 12
s_lshl_b32 s30, s70, 1
v_mov_b32 v220, s30
buffer_load_ushort v215, v220, s[48:51], 0 offen
s_lshl_b32 s73, s76, 7
s_sub_u32 s73, s71, s73
v_lshlrev_b32 v220, 5, v74
v_lshl_add_u32 v221, v75, 4, v220
s_add_u32 s31, s73, 8576
v_add_u32 v212, s31, v221
v_lshl_add_u32 v214, v75, 3, v220
v_add_u32 v220, 1, v74
v_lshrrev_b32 v220, 1, v220
v_lshlrev_b32 v221, 2, v75
v_sub_u32 v220, v221, v220
v_lshlrev_b32 v220, 2, v220
v_and_b32 v221, 1, v74
v_mul_u32_u24 v221, 4160, v221
v_add_u32 v220, v220, v221
s_add_u32 s31, s73, 3296
v_add_u32 v216, s31, v220
v_subrev_u32 v217, 1024, v216
v_subrev_u32 v218, 2048, v216
v_subrev_u32 v219, 3072, v216
v_mov_b32 v0, 0
v_mov_b32 v1, 0
v_mov_b32 v2, 0
v_mov_b32 v3, 0
v_mov_b32 v4, 0
v_mov_b32 v5, 0
v_mov_b32 v6, 0
v_mov_b32 v7, 0
v_mov_b32 v8, 0
v_mov_b32 v9, 0
v_mov_b32 v10, 0
v_mov_b32 v11, 0
v_mov_b32 v12, 0
v_mov_b32 v13, 0
v_mov_b32 v14, 0
v_mov_b32 v15, 0
v_mov_b32 v16, 0
v_mov_b32 v17, 0
v_mov_b32 v18, 0
v_mov_b32 v19, 0
v_mov_b32 v20, 0
v_mov_b32 v21, 0
v_mov_b32 v22, 0
v_mov_b32 v23, 0
v_mov_b32 v24, 0
v_mov_b32 v25, 0
v_mov_b32 v26, 0
v_mov_b32 v27, 0
v_mov_b32 v28, 0
v_mov_b32 v29, 0
v_mov_b32 v30, 0
v_mov_b32 v31, 0
s_mov_b32 s73, 2
mega_cvl_22:
ds_read2_b32 v[180:181], v216 offset0:192 offset1:193
ds_read2_b32 v[182:183], v216 offset0:194 offset1:195
ds_read_b128 v[120:123], v212 offset:256
ds_read_b128 v[128:131], v212 offset:768
ds_read_b128 v[136:139], v212 offset:1280
ds_read_b128 v[144:147], v212 offset:1792
ds_read_b128 v[152:155], v212 offset:2304
ds_read_b128 v[160:163], v212 offset:2816
ds_read_b128 v[168:171], v212 offset:3328
ds_read_b128 v[176:179], v212 offset:3840
ds_read2_b32 v[184:185], v216 offset0:128 offset1:129
ds_read2_b32 v[186:187], v216 offset0:130 offset1:131
s_waitcnt lgkmcnt(2)
v_mfma_f32_16x16x32_bf16 v[0:3], v[180:183], v[120:123], v[0:3]
ds_read_b128 v[116:119], v212 offset:0
v_mfma_f32_16x16x32_bf16 v[4:7], v[180:183], v[128:131], v[4:7]
ds_read_b128 v[124:127], v212 offset:512
v_mfma_f32_16x16x32_bf16 v[8:11], v[180:183], v[136:139], v[8:11]
ds_read_b128 v[132:135], v212 offset:1024
v_mfma_f32_16x16x32_bf16 v[12:15], v[180:183], v[144:147], v[12:15]
ds_read_b128 v[140:143], v212 offset:1536
v_mfma_f32_16x16x32_bf16 v[16:19], v[180:183], v[152:155], v[16:19]
ds_read_b128 v[148:151], v212 offset:2048
v_mfma_f32_16x16x32_bf16 v[20:23], v[180:183], v[160:163], v[20:23]
ds_read_b128 v[156:159], v212 offset:2560
v_mfma_f32_16x16x32_bf16 v[24:27], v[180:183], v[168:171], v[24:27]
ds_read_b128 v[164:167], v212 offset:3072
v_mfma_f32_16x16x32_bf16 v[28:31], v[180:183], v[176:179], v[28:31]
ds_read_b128 v[172:175], v212 offset:3584
ds_read2_b32 v[188:189], v216 offset0:64 offset1:65
ds_read2_b32 v[190:191], v216 offset0:66 offset1:67
ds_read2_b32 v[192:193], v216 offset0:0 offset1:1
ds_read2_b32 v[194:195], v216 offset0:2 offset1:3
s_waitcnt lgkmcnt(4)
v_mfma_f32_16x16x32_bf16 v[0:3], v[184:187], v[116:119], v[0:3]
ds_read2_b32 v[196:197], v217 offset0:192 offset1:193
ds_read2_b32 v[198:199], v217 offset0:194 offset1:195
v_mfma_f32_16x16x32_bf16 v[4:7], v[184:187], v[124:127], v[4:7]
v_mfma_f32_16x16x32_bf16 v[8:11], v[184:187], v[132:135], v[8:11]
v_mfma_f32_16x16x32_bf16 v[12:15], v[184:187], v[140:143], v[12:15]
v_mfma_f32_16x16x32_bf16 v[16:19], v[184:187], v[148:151], v[16:19]
v_mfma_f32_16x16x32_bf16 v[20:23], v[184:187], v[156:159], v[20:23]
v_mfma_f32_16x16x32_bf16 v[24:27], v[184:187], v[164:167], v[24:27]
v_mfma_f32_16x16x32_bf16 v[28:31], v[184:187], v[172:175], v[28:31]
s_waitcnt lgkmcnt(4)
v_mfma_f32_16x16x32_bf16 v[4:7], v[188:191], v[120:123], v[4:7]
ds_read2_b32 v[200:201], v217 offset0:128 offset1:129
ds_read2_b32 v[202:203], v217 offset0:130 offset1:131
v_mfma_f32_16x16x32_bf16 v[8:11], v[188:191], v[128:131], v[8:11]
v_mfma_f32_16x16x32_bf16 v[12:15], v[188:191], v[136:139], v[12:15]
v_mfma_f32_16x16x32_bf16 v[16:19], v[188:191], v[144:147], v[16:19]
v_mfma_f32_16x16x32_bf16 v[20:23], v[188:191], v[152:155], v[20:23]
v_mfma_f32_16x16x32_bf16 v[24:27], v[188:191], v[160:163], v[24:27]
v_mfma_f32_16x16x32_bf16 v[28:31], v[188:191], v[168:171], v[28:31]
s_waitcnt lgkmcnt(4)
v_mfma_f32_16x16x32_bf16 v[4:7], v[192:195], v[116:119], v[4:7]
ds_read2_b32 v[204:205], v217 offset0:64 offset1:65
ds_read2_b32 v[206:207], v217 offset0:66 offset1:67
v_mfma_f32_16x16x32_bf16 v[8:11], v[192:195], v[124:127], v[8:11]
v_mfma_f32_16x16x32_bf16 v[12:15], v[192:195], v[132:135], v[12:15]
v_mfma_f32_16x16x32_bf16 v[16:19], v[192:195], v[140:143], v[16:19]
v_mfma_f32_16x16x32_bf16 v[20:23], v[192:195], v[148:151], v[20:23]
v_mfma_f32_16x16x32_bf16 v[24:27], v[192:195], v[156:159], v[24:27]
v_mfma_f32_16x16x32_bf16 v[28:31], v[192:195], v[164:167], v[28:31]
s_waitcnt lgkmcnt(4)
v_mfma_f32_16x16x32_bf16 v[8:11], v[196:199], v[120:123], v[8:11]
ds_read2_b32 v[208:209], v217 offset0:0 offset1:1
ds_read2_b32 v[210:211], v217 offset0:2 offset1:3
v_mfma_f32_16x16x32_bf16 v[12:15], v[196:199], v[128:131], v[12:15]
v_mfma_f32_16x16x32_bf16 v[16:19], v[196:199], v[136:139], v[16:19]
v_mfma_f32_16x16x32_bf16 v[20:23], v[196:199], v[144:147], v[20:23]
v_mfma_f32_16x16x32_bf16 v[24:27], v[196:199], v[152:155], v[24:27]
v_mfma_f32_16x16x32_bf16 v[28:31], v[196:199], v[160:163], v[28:31]
s_waitcnt lgkmcnt(4)
v_mfma_f32_16x16x32_bf16 v[8:11], v[200:203], v[116:119], v[8:11]
ds_read2_b32 v[180:181], v218 offset0:192 offset1:193
ds_read2_b32 v[182:183], v218 offset0:194 offset1:195
v_mfma_f32_16x16x32_bf16 v[12:15], v[200:203], v[124:127], v[12:15]
v_mfma_f32_16x16x32_bf16 v[16:19], v[200:203], v[132:135], v[16:19]
v_mfma_f32_16x16x32_bf16 v[20:23], v[200:203], v[140:143], v[20:23]
v_mfma_f32_16x16x32_bf16 v[24:27], v[200:203], v[148:151], v[24:27]
v_mfma_f32_16x16x32_bf16 v[28:31], v[200:203], v[156:159], v[28:31]
s_waitcnt lgkmcnt(4)
v_mfma_f32_16x16x32_bf16 v[12:15], v[204:207], v[120:123], v[12:15]
ds_read2_b32 v[184:185], v218 offset0:128 offset1:129
ds_read2_b32 v[186:187], v218 offset0:130 offset1:131
v_mfma_f32_16x16x32_bf16 v[16:19], v[204:207], v[128:131], v[16:19]
v_mfma_f32_16x16x32_bf16 v[20:23], v[204:207], v[136:139], v[20:23]
v_mfma_f32_16x16x32_bf16 v[24:27], v[204:207], v[144:147], v[24:27]
v_mfma_f32_16x16x32_bf16 v[28:31], v[204:207], v[152:155], v[28:31]
s_waitcnt lgkmcnt(4)
v_mfma_f32_16x16x32_bf16 v[12:15], v[208:211], v[116:119], v[12:15]
ds_read2_b32 v[188:189], v218 offset0:64 offset1:65
ds_read2_b32 v[190:191], v218 offset0:66 offset1:67
v_mfma_f32_16x16x32_bf16 v[16:19], v[208:211], v[124:127], v[16:19]
v_mfma_f32_16x16x32_bf16 v[20:23], v[208:211], v[132:135], v[20:23]
v_mfma_f32_16x16x32_bf16 v[24:27], v[208:211], v[140:143], v[24:27]
v_mfma_f32_16x16x32_bf16 v[28:31], v[208:211], v[148:151], v[28:31]
s_waitcnt lgkmcnt(4)
v_mfma_f32_16x16x32_bf16 v[16:19], v[180:183], v[120:123], v[16:19]
ds_read2_b32 v[192:193], v218 offset0:0 offset1:1
ds_read2_b32 v[194:195], v218 offset0:2 offset1:3
v_mfma_f32_16x16x32_bf16 v[20:23], v[180:183], v[128:131], v[20:23]
v_mfma_f32_16x16x32_bf16 v[24:27], v[180:183], v[136:139], v[24:27]
v_mfma_f32_16x16x32_bf16 v[28:31], v[180:183], v[144:147], v[28:31]
s_waitcnt lgkmcnt(4)
v_mfma_f32_16x16x32_bf16 v[16:19], v[184:187], v[116:119], v[16:19]
ds_read2_b32 v[196:197], v219 offset0:192 offset1:193
ds_read2_b32 v[198:199], v219 offset0:194 offset1:195
v_mfma_f32_16x16x32_bf16 v[20:23], v[184:187], v[124:127], v[20:23]
v_mfma_f32_16x16x32_bf16 v[24:27], v[184:187], v[132:135], v[24:27]
v_mfma_f32_16x16x32_bf16 v[28:31], v[184:187], v[140:143], v[28:31]
s_waitcnt lgkmcnt(4)
v_mfma_f32_16x16x32_bf16 v[20:23], v[188:191], v[120:123], v[20:23]
ds_read2_b32 v[200:201], v219 offset0:128 offset1:129
ds_read2_b32 v[202:203], v219 offset0:130 offset1:131
v_mfma_f32_16x16x32_bf16 v[24:27], v[188:191], v[128:131], v[24:27]
v_mfma_f32_16x16x32_bf16 v[28:31], v[188:191], v[136:139], v[28:31]
s_waitcnt lgkmcnt(4)
v_mfma_f32_16x16x32_bf16 v[20:23], v[192:195], v[116:119], v[20:23]
ds_read2_b32 v[204:205], v219 offset0:64 offset1:65
ds_read2_b32 v[206:207], v219 offset0:66 offset1:67
v_mfma_f32_16x16x32_bf16 v[24:27], v[192:195], v[124:127], v[24:27]
v_mfma_f32_16x16x32_bf16 v[28:31], v[192:195], v[132:135], v[28:31]
s_waitcnt lgkmcnt(4)
v_mfma_f32_16x16x32_bf16 v[24:27], v[196:199], v[120:123], v[24:27]
ds_read2_b32 v[208:209], v219 offset0:0 offset1:1
ds_read2_b32 v[210:211], v219 offset0:2 offset1:3
v_mfma_f32_16x16x32_bf16 v[28:31], v[196:199], v[128:131], v[28:31]
s_waitcnt lgkmcnt(4)
v_mfma_f32_16x16x32_bf16 v[24:27], v[200:203], v[116:119], v[24:27]
v_mfma_f32_16x16x32_bf16 v[28:31], v[200:203], v[124:127], v[28:31]
s_waitcnt lgkmcnt(2)
v_mfma_f32_16x16x32_bf16 v[28:31], v[204:207], v[120:123], v[28:31]
s_waitcnt lgkmcnt(0)
v_mfma_f32_16x16x32_bf16 v[28:31], v[208:211], v[116:119], v[28:31]
v_subrev_u32 v212, 64, v212
v_subrev_u32 v216, 64, v216
v_subrev_u32 v217, 64, v217
v_subrev_u32 v218, 64, v218
v_subrev_u32 v219, 64, v219
s_sub_u32 s73, s73, 1
s_cmp_lg_u32 s73, 0
s_cbranch_scc1 mega_cvl_22
s_lshl_b32 s30, s76, 12
s_add_u32 s31, s74, s30
s_xor_b32 s30, s30, 4096
s_add_u32 s30, s74, s30
v_add_u32 v226, s31, v72
v_add_u32 v227, s30, v72
s_lshl_b32 s30, s76, 11
s_add_u32 s30, s30, s71
s_add_u32 s30, s30, 8864
v_add_u32 v213, s30, v214
v_add_u32 v214, s31, v214
ds_read_b64 v[48:49], v213 offset:0
ds_read_b64 v[50:51], v213 offset:512
ds_read_b64 v[52:53], v213 offset:1024
ds_read_b64 v[54:55], v213 offset:1536
s_cmp_eq_u32 s76, 0
s_cbranch_scc0 mega_x1_23
ds_write_b128 v227, v[16:19] offset:0
ds_write_b128 v227, v[20:23] offset:1024
ds_write_b128 v227, v[24:27] offset:2048
ds_write_b128 v227, v[28:31] offset:3072
s_branch mega_x2_24
mega_x1_23:
s_nop 7
ds_write_b128 v227, v[0:3] offset:0
ds_write_b128 v227, v[4:7] offset:1024
ds_write_b128 v227, v[8:11] offset:2048
ds_write_b128 v227, v[12:15] offset:3072
v_mov_b32 v0, v16
v_mov_b32 v1, v17
v_mov_b32 v2, v18
v_mov_b32 v3, v19
v_mov_b32 v4, v20
v_mov_b32 v5, v21
v_mov_b32 v6, v22
v_mov_b32 v7, v23
v_mov_b32 v8, v24
v_mov_b32 v9, v25
v_mov_b32 v10, v26
v_mov_b32 v11, v27
v_mov_b32 v12, v28
v_mov_b32 v13, v29
v_mov_b32 v14, v30
v_mov_b32 v15, v31
mega_x2_24:
s_lshl_b32 s30, s76, 2
s_add_u32 s31, s75, s30
s_xor_b32 s30, s30, 4
s_add_u32 s30, s75, s30
v_mov_b32 v220, s30
v_mov_b32 v221, s31
v_mov_b32 v222, 1
s_waitcnt lgkmcnt(0)
ds_write_b32 v220, v222
s_mov_b32 s39, 800000
mega_xw_25:
ds_read_b32 v223, v221
s_waitcnt lgkmcnt(0)
v_cmp_eq_u32 vcc, 0, v223
s_nop 4
s_cbranch_vccz mega_xd_26
s_sub_u32 s39, s39, 1
s_cmp_lg_u32 s39, 0
s_cbranch_scc1 mega_xw_25
mega_xd_26:
ds_read_b128 v[32:35], v226 offset:0
ds_read_b128 v[36:39], v226 offset:1024
ds_read_b128 v[40:43], v226 offset:2048
ds_read_b128 v[44:47], v226 offset:3072
s_waitcnt vmcnt(0)
v_lshlrev_b32 v215, 16, v215
s_waitcnt lgkmcnt(0)
v_add_f32 v0, v0, v32
v_add_f32 v1, v1, v33
v_add_f32 v2, v2, v34
v_add_f32 v3, v3, v35
v_add_f32 v4, v4, v36
v_add_f32 v5, v5, v37
v_add_f32 v6, v6, v38
v_add_f32 v7, v7, v39
v_add_f32 v8, v8, v40
v_add_f32 v9, v9, v41
v_add_f32 v10, v10, v42
v_add_f32 v11, v11, v43
v_add_f32 v12, v12, v44
v_add_f32 v13, v13, v45
v_add_f32 v14, v14, v46
v_add_f32 v15, v15, v47
v_lshlrev_b32 v32, 16, v48
v_and_b32 v33, 0xffff0000, v48
v_lshlrev_b32 v34, 16, v49
v_and_b32 v35, 0xffff0000, v49
v_lshlrev_b32 v36, 16, v50
v_and_b32 v37, 0xffff0000, v50
v_lshlrev_b32 v38, 16, v51
v_and_b32 v39, 0xffff0000, v51
v_lshlrev_b32 v40, 16, v52
v_and_b32 v41, 0xffff0000, v52
v_lshlrev_b32 v42, 16, v53
v_and_b32 v43, 0xffff0000, v53
v_lshlrev_b32 v44, 16, v54
v_and_b32 v45, 0xffff0000, v54
v_lshlrev_b32 v46, 16, v55
v_and_b32 v47, 0xffff0000, v55
v_fmac_f32 v0, v32, v215
v_fmac_f32 v1, v33, v215
v_fmac_f32 v2, v34, v215
v_fmac_f32 v3, v35, v215
v_fmac_f32 v4, v36, v215
v_fmac_f32 v5, v37, v215
v_fmac_f32 v6, v38, v215
v_fmac_f32 v7, v39, v215
v_fmac_f32 v8, v40, v215
v_fmac_f32 v9, v41, v215
v_fmac_f32 v10, v42, v215
v_fmac_f32 v11, v43, v215
v_fmac_f32 v12, v44, v215
v_fmac_f32 v13, v45, v215
v_fmac_f32 v14, v46, v215
v_fmac_f32 v15, v47, v215
v_cvt_pk_bf16_f32 v32, v0, v1
v_cvt_pk_bf16_f32 v33, v2, v3
v_cvt_pk_bf16_f32 v34, v4, v5
v_cvt_pk_bf16_f32 v35, v6, v7
v_cvt_pk_bf16_f32 v36, v8, v9
v_cvt_pk_bf16_f32 v37, v10, v11
v_cvt_pk_bf16_f32 v38, v12, v13
v_cvt_pk_bf16_f32 v39, v14, v15
ds_write_b64 v214, v[32:33] offset:0
ds_write_b64 v214, v[34:35] offset:512
ds_write_b64 v214, v[36:37] offset:1024
ds_write_b64 v214, v[38:39] offset:1536
s_lshl_b32 s30, s76, 11
s_add_u32 s72, s72, s30
s_waitcnt lgkmcnt(0)
ds_read_b128 v[40:43], v226 offset:0
ds_read_b128 v[44:47], v226 offset:1024
s_waitcnt lgkmcnt(1)
buffer_store_dwordx4 v[40:43], v72, s[52:55], s72 offen offset:0 sc1
s_waitcnt lgkmcnt(0)
buffer_store_dwordx4 v[44:47], v72, s[52:55], s72 offen offset:1024 sc1
s_mul_i32 s30, s76, 6144
s_lshl_b32 s31, s70, 3
s_add_u32 s30, s30, s31
s_add_u32 s30, s30, 307200
s_waitcnt vmcnt(0)
v_mov_b32 v220, 1
v_mov_b32 v221, s30
s_mov_b64 exec, 1
buffer_store_dword v220, v221, s[44:47], 0 offen sc1
s_mov_b64 exec, s[62:63]
mega_c3_21:
s_and_b32 s24, s2, 7
s_lshr_b32 s25, s2, 3
s_and_b32 s70, s24, 1
s_lshl_b32 s70, s70, 1
s_bfe_u32 s71, s24, 0x10001
s_add_u32 s70, s70, s71
s_lshl_b32 s70, s70, 3
s_and_b32 s71, s25, 7
s_add_u32 s70, s70, s71
s_lshr_b32 s71, s24, 2
s_lshl_b32 s71, s71, 2
s_lshr_b32 s25, s25, 3
s_add_u32 s71, s71, s25
s_and_b32 s72, s71, 1
s_mul_i32 s73, s71, 9
s_lshr_b32 s73, s73, 1
s_add_u32 s74, s73, s72
s_cmp_eq_u32 s72, 0
s_cselect_b32 s75, 4, 0
s_add_u32 s75, s75, s73
v_mov_b32 v243, v73
v_and_b32 v244, 15, v243
v_bfe_u32 v245, v243, 4, 2
v_lshlrev_b32 v246, 4, v243
s_mul_i32 s34, s70, 72
s_mul_i32 s35, s29, 18
s_add_u32 s34, s34, s35
s_lshl_b32 s34, s34, 12
s_lshl_b32 s35, s29, 10
s_add_u32 s34, s34, s35
v_add_u32 v234, s34, v246
v_xor_b32 v235, 1024, v234
v_xor_b32 v236, 2048, v234
v_xor_b32 v237, 3072, v234
s_mul_i32 s34, s29, 663552
s_lshl_b32 s35, s74, 10
s_add_u32 s35, s35, s34
v_add_u32 v238, s35, v246
s_lshl_b32 s35, s75, 10
s_add_u32 s35, s35, s34
v_add_u32 v239, s35, v246
v_lshrrev_b32 v247, 3, v244
v_cmp_eq_u32 vcc, s72, v247
v_mov_b32 v248, s61
s_nop 0
v_cndmask_b32 v239, v248, v239, vcc
v_lshrrev_b32 v247, 2, v244
v_lshlrev_b32 v247, 3, v247
v_and_b32 v249, 3, v244
v_add_u32 v247, v247, v249
s_lshl_b32 s34, s70, 6
s_lshr_b32 s35, s29, 1
s_lshl_b32 s35, s35, 5
s_add_u32 s34, s34, s35
s_and_b32 s35, s29, 1
s_lshl_b32 s35, s35, 2
s_add_u32 s34, s34, s35
v_add_u32 v247, s34, v247
v_mul_u32_u24 v247, 1152, v247
v_lshl_add_u32 v247, v245, 3, v247
s_lshl_b32 s34, s74, 5
v_add_u32 v240, s34, v247
s_lshl_b32 s34, s75, 5
v_add_u32 v241, s34, v247
v_lshrrev_b32 v249, 1, v245
v_cmp_eq_u32 vcc, s72, v249
s_nop 1
v_cndmask_b32 v241, v248, v241, vcc
s_add_u32 s16, s8, 33554432
s_addc_u32 s17, s9, 0
s_and_b32 s17, s17, 0xffff
s_mov_b32 s18, 2654208
s_mov_b32 s19, 0x20000
s_waitcnt lgkmcnt(0)
s_mov_b32 s20, s4
s_and_b32 s21, s5, 0xffff
s_mov_b32 s22, 2359296
s_mov_b32 s23, 0x20000
s_mov_b32 s40, s6
s_and_b32 s41, s7, 0xffff
s_mov_b32 s42, 2359296
s_mov_b32 s43, 0x20000
s_xor_b32 s34, s29, 1
s_mul_i32 s34, s34, 15360
s_add_u32 s34, s34, 88320
v_add_u32 v247, s34, v246
s_xor_b32 s34, s29, 2
s_mul_i32 s34, s34, 15360
s_add_u32 s34, s34, 93440
v_add_u32 v248, s34, v246
s_xor_b32 s34, s29, 3
s_mul_i32 s34, s34, 15360
s_add_u32 s34, s34, 98560
v_add_u32 v249, s34, v246
s_mul_i32 s34, s29, 15360
s_add_u32 s34, s34, 88320
v_add_u32 v250, s34, v246
v_lshrrev_b32 v254, 2, v244
v_lshl_add_u32 v254, v245, 2, v254
v_lshlrev_b32 v254, 7, v254
v_and_b32 v255, 3, v244
v_lshl_add_u32 v254, v255, 4, v254
s_lshr_b32 s34, s29, 1
s_lshl_b32 s34, s34, 6
s_and_b32 s35, s29, 1
s_lshl_b32 s35, s35, 3
s_add_u32 s34, s34, s35
s_add_u32 s34, s34, 149760
s_lshl_b32 s35, s72, 11
s_add_u32 s35, s35, s34
s_sub_u32 s50, s75, s73
s_lshl_b32 s50, s50, 11
s_add_u32 s50, s50, s34
v_mov_b32 v0, 0
v_mov_b32 v1, 0
v_mov_b32 v2, 0
v_mov_b32 v3, 0
v_mov_b32 v4, 0
v_mov_b32 v5, 0
v_mov_b32 v6, 0
v_mov_b32 v7, 0
v_mov_b32 v8, 0
v_mov_b32 v9, 0
v_mov_b32 v10, 0
v_mov_b32 v11, 0
v_mov_b32 v12, 0
v_mov_b32 v13, 0
v_mov_b32 v14, 0
v_mov_b32 v15, 0
v_mov_b32 v16, 0
v_mov_b32 v17, 0
v_mov_b32 v18, 0
v_mov_b32 v19, 0
v_mov_b32 v20, 0
v_mov_b32 v21, 0
v_mov_b32 v22, 0
v_mov_b32 v23, 0
v_mov_b32 v24, 0
v_mov_b32 v25, 0
v_mov_b32 v26, 0
v_mov_b32 v27, 0
v_mov_b32 v28, 0
v_mov_b32 v29, 0
v_mov_b32 v30, 0
v_mov_b32 v31, 0
v_mov_b32 v32, 0
v_mov_b32 v33, 0
v_mov_b32 v34, 0
v_mov_b32 v35, 0
v_mov_b32 v36, 0
v_mov_b32 v37, 0
v_mov_b32 v38, 0
v_mov_b32 v39, 0
v_mov_b32 v40, 0
v_mov_b32 v41, 0
v_mov_b32 v42, 0
v_mov_b32 v43, 0
v_mov_b32 v44, 0
v_mov_b32 v45, 0
v_mov_b32 v46, 0
v_mov_b32 v47, 0
v_mov_b32 v48, 0
v_mov_b32 v49, 0
v_mov_b32 v50, 0
v_mov_b32 v51, 0
v_mov_b32 v52, 0
v_mov_b32 v53, 0
v_mov_b32 v54, 0
v_mov_b32 v55, 0
v_mov_b32 v56, 0
v_mov_b32 v57, 0
v_mov_b32 v58, 0
v_mov_b32 v59, 0
v_mov_b32 v60, 0
v_mov_b32 v61, 0
v_mov_b32 v62, 0
v_mov_b32 v63, 0
v_mov_b32 v64, 0
v_mov_b32 v65, 0
v_mov_b32 v66, 0
v_mov_b32 v67, 0
v_mov_b32 v68, 0
v_mov_b32 v69, 0
v_mov_b32 v70, 0
v_mov_b32 v71, 0
v_mov_b32 v72, 0
v_mov_b32 v73, 0
v_mov_b32 v74, 0
v_mov_b32 v75, 0
v_mov_b32 v76, 0
v_mov_b32 v77, 0
v_mov_b32 v78, 0
v_mov_b32 v79, 0
v_bfe_u32 v253, v243, 2, 1
v_and_b32 v255, 3, v243
v_lshlrev_b32 v255, 2, v255
v_lshl_add_u32 v253, v253, 7, v255
s_lshl_b32 s51, s70, 8
s_lshl_b32 s31, s29, 4
s_add_u32 s51, s51, s31
s_add_u32 s51, s51, 299008
buffer_load_dword v255, v253, s[44:47], s51 offen sc1
s_mov_b32 s49, 0
buffer_load_dwordx4 v[96:99], v238, s[16:19], s49 offen
buffer_load_dwordx4 v[100:103], v238, s[16:19], s49 offen offset:1024
buffer_load_dwordx4 v[104:107], v238, s[16:19], s49 offen offset:2048
buffer_load_dwordx4 v[108:111], v238, s[16:19], s49 offen offset:3072
buffer_load_dwordx4 v[112:115], v239, s[16:19], s49 offen
s_mov_b32 s49, 36864
buffer_load_dwordx4 v[132:135], v238, s[16:19], s49 offen
buffer_load_dwordx4 v[136:139], v238, s[16:19], s49 offen offset:1024
buffer_load_dwordx4 v[140:143], v238, s[16:19], s49 offen offset:2048
buffer_load_dwordx4 v[144:147], v238, s[16:19], s49 offen offset:3072
buffer_load_dwordx4 v[148:151], v239, s[16:19], s49 offen
s_mov_b32 s49, 73728
buffer_load_dwordx4 v[168:171], v238, s[16:19], s49 offen
buffer_load_dwordx4 v[172:175], v238, s[16:19], s49 offen offset:1024
buffer_load_dwordx4 v[176:179], v238, s[16:19], s49 offen offset:2048
buffer_load_dwordx4 v[180:183], v238, s[16:19], s49 offen offset:3072
buffer_load_dwordx4 v[184:187], v239, s[16:19], s49 offen
s_mov_b32 s49, 110592
buffer_load_dwordx4 v[204:207], v238, s[16:19], s49 offen
buffer_load_dwordx4 v[208:211], v238, s[16:19], s49 offen offset:1024
buffer_load_dwordx4 v[212:215], v238, s[16:19], s49 offen offset:2048
buffer_load_dwordx4 v[216:219], v238, s[16:19], s49 offen offset:3072
buffer_load_dwordx4 v[220:223], v239, s[16:19], s49 offen
s_mov_b32 s39, 100000
s_waitcnt vmcnt(20)
mega_pl_27:
v_cmp_eq_u32 vcc, 0, v255
s_nop 4
s_cbranch_vccz mega_pe_28
s_sub_u32 s39, s39, 1
s_cmp_eq_u32 s39, 0
s_cbranch_scc1 mega_pe_28
s_sleep 8
buffer_load_dword v255, v253, s[44:47], s51 offen sc1
s_waitcnt vmcnt(0)
s_branch mega_pl_27
mega_pe_28:
s_mov_b32 s48, 0
buffer_load_dwordx4 v[80:83], v234, s[12:15], s48 offen
buffer_load_dwordx4 v[84:87], v235, s[12:15], s48 offen
buffer_load_dwordx4 v[88:91], v236, s[12:15], s48 offen
buffer_load_dwordx4 v[92:95], v237, s[12:15], s48 offen
s_mov_b32 s48, 4096
buffer_load_dwordx4 v[116:119], v234, s[12:15], s48 offen
buffer_load_dwordx4 v[120:123], v235, s[12:15], s48 offen
buffer_load_dwordx4 v[124:127], v236, s[12:15], s48 offen
buffer_load_dwordx4 v[128:131], v237, s[12:15], s48 offen
s_mov_b32 s48, 8192
buffer_load_dwordx4 v[152:155], v234, s[12:15], s48 offen
buffer_load_dwordx4 v[156:159], v235, s[12:15], s48 offen
buffer_load_dwordx4 v[160:163], v236, s[12:15], s48 offen
buffer_load_dwordx4 v[164:167], v237, s[12:15], s48 offen
s_mov_b32 s48, 12288
buffer_load_dwordx4 v[188:191], v234, s[12:15], s48 offen
buffer_load_dwordx4 v[192:195], v235, s[12:15], s48 offen
buffer_load_dwordx4 v[196:199], v236, s[12:15], s48 offen
buffer_load_dwordx4 v[200:203], v237, s[12:15], s48 offen
buffer_load_dwordx2 v[224:225], v240, s[20:23], 0 offen offset:0
buffer_load_dwordx2 v[226:227], v240, s[20:23], 0 offen offset:32
buffer_load_dwordx2 v[228:229], v240, s[20:23], 0 offen offset:64
buffer_load_dwordx2 v[230:231], v240, s[20:23], 0 offen offset:96
buffer_load_dwordx2 v[232:233], v241, s[20:23], 0 offen
v_add_u32 v251, s35, v254
v_add_u32 v252, s50, v254
s_waitcnt vmcnt(17)
v_mfma_f32_16x16x32_bf16 v[0:3], v[96:99], v[80:83], v[0:3]
v_mfma_f32_16x16x32_bf16 v[4:7], v[100:103], v[80:83], v[4:7]
v_mfma_f32_16x16x32_bf16 v[8:11], v[104:107], v[80:83], v[8:11]
v_mfma_f32_16x16x32_bf16 v[12:15], v[108:111], v[80:83], v[12:15]
v_mfma_f32_16x16x32_bf16 v[16:19], v[112:115], v[80:83], v[16:19]
v_mfma_f32_16x16x32_bf16 v[20:23], v[96:99], v[84:87], v[20:23]
v_mfma_f32_16x16x32_bf16 v[24:27], v[100:103], v[84:87], v[24:27]
v_mfma_f32_16x16x32_bf16 v[28:31], v[104:107], v[84:87], v[28:31]
v_mfma_f32_16x16x32_bf16 v[32:35], v[108:111], v[84:87], v[32:35]
v_mfma_f32_16x16x32_bf16 v[36:39], v[112:115], v[84:87], v[36:39]
v_mfma_f32_16x16x32_bf16 v[40:43], v[96:99], v[88:91], v[40:43]
v_mfma_f32_16x16x32_bf16 v[44:47], v[100:103], v[88:91], v[44:47]
v_mfma_f32_16x16x32_bf16 v[48:51], v[104:107], v[88:91], v[48:51]
v_mfma_f32_16x16x32_bf16 v[52:55], v[108:111], v[88:91], v[52:55]
v_mfma_f32_16x16x32_bf16 v[56:59], v[112:115], v[88:91], v[56:59]
v_mfma_f32_16x16x32_bf16 v[60:63], v[96:99], v[92:95], v[60:63]
v_mfma_f32_16x16x32_bf16 v[64:67], v[100:103], v[92:95], v[64:67]
v_mfma_f32_16x16x32_bf16 v[68:71], v[104:107], v[92:95], v[68:71]
v_mfma_f32_16x16x32_bf16 v[72:75], v[108:111], v[92:95], v[72:75]
v_mfma_f32_16x16x32_bf16 v[76:79], v[112:115], v[92:95], v[76:79]
s_waitcnt vmcnt(13)
v_mfma_f32_16x16x32_bf16 v[0:3], v[132:135], v[116:119], v[0:3]
v_mfma_f32_16x16x32_bf16 v[4:7], v[136:139], v[116:119], v[4:7]
s_mov_b32 s48, 16384
buffer_load_dwordx4 v[80:83], v234, s[12:15], s48 offen
v_mfma_f32_16x16x32_bf16 v[8:11], v[140:143], v[116:119], v[8:11]
v_mfma_f32_16x16x32_bf16 v[12:15], v[144:147], v[116:119], v[12:15]
buffer_load_dwordx4 v[84:87], v235, s[12:15], s48 offen
v_mfma_f32_16x16x32_bf16 v[16:19], v[148:151], v[116:119], v[16:19]
v_mfma_f32_16x16x32_bf16 v[20:23], v[132:135], v[120:123], v[20:23]
buffer_load_dwordx4 v[88:91], v236, s[12:15], s48 offen
v_mfma_f32_16x16x32_bf16 v[24:27], v[136:139], v[120:123], v[24:27]
v_mfma_f32_16x16x32_bf16 v[28:31], v[140:143], v[120:123], v[28:31]
buffer_load_dwordx4 v[92:95], v237, s[12:15], s48 offen
v_mfma_f32_16x16x32_bf16 v[32:35], v[144:147], v[120:123], v[32:35]
v_mfma_f32_16x16x32_bf16 v[36:39], v[148:151], v[120:123], v[36:39]
s_mov_b32 s49, 147456
buffer_load_dwordx4 v[96:99], v238, s[16:19], s49 offen
v_mfma_f32_16x16x32_bf16 v[40:43], v[132:135], v[124:127], v[40:43]
v_mfma_f32_16x16x32_bf16 v[44:47], v[136:139], v[124:127], v[44:47]
buffer_load_dwordx4 v[100:103], v238, s[16:19], s49 offen offset:1024
v_mfma_f32_16x16x32_bf16 v[48:51], v[140:143], v[124:127], v[48:51]
v_mfma_f32_16x16x32_bf16 v[52:55], v[144:147], v[124:127], v[52:55]
buffer_load_dwordx4 v[104:107], v238, s[16:19], s49 offen offset:2048
v_mfma_f32_16x16x32_bf16 v[56:59], v[148:151], v[124:127], v[56:59]
v_mfma_f32_16x16x32_bf16 v[60:63], v[132:135], v[128:131], v[60:63]
buffer_load_dwordx4 v[108:111], v238, s[16:19], s49 offen offset:3072
v_mfma_f32_16x16x32_bf16 v[64:67], v[136:139], v[128:131], v[64:67]
v_mfma_f32_16x16x32_bf16 v[68:71], v[140:143], v[128:131], v[68:71]
buffer_load_dwordx4 v[112:115], v239, s[16:19], s49 offen
v_mfma_f32_16x16x32_bf16 v[72:75], v[144:147], v[128:131], v[72:75]
v_mfma_f32_16x16x32_bf16 v[76:79], v[148:151], v[128:131], v[76:79]
s_waitcnt vmcnt(18)
v_mfma_f32_16x16x32_bf16 v[0:3], v[168:171], v[152:155], v[0:3]
v_mfma_f32_16x16x32_bf16 v[4:7], v[172:175], v[152:155], v[4:7]
s_mov_b32 s48, 20480
buffer_load_dwordx4 v[116:119], v234, s[12:15], s48 offen
v_mfma_f32_16x16x32_bf16 v[8:11], v[176:179], v[152:155], v[8:11]
v_mfma_f32_16x16x32_bf16 v[12:15], v[180:183], v[152:155], v[12:15]
buffer_load_dwordx4 v[120:123], v235, s[12:15], s48 offen
v_mfma_f32_16x16x32_bf16 v[16:19], v[184:187], v[152:155], v[16:19]
v_mfma_f32_16x16x32_bf16 v[20:23], v[168:171], v[156:159], v[20:23]
buffer_load_dwordx4 v[124:127], v236, s[12:15], s48 offen
v_mfma_f32_16x16x32_bf16 v[24:27], v[172:175], v[156:159], v[24:27]
v_mfma_f32_16x16x32_bf16 v[28:31], v[176:179], v[156:159], v[28:31]
buffer_load_dwordx4 v[128:131], v237, s[12:15], s48 offen
v_mfma_f32_16x16x32_bf16 v[32:35], v[180:183], v[156:159], v[32:35]
v_mfma_f32_16x16x32_bf16 v[36:39], v[184:187], v[156:159], v[36:39]
s_mov_b32 s49, 184320
buffer_load_dwordx4 v[132:135], v238, s[16:19], s49 offen
v_mfma_f32_16x16x32_bf16 v[40:43], v[168:171], v[160:163], v[40:43]
v_mfma_f32_16x16x32_bf16 v[44:47], v[172:175], v[160:163], v[44:47]
buffer_load_dwordx4 v[136:139], v238, s[16:19], s49 offen offset:1024
v_mfma_f32_16x16x32_bf16 v[48:51], v[176:179], v[160:163], v[48:51]
v_mfma_f32_16x16x32_bf16 v[52:55], v[180:183], v[160:163], v[52:55]
buffer_load_dwordx4 v[140:143], v238, s[16:19], s49 offen offset:2048
v_mfma_f32_16x16x32_bf16 v[56:59], v[184:187], v[160:163], v[56:59]
v_mfma_f32_16x16x32_bf16 v[60:63], v[168:171], v[164:167], v[60:63]
buffer_load_dwordx4 v[144:147], v238, s[16:19], s49 offen offset:3072
v_mfma_f32_16x16x32_bf16 v[64:67], v[172:175], v[164:167], v[64:67]
v_mfma_f32_16x16x32_bf16 v[68:71], v[176:179], v[164:167], v[68:71]
buffer_load_dwordx4 v[148:151], v239, s[16:19], s49 offen
v_mfma_f32_16x16x32_bf16 v[72:75], v[180:183], v[164:167], v[72:75]
v_mfma_f32_16x16x32_bf16 v[76:79], v[184:187], v[164:167], v[76:79]
s_waitcnt vmcnt(23)
v_mfma_f32_16x16x32_bf16 v[0:3], v[204:207], v[188:191], v[0:3]
v_mfma_f32_16x16x32_bf16 v[4:7], v[208:211], v[188:191], v[4:7]
s_mov_b32 s48, 24576
buffer_load_dwordx4 v[152:155], v234, s[12:15], s48 offen
v_mfma_f32_16x16x32_bf16 v[8:11], v[212:215], v[188:191], v[8:11]
v_mfma_f32_16x16x32_bf16 v[12:15], v[216:219], v[188:191], v[12:15]
buffer_load_dwordx4 v[156:159], v235, s[12:15], s48 offen
v_mfma_f32_16x16x32_bf16 v[16:19], v[220:223], v[188:191], v[16:19]
v_mfma_f32_16x16x32_bf16 v[20:23], v[204:207], v[192:195], v[20:23]
buffer_load_dwordx4 v[160:163], v236, s[12:15], s48 offen
v_mfma_f32_16x16x32_bf16 v[24:27], v[208:211], v[192:195], v[24:27]
v_mfma_f32_16x16x32_bf16 v[28:31], v[212:215], v[192:195], v[28:31]
buffer_load_dwordx4 v[164:167], v237, s[12:15], s48 offen
v_mfma_f32_16x16x32_bf16 v[32:35], v[216:219], v[192:195], v[32:35]
v_mfma_f32_16x16x32_bf16 v[36:39], v[220:223], v[192:195], v[36:39]
s_mov_b32 s49, 221184
buffer_load_dwordx4 v[168:171], v238, s[16:19], s49 offen
v_mfma_f32_16x16x32_bf16 v[40:43], v[204:207], v[196:199], v[40:43]
v_mfma_f32_16x16x32_bf16 v[44:47], v[208:211], v[196:199], v[44:47]
buffer_load_dwordx4 v[172:175], v238, s[16:19], s49 offen offset:1024
v_mfma_f32_16x16x32_bf16 v[48:51], v[212:215], v[196:199], v[48:51]
v_mfma_f32_16x16x32_bf16 v[52:55], v[216:219], v[196:199], v[52:55]
buffer_load_dwordx4 v[176:179], v238, s[16:19], s49 offen offset:2048
v_mfma_f32_16x16x32_bf16 v[56:59], v[220:223], v[196:199], v[56:59]
v_mfma_f32_16x16x32_bf16 v[60:63], v[204:207], v[200:203], v[60:63]
buffer_load_dwordx4 v[180:183], v238, s[16:19], s49 offen offset:3072
v_mfma_f32_16x16x32_bf16 v[64:67], v[208:211], v[200:203], v[64:67]
v_mfma_f32_16x16x32_bf16 v[68:71], v[212:215], v[200:203], v[68:71]
buffer_load_dwordx4 v[184:187], v239, s[16:19], s49 offen
v_mfma_f32_16x16x32_bf16 v[72:75], v[216:219], v[200:203], v[72:75]
v_mfma_f32_16x16x32_bf16 v[76:79], v[220:223], v[200:203], v[76:79]
s_waitcnt vmcnt(18)
v_mfma_f32_16x16x32_bf16 v[0:3], v[96:99], v[80:83], v[0:3]
v_mfma_f32_16x16x32_bf16 v[4:7], v[100:103], v[80:83], v[4:7]
s_mov_b32 s48, 28672
buffer_load_dwordx4 v[188:191], v234, s[12:15], s48 offen
v_mfma_f32_16x16x32_bf16 v[8:11], v[104:107], v[80:83], v[8:11]
v_mfma_f32_16x16x32_bf16 v[12:15], v[108:111], v[80:83], v[12:15]
buffer_load_dwordx4 v[192:195], v235, s[12:15], s48 offen
v_mfma_f32_16x16x32_bf16 v[16:19], v[112:115], v[80:83], v[16:19]
v_mfma_f32_16x16x32_bf16 v[20:23], v[96:99], v[84:87], v[20:23]
buffer_load_dwordx4 v[196:199], v236, s[12:15], s48 offen
v_mfma_f32_16x16x32_bf16 v[24:27], v[100:103], v[84:87], v[24:27]
v_mfma_f32_16x16x32_bf16 v[28:31], v[104:107], v[84:87], v[28:31]
buffer_load_dwordx4 v[200:203], v237, s[12:15], s48 offen
v_mfma_f32_16x16x32_bf16 v[32:35], v[108:111], v[84:87], v[32:35]
v_mfma_f32_16x16x32_bf16 v[36:39], v[112:115], v[84:87], v[36:39]
s_mov_b32 s49, 258048
buffer_load_dwordx4 v[204:207], v238, s[16:19], s49 offen
v_mfma_f32_16x16x32_bf16 v[40:43], v[96:99], v[88:91], v[40:43]
v_mfma_f32_16x16x32_bf16 v[44:47], v[100:103], v[88:91], v[44:47]
buffer_load_dwordx4 v[208:211], v238, s[16:19], s49 offen offset:1024
v_mfma_f32_16x16x32_bf16 v[48:51], v[104:107], v[88:91], v[48:51]
v_mfma_f32_16x16x32_bf16 v[52:55], v[108:111], v[88:91], v[52:55]
buffer_load_dwordx4 v[212:215], v238, s[16:19], s49 offen offset:2048
v_mfma_f32_16x16x32_bf16 v[56:59], v[112:115], v[88:91], v[56:59]
v_mfma_f32_16x16x32_bf16 v[60:63], v[96:99], v[92:95], v[60:63]
buffer_load_dwordx4 v[216:219], v238, s[16:19], s49 offen offset:3072
v_mfma_f32_16x16x32_bf16 v[64:67], v[100:103], v[92:95], v[64:67]
v_mfma_f32_16x16x32_bf16 v[68:71], v[104:107], v[92:95], v[68:71]
buffer_load_dwordx4 v[220:223], v239, s[16:19], s49 offen
v_mfma_f32_16x16x32_bf16 v[72:75], v[108:111], v[92:95], v[72:75]
v_mfma_f32_16x16x32_bf16 v[76:79], v[112:115], v[92:95], v[76:79]
s_waitcnt vmcnt(18)
v_mfma_f32_16x16x32_bf16 v[0:3], v[132:135], v[116:119], v[0:3]
v_mfma_f32_16x16x32_bf16 v[4:7], v[136:139], v[116:119], v[4:7]
s_mov_b32 s48, 32768
v_lshrrev_b32 v242, 1, v246
v_sub_u32 v242, v234, v242
buffer_load_dwordx2 v[80:81], v242, s[12:15], s48 offen
buffer_load_dwordx2 v[82:83], v242, s[12:15], s48 offen offset:512
v_mfma_f32_16x16x32_bf16 v[8:11], v[140:143], v[116:119], v[8:11]
v_mfma_f32_16x16x32_bf16 v[12:15], v[144:147], v[116:119], v[12:15]
v_lshrrev_b32 v242, 1, v246
v_sub_u32 v242, v235, v242
buffer_load_dwordx2 v[84:85], v242, s[12:15], s48 offen
buffer_load_dwordx2 v[86:87], v242, s[12:15], s48 offen offset:512
v_mfma_f32_16x16x32_bf16 v[16:19], v[148:151], v[116:119], v[16:19]
v_mfma_f32_16x16x32_bf16 v[20:23], v[132:135], v[120:123], v[20:23]
v_lshrrev_b32 v242, 1, v246
v_sub_u32 v242, v236, v242
buffer_load_dwordx2 v[88:89], v242, s[12:15], s48 offen
buffer_load_dwordx2 v[90:91], v242, s[12:15], s48 offen offset:512
v_mfma_f32_16x16x32_bf16 v[24:27], v[136:139], v[120:123], v[24:27]
v_mfma_f32_16x16x32_bf16 v[28:31], v[140:143], v[120:123], v[28:31]
v_lshrrev_b32 v242, 1, v246
v_sub_u32 v242, v237, v242
buffer_load_dwordx2 v[92:93], v242, s[12:15], s48 offen
buffer_load_dwordx2 v[94:95], v242, s[12:15], s48 offen offset:512
v_mfma_f32_16x16x32_bf16 v[32:35], v[144:147], v[120:123], v[32:35]
v_mfma_f32_16x16x32_bf16 v[36:39], v[148:151], v[120:123], v[36:39]
s_mov_b32 s49, 294912
buffer_load_dwordx4 v[96:99], v238, s[16:19], s49 offen
v_mfma_f32_16x16x32_bf16 v[40:43], v[132:135], v[124:127], v[40:43]
v_mfma_f32_16x16x32_bf16 v[44:47], v[136:139], v[124:127], v[44:47]
buffer_load_dwordx4 v[100:103], v238, s[16:19], s49 offen offset:1024
v_mfma_f32_16x16x32_bf16 v[48:51], v[140:143], v[124:127], v[48:51]
v_mfma_f32_16x16x32_bf16 v[52:55], v[144:147], v[124:127], v[52:55]
buffer_load_dwordx4 v[104:107], v238, s[16:19], s49 offen offset:2048
v_mfma_f32_16x16x32_bf16 v[56:59], v[148:151], v[124:127], v[56:59]
v_mfma_f32_16x16x32_bf16 v[60:63], v[132:135], v[128:131], v[60:63]
buffer_load_dwordx4 v[108:111], v238, s[16:19], s49 offen offset:3072
v_mfma_f32_16x16x32_bf16 v[64:67], v[136:139], v[128:131], v[64:67]
v_mfma_f32_16x16x32_bf16 v[68:71], v[140:143], v[128:131], v[68:71]
buffer_load_dwordx4 v[112:115], v239, s[16:19], s49 offen
v_mfma_f32_16x16x32_bf16 v[72:75], v[144:147], v[128:131], v[72:75]
v_mfma_f32_16x16x32_bf16 v[76:79], v[148:151], v[128:131], v[76:79]
s_waitcnt vmcnt(22)
v_mfma_f32_16x16x32_bf16 v[0:3], v[168:171], v[152:155], v[0:3]
v_mfma_f32_16x16x32_bf16 v[4:7], v[172:175], v[152:155], v[4:7]
s_mov_b32 s48, 36864
buffer_load_dwordx4 v[116:119], v234, s[12:15], s48 offen
v_mfma_f32_16x16x32_bf16 v[8:11], v[176:179], v[152:155], v[8:11]
v_mfma_f32_16x16x32_bf16 v[12:15], v[180:183], v[152:155], v[12:15]
buffer_load_dwordx4 v[120:123], v235, s[12:15], s48 offen
v_mfma_f32_16x16x32_bf16 v[16:19], v[184:187], v[152:155], v[16:19]
v_mfma_f32_16x16x32_bf16 v[20:23], v[168:171], v[156:159], v[20:23]
buffer_load_dwordx4 v[124:127], v236, s[12:15], s48 offen
v_mfma_f32_16x16x32_bf16 v[24:27], v[172:175], v[156:159], v[24:27]
v_mfma_f32_16x16x32_bf16 v[28:31], v[176:179], v[156:159], v[28:31]
buffer_load_dwordx4 v[128:131], v237, s[12:15], s48 offen
v_mfma_f32_16x16x32_bf16 v[32:35], v[180:183], v[156:159], v[32:35]
v_mfma_f32_16x16x32_bf16 v[36:39], v[184:187], v[156:159], v[36:39]
s_mov_b32 s49, 331776
buffer_load_dwordx4 v[132:135], v238, s[16:19], s49 offen
v_mfma_f32_16x16x32_bf16 v[40:43], v[168:171], v[160:163], v[40:43]
v_mfma_f32_16x16x32_bf16 v[44:47], v[172:175], v[160:163], v[44:47]
buffer_load_dwordx4 v[136:139], v238, s[16:19], s49 offen offset:1024
v_mfma_f32_16x16x32_bf16 v[48:51], v[176:179], v[160:163], v[48:51]
v_mfma_f32_16x16x32_bf16 v[52:55], v[180:183], v[160:163], v[52:55]
buffer_load_dwordx4 v[140:143], v238, s[16:19], s49 offen offset:2048
v_mfma_f32_16x16x32_bf16 v[56:59], v[184:187], v[160:163], v[56:59]
v_mfma_f32_16x16x32_bf16 v[60:63], v[168:171], v[164:167], v[60:63]
buffer_load_dwordx4 v[144:147], v238, s[16:19], s49 offen offset:3072
v_mfma_f32_16x16x32_bf16 v[64:67], v[172:175], v[164:167], v[64:67]
v_mfma_f32_16x16x32_bf16 v[68:71], v[176:179], v[164:167], v[68:71]
buffer_load_dwordx4 v[148:151], v239, s[16:19], s49 offen
v_mfma_f32_16x16x32_bf16 v[72:75], v[180:183], v[164:167], v[72:75]
v_mfma_f32_16x16x32_bf16 v[76:79], v[184:187], v[164:167], v[76:79]
s_waitcnt vmcnt(22)
v_mfma_f32_16x16x32_bf16 v[0:3], v[204:207], v[188:191], v[0:3]
v_mfma_f32_16x16x32_bf16 v[4:7], v[208:211], v[188:191], v[4:7]
s_mov_b32 s48, 40960
buffer_load_dwordx4 v[152:155], v234, s[12:15], s48 offen
v_mfma_f32_16x16x32_bf16 v[8:11], v[212:215], v[188:191], v[8:11]
v_mfma_f32_16x16x32_bf16 v[12:15], v[216:219], v[188:191], v[12:15]
buffer_load_dwordx4 v[156:159], v235, s[12:15], s48 offen
v_mfma_f32_16x16x32_bf16 v[16:19], v[220:223], v[188:191], v[16:19]
v_mfma_f32_16x16x32_bf16 v[20:23], v[204:207], v[192:195], v[20:23]
buffer_load_dwordx4 v[160:163], v236, s[12:15], s48 offen
v_mfma_f32_16x16x32_bf16 v[24:27], v[208:211], v[192:195], v[24:27]
v_mfma_f32_16x16x32_bf16 v[28:31], v[212:215], v[192:195], v[28:31]
buffer_load_dwordx4 v[164:167], v237, s[12:15], s48 offen
v_mfma_f32_16x16x32_bf16 v[32:35], v[216:219], v[192:195], v[32:35]
v_mfma_f32_16x16x32_bf16 v[36:39], v[220:223], v[192:195], v[36:39]
s_mov_b32 s49, 368640
buffer_load_dwordx4 v[168:171], v238, s[16:19], s49 offen
v_mfma_f32_16x16x32_bf16 v[40:43], v[204:207], v[196:199], v[40:43]
v_mfma_f32_16x16x32_bf16 v[44:47], v[208:211], v[196:199], v[44:47]
buffer_load_dwordx4 v[172:175], v238, s[16:19], s49 offen offset:1024
v_mfma_f32_16x16x32_bf16 v[48:51], v[212:215], v[196:199], v[48:51]
v_mfma_f32_16x16x32_bf16 v[52:55], v[216:219], v[196:199], v[52:55]
buffer_load_dwordx4 v[176:179], v238, s[16:19], s49 offen offset:2048
v_mfma_f32_16x16x32_bf16 v[56:59], v[220:223], v[196:199], v[56:59]
v_mfma_f32_16x16x32_bf16 v[60:63], v[204:207], v[200:203], v[60:63]
buffer_load_dwordx4 v[180:183], v238, s[16:19], s49 offen offset:3072
v_mfma_f32_16x16x32_bf16 v[64:67], v[208:211], v[200:203], v[64:67]
v_mfma_f32_16x16x32_bf16 v[68:71], v[212:215], v[200:203], v[68:71]
buffer_load_dwordx4 v[184:187], v239, s[16:19], s49 offen
v_mfma_f32_16x16x32_bf16 v[72:75], v[216:219], v[200:203], v[72:75]
v_mfma_f32_16x16x32_bf16 v[76:79], v[220:223], v[200:203], v[76:79]
s_waitcnt vmcnt(18)
v_mfma_f32_16x16x32_bf16 v[0:3], v[96:99], v[80:83], v[0:3]
v_mfma_f32_16x16x32_bf16 v[4:7], v[100:103], v[80:83], v[4:7]
s_mov_b32 s48, 45056
buffer_load_dwordx4 v[188:191], v234, s[12:15], s48 offen
v_mfma_f32_16x16x32_bf16 v[8:11], v[104:107], v[80:83], v[8:11]
v_mfma_f32_16x16x32_bf16 v[12:15], v[108:111], v[80:83], v[12:15]
buffer_load_dwordx4 v[192:195], v235, s[12:15], s48 offen
v_mfma_f32_16x16x32_bf16 v[16:19], v[112:115], v[80:83], v[16:19]
v_mfma_f32_16x16x32_bf16 v[20:23], v[96:99], v[84:87], v[20:23]
buffer_load_dwordx4 v[196:199], v236, s[12:15], s48 offen
v_mfma_f32_16x16x32_bf16 v[24:27], v[100:103], v[84:87], v[24:27]
v_mfma_f32_16x16x32_bf16 v[28:31], v[104:107], v[84:87], v[28:31]
buffer_load_dwordx4 v[200:203], v237, s[12:15], s48 offen
v_mfma_f32_16x16x32_bf16 v[32:35], v[108:111], v[84:87], v[32:35]
v_mfma_f32_16x16x32_bf16 v[36:39], v[112:115], v[84:87], v[36:39]
s_mov_b32 s49, 405504
buffer_load_dwordx4 v[204:207], v238, s[16:19], s49 offen
v_mfma_f32_16x16x32_bf16 v[40:43], v[96:99], v[88:91], v[40:43]
v_mfma_f32_16x16x32_bf16 v[44:47], v[100:103], v[88:91], v[44:47]
buffer_load_dwordx4 v[208:211], v238, s[16:19], s49 offen offset:1024
v_mfma_f32_16x16x32_bf16 v[48:51], v[104:107], v[88:91], v[48:51]
v_mfma_f32_16x16x32_bf16 v[52:55], v[108:111], v[88:91], v[52:55]
buffer_load_dwordx4 v[212:215], v238, s[16:19], s49 offen offset:2048
v_mfma_f32_16x16x32_bf16 v[56:59], v[112:115], v[88:91], v[56:59]
v_mfma_f32_16x16x32_bf16 v[60:63], v[96:99], v[92:95], v[60:63]
buffer_load_dwordx4 v[216:219], v238, s[16:19], s49 offen offset:3072
v_mfma_f32_16x16x32_bf16 v[64:67], v[100:103], v[92:95], v[64:67]
v_mfma_f32_16x16x32_bf16 v[68:71], v[104:107], v[92:95], v[68:71]
buffer_load_dwordx4 v[220:223], v239, s[16:19], s49 offen
v_mfma_f32_16x16x32_bf16 v[72:75], v[108:111], v[92:95], v[72:75]
v_mfma_f32_16x16x32_bf16 v[76:79], v[112:115], v[92:95], v[76:79]
s_waitcnt vmcnt(18)
v_mfma_f32_16x16x32_bf16 v[0:3], v[132:135], v[116:119], v[0:3]
v_mfma_f32_16x16x32_bf16 v[4:7], v[136:139], v[116:119], v[4:7]
s_mov_b32 s48, 49152
buffer_load_dwordx4 v[80:83], v234, s[12:15], s48 offen
v_mfma_f32_16x16x32_bf16 v[8:11], v[140:143], v[116:119], v[8:11]
v_mfma_f32_16x16x32_bf16 v[12:15], v[144:147], v[116:119], v[12:15]
buffer_load_dwordx4 v[84:87], v235, s[12:15], s48 offen
v_mfma_f32_16x16x32_bf16 v[16:19], v[148:151], v[116:119], v[16:19]
v_mfma_f32_16x16x32_bf16 v[20:23], v[132:135], v[120:123], v[20:23]
buffer_load_dwordx4 v[88:91], v236, s[12:15], s48 offen
v_mfma_f32_16x16x32_bf16 v[24:27], v[136:139], v[120:123], v[24:27]
v_mfma_f32_16x16x32_bf16 v[28:31], v[140:143], v[120:123], v[28:31]
buffer_load_dwordx4 v[92:95], v237, s[12:15], s48 offen
v_mfma_f32_16x16x32_bf16 v[32:35], v[144:147], v[120:123], v[32:35]
v_mfma_f32_16x16x32_bf16 v[36:39], v[148:151], v[120:123], v[36:39]
s_mov_b32 s49, 442368
buffer_load_dwordx4 v[96:99], v238, s[16:19], s49 offen
v_mfma_f32_16x16x32_bf16 v[40:43], v[132:135], v[124:127], v[40:43]
v_mfma_f32_16x16x32_bf16 v[44:47], v[136:139], v[124:127], v[44:47]
buffer_load_dwordx4 v[100:103], v238, s[16:19], s49 offen offset:1024
v_mfma_f32_16x16x32_bf16 v[48:51], v[140:143], v[124:127], v[48:51]
v_mfma_f32_16x16x32_bf16 v[52:55], v[144:147], v[124:127], v[52:55]
buffer_load_dwordx4 v[104:107], v238, s[16:19], s49 offen offset:2048
v_mfma_f32_16x16x32_bf16 v[56:59], v[148:151], v[124:127], v[56:59]
v_mfma_f32_16x16x32_bf16 v[60:63], v[132:135], v[128:131], v[60:63]
buffer_load_dwordx4 v[108:111], v238, s[16:19], s49 offen offset:3072
v_mfma_f32_16x16x32_bf16 v[64:67], v[136:139], v[128:131], v[64:67]
v_mfma_f32_16x16x32_bf16 v[68:71], v[140:143], v[128:131], v[68:71]
buffer_load_dwordx4 v[112:115], v239, s[16:19], s49 offen
v_mfma_f32_16x16x32_bf16 v[72:75], v[144:147], v[128:131], v[72:75]
v_mfma_f32_16x16x32_bf16 v[76:79], v[148:151], v[128:131], v[76:79]
s_waitcnt vmcnt(18)
v_mfma_f32_16x16x32_bf16 v[0:3], v[168:171], v[152:155], v[0:3]
v_mfma_f32_16x16x32_bf16 v[4:7], v[172:175], v[152:155], v[4:7]
s_mov_b32 s48, 53248
buffer_load_dwordx4 v[116:119], v234, s[12:15], s48 offen
v_mfma_f32_16x16x32_bf16 v[8:11], v[176:179], v[152:155], v[8:11]
v_mfma_f32_16x16x32_bf16 v[12:15], v[180:183], v[152:155], v[12:15]
buffer_load_dwordx4 v[120:123], v235, s[12:15], s48 offen
v_mfma_f32_16x16x32_bf16 v[16:19], v[184:187], v[152:155], v[16:19]
v_mfma_f32_16x16x32_bf16 v[20:23], v[168:171], v[156:159], v[20:23]
buffer_load_dwordx4 v[124:127], v236, s[12:15], s48 offen
v_mfma_f32_16x16x32_bf16 v[24:27], v[172:175], v[156:159], v[24:27]
v_mfma_f32_16x16x32_bf16 v[28:31], v[176:179], v[156:159], v[28:31]
buffer_load_dwordx4 v[128:131], v237, s[12:15], s48 offen
v_mfma_f32_16x16x32_bf16 v[32:35], v[180:183], v[156:159], v[32:35]
v_mfma_f32_16x16x32_bf16 v[36:39], v[184:187], v[156:159], v[36:39]
s_mov_b32 s49, 479232
buffer_load_dwordx4 v[132:135], v238, s[16:19], s49 offen
v_mfma_f32_16x16x32_bf16 v[40:43], v[168:171], v[160:163], v[40:43]
v_mfma_f32_16x16x32_bf16 v[44:47], v[172:175], v[160:163], v[44:47]
buffer_load_dwordx4 v[136:139], v238, s[16:19], s49 offen offset:1024
v_mfma_f32_16x16x32_bf16 v[48:51], v[176:179], v[160:163], v[48:51]
v_mfma_f32_16x16x32_bf16 v[52:55], v[180:183], v[160:163], v[52:55]
buffer_load_dwordx4 v[140:143], v238, s[16:19], s49 offen offset:2048
v_mfma_f32_16x16x32_bf16 v[56:59], v[184:187], v[160:163], v[56:59]
v_mfma_f32_16x16x32_bf16 v[60:63], v[168:171], v[164:167], v[60:63]
buffer_load_dwordx4 v[144:147], v238, s[16:19], s49 offen offset:3072
v_mfma_f32_16x16x32_bf16 v[64:67], v[172:175], v[164:167], v[64:67]
v_mfma_f32_16x16x32_bf16 v[68:71], v[176:179], v[164:167], v[68:71]
buffer_load_dwordx4 v[148:151], v239, s[16:19], s49 offen
v_mfma_f32_16x16x32_bf16 v[72:75], v[180:183], v[164:167], v[72:75]
v_mfma_f32_16x16x32_bf16 v[76:79], v[184:187], v[164:167], v[76:79]
s_waitcnt vmcnt(18)
v_mfma_f32_16x16x32_bf16 v[0:3], v[204:207], v[188:191], v[0:3]
v_mfma_f32_16x16x32_bf16 v[4:7], v[208:211], v[188:191], v[4:7]
s_mov_b32 s48, 57344
buffer_load_dwordx4 v[152:155], v234, s[12:15], s48 offen
v_mfma_f32_16x16x32_bf16 v[8:11], v[212:215], v[188:191], v[8:11]
v_mfma_f32_16x16x32_bf16 v[12:15], v[216:219], v[188:191], v[12:15]
buffer_load_dwordx4 v[156:159], v235, s[12:15], s48 offen
v_mfma_f32_16x16x32_bf16 v[16:19], v[220:223], v[188:191], v[16:19]
v_mfma_f32_16x16x32_bf16 v[20:23], v[204:207], v[192:195], v[20:23]
buffer_load_dwordx4 v[160:163], v236, s[12:15], s48 offen
v_mfma_f32_16x16x32_bf16 v[24:27], v[208:211], v[192:195], v[24:27]
v_mfma_f32_16x16x32_bf16 v[28:31], v[212:215], v[192:195], v[28:31]
buffer_load_dwordx4 v[164:167], v237, s[12:15], s48 offen
v_mfma_f32_16x16x32_bf16 v[32:35], v[216:219], v[192:195], v[32:35]
v_mfma_f32_16x16x32_bf16 v[36:39], v[220:223], v[192:195], v[36:39]
s_mov_b32 s49, 516096
buffer_load_dwordx4 v[168:171], v238, s[16:19], s49 offen
v_mfma_f32_16x16x32_bf16 v[40:43], v[204:207], v[196:199], v[40:43]
v_mfma_f32_16x16x32_bf16 v[44:47], v[208:211], v[196:199], v[44:47]
buffer_load_dwordx4 v[172:175], v238, s[16:19], s49 offen offset:1024
v_mfma_f32_16x16x32_bf16 v[48:51], v[212:215], v[196:199], v[48:51]
v_mfma_f32_16x16x32_bf16 v[52:55], v[216:219], v[196:199], v[52:55]
buffer_load_dwordx4 v[176:179], v238, s[16:19], s49 offen offset:2048
v_mfma_f32_16x16x32_bf16 v[56:59], v[220:223], v[196:199], v[56:59]
v_mfma_f32_16x16x32_bf16 v[60:63], v[204:207], v[200:203], v[60:63]
buffer_load_dwordx4 v[180:183], v238, s[16:19], s49 offen offset:3072
v_mfma_f32_16x16x32_bf16 v[64:67], v[208:211], v[200:203], v[64:67]
v_mfma_f32_16x16x32_bf16 v[68:71], v[212:215], v[200:203], v[68:71]
buffer_load_dwordx4 v[184:187], v239, s[16:19], s49 offen
v_mfma_f32_16x16x32_bf16 v[72:75], v[216:219], v[200:203], v[72:75]
v_mfma_f32_16x16x32_bf16 v[76:79], v[220:223], v[200:203], v[76:79]
s_waitcnt vmcnt(18)
v_mov_b32 v244, 83232
v_mov_b32 v245, 1
ds_write_b32 v244, v245
v_mfma_f32_16x16x32_bf16 v[0:3], v[96:99], v[80:83], v[0:3]
v_mfma_f32_16x16x32_bf16 v[4:7], v[100:103], v[80:83], v[4:7]
s_mov_b32 s48, 61440
buffer_load_dwordx4 v[188:191], v234, s[12:15], s48 offen
v_mfma_f32_16x16x32_bf16 v[8:11], v[104:107], v[80:83], v[8:11]
v_mfma_f32_16x16x32_bf16 v[12:15], v[108:111], v[80:83], v[12:15]
buffer_load_dwordx4 v[192:195], v235, s[12:15], s48 offen
v_mfma_f32_16x16x32_bf16 v[16:19], v[112:115], v[80:83], v[16:19]
v_mfma_f32_16x16x32_bf16 v[20:23], v[96:99], v[84:87], v[20:23]
buffer_load_dwordx4 v[196:199], v236, s[12:15], s48 offen
v_mfma_f32_16x16x32_bf16 v[24:27], v[100:103], v[84:87], v[24:27]
v_mfma_f32_16x16x32_bf16 v[28:31], v[104:107], v[84:87], v[28:31]
buffer_load_dwordx4 v[200:203], v237, s[12:15], s48 offen
v_mfma_f32_16x16x32_bf16 v[32:35], v[108:111], v[84:87], v[32:35]
v_mfma_f32_16x16x32_bf16 v[36:39], v[112:115], v[84:87], v[36:39]
s_mov_b32 s49, 552960
buffer_load_dwordx4 v[204:207], v238, s[16:19], s49 offen
v_mfma_f32_16x16x32_bf16 v[40:43], v[96:99], v[88:91], v[40:43]
v_mfma_f32_16x16x32_bf16 v[44:47], v[100:103], v[88:91], v[44:47]
buffer_load_dwordx4 v[208:211], v238, s[16:19], s49 offen offset:1024
v_mfma_f32_16x16x32_bf16 v[48:51], v[104:107], v[88:91], v[48:51]
v_mfma_f32_16x16x32_bf16 v[52:55], v[108:111], v[88:91], v[52:55]
buffer_load_dwordx4 v[212:215], v238, s[16:19], s49 offen offset:2048
v_mfma_f32_16x16x32_bf16 v[56:59], v[112:115], v[88:91], v[56:59]
v_mfma_f32_16x16x32_bf16 v[60:63], v[96:99], v[92:95], v[60:63]
buffer_load_dwordx4 v[216:219], v238, s[16:19], s49 offen offset:3072
v_mfma_f32_16x16x32_bf16 v[64:67], v[100:103], v[92:95], v[64:67]
v_mfma_f32_16x16x32_bf16 v[68:71], v[104:107], v[92:95], v[68:71]
buffer_load_dwordx4 v[220:223], v239, s[16:19], s49 offen
v_mfma_f32_16x16x32_bf16 v[72:75], v[108:111], v[92:95], v[72:75]
v_mfma_f32_16x16x32_bf16 v[76:79], v[112:115], v[92:95], v[76:79]
s_waitcnt vmcnt(18)
v_mfma_f32_16x16x32_bf16 v[0:3], v[132:135], v[116:119], v[0:3]
v_mfma_f32_16x16x32_bf16 v[4:7], v[136:139], v[116:119], v[4:7]
s_mov_b32 s48, 65536
buffer_load_dwordx4 v[80:83], v234, s[12:15], s48 offen
v_mfma_f32_16x16x32_bf16 v[8:11], v[140:143], v[116:119], v[8:11]
v_mfma_f32_16x16x32_bf16 v[12:15], v[144:147], v[116:119], v[12:15]
buffer_load_dwordx4 v[84:87], v235, s[12:15], s48 offen
v_mfma_f32_16x16x32_bf16 v[16:19], v[148:151], v[116:119], v[16:19]
v_mfma_f32_16x16x32_bf16 v[20:23], v[132:135], v[120:123], v[20:23]
buffer_load_dwordx4 v[88:91], v236, s[12:15], s48 offen
v_mfma_f32_16x16x32_bf16 v[24:27], v[136:139], v[120:123], v[24:27]
v_mfma_f32_16x16x32_bf16 v[28:31], v[140:143], v[120:123], v[28:31]
buffer_load_dwordx4 v[92:95], v237, s[12:15], s48 offen
v_mfma_f32_16x16x32_bf16 v[32:35], v[144:147], v[120:123], v[32:35]
v_mfma_f32_16x16x32_bf16 v[36:39], v[148:151], v[120:123], v[36:39]
s_mov_b32 s49, 589824
buffer_load_dwordx4 v[96:99], v238, s[16:19], s49 offen
v_mfma_f32_16x16x32_bf16 v[40:43], v[132:135], v[124:127], v[40:43]
v_mfma_f32_16x16x32_bf16 v[44:47], v[136:139], v[124:127], v[44:47]
buffer_load_dwordx4 v[100:103], v238, s[16:19], s49 offen offset:1024
v_mfma_f32_16x16x32_bf16 v[48:51], v[140:143], v[124:127], v[48:51]
v_mfma_f32_16x16x32_bf16 v[52:55], v[144:147], v[124:127], v[52:55]
buffer_load_dwordx4 v[104:107], v238, s[16:19], s49 offen offset:2048
v_mfma_f32_16x16x32_bf16 v[56:59], v[148:151], v[124:127], v[56:59]
v_mfma_f32_16x16x32_bf16 v[60:63], v[132:135], v[128:131], v[60:63]
buffer_load_dwordx4 v[108:111], v238, s[16:19], s49 offen offset:3072
v_mfma_f32_16x16x32_bf16 v[64:67], v[136:139], v[128:131], v[64:67]
v_mfma_f32_16x16x32_bf16 v[68:71], v[140:143], v[128:131], v[68:71]
buffer_load_dwordx4 v[112:115], v239, s[16:19], s49 offen
v_mfma_f32_16x16x32_bf16 v[72:75], v[144:147], v[128:131], v[72:75]
v_mfma_f32_16x16x32_bf16 v[76:79], v[148:151], v[128:131], v[76:79]
s_waitcnt vmcnt(18)
v_mfma_f32_16x16x32_bf16 v[0:3], v[168:171], v[152:155], v[0:3]
v_mfma_f32_16x16x32_bf16 v[4:7], v[172:175], v[152:155], v[4:7]
s_mov_b32 s48, 69632
v_lshrrev_b32 v242, 1, v246
v_sub_u32 v242, v234, v242
buffer_load_dwordx2 v[116:117], v242, s[12:15], s48 offen
buffer_load_dwordx2 v[118:119], v242, s[12:15], s48 offen offset:512
v_mfma_f32_16x16x32_bf16 v[8:11], v[176:179], v[152:155], v[8:11]
v_mfma_f32_16x16x32_bf16 v[12:15], v[180:183], v[152:155], v[12:15]
v_lshrrev_b32 v242, 1, v246
v_sub_u32 v242, v235, v242
buffer_load_dwordx2 v[120:121], v242, s[12:15], s48 offen
buffer_load_dwordx2 v[122:123], v242, s[12:15], s48 offen offset:512
v_mfma_f32_16x16x32_bf16 v[16:19], v[184:187], v[152:155], v[16:19]
v_mfma_f32_16x16x32_bf16 v[20:23], v[168:171], v[156:159], v[20:23]
v_lshrrev_b32 v242, 1, v246
v_sub_u32 v242, v236, v242
buffer_load_dwordx2 v[124:125], v242, s[12:15], s48 offen
buffer_load_dwordx2 v[126:127], v242, s[12:15], s48 offen offset:512
v_mfma_f32_16x16x32_bf16 v[24:27], v[172:175], v[156:159], v[24:27]
v_mfma_f32_16x16x32_bf16 v[28:31], v[176:179], v[156:159], v[28:31]
v_lshrrev_b32 v242, 1, v246
v_sub_u32 v242, v237, v242
buffer_load_dwordx2 v[128:129], v242, s[12:15], s48 offen
buffer_load_dwordx2 v[130:131], v242, s[12:15], s48 offen offset:512
v_mfma_f32_16x16x32_bf16 v[32:35], v[180:183], v[156:159], v[32:35]
v_mfma_f32_16x16x32_bf16 v[36:39], v[184:187], v[156:159], v[36:39]
s_mov_b32 s49, 626688
buffer_load_dwordx4 v[132:135], v238, s[16:19], s49 offen
v_mfma_f32_16x16x32_bf16 v[40:43], v[168:171], v[160:163], v[40:43]
v_mfma_f32_16x16x32_bf16 v[44:47], v[172:175], v[160:163], v[44:47]
buffer_load_dwordx4 v[136:139], v238, s[16:19], s49 offen offset:1024
v_mfma_f32_16x16x32_bf16 v[48:51], v[176:179], v[160:163], v[48:51]
v_mfma_f32_16x16x32_bf16 v[52:55], v[180:183], v[160:163], v[52:55]
buffer_load_dwordx4 v[140:143], v238, s[16:19], s49 offen offset:2048
v_mfma_f32_16x16x32_bf16 v[56:59], v[184:187], v[160:163], v[56:59]
v_mfma_f32_16x16x32_bf16 v[60:63], v[168:171], v[164:167], v[60:63]
buffer_load_dwordx4 v[144:147], v238, s[16:19], s49 offen offset:3072
v_mfma_f32_16x16x32_bf16 v[64:67], v[172:175], v[164:167], v[64:67]
v_mfma_f32_16x16x32_bf16 v[68:71], v[176:179], v[164:167], v[68:71]
buffer_load_dwordx4 v[148:151], v239, s[16:19], s49 offen
v_mfma_f32_16x16x32_bf16 v[72:75], v[180:183], v[164:167], v[72:75]
v_mfma_f32_16x16x32_bf16 v[76:79], v[184:187], v[164:167], v[76:79]
s_waitcnt vmcnt(22)
v_mfma_f32_16x16x32_bf16 v[0:3], v[204:207], v[188:191], v[0:3]
v_mfma_f32_16x16x32_bf16 v[4:7], v[208:211], v[188:191], v[4:7]
v_mfma_f32_16x16x32_bf16 v[8:11], v[212:215], v[188:191], v[8:11]
v_mfma_f32_16x16x32_bf16 v[12:15], v[216:219], v[188:191], v[12:15]
v_mfma_f32_16x16x32_bf16 v[16:19], v[220:223], v[188:191], v[16:19]
v_mfma_f32_16x16x32_bf16 v[20:23], v[204:207], v[192:195], v[20:23]
v_mfma_f32_16x16x32_bf16 v[24:27], v[208:211], v[192:195], v[24:27]
v_mfma_f32_16x16x32_bf16 v[28:31], v[212:215], v[192:195], v[28:31]
v_mfma_f32_16x16x32_bf16 v[32:35], v[216:219], v[192:195], v[32:35]
v_mfma_f32_16x16x32_bf16 v[36:39], v[220:223], v[192:195], v[36:39]
v_mfma_f32_16x16x32_bf16 v[40:43], v[204:207], v[196:199], v[40:43]
v_mfma_f32_16x16x32_bf16 v[44:47], v[208:211], v[196:199], v[44:47]
v_mfma_f32_16x16x32_bf16 v[48:51], v[212:215], v[196:199], v[48:51]
v_mfma_f32_16x16x32_bf16 v[52:55], v[216:219], v[196:199], v[52:55]
v_mfma_f32_16x16x32_bf16 v[56:59], v[220:223], v[196:199], v[56:59]
v_mfma_f32_16x16x32_bf16 v[60:63], v[204:207], v[200:203], v[60:63]
v_mfma_f32_16x16x32_bf16 v[64:67], v[208:211], v[200:203], v[64:67]
v_mfma_f32_16x16x32_bf16 v[68:71], v[212:215], v[200:203], v[68:71]
v_mfma_f32_16x16x32_bf16 v[72:75], v[216:219], v[200:203], v[72:75]
v_mfma_f32_16x16x32_bf16 v[76:79], v[220:223], v[200:203], v[76:79]
s_waitcnt vmcnt(13)
v_mfma_f32_16x16x32_bf16 v[0:3], v[96:99], v[80:83], v[0:3]
v_mfma_f32_16x16x32_bf16 v[4:7], v[100:103], v[80:83], v[4:7]
v_mfma_f32_16x16x32_bf16 v[8:11], v[104:107], v[80:83], v[8:11]
v_mfma_f32_16x16x32_bf16 v[12:15], v[108:111], v[80:83], v[12:15]
v_mfma_f32_16x16x32_bf16 v[16:19], v[112:115], v[80:83], v[16:19]
v_mfma_f32_16x16x32_bf16 v[20:23], v[96:99], v[84:87], v[20:23]
v_mfma_f32_16x16x32_bf16 v[24:27], v[100:103], v[84:87], v[24:27]
v_mfma_f32_16x16x32_bf16 v[28:31], v[104:107], v[84:87], v[28:31]
v_mfma_f32_16x16x32_bf16 v[32:35], v[108:111], v[84:87], v[32:35]
v_mfma_f32_16x16x32_bf16 v[36:39], v[112:115], v[84:87], v[36:39]
v_mfma_f32_16x16x32_bf16 v[40:43], v[96:99], v[88:91], v[40:43]
v_mfma_f32_16x16x32_bf16 v[44:47], v[100:103], v[88:91], v[44:47]
v_mfma_f32_16x16x32_bf16 v[48:51], v[104:107], v[88:91], v[48:51]
v_mfma_f32_16x16x32_bf16 v[52:55], v[108:111], v[88:91], v[52:55]
v_mfma_f32_16x16x32_bf16 v[56:59], v[112:115], v[88:91], v[56:59]
v_mfma_f32_16x16x32_bf16 v[60:63], v[96:99], v[92:95], v[60:63]
v_mfma_f32_16x16x32_bf16 v[64:67], v[100:103], v[92:95], v[64:67]
v_mfma_f32_16x16x32_bf16 v[68:71], v[104:107], v[92:95], v[68:71]
v_mfma_f32_16x16x32_bf16 v[72:75], v[108:111], v[92:95], v[72:75]
v_mfma_f32_16x16x32_bf16 v[76:79], v[112:115], v[92:95], v[76:79]
s_waitcnt vmcnt(0)
v_mfma_f32_16x16x32_bf16 v[20:23], v[132:135], v[120:123], v[20:23]
v_mfma_f32_16x16x32_bf16 v[24:27], v[136:139], v[120:123], v[24:27]
v_mfma_f32_16x16x32_bf16 v[28:31], v[140:143], v[120:123], v[28:31]
v_mfma_f32_16x16x32_bf16 v[32:35], v[144:147], v[120:123], v[32:35]
v_mfma_f32_16x16x32_bf16 v[36:39], v[148:151], v[120:123], v[36:39]
v_mfma_f32_16x16x32_bf16 v[40:43], v[132:135], v[124:127], v[40:43]
s_nop 2
ds_write_b128 v247, v[20:23] offset:0
v_mfma_f32_16x16x32_bf16 v[44:47], v[136:139], v[124:127], v[44:47]
ds_write_b128 v247, v[24:27] offset:1024
v_mfma_f32_16x16x32_bf16 v[48:51], v[140:143], v[124:127], v[48:51]
ds_write_b128 v247, v[28:31] offset:2048
v_mfma_f32_16x16x32_bf16 v[52:55], v[144:147], v[124:127], v[52:55]
ds_write_b128 v247, v[32:35] offset:3072
v_mfma_f32_16x16x32_bf16 v[56:59], v[148:151], v[124:127], v[56:59]
ds_write_b128 v247, v[36:39] offset:4096
v_mfma_f32_16x16x32_bf16 v[60:63], v[132:135], v[128:131], v[60:63]
ds_write_b128 v248, v[40:43] offset:0
v_mfma_f32_16x16x32_bf16 v[64:67], v[136:139], v[128:131], v[64:67]
ds_write_b128 v248, v[44:47] offset:1024
v_mfma_f32_16x16x32_bf16 v[68:71], v[140:143], v[128:131], v[68:71]
ds_write_b128 v248, v[48:51] offset:2048
v_mfma_f32_16x16x32_bf16 v[72:75], v[144:147], v[128:131], v[72:75]
ds_write_b128 v248, v[52:55] offset:3072
v_mfma_f32_16x16x32_bf16 v[76:79], v[148:151], v[128:131], v[76:79]
ds_write_b128 v248, v[56:59] offset:4096
v_mfma_f32_16x16x32_bf16 v[0:3], v[132:135], v[116:119], v[0:3]
ds_write_b128 v249, v[60:63] offset:0
v_mfma_f32_16x16x32_bf16 v[4:7], v[136:139], v[116:119], v[4:7]
ds_write_b128 v249, v[64:67] offset:1024
v_mfma_f32_16x16x32_bf16 v[8:11], v[140:143], v[116:119], v[8:11]
ds_write_b128 v249, v[68:71] offset:2048
v_mfma_f32_16x16x32_bf16 v[12:15], v[144:147], v[116:119], v[12:15]
ds_write_b128 v249, v[72:75] offset:3072
v_mfma_f32_16x16x32_bf16 v[16:19], v[148:151], v[116:119], v[16:19]
ds_write_b128 v249, v[76:79] offset:4096
s_waitcnt vmcnt(0)
v_lshlrev_b32 v180, 16, v224
v_and_b32 v181, 0xffff0000, v224
v_lshlrev_b32 v182, 16, v225
v_and_b32 v183, 0xffff0000, v225
v_lshlrev_b32 v184, 16, v226
v_and_b32 v185, 0xffff0000, v226
v_lshlrev_b32 v186, 16, v227
v_and_b32 v187, 0xffff0000, v227
v_lshlrev_b32 v188, 16, v228
v_and_b32 v189, 0xffff0000, v228
v_lshlrev_b32 v190, 16, v229
v_and_b32 v191, 0xffff0000, v229
v_lshlrev_b32 v192, 16, v230
v_and_b32 v193, 0xffff0000, v230
v_lshlrev_b32 v194, 16, v231
v_and_b32 v195, 0xffff0000, v231
v_lshlrev_b32 v196, 16, v232
v_and_b32 v197, 0xffff0000, v232
v_lshlrev_b32 v198, 16, v233
v_and_b32 v199, 0xffff0000, v233
v_add_f32 v0, v0, v180
v_add_f32 v1, v1, v181
v_add_f32 v2, v2, v182
v_add_f32 v3, v3, v183
v_add_f32 v4, v4, v184
v_add_f32 v5, v5, v185
v_add_f32 v6, v6, v186
v_add_f32 v7, v7, v187
v_add_f32 v8, v8, v188
v_add_f32 v9, v9, v189
v_add_f32 v10, v10, v190
v_add_f32 v11, v11, v191
v_add_f32 v12, v12, v192
v_add_f32 v13, v13, v193
v_add_f32 v14, v14, v194
v_add_f32 v15, v15, v195
v_add_f32 v16, v16, v196
v_add_f32 v17, v17, v197
v_add_f32 v18, v18, v198
v_add_f32 v19, v19, v199
s_waitcnt vmcnt(0) lgkmcnt(0)
s_barrier
ds_read_b128 v[84:87], v250 offset:0
ds_read_b128 v[88:91], v250 offset:1024
ds_read_b128 v[92:95], v250 offset:2048
ds_read_b128 v[96:99], v250 offset:3072
ds_read_b128 v[100:103], v250 offset:4096
ds_read_b128 v[104:107], v250 offset:5120
ds_read_b128 v[108:111], v250 offset:6144
ds_read_b128 v[112:115], v250 offset:7168
ds_read_b128 v[116:119], v250 offset:8192
ds_read_b128 v[120:123], v250 offset:9216
ds_read_b128 v[124:127], v250 offset:10240
ds_read_b128 v[128:131], v250 offset:11264
ds_read_b128 v[132:135], v250 offset:12288
ds_read_b128 v[136:139], v250 offset:13312
ds_read_b128 v[140:143], v250 offset:14336
ds_read_b64_tr_b16 v[144:145], v251 offset:0
ds_read_b64_tr_b16 v[146:147], v251 offset:2048
ds_read_b64_tr_b16 v[148:149], v251 offset:4096
ds_read_b64_tr_b16 v[150:151], v251 offset:6144
ds_read_b64_tr_b16 v[152:153], v252
s_waitcnt lgkmcnt(0)
v_lshlrev_b32 v160, 16, v144
v_and_b32 v161, 0xffff0000, v144
v_lshlrev_b32 v162, 16, v145
v_and_b32 v163, 0xffff0000, v145
v_add_f32 v0, v0, v84
v_add_f32 v156, v104, v124
v_add_f32 v1, v1, v85
v_add_f32 v157, v105, v125
v_add_f32 v2, v2, v86
v_add_f32 v158, v106, v126
v_add_f32 v3, v3, v87
v_add_f32 v159, v107, v127
v_add_f32 v0, v0, v160
v_add_f32 v1, v1, v161
v_add_f32 v2, v2, v162
v_add_f32 v3, v3, v163
v_add_f32 v0, v0, v156
v_add_f32 v1, v1, v157
v_add_f32 v2, v2, v158
v_add_f32 v3, v3, v159
v_cvt_pk_bf16_f32 v0, v0, v1
v_cvt_pk_bf16_f32 v1, v2, v3
buffer_store_dwordx2 v[0:1], v240, s[40:43], 0 offen offset:0
v_lshlrev_b32 v160, 16, v146
v_and_b32 v161, 0xffff0000, v146
v_lshlrev_b32 v162, 16, v147
v_and_b32 v163, 0xffff0000, v147
v_add_f32 v4, v4, v88
v_add_f32 v156, v108, v128
v_add_f32 v5, v5, v89
v_add_f32 v157, v109, v129
v_add_f32 v6, v6, v90
v_add_f32 v158, v110, v130
v_add_f32 v7, v7, v91
v_add_f32 v159, v111, v131
v_add_f32 v4, v4, v160
v_add_f32 v5, v5, v161
v_add_f32 v6, v6, v162
v_add_f32 v7, v7, v163
v_add_f32 v4, v4, v156
v_add_f32 v5, v5, v157
v_add_f32 v6, v6, v158
v_add_f32 v7, v7, v159
v_cvt_pk_bf16_f32 v4, v4, v5
v_cvt_pk_bf16_f32 v5, v6, v7
buffer_store_dwordx2 v[4:5], v240, s[40:43], 0 offen offset:32
v_lshlrev_b32 v160, 16, v148
v_and_b32 v161, 0xffff0000, v148
v_lshlrev_b32 v162, 16, v149
v_and_b32 v163, 0xffff0000, v149
v_add_f32 v8, v8, v92
v_add_f32 v156, v112, v132
v_add_f32 v9, v9, v93
v_add_f32 v157, v113, v133
v_add_f32 v10, v10, v94
v_add_f32 v158, v114, v134
v_add_f32 v11, v11, v95
v_add_f32 v159, v115, v135
v_add_f32 v8, v8, v160
v_add_f32 v9, v9, v161
v_add_f32 v10, v10, v162
v_add_f32 v11, v11, v163
v_add_f32 v8, v8, v156
v_add_f32 v9, v9, v157
v_add_f32 v10, v10, v158
v_add_f32 v11, v11, v159
v_cvt_pk_bf16_f32 v8, v8, v9
v_cvt_pk_bf16_f32 v9, v10, v11
buffer_store_dwordx2 v[8:9], v240, s[40:43], 0 offen offset:64
v_lshlrev_b32 v160, 16, v150
v_and_b32 v161, 0xffff0000, v150
v_lshlrev_b32 v162, 16, v151
v_and_b32 v163, 0xffff0000, v151
v_add_f32 v12, v12, v96
v_add_f32 v156, v116, v136
v_add_f32 v13, v13, v97
v_add_f32 v157, v117, v137
v_add_f32 v14, v14, v98
v_add_f32 v158, v118, v138
v_add_f32 v15, v15, v99
v_add_f32 v159, v119, v139
v_add_f32 v12, v12, v160
v_add_f32 v13, v13, v161
v_add_f32 v14, v14, v162
v_add_f32 v15, v15, v163
v_add_f32 v12, v12, v156
v_add_f32 v13, v13, v157
v_add_f32 v14, v14, v158
v_add_f32 v15, v15, v159
v_cvt_pk_bf16_f32 v12, v12, v13
v_cvt_pk_bf16_f32 v13, v14, v15
buffer_store_dwordx2 v[12:13], v240, s[40:43], 0 offen offset:96
v_lshlrev_b32 v160, 16, v152
v_and_b32 v161, 0xffff0000, v152
v_lshlrev_b32 v162, 16, v153
v_and_b32 v163, 0xffff0000, v153
v_add_f32 v16, v16, v100
v_add_f32 v156, v120, v140
v_add_f32 v17, v17, v101
v_add_f32 v157, v121, v141
v_add_f32 v18, v18, v102
v_add_f32 v158, v122, v142
v_add_f32 v19, v19, v103
v_add_f32 v159, v123, v143
v_add_f32 v16, v16, v160
v_add_f32 v17, v17, v161
v_add_f32 v18, v18, v162
v_add_f32 v19, v19, v163
v_add_f32 v16, v16, v156
v_add_f32 v17, v17, v157
v_add_f32 v18, v18, v158
v_add_f32 v19, v19, v159
v_cvt_pk_bf16_f32 v16, v16, v17
v_cvt_pk_bf16_f32 v17, v18, v19
buffer_store_dwordx2 v[16:17], v241, s[40:43], 0 offen
s_endpgm
mega_hf1:
ds_read_b128 v[72:75], v40 offset:0
ds_read_b128 v[76:79], v40 offset:512
ds_read_b64_tr_b16 v[80:81], v42 offset:128
ds_read_b64_tr_b16 v[82:83], v42 offset:1280
ds_read_b64_tr_b16 v[84:85], v42 offset:160
ds_read_b64_tr_b16 v[86:87], v42 offset:1312
ds_read_b64_tr_b16 v[88:89], v42 offset:192
ds_read_b64_tr_b16 v[90:91], v42 offset:1344
ds_read_b64_tr_b16 v[92:93], v42 offset:224
ds_read_b64_tr_b16 v[94:95], v42 offset:1376
ds_read_b64_tr_b16 v[96:97], v42 offset:256
ds_read_b64_tr_b16 v[98:99], v42 offset:1408
s_waitcnt lgkmcnt(0)
v_mfma_f32_16x16x32_bf16 v[0:3], v[72:75], v[80:83], v[0:3]
ds_read_b128 v[100:103], v41 offset:0
ds_read_b128 v[104:107], v41 offset:512
v_mfma_f32_16x16x32_bf16 v[4:7], v[76:79], v[80:83], v[4:7]
ds_read_b64_tr_b16 v[108:109], v42 offset:9856
s_add_u32 m0, s36, 51456
s_lshl_b32 s32, s59, 7
s_add_u32 s35, s32, s49
buffer_load_dwordx4 v46, s[12:15], s35 offen lds
v_mfma_f32_16x16x32_bf16 v[8:11], v[72:75], v[84:87], v[8:11]
ds_read_b64_tr_b16 v[110:111], v42 offset:11008
ds_read_b64_tr_b16 v[112:113], v42 offset:9888
s_add_u32 m0, s36, 52480
s_add_u32 s59, s59, 1
buffer_load_dwordx4 v47, s[12:15], s35 offen lds
s_cmp_eq_u32 s59, 9
s_cselect_b32 s59, 0, s59
v_mfma_f32_16x16x32_bf16 v[12:15], v[76:79], v[84:87], v[12:15]
ds_read_b64_tr_b16 v[114:115], v42 offset:11040
v_mfma_f32_16x16x32_bf16 v[16:19], v[72:75], v[88:91], v[16:19]
ds_read_b64_tr_b16 v[116:117], v42 offset:9920
ds_read_b64_tr_b16 v[118:119], v42 offset:11072
s_add_u32 m0, s37, 38912
s_mul_i32 s33, s3, 589824
s_add_u32 s33, s33, 4608
s_add_u32 s34, s33, s50
buffer_load_dwordx4 v48, s[16:19], s34 offen lds
v_mfma_f32_16x16x32_bf16 v[20:23], v[76:79], v[88:91], v[20:23]
ds_read_b64_tr_b16 v[120:121], v42 offset:9952
v_mfma_f32_16x16x32_bf16 v[24:27], v[72:75], v[92:95], v[24:27]
ds_read_b64_tr_b16 v[122:123], v42 offset:11104
ds_read_b64_tr_b16 v[124:125], v42 offset:9984
s_add_u32 m0, s37, 39936
s_add_u32 s3, s3, 1
buffer_load_dwordx4 v49, s[16:19], s34 offen lds
v_mfma_f32_16x16x32_bf16 v[28:31], v[76:79], v[92:95], v[28:31]
ds_read_b64_tr_b16 v[126:127], v42 offset:11136
v_mfma_f32_16x16x32_bf16 v[32:35], v[72:75], v[96:99], v[32:35]
s_add_u32 m0, s37, 40960
s_mov_b64 exec, s[64:65]
buffer_load_dwordx4 v50, s[16:19], s34 offen lds
s_mov_b64 exec, s[62:63]
s_cmp_eq_u32 s3, 9
s_cselect_b32 s3, 0, s3
v_mfma_f32_16x16x32_bf16 v[36:39], v[76:79], v[96:99], v[36:39]
v_mfma_f32_16x16x32_bf16 v[160:163], v[54:57], v[76:79], v[160:163]
v_mfma_f32_16x16x32_bf16 v[164:167], v[76:79], v[76:79], v[164:167]
s_cmp_eq_u32 s28, 1
s_cbranch_scc1 mega_cs_30
s_cmp_eq_u32 s28, 2
s_cbranch_scc1 mega_cs_31
s_cmp_eq_u32 s28, 3
s_cbranch_scc1 mega_cs_32
v_mfma_f32_16x16x32_bf16 v[58:61], v[54:57], v[80:83], v[58:61]
v_mfma_f32_16x16x32_bf16 v[62:65], v[54:57], v[96:99], v[62:65]
s_branch mega_cse_29
mega_cs_30:
v_mfma_f32_16x16x32_bf16 v[58:61], v[54:57], v[84:87], v[58:61]
s_branch mega_cse_29
mega_cs_31:
v_mfma_f32_16x16x32_bf16 v[58:61], v[54:57], v[88:91], v[58:61]
s_branch mega_cse_29
mega_cs_32:
v_mfma_f32_16x16x32_bf16 v[58:61], v[54:57], v[92:95], v[58:61]
mega_cse_29:
s_lshr_b32 s30, s28, 1
s_lshl_b32 s30, s30, 8
s_add_u32 s30, s30, s2
s_lshl_b32 s31, s30, 8
s_and_b32 s34, s29, 1
s_lshl_b32 s34, s34, 7
s_add_u32 s31, s31, s34
v_lshl_add_u32 v234, v250, 1, s31
s_lshl_b32 s30, s30, 1
v_mov_b32 v235, s30
buffer_load_ushort v146, v234, s[68:71], 0 offen
buffer_load_ushort v147, v234, s[72:75], 0 offen
buffer_load_ushort v148, v234, s[76:79], 0 offen
buffer_load_ushort v149, v234, s[80:83], 0 offen
buffer_load_ushort v150, v234, s[84:87], 0 offen
buffer_load_ushort v151, v234, s[88:91], 0 offen
buffer_load_ushort v152, v235, s[92:95], 0 offen
s_waitcnt vmcnt(12) lgkmcnt(0)
s_barrier
s_cmp_eq_u32 s29, 7
s_cbranch_scc0 mega_ow_33
s_and_b32 s30, s2, 15
s_lshl_b32 s30, s30, 4
v_mov_b32 v234, 1
v_mov_b32 v235, s30
s_mov_b64 exec, 1
buffer_atomic_add v234, v235, s[40:43], 0 offen sc1
s_mov_b64 exec, s[62:63]
mega_ow_33:
v_mfma_f32_16x16x32_bf16 v[0:3], v[100:103], v[108:111], v[0:3]
ds_read_b128 v[72:75], v40 offset:16384
ds_read_b128 v[76:79], v40 offset:16896
v_mfma_f32_16x16x32_bf16 v[4:7], v[104:107], v[108:111], v[4:7]
ds_read_b64_tr_b16 v[80:81], v42 offset:19584
s_add_u32 m0, s36, 67840
s_lshl_b32 s32, s59, 7
s_add_u32 s35, s32, s49
buffer_load_dwordx4 v46, s[12:15], s35 offen lds
s_add_u32 m0, s36, 68864
s_add_u32 s59, s59, 1
buffer_load_dwordx4 v47, s[12:15], s35 offen lds
s_cmp_eq_u32 s59, 9
s_cselect_b32 s59, 0, s59
v_mfma_f32_16x16x32_bf16 v[8:11], v[100:103], v[112:115], v[8:11]
ds_read_b64_tr_b16 v[82:83], v42 offset:20736
ds_read_b64_tr_b16 v[84:85], v42 offset:19616
s_add_u32 m0, s37, 58368
s_mul_i32 s33, s3, 589824
s_add_u32 s33, s33, 4608
s_add_u32 s34, s33, s50
buffer_load_dwordx4 v48, s[16:19], s34 offen lds
v_mfma_f32_16x16x32_bf16 v[12:15], v[104:107], v[112:115], v[12:15]
ds_read_b64_tr_b16 v[86:87], v42 offset:20768
s_add_u32 m0, s37, 59392
s_add_u32 s3, s3, 1
buffer_load_dwordx4 v49, s[16:19], s34 offen lds
v_mfma_f32_16x16x32_bf16 v[16:19], v[100:103], v[116:119], v[16:19]
ds_read_b64_tr_b16 v[88:89], v42 offset:19648
ds_read_b64_tr_b16 v[90:91], v42 offset:20800
s_add_u32 m0, s37, 60416
s_mov_b64 exec, s[64:65]
buffer_load_dwordx4 v50, s[16:19], s34 offen lds
s_mov_b64 exec, s[62:63]
s_cmp_eq_u32 s3, 9
s_cselect_b32 s3, 0, s3
v_mfma_f32_16x16x32_bf16 v[20:23], v[104:107], v[116:119], v[20:23]
ds_read_b64_tr_b16 v[92:93], v42 offset:19680
s_add_u32 m0, s36, 18688
s_lshl_b32 s32, s59, 7
s_add_u32 s35, s32, s49
buffer_load_dwordx4 v46, s[12:15], s35 offen lds
v_mfma_f32_16x16x32_bf16 v[24:27], v[100:103], v[120:123], v[24:27]
ds_read_b64_tr_b16 v[94:95], v42 offset:20832
ds_read_b64_tr_b16 v[96:97], v42 offset:19712
s_add_u32 m0, s36, 19712
s_add_u32 s59, s59, 1
buffer_load_dwordx4 v47, s[12:15], s35 offen lds
s_cmp_eq_u32 s59, 9
s_cselect_b32 s59, 0, s59
v_mfma_f32_16x16x32_bf16 v[28:31], v[104:107], v[120:123], v[28:31]
ds_read_b64_tr_b16 v[98:99], v42 offset:20864
s_add_u32 m0, s37, 0
s_mul_i32 s33, s3, 589824
s_add_u32 s33, s33, 4608
s_add_u32 s34, s33, s50
buffer_load_dwordx4 v48, s[16:19], s34 offen lds
v_mfma_f32_16x16x32_bf16 v[32:35], v[100:103], v[124:127], v[32:35]
s_add_u32 m0, s37, 1024
s_add_u32 s3, s3, 1
buffer_load_dwordx4 v49, s[16:19], s34 offen lds
v_mfma_f32_16x16x32_bf16 v[36:39], v[104:107], v[124:127], v[36:39]
s_add_u32 m0, s37, 2048
s_mov_b64 exec, s[64:65]
buffer_load_dwordx4 v50, s[16:19], s34 offen lds
s_mov_b64 exec, s[62:63]
s_cmp_eq_u32 s3, 9
s_cselect_b32 s3, 0, s3
v_mfma_f32_16x16x32_bf16 v[160:163], v[54:57], v[104:107], v[160:163]
v_mfma_f32_16x16x32_bf16 v[164:167], v[104:107], v[104:107], v[164:167]
s_cmp_eq_u32 s28, 1
s_cbranch_scc1 mega_cs_35
s_cmp_eq_u32 s28, 2
s_cbranch_scc1 mega_cs_36
s_cmp_eq_u32 s28, 3
s_cbranch_scc1 mega_cs_37
v_mfma_f32_16x16x32_bf16 v[58:61], v[54:57], v[108:111], v[58:61]
v_mfma_f32_16x16x32_bf16 v[62:65], v[54:57], v[124:127], v[62:65]
s_branch mega_cse_34
mega_cs_35:
v_mfma_f32_16x16x32_bf16 v[58:61], v[54:57], v[112:115], v[58:61]
s_branch mega_cse_34
mega_cs_36:
v_mfma_f32_16x16x32_bf16 v[58:61], v[54:57], v[116:119], v[58:61]
s_branch mega_cse_34
mega_cs_37:
v_mfma_f32_16x16x32_bf16 v[58:61], v[54:57], v[120:123], v[58:61]
mega_cse_34:
s_waitcnt lgkmcnt(0)
v_mfma_f32_16x16x32_bf16 v[0:3], v[72:75], v[80:83], v[0:3]
ds_read_b128 v[100:103], v41 offset:16384
ds_read_b128 v[104:107], v41 offset:16896
v_and_b32 v234, 3, v251
v_cmp_eq_u32 vcc, 1, v234
v_mfma_f32_16x16x32_bf16 v[4:7], v[76:79], v[80:83], v[4:7]
ds_read_b64_tr_b16 v[108:109], v42 offset:29312
v_cndmask_b32 v164, v164, v165, vcc
v_and_b32 v234, 3, v251
v_mfma_f32_16x16x32_bf16 v[8:11], v[72:75], v[84:87], v[8:11]
ds_read_b64_tr_b16 v[110:111], v42 offset:30464
ds_read_b64_tr_b16 v[112:113], v42 offset:29344
v_cmp_eq_u32 vcc, 2, v234
v_mfma_f32_16x16x32_bf16 v[12:15], v[76:79], v[84:87], v[12:15]
ds_read_b64_tr_b16 v[114:115], v42 offset:30496
v_cndmask_b32 v164, v164, v166, vcc
v_and_b32 v234, 3, v251
v_mfma_f32_16x16x32_bf16 v[16:19], v[72:75], v[88:91], v[16:19]
ds_read_b64_tr_b16 v[116:117], v42 offset:29376
ds_read_b64_tr_b16 v[118:119], v42 offset:30528
v_cmp_eq_u32 vcc, 3, v234
v_mfma_f32_16x16x32_bf16 v[20:23], v[76:79], v[88:91], v[20:23]
ds_read_b64_tr_b16 v[120:121], v42 offset:29408
v_cndmask_b32 v164, v164, v167, vcc
v_mov_b32 v161, v164
v_mfma_f32_16x16x32_bf16 v[24:27], v[72:75], v[92:95], v[24:27]
ds_read_b64_tr_b16 v[122:123], v42 offset:30560
ds_read_b64_tr_b16 v[124:125], v42 offset:29440
buffer_store_dwordx2 v[160:161], v51, s[44:47], 0 offen sc1
s_add_u32 s31, s28, 4
v_mfma_f32_16x16x32_bf16 v[28:31], v[76:79], v[92:95], v[28:31]
ds_read_b64_tr_b16 v[126:127], v42 offset:30592
s_lshl_b32 s31, s31, 6
v_mfma_f32_16x16x32_bf16 v[32:35], v[72:75], v[96:99], v[32:35]
buffer_store_dword v58, v52, s[44:47], s31 offen sc1
s_cmp_eq_u32 s28, 0
s_cselect_b32 s31, 512, s61
v_mfma_f32_16x16x32_bf16 v[36:39], v[76:79], v[96:99], v[36:39]
buffer_store_dword v62, v52, s[44:47], s31 offen sc1
s_waitcnt vmcnt(13) lgkmcnt(0)
s_barrier
v_mfma_f32_16x16x32_bf16 v[0:3], v[100:103], v[108:111], v[0:3]
ds_read_b128 v[72:75], v40 offset:32768
ds_read_b128 v[76:79], v40 offset:33280
v_mfma_f32_16x16x32_bf16 v[4:7], v[104:107], v[108:111], v[4:7]
ds_read_b64_tr_b16 v[80:81], v43 offset:128
s_add_u32 m0, s36, 35072
s_lshl_b32 s32, s59, 7
s_add_u32 s35, s32, s49
buffer_load_dwordx4 v46, s[12:15], s35 offen lds
v_mfma_f32_16x16x32_bf16 v[8:11], v[100:103], v[112:115], v[8:11]
ds_read_b64_tr_b16 v[82:83], v43 offset:1280
ds_read_b64_tr_b16 v[84:85], v43 offset:160
s_add_u32 m0, s36, 36096
s_add_u32 s59, s59, 1
buffer_load_dwordx4 v47, s[12:15], s35 offen lds
s_cmp_eq_u32 s59, 9
s_cselect_b32 s59, 0, s59
v_mfma_f32_16x16x32_bf16 v[12:15], v[104:107], v[112:115], v[12:15]
ds_read_b64_tr_b16 v[86:87], v43 offset:1312
v_mfma_f32_16x16x32_bf16 v[16:19], v[100:103], v[116:119], v[16:19]
ds_read_b64_tr_b16 v[88:89], v43 offset:192
ds_read_b64_tr_b16 v[90:91], v43 offset:1344
s_add_u32 m0, s37, 19456
s_mul_i32 s33, s3, 589824
s_add_u32 s33, s33, 4608
s_add_u32 s34, s33, s50
buffer_load_dwordx4 v48, s[16:19], s34 offen lds
v_mfma_f32_16x16x32_bf16 v[20:23], v[104:107], v[116:119], v[20:23]
ds_read_b64_tr_b16 v[92:93], v43 offset:224
v_mfma_f32_16x16x32_bf16 v[24:27], v[100:103], v[120:123], v[24:27]
ds_read_b64_tr_b16 v[94:95], v43 offset:1376
ds_read_b64_tr_b16 v[96:97], v43 offset:256
s_add_u32 m0, s37, 20480
s_add_u32 s3, s3, 1
buffer_load_dwordx4 v49, s[16:19], s34 offen lds
v_mfma_f32_16x16x32_bf16 v[28:31], v[104:107], v[120:123], v[28:31]
ds_read_b64_tr_b16 v[98:99], v43 offset:1408
v_mfma_f32_16x16x32_bf16 v[32:35], v[100:103], v[124:127], v[32:35]
s_add_u32 m0, s37, 21504
s_mov_b64 exec, s[64:65]
buffer_load_dwordx4 v50, s[16:19], s34 offen lds
s_mov_b64 exec, s[62:63]
s_cmp_eq_u32 s3, 9
s_cselect_b32 s3, 0, s3
v_mfma_f32_16x16x32_bf16 v[36:39], v[104:107], v[124:127], v[36:39]
s_waitcnt lgkmcnt(0)
v_mfma_f32_16x16x32_bf16 v[0:3], v[72:75], v[80:83], v[0:3]
ds_read_b128 v[100:103], v41 offset:32768
ds_read_b128 v[104:107], v41 offset:33280
v_lshlrev_b32 v146, 16, v146
v_lshlrev_b32 v147, 16, v147
v_lshlrev_b32 v148, 16, v148
s_mul_hi_u32 s24, s2, 0x55555556
s_mul_i32 s25, s24, 3
s_sub_u32 s25, s2, s25
s_mul_hi_u32 s10, s24, 0x1c71c71d
v_mfma_f32_16x16x32_bf16 v[4:7], v[76:79], v[80:83], v[4:7]
ds_read_b64_tr_b16 v[108:109], v43 offset:9856
v_lshlrev_b32 v149, 16, v149
v_lshlrev_b32 v150, 16, v150
s_mul_i32 s11, s10, 9
s_sub_u32 s11, s24, s11
s_mul_i32 s10, s10, 288
s_lshl_b32 s39, s11, 5
v_mfma_f32_16x16x32_bf16 v[8:11], v[72:75], v[84:87], v[8:11]
ds_read_b64_tr_b16 v[110:111], v43 offset:11008
ds_read_b64_tr_b16 v[112:113], v43 offset:9888
v_lshlrev_b32 v151, 16, v151
v_lshlrev_b32 v152, 16, v152
v_mul_f32 v152, 0x3fb8aa3b, v152
s_cmp_ge_u32 s11, 4
s_cselect_b32 s35, 16, 0
s_add_u32 s39, s39, s35
s_add_u32 s39, s39, 16
s_cmp_eq_u32 s11, 8
s_cselect_b32 s39, 272, s39
v_mfma_f32_16x16x32_bf16 v[12:15], v[76:79], v[84:87], v[12:15]
ds_read_b64_tr_b16 v[114:115], v43 offset:11040
v_exp_f32 v152, v152
s_nop 0
v_cvt_pk_bf16_f32 v152, v152, v152
s_lshl_b32 s35, s29, 2
s_sub_u32 s35, s35, 16
s_add_u32 s39, s39, s10
v_mfma_f32_16x16x32_bf16 v[16:19], v[72:75], v[88:91], v[16:19]
ds_read_b64_tr_b16 v[116:117], v43 offset:9920
ds_read_b64_tr_b16 v[118:119], v43 offset:11072
v_lshlrev_b32 v152, 16, v152
v_mul_f32 v146, v146, v152
v_mul_f32 v147, v147, v152
s_add_u32 s39, s39, s35
s_mul_i32 s39, s39, 1152
s_mul_i32 s35, s25, 384
s_add_u32 s39, s39, s35
v_mfma_f32_16x16x32_bf16 v[20:23], v[76:79], v[88:91], v[20:23]
ds_read_b64_tr_b16 v[120:121], v43 offset:9952
v_mul_f32 v148, v148, v152
v_mul_f32 v149, v149, v152
s_cmp_lt_u32 s2, 216
s_cselect_b32 s39, s39, s61
s_mov_b32 s35, 178956971
s_mul_i32 s34, s29, 1536
v_add_u32 v234, 0, v250
v_mfma_f32_16x16x32_bf16 v[24:27], v[72:75], v[92:95], v[24:27]
ds_read_b64_tr_b16 v[122:123], v43 offset:11104
ds_read_b64_tr_b16 v[124:125], v43 offset:9984
v_mul_f32 v146, 0x3fb8aa3b, v146
v_mul_f32 v147, 0x3e22f983, v147
v_mul_f32 v182, 0x3f800000, v146
v_mul_hi_u32 v235, v234, s35
v_mul_u32_u24 v236, 24, v235
v_sub_u32 v236, v234, v236
v_mfma_f32_16x16x32_bf16 v[28:31], v[76:79], v[92:95], v[28:31]
ds_read_b64_tr_b16 v[126:127], v43 offset:11136
v_mul_f32 v183, 0x3f800000, v147
v_exp_f32 v182, v182
v_mul_u32_u24 v235, 1152, v235
v_lshl_add_u32 v235, v236, 4, v235
s_add_u32 m0, s34, 6272
s_nop 0
buffer_load_dwordx4 v235, s[20:23], s39 offen lds
v_add_u32 v234, 64, v250
v_mfma_f32_16x16x32_bf16 v[32:35], v[72:75], v[96:99], v[32:35]
v_fract_f32 v183, v183
v_cos_f32 v160, v183
v_sin_f32 v161, v183
v_mul_hi_u32 v235, v234, s35
v_mul_u32_u24 v236, 24, v235
v_sub_u32 v236, v234, v236
v_mul_u32_u24 v235, 1152, v235
v_mfma_f32_16x16x32_bf16 v[36:39], v[76:79], v[96:99], v[36:39]
v_mul_f32 v160, v160, v182
v_mul_f32 v161, v161, v182
v_lshl_add_u32 v235, v236, 4, v235
s_add_u32 m0, s34, 7296
s_mov_b64 exec, s[66:67]
buffer_load_dwordx4 v235, s[20:23], s39 offen lds
s_mov_b64 exec, s[62:63]
s_waitcnt vmcnt(15) lgkmcnt(0)
s_barrier
v_mfma_f32_16x16x32_bf16 v[0:3], v[100:103], v[108:111], v[0:3]
ds_read_b128 v[72:75], v40 offset:49152
ds_read_b128 v[76:79], v40 offset:49664
v_mul_f32 v182, 0x41000000, v146
v_mul_f32 v183, 0x41000000, v147
v_exp_f32 v182, v182
v_mfma_f32_16x16x32_bf16 v[4:7], v[104:107], v[108:111], v[4:7]
ds_read_b64_tr_b16 v[80:81], v43 offset:19584
s_add_u32 m0, s36, 51456
s_lshl_b32 s32, s59, 7
s_add_u32 s35, s32, s49
buffer_load_dwordx4 v46, s[12:15], s35 offen lds
v_fract_f32 v183, v183
v_cos_f32 v162, v183
v_mfma_f32_16x16x32_bf16 v[8:11], v[100:103], v[112:115], v[8:11]
ds_read_b64_tr_b16 v[82:83], v43 offset:20736
ds_read_b64_tr_b16 v[84:85], v43 offset:19616
s_add_u32 m0, s36, 52480
s_add_u32 s59, s59, 1
buffer_load_dwordx4 v47, s[12:15], s35 offen lds
s_cmp_eq_u32 s59, 9
s_cselect_b32 s59, 0, s59
v_sin_f32 v163, v183
v_mul_f32 v162, v162, v182
v_mul_f32 v163, v163, v182
v_mfma_f32_16x16x32_bf16 v[12:15], v[104:107], v[112:115], v[12:15]
ds_read_b64_tr_b16 v[86:87], v43 offset:20768
v_mul_f32 v182, 0x43000000, v146
v_mul_f32 v183, 0x43000000, v147
v_mfma_f32_16x16x32_bf16 v[16:19], v[100:103], v[116:119], v[16:19]
ds_read_b64_tr_b16 v[88:89], v43 offset:19648
ds_read_b64_tr_b16 v[90:91], v43 offset:20800
s_add_u32 m0, s37, 38912
s_mul_i32 s33, s3, 589824
s_add_u32 s33, s33, 4608
s_add_u32 s34, s33, s50
buffer_load_dwordx4 v48, s[16:19], s34 offen lds
v_exp_f32 v182, v182
v_fract_f32 v183, v183
v_cos_f32 v164, v183
v_mfma_f32_16x16x32_bf16 v[20:23], v[104:107], v[116:119], v[20:23]
ds_read_b64_tr_b16 v[92:93], v43 offset:19680
v_sin_f32 v165, v183
v_mul_f32 v164, v164, v182
v_mfma_f32_16x16x32_bf16 v[24:27], v[100:103], v[120:123], v[24:27]
ds_read_b64_tr_b16 v[94:95], v43 offset:20832
ds_read_b64_tr_b16 v[96:97], v43 offset:19712
s_add_u32 m0, s37, 39936
s_add_u32 s3, s3, 1
buffer_load_dwordx4 v49, s[16:19], s34 offen lds
v_mul_f32 v165, v165, v182
v_mul_f32 v166, v150, v148
v_mul_f32 v167, v150, v149
v_mfma_f32_16x16x32_bf16 v[28:31], v[104:107], v[120:123], v[28:31]
ds_read_b64_tr_b16 v[98:99], v43 offset:20864
v_fma_f32 v166, -v151, v149, v166
v_fma_f32 v167, v151, v148, v167
v_mfma_f32_16x16x32_bf16 v[32:35], v[100:103], v[124:127], v[32:35]
s_add_u32 m0, s37, 40960
s_mov_b64 exec, s[64:65]
buffer_load_dwordx4 v50, s[16:19], s34 offen lds
s_mov_b64 exec, s[62:63]
s_cmp_eq_u32 s3, 9
s_cselect_b32 s3, 0, s3
v_mov_b32 v186, 0x3f80
v_cvt_pk_bf16_f32 v187, v160, v161
v_cvt_pk_bf16_f32 v227, v166, -v167
v_mfma_f32_16x16x32_bf16 v[36:39], v[104:107], v[124:127], v[36:39]
v_mul_f32 v168, v160, v160
v_mul_f32 v169, v160, v161
s_waitcnt lgkmcnt(0)
v_mfma_f32_16x16x32_bf16 v[0:3], v[72:75], v[80:83], v[0:3]
ds_read_b128 v[100:103], v41 offset:49152
ds_read_b128 v[104:107], v41 offset:49664
v_fma_f32 v168, -v161, v161, v168
v_fma_f32 v169, v161, v160, v169
v_cvt_pk_bf16_f32 v188, v168, v169
s_cmp_lt_u32 s29, 6
s_cselect_b32 s58, s2, 64
s_add_u32 s30, s58, 512
v_mfma_f32_16x16x32_bf16 v[4:7], v[76:79], v[80:83], v[4:7]
ds_read_b64_tr_b16 v[108:109], v43 offset:29312
v_mul_f32 v184, v167, v163
v_mul_f32 v185, v167, v162
s_cmp_lt_u32 s58, 64
s_cselect_b32 s30, s30, 1024
s_lshl_b32 s31, s30, 8
v_mfma_f32_16x16x32_bf16 v[8:11], v[72:75], v[84:87], v[8:11]
ds_read_b64_tr_b16 v[110:111], v43 offset:30464
ds_read_b64_tr_b16 v[112:113], v43 offset:29344
v_fma_f32 v167, v166, v163, v185
v_fma_f32 v166, v166, v162, -v184
v_cvt_pk_bf16_f32 v228, v166, -v167
s_and_b32 s34, s29, 1
s_lshl_b32 s34, s34, 7
v_mfma_f32_16x16x32_bf16 v[12:15], v[76:79], v[84:87], v[12:15]
ds_read_b64_tr_b16 v[114:115], v43 offset:30496
v_mul_f32 v170, v168, v160
v_mul_f32 v171, v168, v161
s_add_u32 s31, s31, s34
v_mfma_f32_16x16x32_bf16 v[16:19], v[72:75], v[88:91], v[16:19]
ds_read_b64_tr_b16 v[116:117], v43 offset:29376
ds_read_b64_tr_b16 v[118:119], v43 offset:30528
v_fma_f32 v170, -v169, v161, v170
v_fma_f32 v171, v169, v160, v171
v_cvt_pk_bf16_f32 v189, v170, v171
v_lshl_add_u32 v234, v250, 1, s31
s_lshl_b32 s30, s30, 1
v_mfma_f32_16x16x32_bf16 v[20:23], v[76:79], v[88:91], v[20:23]
ds_read_b64_tr_b16 v[120:121], v43 offset:29408
v_mul_f32 v172, v170, v160
v_mul_f32 v173, v170, v161
v_mov_b32 v235, s30
buffer_load_ushort v58, v234, s[68:71], 0 offen
v_mfma_f32_16x16x32_bf16 v[24:27], v[72:75], v[92:95], v[24:27]
ds_read_b64_tr_b16 v[122:123], v43 offset:30560
ds_read_b64_tr_b16 v[124:125], v43 offset:29440
v_fma_f32 v172, -v171, v161, v172
v_fma_f32 v173, v171, v160, v173
v_cvt_pk_bf16_f32 v190, v172, v173
buffer_load_ushort v59, v234, s[72:75], 0 offen
v_mfma_f32_16x16x32_bf16 v[28:31], v[76:79], v[92:95], v[28:31]
ds_read_b64_tr_b16 v[126:127], v43 offset:30592
v_mul_f32 v182, v167, v163
v_mul_f32 v183, v167, v162
buffer_load_ushort v60, v234, s[76:79], 0 offen
buffer_load_ushort v61, v234, s[80:83], 0 offen
v_mfma_f32_16x16x32_bf16 v[32:35], v[72:75], v[96:99], v[32:35]
v_fma_f32 v167, v166, v163, v183
v_fma_f32 v166, v166, v162, -v182
v_cvt_pk_bf16_f32 v229, v166, -v167
buffer_load_ushort v62, v234, s[84:87], 0 offen
buffer_load_ushort v63, v234, s[88:91], 0 offen
v_mfma_f32_16x16x32_bf16 v[36:39], v[76:79], v[96:99], v[36:39]
v_mul_f32 v174, v172, v160
v_mul_f32 v175, v172, v161
buffer_load_ushort v64, v235, s[92:95], 0 offen
s_waitcnt vmcnt(22) lgkmcnt(0)
s_barrier
v_mfma_f32_16x16x32_bf16 v[0:3], v[100:103], v[108:111], v[0:3]
ds_read_b128 v[72:75], v40 offset:0
ds_read_b128 v[76:79], v40 offset:512
v_fma_f32 v174, -v173, v161, v174
v_fma_f32 v175, v173, v160, v175
v_cvt_pk_bf16_f32 v191, v174, v175
v_mfma_f32_16x16x32_bf16 v[4:7], v[104:107], v[108:111], v[4:7]
ds_read_b64_tr_b16 v[80:81], v42 offset:128
s_add_u32 m0, s36, 67840
s_lshl_b32 s32, s59, 7
s_add_u32 s35, s32, s49
buffer_load_dwordx4 v46, s[12:15], s35 offen lds
v_mul_f32 v176, v174, v160
v_mul_f32 v177, v174, v161
v_mfma_f32_16x16x32_bf16 v[8:11], v[100:103], v[112:115], v[8:11]
ds_read_b64_tr_b16 v[82:83], v42 offset:1280
ds_read_b64_tr_b16 v[84:85], v42 offset:160
s_add_u32 m0, s36, 68864
s_add_u32 s59, s59, 1
buffer_load_dwordx4 v47, s[12:15], s35 offen lds
s_cmp_eq_u32 s59, 9
s_cselect_b32 s59, 0, s59
v_fma_f32 v176, -v175, v161, v176
v_fma_f32 v177, v175, v160, v177
v_cvt_pk_bf16_f32 v192, v176, v177
v_mfma_f32_16x16x32_bf16 v[12:15], v[104:107], v[112:115], v[12:15]
ds_read_b64_tr_b16 v[86:87], v42 offset:1312
v_mul_f32 v184, v167, v163
v_mul_f32 v185, v167, v162
v_mfma_f32_16x16x32_bf16 v[16:19], v[100:103], v[116:119], v[16:19]
ds_read_b64_tr_b16 v[88:89], v42 offset:192
ds_read_b64_tr_b16 v[90:91], v42 offset:1344
s_add_u32 m0, s37, 58368
s_mul_i32 s33, s3, 589824
s_add_u32 s33, s33, 4608
s_add_u32 s34, s33, s50
buffer_load_dwordx4 v48, s[16:19], s34 offen lds
v_fma_f32 v167, v166, v163, v185
v_fma_f32 v166, v166, v162, -v184
v_cvt_pk_bf16_f32 v230, v166, -v167
v_mfma_f32_16x16x32_bf16 v[20:23], v[104:107], v[116:119], v[20:23]
ds_read_b64_tr_b16 v[92:93], v42 offset:224
v_mul_f32 v178, v176, v160
v_mul_f32 v179, v176, v161
v_mfma_f32_16x16x32_bf16 v[24:27], v[100:103], v[120:123], v[24:27]
ds_read_b64_tr_b16 v[94:95], v42 offset:1376
ds_read_b64_tr_b16 v[96:97], v42 offset:256
s_add_u32 m0, s37, 59392
s_add_u32 s3, s3, 1
buffer_load_dwordx4 v49, s[16:19], s34 offen lds
v_fma_f32 v178, -v177, v161, v178
v_fma_f32 v179, v177, v160, v179
v_cvt_pk_bf16_f32 v193, v178, v179
v_mfma_f32_16x16x32_bf16 v[28:31], v[104:107], v[120:123], v[28:31]
ds_read_b64_tr_b16 v[98:99], v42 offset:1408
v_mov_b32 v180, v164
v_mov_b32 v181, v165
v_mfma_f32_16x16x32_bf16 v[32:35], v[100:103], v[124:127], v[32:35]
s_add_u32 m0, s37, 60416
s_mov_b64 exec, s[64:65]
buffer_load_dwordx4 v50, s[16:19], s34 offen lds
s_mov_b64 exec, s[62:63]
s_cmp_eq_u32 s3, 9
s_cselect_b32 s3, 0, s3
v_cvt_pk_bf16_f32 v194, v180, v181
v_mul_f32 v150, v180, v160
v_mul_f32 v151, v180, v161
v_mfma_f32_16x16x32_bf16 v[36:39], v[104:107], v[124:127], v[36:39]
v_fma_f32 v150, -v181, v161, v150
v_fma_f32 v151, v181, v160, v151
s_waitcnt lgkmcnt(0)
s_cmp_eq_u32 s29, 7
s_cbranch_scc0 mega_ow_38
buffer_load_dword v249, v245, s[40:43], 0 offen sc1
mega_ow_38:
v_mfma_f32_16x16x32_bf16 v[0:3], v[72:75], v[80:83], v[0:3]
ds_read_b128 v[100:103], v41 offset:0
ds_read_b128 v[104:107], v41 offset:512
v_cvt_pk_bf16_f32 v195, v150, v151
v_mul_f32 v150, v180, v168
v_mul_f32 v151, v180, v169
v_mfma_f32_16x16x32_bf16 v[4:7], v[76:79], v[80:83], v[4:7]
ds_read_b64_tr_b16 v[108:109], v42 offset:9856
v_fma_f32 v150, -v181, v169, v150
v_fma_f32 v151, v181, v168, v151
v_mfma_f32_16x16x32_bf16 v[8:11], v[72:75], v[84:87], v[8:11]
ds_read_b64_tr_b16 v[110:111], v42 offset:11008
ds_read_b64_tr_b16 v[112:113], v42 offset:9888
v_cvt_pk_bf16_f32 v196, v150, v151
v_mul_f32 v150, v180, v170
v_mul_f32 v151, v180, v171
v_mfma_f32_16x16x32_bf16 v[12:15], v[76:79], v[84:87], v[12:15]
ds_read_b64_tr_b16 v[114:115], v42 offset:11040
v_fma_f32 v150, -v181, v171, v150
v_fma_f32 v151, v181, v170, v151
v_mfma_f32_16x16x32_bf16 v[16:19], v[72:75], v[88:91], v[16:19]
ds_read_b64_tr_b16 v[116:117], v42 offset:9920
ds_read_b64_tr_b16 v[118:119], v42 offset:11072
v_cvt_pk_bf16_f32 v197, v150, v151
v_mul_f32 v150, v180, v172
v_mul_f32 v151, v180, v173
v_mfma_f32_16x16x32_bf16 v[20:23], v[76:79], v[88:91], v[20:23]
ds_read_b64_tr_b16 v[120:121], v42 offset:9952
v_fma_f32 v150, -v181, v173, v150
v_fma_f32 v151, v181, v172, v151
v_mfma_f32_16x16x32_bf16 v[24:27], v[72:75], v[92:95], v[24:27]
ds_read_b64_tr_b16 v[122:123], v42 offset:11104
ds_read_b64_tr_b16 v[124:125], v42 offset:9984
v_cvt_pk_bf16_f32 v198, v150, v151
v_mul_f32 v150, v180, v174
v_mul_f32 v151, v180, v175
v_mfma_f32_16x16x32_bf16 v[28:31], v[76:79], v[92:95], v[28:31]
ds_read_b64_tr_b16 v[126:127], v42 offset:11136
v_fma_f32 v150, -v181, v175, v150
v_fma_f32 v151, v181, v174, v151
v_mfma_f32_16x16x32_bf16 v[32:35], v[72:75], v[96:99], v[32:35]
v_cvt_pk_bf16_f32 v199, v150, v151
v_mul_f32 v150, v180, v176
v_mul_f32 v151, v180, v177
v_mfma_f32_16x16x32_bf16 v[36:39], v[76:79], v[96:99], v[36:39]
v_fma_f32 v150, -v181, v177, v150
v_fma_f32 v151, v181, v176, v151
s_waitcnt vmcnt(19) lgkmcnt(0)
s_barrier
v_mfma_f32_16x16x32_bf16 v[0:3], v[100:103], v[108:111], v[0:3]
ds_read_b128 v[72:75], v40 offset:16384
ds_read_b128 v[76:79], v40 offset:16896
v_cvt_pk_bf16_f32 v200, v150, v151
v_mul_f32 v150, v180, v178
v_mul_f32 v151, v180, v179
v_mfma_f32_16x16x32_bf16 v[4:7], v[104:107], v[108:111], v[4:7]
ds_read_b64_tr_b16 v[80:81], v42 offset:19584
s_add_u32 m0, s36, 18688
s_lshl_b32 s32, s59, 7
s_add_u32 s35, s32, s49
buffer_load_dwordx4 v46, s[12:15], s35 offen lds
v_fma_f32 v150, -v181, v179, v150
v_fma_f32 v151, v181, v178, v151
v_mfma_f32_16x16x32_bf16 v[8:11], v[100:103], v[112:115], v[8:11]
ds_read_b64_tr_b16 v[82:83], v42 offset:20736
ds_read_b64_tr_b16 v[84:85], v42 offset:19616
s_add_u32 m0, s36, 19712
s_add_u32 s59, s59, 1
buffer_load_dwordx4 v47, s[12:15], s35 offen lds
s_cmp_eq_u32 s59, 9
s_cselect_b32 s59, 0, s59
v_cvt_pk_bf16_f32 v201, v150, v151
v_mul_f32 v182, v167, v163
v_mul_f32 v183, v167, v162
v_mfma_f32_16x16x32_bf16 v[12:15], v[104:107], v[112:115], v[12:15]
ds_read_b64_tr_b16 v[86:87], v42 offset:20768
v_fma_f32 v167, v166, v163, v183
v_fma_f32 v166, v166, v162, -v182
v_mfma_f32_16x16x32_bf16 v[16:19], v[100:103], v[116:119], v[16:19]
ds_read_b64_tr_b16 v[88:89], v42 offset:19648
ds_read_b64_tr_b16 v[90:91], v42 offset:20800
s_add_u32 m0, s37, 0
s_mul_i32 s33, s3, 589824
s_add_u32 s33, s33, 4608
s_add_u32 s34, s33, s50
buffer_load_dwordx4 v48, s[16:19], s34 offen lds
v_cvt_pk_bf16_f32 v231, v166, -v167
v_mul_f32 v184, v181, v165
v_mul_f32 v185, v181, v164
v_mfma_f32_16x16x32_bf16 v[20:23], v[104:107], v[116:119], v[20:23]
ds_read_b64_tr_b16 v[92:93], v42 offset:19680
v_fma_f32 v181, v180, v165, v185
v_fma_f32 v180, v180, v164, -v184
v_mfma_f32_16x16x32_bf16 v[24:27], v[100:103], v[120:123], v[24:27]
ds_read_b64_tr_b16 v[94:95], v42 offset:20832
ds_read_b64_tr_b16 v[96:97], v42 offset:19712
s_add_u32 m0, s37, 1024
s_add_u32 s3, s3, 1
buffer_load_dwordx4 v49, s[16:19], s34 offen lds
v_cvt_pk_bf16_f32 v202, v180, v181
v_mul_f32 v150, v180, v168
v_mul_f32 v151, v180, v169
v_mfma_f32_16x16x32_bf16 v[28:31], v[104:107], v[120:123], v[28:31]
ds_read_b64_tr_b16 v[98:99], v42 offset:20864
v_fma_f32 v150, -v181, v169, v150
v_fma_f32 v151, v181, v168, v151
v_mfma_f32_16x16x32_bf16 v[32:35], v[100:103], v[124:127], v[32:35]
s_add_u32 m0, s37, 2048
s_mov_b64 exec, s[64:65]
buffer_load_dwordx4 v50, s[16:19], s34 offen lds
s_mov_b64 exec, s[62:63]
s_cmp_eq_u32 s3, 9
s_cselect_b32 s3, 0, s3
v_cvt_pk_bf16_f32 v203, v150, v151
v_mul_f32 v150, v180, v172
v_mul_f32 v151, v180, v173
v_mfma_f32_16x16x32_bf16 v[36:39], v[104:107], v[124:127], v[36:39]
v_fma_f32 v150, -v181, v173, v150
v_fma_f32 v151, v181, v172, v151
s_waitcnt lgkmcnt(0)
v_mfma_f32_16x16x32_bf16 v[0:3], v[72:75], v[80:83], v[0:3]
ds_read_b128 v[100:103], v41 offset:16384
ds_read_b128 v[104:107], v41 offset:16896
v_cvt_pk_bf16_f32 v204, v150, v151
v_mul_f32 v150, v180, v176
v_mul_f32 v151, v180, v177
v_mfma_f32_16x16x32_bf16 v[4:7], v[76:79], v[80:83], v[4:7]
ds_read_b64_tr_b16 v[108:109], v42 offset:29312
v_fma_f32 v150, -v181, v177, v150
v_fma_f32 v151, v181, v176, v151
v_mfma_f32_16x16x32_bf16 v[8:11], v[72:75], v[84:87], v[8:11]
ds_read_b64_tr_b16 v[110:111], v42 offset:30464
ds_read_b64_tr_b16 v[112:113], v42 offset:29344
v_cvt_pk_bf16_f32 v205, v150, v151
v_mul_f32 v184, v167, v163
v_mul_f32 v185, v167, v162
v_mfma_f32_16x16x32_bf16 v[12:15], v[76:79], v[84:87], v[12:15]
ds_read_b64_tr_b16 v[114:115], v42 offset:30496
v_fma_f32 v167, v166, v163, v185
v_fma_f32 v166, v166, v162, -v184
v_mfma_f32_16x16x32_bf16 v[16:19], v[72:75], v[88:91], v[16:19]
ds_read_b64_tr_b16 v[116:117], v42 offset:29376
ds_read_b64_tr_b16 v[118:119], v42 offset:30528
v_cvt_pk_bf16_f32 v232, v166, -v167
v_mul_f32 v182, v181, v165
v_mul_f32 v183, v181, v164
v_mfma_f32_16x16x32_bf16 v[20:23], v[76:79], v[88:91], v[20:23]
ds_read_b64_tr_b16 v[120:121], v42 offset:29408
v_fma_f32 v181, v180, v165, v183
v_fma_f32 v180, v180, v164, -v182
v_mfma_f32_16x16x32_bf16 v[24:27], v[72:75], v[92:95], v[24:27]
ds_read_b64_tr_b16 v[122:123], v42 offset:30560
ds_read_b64_tr_b16 v[124:125], v42 offset:29440
v_cvt_pk_bf16_f32 v206, v180, v181
v_mul_f32 v150, v180, v168
v_mul_f32 v151, v180, v169
v_mfma_f32_16x16x32_bf16 v[28:31], v[76:79], v[92:95], v[28:31]
ds_read_b64_tr_b16 v[126:127], v42 offset:30592
v_fma_f32 v150, -v181, v169, v150
v_fma_f32 v151, v181, v168, v151
v_mfma_f32_16x16x32_bf16 v[32:35], v[72:75], v[96:99], v[32:35]
v_cvt_pk_bf16_f32 v207, v150, v151
v_mul_f32 v150, v180, v172
v_mul_f32 v151, v180, v173
v_mfma_f32_16x16x32_bf16 v[36:39], v[76:79], v[96:99], v[36:39]
v_fma_f32 v150, -v181, v173, v150
v_fma_f32 v151, v181, v172, v151
s_waitcnt vmcnt(17) lgkmcnt(0)
s_barrier
v_mfma_f32_16x16x32_bf16 v[0:3], v[100:103], v[108:111], v[0:3]
ds_read_b128 v[72:75], v40 offset:32768
ds_read_b128 v[76:79], v40 offset:33280
v_cvt_pk_bf16_f32 v208, v150, v151
v_mul_f32 v150, v180, v176
v_mul_f32 v151, v180, v177
v_mfma_f32_16x16x32_bf16 v[4:7], v[104:107], v[108:111], v[4:7]
ds_read_b64_tr_b16 v[80:81], v43 offset:128
s_add_u32 s3, s3, 5
s_cmp_ge_u32 s3, 9
s_cselect_b32 s33, 9, 0
s_sub_u32 s3, s3, s33
s_add_u32 m0, s37, 19456
s_mul_i32 s33, s3, 589824
s_add_u32 s34, s33, s50
buffer_load_dwordx4 v48, s[16:19], s34 offen lds
v_fma_f32 v150, -v181, v177, v150
v_fma_f32 v151, v181, v176, v151
v_mfma_f32_16x16x32_bf16 v[8:11], v[100:103], v[112:115], v[8:11]
ds_read_b64_tr_b16 v[82:83], v43 offset:1280
ds_read_b64_tr_b16 v[84:85], v43 offset:160
v_cvt_pk_bf16_f32 v209, v150, v151
v_mul_f32 v182, v167, v163
v_mul_f32 v183, v167, v162
v_mfma_f32_16x16x32_bf16 v[12:15], v[104:107], v[112:115], v[12:15]
ds_read_b64_tr_b16 v[86:87], v43 offset:1312
v_fma_f32 v167, v166, v163, v183
v_fma_f32 v166, v166, v162, -v182
v_mfma_f32_16x16x32_bf16 v[16:19], v[100:103], v[116:119], v[16:19]
ds_read_b64_tr_b16 v[88:89], v43 offset:192
ds_read_b64_tr_b16 v[90:91], v43 offset:1344
s_add_u32 m0, s37, 20480
s_add_u32 s3, s3, 1
buffer_load_dwordx4 v49, s[16:19], s34 offen lds
v_cvt_pk_bf16_f32 v233, v166, -v167
v_mul_f32 v184, v181, v165
v_mul_f32 v185, v181, v164
v_mfma_f32_16x16x32_bf16 v[20:23], v[104:107], v[116:119], v[20:23]
ds_read_b64_tr_b16 v[92:93], v43 offset:224
v_fma_f32 v181, v180, v165, v185
v_fma_f32 v180, v180, v164, -v184
v_mfma_f32_16x16x32_bf16 v[24:27], v[100:103], v[120:123], v[24:27]
ds_read_b64_tr_b16 v[94:95], v43 offset:1376
ds_read_b64_tr_b16 v[96:97], v43 offset:256
v_cvt_pk_bf16_f32 v210, v180, v181
v_mul_f32 v150, v180, v172
v_mul_f32 v151, v180, v173
v_mfma_f32_16x16x32_bf16 v[28:31], v[104:107], v[120:123], v[28:31]
ds_read_b64_tr_b16 v[98:99], v43 offset:1408
s_add_u32 m0, s37, 21504
s_mov_b64 exec, s[64:65]
buffer_load_dwordx4 v50, s[16:19], s34 offen lds
s_mov_b64 exec, s[62:63]
s_cmp_eq_u32 s3, 9
s_cselect_b32 s3, 0, s3
v_fma_f32 v150, -v181, v173, v150
v_fma_f32 v151, v181, v172, v151
v_mfma_f32_16x16x32_bf16 v[32:35], v[100:103], v[124:127], v[32:35]
v_cvt_pk_bf16_f32 v211, v150, v151
v_mul_f32 v184, v167, v163
v_mul_f32 v185, v167, v162
v_mfma_f32_16x16x32_bf16 v[36:39], v[104:107], v[124:127], v[36:39]
v_fma_f32 v167, v166, v163, v185
v_fma_f32 v166, v166, v162, -v184
s_waitcnt lgkmcnt(0)
s_cmp_eq_u32 s29, 7
s_cbranch_scc0 mega_ow_39
s_mov_b32 s39, 100000
s_waitcnt vmcnt(8)
mega_pl_40:
v_cmp_gt_u32 vcc, 16, v249
s_nop 4
s_cbranch_vccz mega_pe_41
s_sub_u32 s39, s39, 1
s_cmp_eq_u32 s39, 0
s_cbranch_scc1 mega_pe_41
s_sleep 8
buffer_load_dword v249, v245, s[40:43], 0 offen sc1
s_waitcnt vmcnt(0)
s_branch mega_pl_40
mega_pe_41:
mega_ow_39:
v_mfma_f32_16x16x32_bf16 v[0:3], v[72:75], v[80:83], v[0:3]
ds_read_b128 v[100:103], v41 offset:32768
ds_read_b128 v[104:107], v41 offset:33280
v_cvt_pk_bf16_f32 v153, v166, -v167
v_mul_f32 v182, v181, v165
v_mul_f32 v183, v181, v164
v_mfma_f32_16x16x32_bf16 v[4:7], v[76:79], v[80:83], v[4:7]
ds_read_b64_tr_b16 v[108:109], v43 offset:9856
v_fma_f32 v181, v180, v165, v183
v_fma_f32 v180, v180, v164, -v182
v_mfma_f32_16x16x32_bf16 v[8:11], v[72:75], v[84:87], v[8:11]
ds_read_b64_tr_b16 v[110:111], v43 offset:11008
ds_read_b64_tr_b16 v[112:113], v43 offset:9888
v_cvt_pk_bf16_f32 v212, v180, v181
v_mul_f32 v150, v180, v172
v_mul_f32 v151, v180, v173
v_mfma_f32_16x16x32_bf16 v[12:15], v[76:79], v[84:87], v[12:15]
ds_read_b64_tr_b16 v[114:115], v43 offset:11040
v_fma_f32 v150, -v181, v173, v150
v_fma_f32 v151, v181, v172, v151
v_mfma_f32_16x16x32_bf16 v[16:19], v[72:75], v[88:91], v[16:19]
ds_read_b64_tr_b16 v[116:117], v43 offset:9920
ds_read_b64_tr_b16 v[118:119], v43 offset:11072
v_cvt_pk_bf16_f32 v213, v150, v151
v_mul_f32 v182, v167, v163
v_mul_f32 v183, v167, v162
v_mfma_f32_16x16x32_bf16 v[20:23], v[76:79], v[88:91], v[20:23]
ds_read_b64_tr_b16 v[120:121], v43 offset:9952
v_fma_f32 v167, v166, v163, v183
v_fma_f32 v166, v166, v162, -v182
v_mfma_f32_16x16x32_bf16 v[24:27], v[72:75], v[92:95], v[24:27]
ds_read_b64_tr_b16 v[122:123], v43 offset:11104
ds_read_b64_tr_b16 v[124:125], v43 offset:9984
v_cvt_pk_bf16_f32 v154, v166, -v167
v_mul_f32 v184, v181, v165
v_mul_f32 v185, v181, v164
v_mfma_f32_16x16x32_bf16 v[28:31], v[76:79], v[92:95], v[28:31]
ds_read_b64_tr_b16 v[126:127], v43 offset:11136
v_fma_f32 v181, v180, v165, v185
v_fma_f32 v180, v180, v164, -v184
v_mfma_f32_16x16x32_bf16 v[32:35], v[72:75], v[96:99], v[32:35]
v_cvt_pk_bf16_f32 v214, v180, v181
v_mul_f32 v150, v180, v172
v_mul_f32 v151, v180, v173
v_mfma_f32_16x16x32_bf16 v[36:39], v[76:79], v[96:99], v[36:39]
v_fma_f32 v150, -v181, v173, v150
v_fma_f32 v151, v181, v172, v151
s_waitcnt vmcnt(8) lgkmcnt(0)
s_barrier
v_mfma_f32_16x16x32_bf16 v[0:3], v[100:103], v[108:111], v[0:3]
ds_read_b128 v[72:75], v40 offset:49152
ds_read_b128 v[76:79], v40 offset:49664
v_cvt_pk_bf16_f32 v215, v150, v151
v_mul_f32 v184, v167, v163
v_mul_f32 v185, v167, v162
v_mfma_f32_16x16x32_bf16 v[4:7], v[104:107], v[108:111], v[4:7]
ds_read_b64_tr_b16 v[80:81], v43 offset:19584
s_add_u32 m0, s37, 38912
s_mul_i32 s33, s3, 589824
s_add_u32 s34, s33, s50
buffer_load_dwordx4 v48, s[16:19], s34 offen lds
v_fma_f32 v167, v166, v163, v185
v_fma_f32 v166, v166, v162, -v184
v_mfma_f32_16x16x32_bf16 v[8:11], v[100:103], v[112:115], v[8:11]
ds_read_b64_tr_b16 v[82:83], v43 offset:20736
ds_read_b64_tr_b16 v[84:85], v43 offset:19616
v_cvt_pk_bf16_f32 v155, v166, -v167
v_mul_f32 v182, v181, v165
v_mul_f32 v183, v181, v164
v_mfma_f32_16x16x32_bf16 v[12:15], v[104:107], v[112:115], v[12:15]
ds_read_b64_tr_b16 v[86:87], v43 offset:20768
v_fma_f32 v181, v180, v165, v183
v_fma_f32 v180, v180, v164, -v182
v_mfma_f32_16x16x32_bf16 v[16:19], v[100:103], v[116:119], v[16:19]
ds_read_b64_tr_b16 v[88:89], v43 offset:19648
ds_read_b64_tr_b16 v[90:91], v43 offset:20800
s_add_u32 m0, s37, 39936
s_add_u32 s3, s3, 1
buffer_load_dwordx4 v49, s[16:19], s34 offen lds
v_cvt_pk_bf16_f32 v216, v180, v181
v_mul_f32 v150, v180, v172
v_mul_f32 v151, v180, v173
v_mfma_f32_16x16x32_bf16 v[20:23], v[104:107], v[116:119], v[20:23]
ds_read_b64_tr_b16 v[92:93], v43 offset:19680
v_fma_f32 v150, -v181, v173, v150
v_fma_f32 v151, v181, v172, v151
v_mfma_f32_16x16x32_bf16 v[24:27], v[100:103], v[120:123], v[24:27]
ds_read_b64_tr_b16 v[94:95], v43 offset:20832
ds_read_b64_tr_b16 v[96:97], v43 offset:19712
v_cvt_pk_bf16_f32 v217, v150, v151
v_mul_f32 v182, v167, v163
v_mul_f32 v183, v167, v162
v_mfma_f32_16x16x32_bf16 v[28:31], v[104:107], v[120:123], v[28:31]
ds_read_b64_tr_b16 v[98:99], v43 offset:20864
s_add_u32 m0, s37, 40960
s_mov_b64 exec, s[64:65]
buffer_load_dwordx4 v50, s[16:19], s34 offen lds
s_mov_b64 exec, s[62:63]
s_cmp_eq_u32 s3, 9
s_cselect_b32 s3, 0, s3
v_fma_f32 v167, v166, v163, v183
v_fma_f32 v166, v166, v162, -v182
v_mfma_f32_16x16x32_bf16 v[32:35], v[100:103], v[124:127], v[32:35]
v_cvt_pk_bf16_f32 v156, v166, -v167
v_mul_f32 v184, v181, v165
v_mul_f32 v185, v181, v164
v_mfma_f32_16x16x32_bf16 v[36:39], v[104:107], v[124:127], v[36:39]
v_fma_f32 v181, v180, v165, v185
v_fma_f32 v180, v180, v164, -v184
s_waitcnt lgkmcnt(0)
v_mfma_f32_16x16x32_bf16 v[0:3], v[72:75], v[80:83], v[0:3]
ds_read_b128 v[100:103], v41 offset:49152
ds_read_b128 v[104:107], v41 offset:49664
v_cvt_pk_bf16_f32 v218, v180, v181
v_mul_f32 v182, v167, v163
v_mul_f32 v183, v167, v162
v_mfma_f32_16x16x32_bf16 v[4:7], v[76:79], v[80:83], v[4:7]
ds_read_b64_tr_b16 v[108:109], v43 offset:29312
v_fma_f32 v167, v166, v163, v183
v_fma_f32 v166, v166, v162, -v182
v_mfma_f32_16x16x32_bf16 v[8:11], v[72:75], v[84:87], v[8:11]
ds_read_b64_tr_b16 v[110:111], v43 offset:30464
ds_read_b64_tr_b16 v[112:113], v43 offset:29344
v_cvt_pk_bf16_f32 v157, v166, -v167
v_mul_f32 v184, v181, v165
v_mul_f32 v185, v181, v164
v_mfma_f32_16x16x32_bf16 v[12:15], v[76:79], v[84:87], v[12:15]
ds_read_b64_tr_b16 v[114:115], v43 offset:30496
v_fma_f32 v181, v180, v165, v185
v_fma_f32 v180, v180, v164, -v184
v_mfma_f32_16x16x32_bf16 v[16:19], v[72:75], v[88:91], v[16:19]
ds_read_b64_tr_b16 v[116:117], v43 offset:29376
ds_read_b64_tr_b16 v[118:119], v43 offset:30528
v_cvt_pk_bf16_f32 v219, v180, v181
v_mul_f32 v182, v167, v163
v_mul_f32 v183, v167, v162
v_mfma_f32_16x16x32_bf16 v[20:23], v[76:79], v[88:91], v[20:23]
ds_read_b64_tr_b16 v[120:121], v43 offset:29408
v_fma_f32 v167, v166, v163, v183
v_fma_f32 v166, v166, v162, -v182
v_mfma_f32_16x16x32_bf16 v[24:27], v[72:75], v[92:95], v[24:27]
ds_read_b64_tr_b16 v[122:123], v43 offset:30560
ds_read_b64_tr_b16 v[124:125], v43 offset:29440
v_cvt_pk_bf16_f32 v158, v166, -v167
v_mul_f32 v184, v181, v165
v_mul_f32 v185, v181, v164
v_mfma_f32_16x16x32_bf16 v[28:31], v[76:79], v[92:95], v[28:31]
ds_read_b64_tr_b16 v[126:127], v43 offset:30592
v_fma_f32 v181, v180, v165, v185
v_fma_f32 v180, v180, v164, -v184
v_mfma_f32_16x16x32_bf16 v[32:35], v[72:75], v[96:99], v[32:35]
v_cvt_pk_bf16_f32 v220, v180, v181
v_mul_f32 v182, v167, v163
v_mul_f32 v183, v167, v162
v_mfma_f32_16x16x32_bf16 v[36:39], v[76:79], v[96:99], v[36:39]
v_fma_f32 v167, v166, v163, v183
v_fma_f32 v166, v166, v162, -v182
s_waitcnt vmcnt(6) lgkmcnt(0)
s_barrier
v_mfma_f32_16x16x32_bf16 v[0:3], v[100:103], v[108:111], v[0:3]
ds_read_b128 v[72:75], v40 offset:0
ds_read_b128 v[76:79], v40 offset:512
v_cvt_pk_bf16_f32 v159, v166, -v167
v_mul_f32 v184, v181, v165
v_mul_f32 v185, v181, v164
v_mfma_f32_16x16x32_bf16 v[4:7], v[104:107], v[108:111], v[4:7]
ds_read_b64_tr_b16 v[80:81], v42 offset:128
s_add_u32 m0, s37, 58368
s_mul_i32 s33, s3, 589824
s_add_u32 s34, s33, s50
buffer_load_dwordx4 v48, s[16:19], s34 offen lds
v_fma_f32 v181, v180, v165, v185
v_fma_f32 v180, v180, v164, -v184
v_mfma_f32_16x16x32_bf16 v[8:11], v[100:103], v[112:115], v[8:11]
ds_read_b64_tr_b16 v[82:83], v42 offset:1280
ds_read_b64_tr_b16 v[84:85], v42 offset:160
v_cvt_pk_bf16_f32 v221, v180, v181
v_mul_f32 v182, v167, v163
v_mul_f32 v183, v167, v162
v_mfma_f32_16x16x32_bf16 v[12:15], v[104:107], v[112:115], v[12:15]
ds_read_b64_tr_b16 v[86:87], v42 offset:1312
v_fma_f32 v167, v166, v163, v183
v_fma_f32 v166, v166, v162, -v182
v_mfma_f32_16x16x32_bf16 v[16:19], v[100:103], v[116:119], v[16:19]
ds_read_b64_tr_b16 v[88:89], v42 offset:192
ds_read_b64_tr_b16 v[90:91], v42 offset:1344
s_add_u32 m0, s37, 59392
s_add_u32 s3, s3, 1
buffer_load_dwordx4 v49, s[16:19], s34 offen lds
v_cvt_pk_bf16_f32 v70, v166, -v167
v_mul_f32 v184, v181, v165
v_mul_f32 v185, v181, v164
v_mfma_f32_16x16x32_bf16 v[20:23], v[104:107], v[116:119], v[20:23]
ds_read_b64_tr_b16 v[92:93], v42 offset:224
v_fma_f32 v181, v180, v165, v185
v_fma_f32 v180, v180, v164, -v184
v_mfma_f32_16x16x32_bf16 v[24:27], v[100:103], v[120:123], v[24:27]
ds_read_b64_tr_b16 v[94:95], v42 offset:1376
ds_read_b64_tr_b16 v[96:97], v42 offset:256
v_cvt_pk_bf16_f32 v222, v180, v181
v_mul_f32 v182, v167, v163
v_mul_f32 v183, v167, v162
v_mfma_f32_16x16x32_bf16 v[28:31], v[104:107], v[120:123], v[28:31]
ds_read_b64_tr_b16 v[98:99], v42 offset:1408
s_add_u32 m0, s37, 60416
s_mov_b64 exec, s[64:65]
buffer_load_dwordx4 v50, s[16:19], s34 offen lds
s_mov_b64 exec, s[62:63]
s_cmp_eq_u32 s3, 9
s_cselect_b32 s3, 0, s3
v_fma_f32 v167, v166, v163, v183
v_fma_f32 v166, v166, v162, -v182
v_mfma_f32_16x16x32_bf16 v[32:35], v[100:103], v[124:127], v[32:35]
v_cvt_pk_bf16_f32 v71, v166, -v167
v_mul_f32 v184, v181, v165
v_mul_f32 v185, v181, v164
v_mfma_f32_16x16x32_bf16 v[36:39], v[104:107], v[124:127], v[36:39]
v_fma_f32 v181, v180, v165, v185
v_fma_f32 v180, v180, v164, -v184
s_waitcnt lgkmcnt(0)
v_mfma_f32_16x16x32_bf16 v[0:3], v[72:75], v[80:83], v[0:3]
ds_read_b128 v[100:103], v41 offset:0
ds_read_b128 v[104:107], v41 offset:512
v_cvt_pk_bf16_f32 v223, v180, v181
v_mul_f32 v182, v181, v165
v_mfma_f32_16x16x32_bf16 v[4:7], v[76:79], v[80:83], v[4:7]
ds_read_b64_tr_b16 v[108:109], v42 offset:9856
v_mul_f32 v183, v181, v164
v_fma_f32 v181, v180, v165, v183
v_mfma_f32_16x16x32_bf16 v[8:11], v[72:75], v[84:87], v[8:11]
ds_read_b64_tr_b16 v[110:111], v42 offset:11008
ds_read_b64_tr_b16 v[112:113], v42 offset:9888
v_fma_f32 v180, v180, v164, -v182
v_mfma_f32_16x16x32_bf16 v[12:15], v[76:79], v[84:87], v[12:15]
ds_read_b64_tr_b16 v[114:115], v42 offset:11040
v_cvt_pk_bf16_f32 v224, v180, v181
v_mul_f32 v184, v181, v165
v_mfma_f32_16x16x32_bf16 v[16:19], v[72:75], v[88:91], v[16:19]
ds_read_b64_tr_b16 v[116:117], v42 offset:9920
ds_read_b64_tr_b16 v[118:119], v42 offset:11072
v_mul_f32 v185, v181, v164
v_mfma_f32_16x16x32_bf16 v[20:23], v[76:79], v[88:91], v[20:23]
ds_read_b64_tr_b16 v[120:121], v42 offset:9952
v_fma_f32 v181, v180, v165, v185
v_fma_f32 v180, v180, v164, -v184
v_mfma_f32_16x16x32_bf16 v[24:27], v[72:75], v[92:95], v[24:27]
ds_read_b64_tr_b16 v[122:123], v42 offset:11104
ds_read_b64_tr_b16 v[124:125], v42 offset:9984
v_cvt_pk_bf16_f32 v225, v180, v181
v_mul_f32 v182, v181, v165
v_mfma_f32_16x16x32_bf16 v[28:31], v[76:79], v[92:95], v[28:31]
ds_read_b64_tr_b16 v[126:127], v42 offset:11136
v_mul_f32 v183, v181, v164
v_mfma_f32_16x16x32_bf16 v[32:35], v[72:75], v[96:99], v[32:35]
v_fma_f32 v181, v180, v165, v183
v_fma_f32 v180, v180, v164, -v182
v_mfma_f32_16x16x32_bf16 v[36:39], v[76:79], v[96:99], v[36:39]
v_cvt_pk_bf16_f32 v226, v180, v181
s_waitcnt vmcnt(6) lgkmcnt(0)
s_barrier
v_mfma_f32_16x16x32_bf16 v[0:3], v[100:103], v[108:111], v[0:3]
v_mfma_f32_16x16x32_bf16 v[4:7], v[104:107], v[108:111], v[4:7]
s_add_u32 m0, s37, 0
s_mul_i32 s33, s3, 589824
s_add_u32 s34, s33, s50
buffer_load_dwordx4 v48, s[16:19], s34 offen lds
v_mfma_f32_16x16x32_bf16 v[8:11], v[100:103], v[112:115], v[8:11]
v_mfma_f32_16x16x32_bf16 v[12:15], v[104:107], v[112:115], v[12:15]
v_mfma_f32_16x16x32_bf16 v[16:19], v[100:103], v[116:119], v[16:19]
s_add_u32 m0, s37, 1024
s_add_u32 s3, s3, 1
buffer_load_dwordx4 v49, s[16:19], s34 offen lds
v_mfma_f32_16x16x32_bf16 v[20:23], v[104:107], v[116:119], v[20:23]
v_mfma_f32_16x16x32_bf16 v[24:27], v[100:103], v[120:123], v[24:27]
v_mfma_f32_16x16x32_bf16 v[28:31], v[104:107], v[120:123], v[28:31]
s_add_u32 m0, s37, 2048
s_mov_b64 exec, s[64:65]
buffer_load_dwordx4 v50, s[16:19], s34 offen lds
s_mov_b64 exec, s[62:63]
s_cmp_eq_u32 s3, 9
s_cselect_b32 s3, 0, s3
v_mfma_f32_16x16x32_bf16 v[32:35], v[100:103], v[124:127], v[32:35]
v_mfma_f32_16x16x32_bf16 v[36:39], v[104:107], v[124:127], v[36:39]
s_load_dwordx2 s[4:5], s[0:1], 88
s_waitcnt lgkmcnt(0)
s_barrier
s_lshl_b32 s30, s28, 8
v_lshl_add_u32 v238, v252, 6, s30
ds_read_b128 v[72:75], v238 offset:0
ds_read_b128 v[76:79], v238 offset:16
ds_read_b128 v[80:83], v238 offset:32
ds_read_b128 v[84:87], v238 offset:48
v_lshlrev_b32 v239, 2, v251
ds_read_b32 v88, v239 offset:1280
ds_read_b32 v89, v239 offset:1344
ds_read_b32 v90, v239 offset:1408
ds_read_b32 v91, v239 offset:1472
ds_read_b32 v92, v239 offset:1536
s_mov_b32 s20, s4
s_and_b32 s21, s5, 0xffff
s_mov_b32 s22, 8388608
s_mov_b32 s23, 0x20000
s_lshl_b32 s30, s2, 15
s_lshl_b32 s31, s29, 12
s_add_u32 s30, s30, s31
buffer_load_dwordx4 v[128:131], v253, s[20:23], s30 offen offset:0
buffer_load_dwordx4 v[132:135], v253, s[20:23], s30 offen offset:1024
buffer_load_dwordx4 v[136:139], v253, s[20:23], s30 offen offset:2048
buffer_load_dwordx4 v[140:143], v253, s[20:23], s30 offen offset:3072
v_mov_b32 v96, 0
v_mov_b32 v97, 0
v_mov_b32 v98, 0
v_mov_b32 v99, 0
v_mov_b32 v100, 0
v_mov_b32 v101, 0
v_mov_b32 v102, 0
v_mov_b32 v103, 0
v_mov_b32 v104, 0
v_mov_b32 v105, 0
v_mov_b32 v106, 0
v_mov_b32 v107, 0
v_mov_b32 v108, 0
v_mov_b32 v109, 0
v_mov_b32 v110, 0
v_mov_b32 v111, 0
s_waitcnt lgkmcnt(0)
v_fma_f32 v0, -v73, v88, v0
v_fma_f32 v1, -v75, v88, v1
v_fma_f32 v2, -v77, v88, v2
v_fma_f32 v3, -v79, v88, v3
v_fma_f32 v4, -v81, v88, v4
v_fma_f32 v5, -v83, v88, v5
v_fma_f32 v6, -v85, v88, v6
v_fma_f32 v7, -v87, v88, v7
v_fma_f32 v8, -v73, v89, v8
v_fma_f32 v9, -v75, v89, v9
v_fma_f32 v10, -v77, v89, v10
v_fma_f32 v11, -v79, v89, v11
v_fma_f32 v12, -v81, v89, v12
v_fma_f32 v13, -v83, v89, v13
v_fma_f32 v14, -v85, v89, v14
v_fma_f32 v15, -v87, v89, v15
v_fma_f32 v16, -v73, v90, v16
v_fma_f32 v17, -v75, v90, v17
v_fma_f32 v18, -v77, v90, v18
v_fma_f32 v19, -v79, v90, v19
v_fma_f32 v20, -v81, v90, v20
v_fma_f32 v21, -v83, v90, v21
v_fma_f32 v22, -v85, v90, v22
v_fma_f32 v23, -v87, v90, v23
v_fma_f32 v24, -v73, v91, v24
v_fma_f32 v25, -v75, v91, v25
v_fma_f32 v26, -v77, v91, v26
v_fma_f32 v27, -v79, v91, v27
v_fma_f32 v28, -v81, v91, v28
v_fma_f32 v29, -v83, v91, v29
v_fma_f32 v30, -v85, v91, v30
v_fma_f32 v31, -v87, v91, v31
v_fma_f32 v32, -v73, v92, v32
v_fma_f32 v33, -v75, v92, v33
v_fma_f32 v34, -v77, v92, v34
v_fma_f32 v35, -v79, v92, v35
v_fma_f32 v36, -v81, v92, v36
v_fma_f32 v37, -v83, v92, v37
v_fma_f32 v38, -v85, v92, v38
v_fma_f32 v39, -v87, v92, v39
v_mul_f32 v0, v0, v72
v_mul_f32 v1, v1, v74
v_mul_f32 v2, v2, v76
v_mul_f32 v3, v3, v78
v_mul_f32 v4, v4, v80
v_mul_f32 v5, v5, v82
v_mul_f32 v6, v6, v84
v_mul_f32 v7, v7, v86
v_mul_f32 v8, v8, v72
v_mul_f32 v9, v9, v74
v_mul_f32 v10, v10, v76
v_mul_f32 v11, v11, v78
v_mul_f32 v12, v12, v80
v_mul_f32 v13, v13, v82
v_mul_f32 v14, v14, v84
v_mul_f32 v15, v15, v86
v_mul_f32 v16, v16, v72
v_mul_f32 v17, v17, v74
v_mul_f32 v18, v18, v76
v_mul_f32 v19, v19, v78
v_mul_f32 v20, v20, v80
v_mul_f32 v21, v21, v82
v_mul_f32 v22, v22, v84
v_mul_f32 v23, v23, v86
v_mul_f32 v24, v24, v72
v_mul_f32 v25, v25, v74
v_mul_f32 v26, v26, v76
v_mul_f32 v27, v27, v78
v_mul_f32 v28, v28, v80
v_mul_f32 v29, v29, v82
v_mul_f32 v30, v30, v84
v_mul_f32 v31, v31, v86
v_mul_f32 v32, v32, v72
v_mul_f32 v33, v33, v74
v_mul_f32 v34, v34, v76
v_mul_f32 v35, v35, v78
v_mul_f32 v36, v36, v80
v_mul_f32 v37, v37, v82
v_mul_f32 v38, v38, v84
v_mul_f32 v39, v39, v86
v_mul_f32 v112, v0, v0
v_mul_f32 v113, v1, v1
v_mul_f32 v114, v2, v2
v_mul_f32 v115, v3, v3
v_mul_f32 v116, v4, v4
v_mul_f32 v117, v5, v5
v_mul_f32 v118, v6, v6
v_mul_f32 v119, v7, v7
v_mul_f32 v120, v8, v8
v_mul_f32 v121, v9, v9
v_mul_f32 v122, v10, v10
v_mul_f32 v123, v11, v11
v_mul_f32 v124, v12, v12
v_mul_f32 v125, v13, v13
v_mul_f32 v126, v14, v14
v_mul_f32 v127, v15, v15
v_mul_f32 v160, v16, v16
v_mul_f32 v161, v17, v17
v_mul_f32 v162, v18, v18
v_mul_f32 v163, v19, v19
v_mul_f32 v164, v20, v20
v_mul_f32 v165, v21, v21
v_mul_f32 v166, v22, v22
v_mul_f32 v167, v23, v23
v_mul_f32 v168, v24, v24
v_mul_f32 v169, v25, v25
v_mul_f32 v170, v26, v26
v_mul_f32 v171, v27, v27
v_mul_f32 v172, v28, v28
v_mul_f32 v173, v29, v29
v_mul_f32 v174, v30, v30
v_mul_f32 v175, v31, v31
v_mul_f32 v176, v32, v32
v_mul_f32 v177, v33, v33
v_mul_f32 v178, v34, v34
v_mul_f32 v179, v35, v35
v_mul_f32 v180, v36, v36
v_mul_f32 v181, v37, v37
v_mul_f32 v182, v38, v38
v_mul_f32 v183, v39, v39
v_fma_f32 v112, v112, s60, v254
v_fma_f32 v113, v113, s60, v254
v_fma_f32 v114, v114, s60, v254
v_fma_f32 v115, v115, s60, v254
v_fma_f32 v116, v116, s60, v254
v_fma_f32 v117, v117, s60, v254
v_fma_f32 v118, v118, s60, v254
v_fma_f32 v119, v119, s60, v254
v_fma_f32 v120, v120, s60, v254
v_fma_f32 v121, v121, s60, v254
v_fma_f32 v122, v122, s60, v254
v_fma_f32 v123, v123, s60, v254
v_fma_f32 v124, v124, s60, v254
v_fma_f32 v125, v125, s60, v254
v_fma_f32 v126, v126, s60, v254
v_fma_f32 v127, v127, s60, v254
v_fma_f32 v160, v160, s60, v254
v_fma_f32 v161, v161, s60, v254
v_fma_f32 v162, v162, s60, v254
v_fma_f32 v163, v163, s60, v254
v_fma_f32 v164, v164, s60, v254
v_fma_f32 v165, v165, s60, v254
v_fma_f32 v166, v166, s60, v254
v_fma_f32 v167, v167, s60, v254
v_fma_f32 v168, v168, s60, v254
v_fma_f32 v169, v169, s60, v254
v_fma_f32 v170, v170, s60, v254
v_fma_f32 v171, v171, s60, v254
v_fma_f32 v172, v172, s60, v254
v_fma_f32 v173, v173, s60, v254
v_fma_f32 v174, v174, s60, v254
v_fma_f32 v175, v175, s60, v254
v_fma_f32 v176, v176, s60, v254
v_fma_f32 v177, v177, s60, v254
v_fma_f32 v178, v178, s60, v254
v_fma_f32 v179, v179, s60, v254
v_fma_f32 v180, v180, s60, v254
v_fma_f32 v181, v181, s60, v254
v_fma_f32 v182, v182, s60, v254
v_fma_f32 v183, v183, s60, v254
v_mul_f32 v112, v112, v0
v_mul_f32 v113, v113, v1
v_mul_f32 v114, v114, v2
v_mul_f32 v115, v115, v3
v_mul_f32 v116, v116, v4
v_mul_f32 v117, v117, v5
v_mul_f32 v118, v118, v6
v_mul_f32 v119, v119, v7
v_mul_f32 v120, v120, v8
v_mul_f32 v121, v121, v9
v_mul_f32 v122, v122, v10
v_mul_f32 v123, v123, v11
v_mul_f32 v124, v124, v12
v_mul_f32 v125, v125, v13
v_mul_f32 v126, v126, v14
v_mul_f32 v127, v127, v15
v_mul_f32 v160, v160, v16
v_mul_f32 v161, v161, v17
v_mul_f32 v162, v162, v18
v_mul_f32 v163, v163, v19
v_mul_f32 v164, v164, v20
v_mul_f32 v165, v165, v21
v_mul_f32 v166, v166, v22
v_mul_f32 v167, v167, v23
v_mul_f32 v168, v168, v24
v_mul_f32 v169, v169, v25
v_mul_f32 v170, v170, v26
v_mul_f32 v171, v171, v27
v_mul_f32 v172, v172, v28
v_mul_f32 v173, v173, v29
v_mul_f32 v174, v174, v30
v_mul_f32 v175, v175, v31
v_mul_f32 v176, v176, v32
v_mul_f32 v177, v177, v33
v_mul_f32 v178, v178, v34
v_mul_f32 v179, v179, v35
v_mul_f32 v180, v180, v36
v_mul_f32 v181, v181, v37
v_mul_f32 v182, v182, v38
v_mul_f32 v183, v183, v39
v_exp_f32 v112, v112
v_exp_f32 v113, v113
v_exp_f32 v114, v114
v_exp_f32 v115, v115
v_exp_f32 v116, v116
v_exp_f32 v117, v117
v_exp_f32 v118, v118
v_exp_f32 v119, v119
v_exp_f32 v120, v120
v_exp_f32 v121, v121
v_exp_f32 v122, v122
v_exp_f32 v123, v123
v_exp_f32 v124, v124
v_exp_f32 v125, v125
v_exp_f32 v126, v126
v_exp_f32 v127, v127
v_exp_f32 v160, v160
v_exp_f32 v161, v161
v_exp_f32 v162, v162
v_exp_f32 v163, v163
v_exp_f32 v164, v164
v_exp_f32 v165, v165
v_exp_f32 v166, v166
v_exp_f32 v167, v167
v_exp_f32 v168, v168
v_exp_f32 v169, v169
v_exp_f32 v170, v170
v_exp_f32 v171, v171
v_exp_f32 v172, v172
v_exp_f32 v173, v173
v_exp_f32 v174, v174
v_exp_f32 v175, v175
v_exp_f32 v176, v176
v_exp_f32 v177, v177
v_exp_f32 v178, v178
v_exp_f32 v179, v179
v_exp_f32 v180, v180
v_exp_f32 v181, v181
v_exp_f32 v182, v182
v_exp_f32 v183, v183
v_add_f32 v112, 1.0, v112
v_add_f32 v113, 1.0, v113
v_add_f32 v114, 1.0, v114
v_add_f32 v115, 1.0, v115
v_add_f32 v116, 1.0, v116
v_add_f32 v117, 1.0, v117
v_add_f32 v118, 1.0, v118
v_add_f32 v119, 1.0, v119
v_add_f32 v120, 1.0, v120
v_add_f32 v121, 1.0, v121
v_add_f32 v122, 1.0, v122
v_add_f32 v123, 1.0, v123
v_add_f32 v124, 1.0, v124
v_add_f32 v125, 1.0, v125
v_add_f32 v126, 1.0, v126
v_add_f32 v127, 1.0, v127
v_add_f32 v160, 1.0, v160
v_add_f32 v161, 1.0, v161
v_add_f32 v162, 1.0, v162
v_add_f32 v163, 1.0, v163
v_add_f32 v164, 1.0, v164
v_add_f32 v165, 1.0, v165
v_add_f32 v166, 1.0, v166
v_add_f32 v167, 1.0, v167
v_add_f32 v168, 1.0, v168
v_add_f32 v169, 1.0, v169
v_add_f32 v170, 1.0, v170
v_add_f32 v171, 1.0, v171
v_add_f32 v172, 1.0, v172
v_add_f32 v173, 1.0, v173
v_add_f32 v174, 1.0, v174
v_add_f32 v175, 1.0, v175
v_add_f32 v176, 1.0, v176
v_add_f32 v177, 1.0, v177
v_add_f32 v178, 1.0, v178
v_add_f32 v179, 1.0, v179
v_add_f32 v180, 1.0, v180
v_add_f32 v181, 1.0, v181
v_add_f32 v182, 1.0, v182
v_add_f32 v183, 1.0, v183
v_rcp_f32 v112, v112
v_rcp_f32 v113, v113
v_rcp_f32 v114, v114
v_rcp_f32 v115, v115
v_rcp_f32 v116, v116
v_rcp_f32 v117, v117
v_rcp_f32 v118, v118
v_rcp_f32 v119, v119
v_rcp_f32 v120, v120
v_rcp_f32 v121, v121
v_rcp_f32 v122, v122
v_rcp_f32 v123, v123
v_rcp_f32 v124, v124
v_rcp_f32 v125, v125
v_rcp_f32 v126, v126
v_rcp_f32 v127, v127
v_rcp_f32 v160, v160
v_rcp_f32 v161, v161
v_rcp_f32 v162, v162
v_rcp_f32 v163, v163
v_rcp_f32 v164, v164
v_rcp_f32 v165, v165
v_rcp_f32 v166, v166
v_rcp_f32 v167, v167
v_rcp_f32 v168, v168
v_rcp_f32 v169, v169
v_rcp_f32 v170, v170
v_rcp_f32 v171, v171
v_rcp_f32 v172, v172
v_rcp_f32 v173, v173
v_rcp_f32 v174, v174
v_rcp_f32 v175, v175
v_rcp_f32 v176, v176
v_rcp_f32 v177, v177
v_rcp_f32 v178, v178
v_rcp_f32 v179, v179
v_rcp_f32 v180, v180
v_rcp_f32 v181, v181
v_rcp_f32 v182, v182
v_rcp_f32 v183, v183
v_mul_f32 v0, v0, v112
v_mul_f32 v1, v1, v113
v_mul_f32 v2, v2, v114
v_mul_f32 v3, v3, v115
v_mul_f32 v4, v4, v116
v_mul_f32 v5, v5, v117
v_mul_f32 v6, v6, v118
v_mul_f32 v7, v7, v119
v_mul_f32 v8, v8, v120
v_mul_f32 v9, v9, v121
v_mul_f32 v10, v10, v122
v_mul_f32 v11, v11, v123
v_mul_f32 v12, v12, v124
v_mul_f32 v13, v13, v125
v_mul_f32 v14, v14, v126
v_mul_f32 v15, v15, v127
v_mul_f32 v16, v16, v160
v_mul_f32 v17, v17, v161
v_mul_f32 v18, v18, v162
v_mul_f32 v19, v19, v163
v_mul_f32 v20, v20, v164
v_mul_f32 v21, v21, v165
v_mul_f32 v22, v22, v166
v_mul_f32 v23, v23, v167
v_mul_f32 v24, v24, v168
v_mul_f32 v25, v25, v169
v_mul_f32 v26, v26, v170
v_mul_f32 v27, v27, v171
v_mul_f32 v28, v28, v172
v_mul_f32 v29, v29, v173
v_mul_f32 v30, v30, v174
v_mul_f32 v31, v31, v175
v_mul_f32 v32, v32, v176
v_mul_f32 v33, v33, v177
v_mul_f32 v34, v34, v178
v_mul_f32 v35, v35, v179
v_mul_f32 v36, v36, v180
v_mul_f32 v37, v37, v181
v_mul_f32 v38, v38, v182
v_mul_f32 v39, v39, v183
v_add_f32 v96, v96, v0
v_add_f32 v98, v98, v1
v_add_f32 v100, v100, v2
v_add_f32 v102, v102, v3
v_add_f32 v104, v104, v4
v_add_f32 v106, v106, v5
v_add_f32 v108, v108, v6
v_add_f32 v110, v110, v7
v_fmac_f32 v97, v0, v0
v_fmac_f32 v99, v1, v1
v_fmac_f32 v101, v2, v2
v_fmac_f32 v103, v3, v3
v_fmac_f32 v105, v4, v4
v_fmac_f32 v107, v5, v5
v_fmac_f32 v109, v6, v6
v_fmac_f32 v111, v7, v7
v_add_f32 v96, v96, v8
v_add_f32 v98, v98, v9
v_add_f32 v100, v100, v10
v_add_f32 v102, v102, v11
v_add_f32 v104, v104, v12
v_add_f32 v106, v106, v13
v_add_f32 v108, v108, v14
v_add_f32 v110, v110, v15
v_fmac_f32 v97, v8, v8
v_fmac_f32 v99, v9, v9
v_fmac_f32 v101, v10, v10
v_fmac_f32 v103, v11, v11
v_fmac_f32 v105, v12, v12
v_fmac_f32 v107, v13, v13
v_fmac_f32 v109, v14, v14
v_fmac_f32 v111, v15, v15
v_add_f32 v96, v96, v16
v_add_f32 v98, v98, v17
v_add_f32 v100, v100, v18
v_add_f32 v102, v102, v19
v_add_f32 v104, v104, v20
v_add_f32 v106, v106, v21
v_add_f32 v108, v108, v22
v_add_f32 v110, v110, v23
v_fmac_f32 v97, v16, v16
v_fmac_f32 v99, v17, v17
v_fmac_f32 v101, v18, v18
v_fmac_f32 v103, v19, v19
v_fmac_f32 v105, v20, v20
v_fmac_f32 v107, v21, v21
v_fmac_f32 v109, v22, v22
v_fmac_f32 v111, v23, v23
v_add_f32 v96, v96, v24
v_add_f32 v98, v98, v25
v_add_f32 v100, v100, v26
v_add_f32 v102, v102, v27
v_add_f32 v104, v104, v28
v_add_f32 v106, v106, v29
v_add_f32 v108, v108, v30
v_add_f32 v110, v110, v31
v_fmac_f32 v97, v24, v24
v_fmac_f32 v99, v25, v25
v_fmac_f32 v101, v26, v26
v_fmac_f32 v103, v27, v27
v_fmac_f32 v105, v28, v28
v_fmac_f32 v107, v29, v29
v_fmac_f32 v109, v30, v30
v_fmac_f32 v111, v31, v31
v_add_f32 v96, v96, v32
v_add_f32 v98, v98, v33
v_add_f32 v100, v100, v34
v_add_f32 v102, v102, v35
v_add_f32 v104, v104, v36
v_add_f32 v106, v106, v37
v_add_f32 v108, v108, v38
v_add_f32 v110, v110, v39
v_fmac_f32 v97, v32, v32
v_fmac_f32 v99, v33, v33
v_fmac_f32 v101, v34, v34
v_fmac_f32 v103, v35, v35
v_fmac_f32 v105, v36, v36
v_fmac_f32 v107, v37, v37
v_fmac_f32 v109, v38, v38
v_fmac_f32 v111, v39, v39
v_add_f32_dpp v96, v96, v96 row_ror:8 row_mask:0xf bank_mask:0x3
v_add_f32_dpp v97, v97, v97 row_ror:8 row_mask:0xf bank_mask:0x3
v_add_f32_dpp v98, v98, v98 row_ror:8 row_mask:0xf bank_mask:0x3
v_add_f32_dpp v99, v99, v99 row_ror:8 row_mask:0xf bank_mask:0x3
v_add_f32_dpp v100, v100, v100 row_ror:8 row_mask:0xf bank_mask:0x3
v_add_f32_dpp v101, v101, v101 row_ror:8 row_mask:0xf bank_mask:0x3
v_add_f32_dpp v102, v102, v102 row_ror:8 row_mask:0xf bank_mask:0x3
v_add_f32_dpp v103, v103, v103 row_ror:8 row_mask:0xf bank_mask:0x3
v_add_f32_dpp v96, v104, v104 row_ror:8 row_mask:0xf bank_mask:0xc
v_add_f32_dpp v97, v105, v105 row_ror:8 row_mask:0xf bank_mask:0xc
v_add_f32_dpp v98, v106, v106 row_ror:8 row_mask:0xf bank_mask:0xc
v_add_f32_dpp v99, v107, v107 row_ror:8 row_mask:0xf bank_mask:0xc
v_add_f32_dpp v100, v108, v108 row_ror:8 row_mask:0xf bank_mask:0xc
v_add_f32_dpp v101, v109, v109 row_ror:8 row_mask:0xf bank_mask:0xc
v_add_f32_dpp v102, v110, v110 row_ror:8 row_mask:0xf bank_mask:0xc
v_add_f32_dpp v103, v111, v111 row_ror:8 row_mask:0xf bank_mask:0xc
v_add_f32_dpp v104, v96, v96 row_shl:4 row_mask:0xf bank_mask:0x5
v_add_f32_dpp v105, v97, v97 row_shl:4 row_mask:0xf bank_mask:0x5
v_add_f32_dpp v106, v98, v98 row_shl:4 row_mask:0xf bank_mask:0x5
v_add_f32_dpp v107, v99, v99 row_shl:4 row_mask:0xf bank_mask:0x5
v_add_f32_dpp v104, v100, v100 row_shr:4 row_mask:0xf bank_mask:0xa
v_add_f32_dpp v105, v101, v101 row_shr:4 row_mask:0xf bank_mask:0xa
v_add_f32_dpp v106, v102, v102 row_shr:4 row_mask:0xf bank_mask:0xa
v_add_f32_dpp v107, v103, v103 row_shr:4 row_mask:0xf bank_mask:0xa
v_add_f32_dpp v104, v104, v104 quad_perm:[1,0,3,2] row_mask:0xf bank_mask:0xf
v_add_f32_dpp v105, v105, v105 quad_perm:[1,0,3,2] row_mask:0xf bank_mask:0xf
v_add_f32_dpp v106, v106, v106 quad_perm:[1,0,3,2] row_mask:0xf bank_mask:0xf
v_add_f32_dpp v107, v107, v107 quad_perm:[1,0,3,2] row_mask:0xf bank_mask:0xf
v_add_f32_dpp v104, v104, v104 quad_perm:[2,3,0,1] row_mask:0xf bank_mask:0xf
v_add_f32_dpp v105, v105, v105 quad_perm:[2,3,0,1] row_mask:0xf bank_mask:0xf
v_add_f32_dpp v106, v106, v106 quad_perm:[2,3,0,1] row_mask:0xf bank_mask:0xf
v_add_f32_dpp v107, v107, v107 quad_perm:[2,3,0,1] row_mask:0xf bank_mask:0xf
v_lshrrev_b32 v239, 2, v251
v_lshl_add_u32 v238, v239, 4, v238
ds_write_b128 v238, v[104:107] offset:3200
s_mov_b64 exec, s[62:63]
s_waitcnt vmcnt(0) lgkmcnt(0)
s_barrier
s_cmp_eq_u32 s29, 7
s_cbranch_scc0 mega_ow_42
ds_read_b128 v[242:245], v253 offset:2176
ds_read_b128 v[246:249], v253 offset:3200
s_waitcnt lgkmcnt(0)
v_add_f32 v242, v242, v246
v_add_f32 v243, v243, v247
v_add_f32 v244, v244, v248
v_add_f32 v245, v245, v249
buffer_store_dwordx4 v[242:245], v253, s[44:47], s48 offen sc1
mega_ow_42:
s_setprio 0
s_waitcnt vmcnt(0) lgkmcnt(0)
s_barrier
s_add_u32 m0, s36, 35072
s_lshl_b32 s32, s59, 7
s_add_u32 s35, s32, s49
buffer_load_dwordx4 v46, s[12:15], s35 offen lds
s_add_u32 m0, s36, 36096
s_add_u32 s59, s59, 1
buffer_load_dwordx4 v47, s[12:15], s35 offen lds
s_cmp_eq_u32 s59, 9
s_cselect_b32 s59, 0, s59
s_add_u32 m0, s36, 26880
s_nop 0
buffer_load_dwordx4 v46, s[12:15], s32 offen lds
s_add_u32 m0, s36, 27904
s_nop 0
buffer_load_dwordx4 v47, s[12:15], s32 offen lds
s_add_u32 m0, s37, 19456
s_mul_i32 s33, s3, 589824
s_add_u32 s34, s33, 294912
buffer_load_dwordx4 v48, s[16:19], s34 offen lds
s_add_u32 m0, s37, 20480
s_add_u32 s3, s3, 1
buffer_load_dwordx4 v49, s[16:19], s34 offen lds
s_add_u32 m0, s37, 21504
s_mov_b64 exec, s[64:65]
buffer_load_dwordx4 v50, s[16:19], s34 offen lds
s_mov_b64 exec, s[62:63]
s_cmp_eq_u32 s3, 9
s_cselect_b32 s3, 0, s3
s_add_u32 m0, s37, 9728
s_nop 0
buffer_load_dwordx4 v48, s[16:19], s33 offen lds
s_add_u32 m0, s37, 10752
s_nop 0
buffer_load_dwordx4 v49, s[16:19], s33 offen lds
s_add_u32 m0, s37, 11776
s_mov_b64 exec, s[64:65]
buffer_load_dwordx4 v50, s[16:19], s33 offen lds
s_mov_b64 exec, s[62:63]
s_cmp_lt_u32 s58, 64
s_cbranch_scc0 mega_c2_43
v_lshlrev_b32 v58, 16, v58
v_lshlrev_b32 v59, 16, v59
v_lshlrev_b32 v60, 16, v60
v_lshlrev_b32 v61, 16, v61
v_lshlrev_b32 v62, 16, v62
v_lshlrev_b32 v63, 16, v63
v_lshlrev_b32 v64, 16, v64
v_mul_f32 v64, 0x3fb8aa3b, v64
v_exp_f32 v64, v64
s_nop 0
v_cvt_pk_bf16_f32 v64, v64, v64
v_lshlrev_b32 v64, 16, v64
v_mul_f32 v58, v58, v64
v_mul_f32 v59, v59, v64
v_mul_f32 v60, v60, v64
v_mul_f32 v61, v61, v64
v_mul_f32 v58, 0x3fb8aa3b, v58
v_mul_f32 v59, 0x3e22f983, v59
v_mul_f32 v182, 0x3f800000, v58
v_mul_f32 v183, 0x3f800000, v59
v_exp_f32 v182, v182
v_fract_f32 v183, v183
v_cos_f32 v160, v183
v_sin_f32 v161, v183
v_mul_f32 v160, v160, v182
v_mul_f32 v161, v161, v182
v_mul_f32 v182, 0x41000000, v58
v_mul_f32 v183, 0x41000000, v59
v_exp_f32 v182, v182
v_fract_f32 v183, v183
v_cos_f32 v162, v183
v_sin_f32 v163, v183
v_mul_f32 v162, v162, v182
v_mul_f32 v163, v163, v182
v_mul_f32 v182, 0x43000000, v58
v_mul_f32 v183, 0x43000000, v59
v_exp_f32 v182, v182
v_fract_f32 v183, v183
v_cos_f32 v164, v183
v_sin_f32 v165, v183
v_mul_f32 v164, v164, v182
mega_c2_43:
s_waitcnt vmcnt(10) lgkmcnt(0)
s_barrier
s_add_u32 m0, s36, 51456
s_lshl_b32 s32, s59, 7
s_add_u32 s35, s32, s49
buffer_load_dwordx4 v46, s[12:15], s35 offen lds
s_add_u32 m0, s36, 52480
s_add_u32 s59, s59, 1
buffer_load_dwordx4 v47, s[12:15], s35 offen lds
s_cmp_eq_u32 s59, 9
s_cselect_b32 s59, 0, s59
s_add_u32 m0, s36, 43264
s_nop 0
buffer_load_dwordx4 v46, s[12:15], s32 offen lds
s_add_u32 m0, s36, 44288
s_nop 0
buffer_load_dwordx4 v47, s[12:15], s32 offen lds
s_add_u32 m0, s37, 38912
s_mul_i32 s33, s3, 589824
s_add_u32 s34, s33, 294912
buffer_load_dwordx4 v48, s[16:19], s34 offen lds
s_add_u32 m0, s37, 39936
s_add_u32 s3, s3, 1
buffer_load_dwordx4 v49, s[16:19], s34 offen lds
s_add_u32 m0, s37, 40960
s_mov_b64 exec, s[64:65]
buffer_load_dwordx4 v50, s[16:19], s34 offen lds
s_mov_b64 exec, s[62:63]
s_cmp_eq_u32 s3, 9
s_cselect_b32 s3, 0, s3
s_add_u32 m0, s37, 29184
s_nop 0
buffer_load_dwordx4 v48, s[16:19], s33 offen lds
s_add_u32 m0, s37, 30208
s_nop 0
buffer_load_dwordx4 v49, s[16:19], s33 offen lds
s_add_u32 m0, s37, 31232
s_mov_b64 exec, s[64:65]
buffer_load_dwordx4 v50, s[16:19], s33 offen lds
s_mov_b64 exec, s[62:63]
v_and_b32 v240, 31, v250
v_lshlrev_b32 v240, 3, v240
v_lshrrev_b32 v241, 5, v250
v_lshl_add_u32 v241, v241, 13, v240
s_lshl_b32 s30, s26, 14
s_lshl_b32 s31, s28, 8
s_add_u32 s30, s30, s31
s_add_u32 s50, s30, 327680
s_add_u32 s51, s50, 4096
buffer_load_dwordx2 v[72:73], v241, s[44:47], s50 offen offset:0 sc1
buffer_load_dwordx2 v[74:75], v241, s[44:47], s50 offen offset:1024 sc1
buffer_load_dwordx2 v[76:77], v241, s[44:47], s50 offen offset:2048 sc1
buffer_load_dwordx2 v[78:79], v241, s[44:47], s50 offen offset:3072 sc1
buffer_load_dwordx2 v[80:81], v241, s[44:47], s51 offen offset:0 sc1
buffer_load_dwordx2 v[82:83], v241, s[44:47], s51 offen offset:1024 sc1
buffer_load_dwordx2 v[84:85], v241, s[44:47], s51 offen offset:2048 sc1
buffer_load_dwordx2 v[86:87], v241, s[44:47], s51 offen offset:3072 sc1
s_cmp_lt_u32 s58, 64
s_cbranch_scc0 mega_c2_44
v_mul_f32 v165, v165, v182
v_mul_f32 v166, v62, v60
v_mul_f32 v167, v62, v61
v_fma_f32 v166, -v63, v61, v166
v_fma_f32 v167, v63, v60, v167
v_mov_b32 v100, 0x3f80
v_cvt_pk_bf16_f32 v101, v160, v161
v_cvt_pk_bf16_f32 v141, v166, -v167
v_mul_f32 v168, v160, v160
v_mul_f32 v169, v160, v161
v_fma_f32 v168, -v161, v161, v168
v_fma_f32 v169, v161, v160, v169
v_cvt_pk_bf16_f32 v102, v168, v169
v_mul_f32 v184, v167, v163
v_mul_f32 v185, v167, v162
v_fma_f32 v167, v166, v163, v185
v_fma_f32 v166, v166, v162, -v184
v_cvt_pk_bf16_f32 v142, v166, -v167
v_mul_f32 v170, v168, v160
v_mul_f32 v171, v168, v161
v_fma_f32 v170, -v169, v161, v170
v_fma_f32 v171, v169, v160, v171
v_cvt_pk_bf16_f32 v103, v170, v171
v_mul_f32 v172, v170, v160
v_mul_f32 v173, v170, v161
v_fma_f32 v172, -v171, v161, v172
v_fma_f32 v173, v171, v160, v173
v_cvt_pk_bf16_f32 v104, v172, v173
v_mul_f32 v182, v167, v163
v_mul_f32 v183, v167, v162
v_fma_f32 v167, v166, v163, v183
v_fma_f32 v166, v166, v162, -v182
v_cvt_pk_bf16_f32 v143, v166, -v167
v_mul_f32 v174, v172, v160
v_mul_f32 v175, v172, v161
v_fma_f32 v174, -v173, v161, v174
v_fma_f32 v175, v173, v160, v175
v_cvt_pk_bf16_f32 v105, v174, v175
v_mul_f32 v176, v174, v160
v_mul_f32 v177, v174, v161
mega_c2_44:
s_waitcnt vmcnt(28) lgkmcnt(0)
s_barrier
s_add_u32 m0, s36, 67840
s_lshl_b32 s32, s59, 7
s_add_u32 s35, s32, s49
buffer_load_dwordx4 v46, s[12:15], s35 offen lds
s_add_u32 m0, s36, 68864
s_add_u32 s59, s59, 1
buffer_load_dwordx4 v47, s[12:15], s35 offen lds
s_cmp_eq_u32 s59, 9
s_cselect_b32 s59, 0, s59
s_add_u32 m0, s36, 59648
s_nop 0
buffer_load_dwordx4 v46, s[12:15], s32 offen lds
s_add_u32 m0, s36, 60672
s_nop 0
buffer_load_dwordx4 v47, s[12:15], s32 offen lds
s_add_u32 m0, s37, 58368
s_mul_i32 s33, s3, 589824
s_add_u32 s34, s33, 294912
buffer_load_dwordx4 v48, s[16:19], s34 offen lds
s_add_u32 m0, s37, 59392
s_add_u32 s3, s3, 1
buffer_load_dwordx4 v49, s[16:19], s34 offen lds
s_add_u32 m0, s37, 60416
s_mov_b64 exec, s[64:65]
buffer_load_dwordx4 v50, s[16:19], s34 offen lds
s_mov_b64 exec, s[62:63]
s_cmp_eq_u32 s3, 9
s_cselect_b32 s3, 0, s3
s_add_u32 m0, s37, 48640
s_nop 0
buffer_load_dwordx4 v48, s[16:19], s33 offen lds
s_add_u32 m0, s37, 49664
s_nop 0
buffer_load_dwordx4 v49, s[16:19], s33 offen lds
s_add_u32 m0, s37, 50688
s_mov_b64 exec, s[64:65]
buffer_load_dwordx4 v50, s[16:19], s33 offen lds
s_mov_b64 exec, s[62:63]
s_mov_b32 s39, 100000
s_waitcnt vmcnt(10)
mega_pl_45:
v_max3_u32 v244, v72, v73, v74
v_max3_u32 v244, v244, v75, v76
v_max3_u32 v244, v244, v77, v78
v_max3_u32 v244, v244, v79, v80
v_max3_u32 v244, v244, v81, v82
v_max3_u32 v244, v244, v83, v84
v_max3_u32 v244, v244, v85, v86
v_max_u32 v244, v244, v87
v_cmp_eq_u32 vcc, -1, v244
s_nop 4
s_cbranch_vccz mega_pe_46
s_sub_u32 s39, s39, 1
s_cmp_eq_u32 s39, 0
s_cbranch_scc1 mega_pe_46
s_sleep 8
buffer_load_dwordx2 v[72:73], v241, s[44:47], s50 offen offset:0 sc1
buffer_load_dwordx2 v[74:75], v241, s[44:47], s50 offen offset:1024 sc1
buffer_load_dwordx2 v[76:77], v241, s[44:47], s50 offen offset:2048 sc1
buffer_load_dwordx2 v[78:79], v241, s[44:47], s50 offen offset:3072 sc1
buffer_load_dwordx2 v[80:81], v241, s[44:47], s51 offen offset:0 sc1
buffer_load_dwordx2 v[82:83], v241, s[44:47], s51 offen offset:1024 sc1
buffer_load_dwordx2 v[84:85], v241, s[44:47], s51 offen offset:2048 sc1
buffer_load_dwordx2 v[86:87], v241, s[44:47], s51 offen offset:3072 sc1
s_waitcnt vmcnt(0)
s_branch mega_pl_45
mega_pe_46:
v_add_f32 v72, v72, v74
v_add_f32 v73, v73, v75
v_add_f32 v72, v72, v76
v_add_f32 v73, v73, v77
v_add_f32 v72, v72, v78
v_add_f32 v73, v73, v79
v_add_f32 v72, v72, v80
v_add_f32 v73, v73, v81
v_add_f32 v72, v72, v82
v_add_f32 v73, v73, v83
v_add_f32 v72, v72, v84
v_add_f32 v73, v73, v85
v_add_f32 v72, v72, v86
v_add_f32 v73, v73, v87
v_mov_b32 v74, v72
v_mov_b32 v75, v73
s_nop 0
v_permlane32_swap_b32 v72, v74
v_permlane32_swap_b32 v73, v75
v_add_f32 v72, v72, v74
v_add_f32 v73, v73, v75
v_mul_f32 v72, 0x39e38e39, v72
v_mul_f32 v73, 0x39e38e39, v73
v_fma_f32 v73, -v72, v72, v73
v_max_f32 v73, 0, v73
v_cvt_pk_bf16_f32 v74, v72, v73
v_and_b32 v75, 0xffff0000, v74
v_lshlrev_b32 v73, 16, v74
v_add_f32 v75, 0x3727c5ac, v75
v_cvt_pk_bf16_f32 v75, v75, v75
v_lshlrev_b32 v75, 16, v75
v_sqrt_f32 v75, v75
s_nop 0
v_cvt_pk_bf16_f32 v75, v75, v75
v_lshlrev_b32 v75, 16, v75
v_rcp_f32 v72, v75
s_nop 0
v_mul_f32 v73, -v73, v72
s_lshl_b32 s30, s28, 8
v_add_u32 v240, s30, v240
ds_write_b64 v240, v[72:73] offset:4224
s_lshl_b32 s30, s28, 8
v_lshl_add_u32 v241, v252, 6, s30
s_waitcnt lgkmcnt(0)
ds_read_b128 v[76:79], v241 offset:4224
ds_read_b128 v[80:83], v241 offset:4240
ds_read_b128 v[84:87], v241 offset:4256
ds_read_b128 v[88:91], v241 offset:4272
s_lshl_b32 s30, s27, 6
s_lshl_b32 s31, s26, 2
s_add_u32 s30, s30, s31
s_add_u32 s30, s30, s28
s_mul_i32 s30, s30, 9216
s_add_u32 s20, s8, 9437184
s_addc_u32 s21, s9, 0
s_and_b32 s21, s21, 0xffff
s_mov_b32 s22, 9437184
s_mov_b32 s23, 0x20000
s_waitcnt lgkmcnt(0)
v_fma_f32 v0, v0, v76, v77
v_fma_f32 v1, v1, v78, v79
v_fma_f32 v2, v2, v80, v81
v_fma_f32 v3, v3, v82, v83
v_fma_f32 v4, v4, v84, v85
v_fma_f32 v5, v5, v86, v87
v_fma_f32 v6, v6, v88, v89
v_fma_f32 v7, v7, v90, v91
v_cvt_pk_bf16_f32 v92, v0, v1
v_cvt_pk_bf16_f32 v93, v2, v3
v_cvt_pk_bf16_f32 v94, v4, v5
v_cvt_pk_bf16_f32 v95, v6, v7
s_add_u32 s34, s30, 4096
buffer_store_dwordx4 v[92:95], v253, s[20:23], s34 offen sc1
v_fma_f32 v8, v8, v76, v77
v_fma_f32 v9, v9, v78, v79
v_fma_f32 v10, v10, v80, v81
v_fma_f32 v11, v11, v82, v83
v_fma_f32 v12, v12, v84, v85
v_fma_f32 v13, v13, v86, v87
v_fma_f32 v14, v14, v88, v89
v_fma_f32 v15, v15, v90, v91
v_cvt_pk_bf16_f32 v96, v8, v9
v_cvt_pk_bf16_f32 v97, v10, v11
v_cvt_pk_bf16_f32 v98, v12, v13
v_cvt_pk_bf16_f32 v99, v14, v15
s_add_u32 s34, s30, 5120
buffer_store_dwordx4 v[96:99], v253, s[20:23], s34 offen sc1
v_fma_f32 v16, v16, v76, v77
v_fma_f32 v17, v17, v78, v79
v_fma_f32 v18, v18, v80, v81
v_fma_f32 v19, v19, v82, v83
v_fma_f32 v20, v20, v84, v85
v_fma_f32 v21, v21, v86, v87
v_fma_f32 v22, v22, v88, v89
v_fma_f32 v23, v23, v90, v91
v_cvt_pk_bf16_f32 v92, v16, v17
v_cvt_pk_bf16_f32 v93, v18, v19
v_cvt_pk_bf16_f32 v94, v20, v21
v_cvt_pk_bf16_f32 v95, v22, v23
s_add_u32 s34, s30, 6144
buffer_store_dwordx4 v[92:95], v253, s[20:23], s34 offen sc1
v_fma_f32 v24, v24, v76, v77
v_fma_f32 v25, v25, v78, v79
v_fma_f32 v26, v26, v80, v81
v_fma_f32 v27, v27, v82, v83
v_fma_f32 v28, v28, v84, v85
v_fma_f32 v29, v29, v86, v87
v_fma_f32 v30, v30, v88, v89
v_fma_f32 v31, v31, v90, v91
v_cvt_pk_bf16_f32 v96, v24, v25
v_cvt_pk_bf16_f32 v97, v26, v27
v_cvt_pk_bf16_f32 v98, v28, v29
v_cvt_pk_bf16_f32 v99, v30, v31
s_add_u32 s34, s30, 7168
buffer_store_dwordx4 v[96:99], v253, s[20:23], s34 offen sc1
v_fma_f32 v32, v32, v76, v77
v_fma_f32 v33, v33, v78, v79
v_fma_f32 v34, v34, v80, v81
v_fma_f32 v35, v35, v82, v83
v_fma_f32 v36, v36, v84, v85
v_fma_f32 v37, v37, v86, v87
v_fma_f32 v38, v38, v88, v89
v_fma_f32 v39, v39, v90, v91
v_cvt_pk_bf16_f32 v92, v32, v33
v_cvt_pk_bf16_f32 v93, v34, v35
v_cvt_pk_bf16_f32 v94, v36, v37
v_cvt_pk_bf16_f32 v95, v38, v39
s_add_u32 s34, s30, 8192
buffer_store_dwordx4 v[92:95], v253, s[20:23], s34 offen sc1
s_waitcnt vmcnt(15) lgkmcnt(0)
s_barrier
s_add_u32 m0, s36, 18688
s_lshl_b32 s32, s59, 7
s_add_u32 s35, s32, s49
buffer_load_dwordx4 v46, s[12:15], s35 offen lds
s_add_u32 m0, s36, 19712
s_add_u32 s59, s59, 1
buffer_load_dwordx4 v47, s[12:15], s35 offen lds
s_cmp_eq_u32 s59, 9
s_cselect_b32 s59, 0, s59
s_add_u32 m0, s36, 10496
s_nop 0
buffer_load_dwordx4 v46, s[12:15], s32 offen lds
s_add_u32 m0, s36, 11520
s_nop 0
buffer_load_dwordx4 v47, s[12:15], s32 offen lds
s_add_u32 m0, s37, 0
s_mul_i32 s33, s3, 589824
s_add_u32 s34, s33, 294912
buffer_load_dwordx4 v48, s[16:19], s34 offen lds
s_add_u32 m0, s37, 1024
s_add_u32 s3, s3, 1
buffer_load_dwordx4 v49, s[16:19], s34 offen lds
s_add_u32 m0, s37, 2048
s_mov_b64 exec, s[64:65]
buffer_load_dwordx4 v50, s[16:19], s34 offen lds
s_mov_b64 exec, s[62:63]
s_cmp_eq_u32 s3, 9
s_cselect_b32 s3, 0, s3
s_add_u32 m0, s37, -9728
s_nop 0
buffer_load_dwordx4 v48, s[16:19], s33 offen lds
s_add_u32 m0, s37, -8704
s_nop 0
buffer_load_dwordx4 v49, s[16:19], s33 offen lds
s_add_u32 m0, s37, -7680
s_mov_b64 exec, s[64:65]
buffer_load_dwordx4 v50, s[16:19], s33 offen lds
s_mov_b64 exec, s[62:63]
s_cmp_lt_u32 s58, 64
s_cbranch_scc0 mega_c2_47
v_fma_f32 v176, -v175, v161, v176
v_fma_f32 v177, v175, v160, v177
v_cvt_pk_bf16_f32 v106, v176, v177
v_mul_f32 v184, v167, v163
v_mul_f32 v185, v167, v162
v_fma_f32 v167, v166, v163, v185
v_fma_f32 v166, v166, v162, -v184
v_cvt_pk_bf16_f32 v144, v166, -v167
v_mul_f32 v178, v176, v160
v_mul_f32 v179, v176, v161
v_fma_f32 v178, -v177, v161, v178
v_fma_f32 v179, v177, v160, v179
v_cvt_pk_bf16_f32 v107, v178, v179
v_mov_b32 v180, v164
v_mov_b32 v181, v165
v_cvt_pk_bf16_f32 v108, v180, v181
v_mul_f32 v62, v180, v160
v_mul_f32 v63, v180, v161
v_fma_f32 v62, -v181, v161, v62
v_fma_f32 v63, v181, v160, v63
v_cvt_pk_bf16_f32 v109, v62, v63
v_mul_f32 v62, v180, v168
v_mul_f32 v63, v180, v169
v_fma_f32 v62, -v181, v169, v62
v_fma_f32 v63, v181, v168, v63
v_cvt_pk_bf16_f32 v110, v62, v63
v_mul_f32 v62, v180, v170
v_mul_f32 v63, v180, v171
v_fma_f32 v62, -v181, v171, v62
v_fma_f32 v63, v181, v170, v63
v_cvt_pk_bf16_f32 v111, v62, v63
v_mul_f32 v62, v180, v172
v_mul_f32 v63, v180, v173
v_fma_f32 v62, -v181, v173, v62
v_fma_f32 v63, v181, v172, v63
v_cvt_pk_bf16_f32 v112, v62, v63
v_mul_f32 v62, v180, v174
v_mul_f32 v63, v180, v175
v_fma_f32 v62, -v181, v175, v62
v_fma_f32 v63, v181, v174, v63
mega_c2_47:
s_mul_i32 s30, s26, 9216
s_mul_i32 s31, s27, 10368
s_add_u32 s31, s31, 1047104
v_mov_b32 v234, s30
v_mov_b32 v235, s31
v_cmp_gt_u32 vcc, 256, v255
s_nop 1
v_cndmask_b32 v53, v235, v234, vcc
v_mov_b32 v234, 1024
v_mov_b32 v235, 1152
v_cndmask_b32 v45, v235, v234, vcc
v_lshl_add_u32 v53, v255, 3, v53
v_mov_b32 v235, s61
v_cmp_gt_u32 vcc, 328, v255
s_nop 1
v_cndmask_b32 v53, v235, v53, vcc
v_cmp_gt_u32 vcc, 256, v255
v_mad_u32_u24 v235, v45, 0, v53
buffer_load_dwordx2 v[16:17], v235, s[44:47], 0 offen sc1
v_mad_u32_u24 v235, v45, 1, v53
buffer_load_dwordx2 v[18:19], v235, s[44:47], 0 offen sc1
v_mad_u32_u24 v235, v45, 2, v53
buffer_load_dwordx2 v[20:21], v235, s[44:47], 0 offen sc1
v_mad_u32_u24 v235, v45, 3, v53
buffer_load_dwordx2 v[22:23], v235, s[44:47], 0 offen sc1
v_mad_u32_u24 v235, v45, 4, v53
buffer_load_dwordx2 v[24:25], v235, s[44:47], 0 offen sc1
v_mad_u32_u24 v235, v45, 5, v53
buffer_load_dwordx2 v[26:27], v235, s[44:47], 0 offen sc1
v_mad_u32_u24 v235, v45, 6, v53
buffer_load_dwordx2 v[28:29], v235, s[44:47], 0 offen sc1
v_mad_u32_u24 v235, v45, 7, v53
buffer_load_dwordx2 v[30:31], v235, s[44:47], 0 offen sc1
v_mad_u32_u24 v235, v45, 8, v53
buffer_load_dwordx2 v[32:33], v235, s[44:47], 0 offen sc1
s_waitcnt vmcnt(34) lgkmcnt(0)
s_barrier
s_add_u32 m0, s36, 35072
s_lshl_b32 s32, s59, 7
s_add_u32 s35, s32, s49
buffer_load_dwordx4 v46, s[12:15], s35 offen lds
s_add_u32 m0, s36, 36096
s_add_u32 s59, s59, 1
buffer_load_dwordx4 v47, s[12:15], s35 offen lds
s_cmp_eq_u32 s59, 9
s_cselect_b32 s59, 0, s59
s_add_u32 m0, s36, 26880
s_nop 0
buffer_load_dwordx4 v46, s[12:15], s32 offen lds
s_add_u32 m0, s36, 27904
s_nop 0
buffer_load_dwordx4 v47, s[12:15], s32 offen lds
s_add_u32 m0, s37, 19456
s_mul_i32 s33, s3, 589824
s_add_u32 s34, s33, 294912
buffer_load_dwordx4 v48, s[16:19], s34 offen lds
s_add_u32 m0, s37, 20480
s_add_u32 s3, s3, 1
buffer_load_dwordx4 v49, s[16:19], s34 offen lds
s_add_u32 m0, s37, 21504
s_mov_b64 exec, s[64:65]
buffer_load_dwordx4 v50, s[16:19], s34 offen lds
s_mov_b64 exec, s[62:63]
s_cmp_eq_u32 s3, 9
s_cselect_b32 s3, 0, s3
s_add_u32 m0, s37, 9728
s_nop 0
buffer_load_dwordx4 v48, s[16:19], s33 offen lds
s_add_u32 m0, s37, 10752
s_nop 0
buffer_load_dwordx4 v49, s[16:19], s33 offen lds
s_add_u32 m0, s37, 11776
s_mov_b64 exec, s[64:65]
buffer_load_dwordx4 v50, s[16:19], s33 offen lds
s_mov_b64 exec, s[62:63]
s_cmp_lt_u32 s58, 64
s_cbranch_scc0 mega_c2_48
v_cvt_pk_bf16_f32 v113, v62, v63
v_mul_f32 v62, v180, v176
v_mul_f32 v63, v180, v177
v_fma_f32 v62, -v181, v177, v62
v_fma_f32 v63, v181, v176, v63
v_cvt_pk_bf16_f32 v114, v62, v63
v_mul_f32 v62, v180, v178
v_mul_f32 v63, v180, v179
v_fma_f32 v62, -v181, v179, v62
v_fma_f32 v63, v181, v178, v63
v_cvt_pk_bf16_f32 v115, v62, v63
v_mul_f32 v182, v167, v163
v_mul_f32 v183, v167, v162
v_fma_f32 v167, v166, v163, v183
v_fma_f32 v166, v166, v162, -v182
v_cvt_pk_bf16_f32 v145, v166, -v167
v_mul_f32 v184, v181, v165
v_mul_f32 v185, v181, v164
v_fma_f32 v181, v180, v165, v185
v_fma_f32 v180, v180, v164, -v184
v_cvt_pk_bf16_f32 v116, v180, v181
v_mul_f32 v62, v180, v168
v_mul_f32 v63, v180, v169
v_fma_f32 v62, -v181, v169, v62
v_fma_f32 v63, v181, v168, v63
v_cvt_pk_bf16_f32 v117, v62, v63
v_mul_f32 v62, v180, v172
v_mul_f32 v63, v180, v173
v_fma_f32 v62, -v181, v173, v62
v_fma_f32 v63, v181, v172, v63
v_cvt_pk_bf16_f32 v118, v62, v63
v_mul_f32 v62, v180, v176
v_mul_f32 v63, v180, v177
v_fma_f32 v62, -v181, v177, v62
v_fma_f32 v63, v181, v176, v63
v_cvt_pk_bf16_f32 v119, v62, v63
v_mul_f32 v184, v167, v163
v_mul_f32 v185, v167, v162
v_fma_f32 v167, v166, v163, v185
v_fma_f32 v166, v166, v162, -v184
mega_c2_48:
s_mov_b32 s39, 100000
s_waitcnt vmcnt(10)
mega_pl_49:
v_max3_u32 v234, v16, v17, v18
v_max3_u32 v234, v234, v19, v20
v_max3_u32 v234, v234, v21, v22
v_max3_u32 v234, v234, v23, v24
v_max3_u32 v234, v234, v25, v26
v_max3_u32 v234, v234, v27, v28
v_max3_u32 v234, v234, v29, v30
v_max3_u32 v234, v234, v31, v32
v_max_u32 v234, v234, v33
v_cmp_eq_u32 vcc, -1, v234
s_nop 4
s_cbranch_vccz mega_pe_50
s_sub_u32 s39, s39, 1
s_cmp_eq_u32 s39, 0
s_cbranch_scc1 mega_pe_50
s_sleep 8
v_mad_u32_u24 v235, v45, 0, v53
buffer_load_dwordx2 v[16:17], v235, s[44:47], 0 offen sc1
v_mad_u32_u24 v235, v45, 1, v53
buffer_load_dwordx2 v[18:19], v235, s[44:47], 0 offen sc1
v_mad_u32_u24 v235, v45, 2, v53
buffer_load_dwordx2 v[20:21], v235, s[44:47], 0 offen sc1
v_mad_u32_u24 v235, v45, 3, v53
buffer_load_dwordx2 v[22:23], v235, s[44:47], 0 offen sc1
v_mad_u32_u24 v235, v45, 4, v53
buffer_load_dwordx2 v[24:25], v235, s[44:47], 0 offen sc1
v_mad_u32_u24 v235, v45, 5, v53
buffer_load_dwordx2 v[26:27], v235, s[44:47], 0 offen sc1
v_mad_u32_u24 v235, v45, 6, v53
buffer_load_dwordx2 v[28:29], v235, s[44:47], 0 offen sc1
v_mad_u32_u24 v235, v45, 7, v53
buffer_load_dwordx2 v[30:31], v235, s[44:47], 0 offen sc1
v_mad_u32_u24 v235, v45, 8, v53
buffer_load_dwordx2 v[32:33], v235, s[44:47], 0 offen sc1
s_waitcnt vmcnt(0)
s_branch mega_pl_49
mega_pe_50:
v_add_f32 v16, v16, v18
v_add_f32 v17, v17, v19
v_add_f32 v16, v16, v20
v_add_f32 v17, v17, v21
v_add_f32 v16, v16, v22
v_add_f32 v17, v17, v23
v_add_f32 v16, v16, v24
v_add_f32 v17, v17, v25
v_add_f32 v16, v16, v26
v_add_f32 v17, v17, v27
v_add_f32 v16, v16, v28
v_add_f32 v17, v17, v29
v_add_f32 v16, v16, v30
v_add_f32 v17, v17, v31
v_add_f32 v16, v16, v32
v_add_f32 v17, v17, v33
v_lshlrev_b32 v236, 3, v255
v_subrev_u32 v236, 2048, v236
v_cmp_gt_u32 vcc, 328, v255
s_nop 3
s_and_saveexec_b64 s[56:57], vcc
s_cbranch_execz mega_e0_51
ds_write_b64 v236, v[16:17] offset:1600
mega_e0_51:
s_mov_b64 exec, s[62:63]
s_waitcnt lgkmcnt(0)
v_lshrrev_b32 v234, 2, v250
s_lshl_b32 s30, s26, 7
s_lshl_b32 s31, s28, 5
s_add_u32 s30, s30, s31
s_add_u32 s30, s30, 0
v_add_u32 v234, s30, v234
v_mul_u32_u24 v234, 1152, v234
v_and_b32 v235, 3, v250
v_lshl_add_u32 v234, v235, 4, v234
s_lshl_b32 s30, s27, 6
buffer_load_dwordx4 v[0:3], v234, s[12:15], s30 offen
s_cmp_lt_u32 s27, 2
s_cselect_b32 s31, 1024, s61
s_add_u32 s30, s30, s31
buffer_load_dwordx4 v[4:7], v234, s[12:15], s30 offen
v_lshrrev_b32 v234, 2, v250
s_lshl_b32 s30, s26, 7
s_lshl_b32 s31, s28, 5
s_add_u32 s30, s30, s31
s_add_u32 s30, s30, 16
v_add_u32 v234, s30, v234
v_mul_u32_u24 v234, 1152, v234
v_and_b32 v235, 3, v250
v_lshl_add_u32 v234, v235, 4, v234
s_lshl_b32 s30, s27, 6
buffer_load_dwordx4 v[8:11], v234, s[12:15], s30 offen
s_cmp_lt_u32 s27, 2
s_cselect_b32 s31, 1024, s61
s_add_u32 s30, s30, s31
buffer_load_dwordx4 v[12:15], v234, s[12:15], s30 offen
s_waitcnt vmcnt(4)
s_barrier
s_lshl_b32 s30, s27, 4
s_add_u32 s30, s30, s26
s_lshl_b32 s30, s30, 5
s_add_u32 s30, s30, s29
s_lshl_b32 s30, s30, 2
s_add_u32 s30, s30, 266240
s_waitcnt vmcnt(4)
v_mov_b32 v248, 1
v_mov_b32 v249, s30
s_mov_b64 exec, 1
buffer_store_dword v248, v249, s[44:47], 0 offen sc1
s_mov_b64 exec, s[62:63]
v_lshrrev_b32 v242, 2, v250
s_lshl_b32 s30, s28, 8
v_lshl_add_u32 v242, v242, 3, s30
ds_read_b64 v[64:65], v242 offset:0
ds_read_b64 v[66:67], v242 offset:128
s_mul_i32 s30, s28, 2560
s_add_u32 s30, s30, 6272
v_lshrrev_b32 v234, 2, v250
v_mul_u32_u24 v234, 80, v234
v_and_b32 v235, 3, v250
v_lshl_add_u32 v234, v235, 4, v234
v_add_u32 v234, s30, v234
v_lshrrev_b32 v235, 1, v252
v_lshlrev_b32 v235, 4, v235
v_lshrrev_b32 v242, 2, v251
v_add_u32 v242, v242, v235
v_mul_u32_u24 v242, 80, v242
v_and_b32 v243, 1, v252
v_lshl_add_u32 v242, v243, 5, v242
v_and_b32 v244, 3, v251
v_lshl_add_u32 v242, v244, 3, v242
v_add_u32 v242, s30, v242
v_lshl_add_u32 v243, v243, 4, v251
v_lshlrev_b32 v243, 12, v243
v_lshl_add_u32 v243, v235, 1, v243
s_lshl_b32 s30, s27, 17
s_lshl_b32 s34, s26, 8
s_add_u32 s30, s30, s34
s_lshl_b32 s34, s28, 6
s_add_u32 s30, s30, s34
s_waitcnt vmcnt(1) lgkmcnt(0)
v_lshlrev_b32 v16, 16, v0
v_and_b32 v17, 0xffff0000, v0
v_lshlrev_b32 v18, 16, v1
v_and_b32 v19, 0xffff0000, v1
v_lshlrev_b32 v20, 16, v2
v_and_b32 v21, 0xffff0000, v2
v_lshlrev_b32 v22, 16, v3
v_and_b32 v23, 0xffff0000, v3
v_sub_f32 v16, v16, v65
v_sub_f32 v17, v17, v65
v_sub_f32 v18, v18, v65
v_sub_f32 v19, v19, v65
v_sub_f32 v20, v20, v65
v_sub_f32 v21, v21, v65
v_sub_f32 v22, v22, v65
v_sub_f32 v23, v23, v65
v_cvt_pk_bf16_f32 v0, v16, v17
v_cvt_pk_bf16_f32 v1, v18, v19
v_cvt_pk_bf16_f32 v2, v20, v21
v_cvt_pk_bf16_f32 v3, v22, v23
v_lshlrev_b32 v16, 16, v0
v_and_b32 v17, 0xffff0000, v0
v_lshlrev_b32 v18, 16, v1
v_and_b32 v19, 0xffff0000, v1
v_lshlrev_b32 v20, 16, v2
v_and_b32 v21, 0xffff0000, v2
v_lshlrev_b32 v22, 16, v3
v_and_b32 v23, 0xffff0000, v3
v_mul_f32 v16, v16, v64
v_mul_f32 v17, v17, v64
v_mul_f32 v18, v18, v64
v_mul_f32 v19, v19, v64
v_mul_f32 v20, v20, v64
v_mul_f32 v21, v21, v64
v_mul_f32 v22, v22, v64
v_mul_f32 v23, v23, v64
v_cvt_pk_bf16_f32 v0, v16, v17
v_cvt_pk_bf16_f32 v1, v18, v19
v_cvt_pk_bf16_f32 v2, v20, v21
v_cvt_pk_bf16_f32 v3, v22, v23
ds_write_b128 v234, v[0:3] offset:0
v_lshlrev_b32 v24, 16, v8
v_and_b32 v25, 0xffff0000, v8
v_lshlrev_b32 v26, 16, v9
v_and_b32 v27, 0xffff0000, v9
v_lshlrev_b32 v28, 16, v10
v_and_b32 v29, 0xffff0000, v10
v_lshlrev_b32 v30, 16, v11
v_and_b32 v31, 0xffff0000, v11
v_sub_f32 v24, v24, v67
v_sub_f32 v25, v25, v67
v_sub_f32 v26, v26, v67
v_sub_f32 v27, v27, v67
v_sub_f32 v28, v28, v67
v_sub_f32 v29, v29, v67
v_sub_f32 v30, v30, v67
v_sub_f32 v31, v31, v67
v_cvt_pk_bf16_f32 v8, v24, v25
v_cvt_pk_bf16_f32 v9, v26, v27
v_cvt_pk_bf16_f32 v10, v28, v29
v_cvt_pk_bf16_f32 v11, v30, v31
v_lshlrev_b32 v24, 16, v8
v_and_b32 v25, 0xffff0000, v8
v_lshlrev_b32 v26, 16, v9
v_and_b32 v27, 0xffff0000, v9
v_lshlrev_b32 v28, 16, v10
v_and_b32 v29, 0xffff0000, v10
v_lshlrev_b32 v30, 16, v11
v_and_b32 v31, 0xffff0000, v11
v_mul_f32 v24, v24, v66
v_mul_f32 v25, v25, v66
v_mul_f32 v26, v26, v66
v_mul_f32 v27, v27, v66
v_mul_f32 v28, v28, v66
v_mul_f32 v29, v29, v66
v_mul_f32 v30, v30, v66
v_mul_f32 v31, v31, v66
v_cvt_pk_bf16_f32 v8, v24, v25
v_cvt_pk_bf16_f32 v9, v26, v27
v_cvt_pk_bf16_f32 v10, v28, v29
v_cvt_pk_bf16_f32 v11, v30, v31
ds_write_b128 v234, v[8:11] offset:1280
s_waitcnt lgkmcnt(0)
ds_read_b64_tr_b16 v[32:33], v242 offset:0
ds_read_b64_tr_b16 v[34:35], v242 offset:320
ds_read_b64_tr_b16 v[36:37], v242 offset:640
ds_read_b64_tr_b16 v[38:39], v242 offset:960
s_waitcnt lgkmcnt(0)
buffer_store_dwordx4 v[32:35], v243, s[52:55], s30 offen sc1
buffer_store_dwordx4 v[36:39], v243, s[52:55], s30 offen offset:16 sc1
s_cmp_lt_u32 s27, 2
s_cbranch_scc0 mega_xt_52
v_lshlrev_b32 v16, 16, v4
v_and_b32 v17, 0xffff0000, v4
v_lshlrev_b32 v18, 16, v5
v_and_b32 v19, 0xffff0000, v5
v_lshlrev_b32 v20, 16, v6
v_and_b32 v21, 0xffff0000, v6
v_lshlrev_b32 v22, 16, v7
v_and_b32 v23, 0xffff0000, v7
v_sub_f32 v16, v16, v65
v_sub_f32 v17, v17, v65
v_sub_f32 v18, v18, v65
v_sub_f32 v19, v19, v65
v_sub_f32 v20, v20, v65
v_sub_f32 v21, v21, v65
v_sub_f32 v22, v22, v65
v_sub_f32 v23, v23, v65
v_cvt_pk_bf16_f32 v4, v16, v17
v_cvt_pk_bf16_f32 v5, v18, v19
v_cvt_pk_bf16_f32 v6, v20, v21
v_cvt_pk_bf16_f32 v7, v22, v23
v_lshlrev_b32 v16, 16, v4
v_and_b32 v17, 0xffff0000, v4
v_lshlrev_b32 v18, 16, v5
v_and_b32 v19, 0xffff0000, v5
v_lshlrev_b32 v20, 16, v6
v_and_b32 v21, 0xffff0000, v6
v_lshlrev_b32 v22, 16, v7
v_and_b32 v23, 0xffff0000, v7
v_mul_f32 v16, v16, v64
v_mul_f32 v17, v17, v64
v_mul_f32 v18, v18, v64
v_mul_f32 v19, v19, v64
v_mul_f32 v20, v20, v64
v_mul_f32 v21, v21, v64
v_mul_f32 v22, v22, v64
v_mul_f32 v23, v23, v64
v_cvt_pk_bf16_f32 v4, v16, v17
v_cvt_pk_bf16_f32 v5, v18, v19
v_cvt_pk_bf16_f32 v6, v20, v21
v_cvt_pk_bf16_f32 v7, v22, v23
ds_write_b128 v234, v[4:7] offset:0
v_lshlrev_b32 v24, 16, v12
v_and_b32 v25, 0xffff0000, v12
v_lshlrev_b32 v26, 16, v13
v_and_b32 v27, 0xffff0000, v13
v_lshlrev_b32 v28, 16, v14
v_and_b32 v29, 0xffff0000, v14
v_lshlrev_b32 v30, 16, v15
v_and_b32 v31, 0xffff0000, v15
v_sub_f32 v24, v24, v67
v_sub_f32 v25, v25, v67
v_sub_f32 v26, v26, v67
v_sub_f32 v27, v27, v67
v_sub_f32 v28, v28, v67
v_sub_f32 v29, v29, v67
v_sub_f32 v30, v30, v67
v_sub_f32 v31, v31, v67
v_cvt_pk_bf16_f32 v12, v24, v25
v_cvt_pk_bf16_f32 v13, v26, v27
v_cvt_pk_bf16_f32 v14, v28, v29
v_cvt_pk_bf16_f32 v15, v30, v31
v_lshlrev_b32 v24, 16, v12
v_and_b32 v25, 0xffff0000, v12
v_lshlrev_b32 v26, 16, v13
v_and_b32 v27, 0xffff0000, v13
v_lshlrev_b32 v28, 16, v14
v_and_b32 v29, 0xffff0000, v14
v_lshlrev_b32 v30, 16, v15
v_and_b32 v31, 0xffff0000, v15
v_mul_f32 v24, v24, v66
v_mul_f32 v25, v25, v66
v_mul_f32 v26, v26, v66
v_mul_f32 v27, v27, v66
v_mul_f32 v28, v28, v66
v_mul_f32 v29, v29, v66
v_mul_f32 v30, v30, v66
v_mul_f32 v31, v31, v66
v_cvt_pk_bf16_f32 v12, v24, v25
v_cvt_pk_bf16_f32 v13, v26, v27
v_cvt_pk_bf16_f32 v14, v28, v29
v_cvt_pk_bf16_f32 v15, v30, v31
ds_write_b128 v234, v[12:15] offset:1280
s_waitcnt lgkmcnt(0)
ds_read_b64_tr_b16 v[32:33], v242 offset:0
ds_read_b64_tr_b16 v[34:35], v242 offset:320
ds_read_b64_tr_b16 v[36:37], v242 offset:640
ds_read_b64_tr_b16 v[38:39], v242 offset:960
s_add_u32 s30, s30, 2097152
s_waitcnt lgkmcnt(0)
buffer_store_dwordx4 v[32:35], v243, s[52:55], s30 offen sc1
buffer_store_dwordx4 v[36:39], v243, s[52:55], s30 offen offset:16 sc1
mega_xt_52:
s_cmp_lt_u32 s58, 64
s_cbranch_scc0 mega_c2_53
v_cvt_pk_bf16_f32 v146, v166, -v167
v_mul_f32 v182, v181, v165
v_mul_f32 v183, v181, v164
v_fma_f32 v181, v180, v165, v183
v_fma_f32 v180, v180, v164, -v182
v_cvt_pk_bf16_f32 v120, v180, v181
v_mul_f32 v62, v180, v168
v_mul_f32 v63, v180, v169
v_fma_f32 v62, -v181, v169, v62
v_fma_f32 v63, v181, v168, v63
v_cvt_pk_bf16_f32 v121, v62, v63
v_mul_f32 v62, v180, v172
v_mul_f32 v63, v180, v173
v_fma_f32 v62, -v181, v173, v62
v_fma_f32 v63, v181, v172, v63
v_cvt_pk_bf16_f32 v122, v62, v63
v_mul_f32 v62, v180, v176
v_mul_f32 v63, v180, v177
v_fma_f32 v62, -v181, v177, v62
v_fma_f32 v63, v181, v176, v63
v_cvt_pk_bf16_f32 v123, v62, v63
v_mul_f32 v182, v167, v163
v_mul_f32 v183, v167, v162
v_fma_f32 v167, v166, v163, v183
v_fma_f32 v166, v166, v162, -v182
v_cvt_pk_bf16_f32 v147, v166, -v167
v_mul_f32 v184, v181, v165
v_mul_f32 v185, v181, v164
v_fma_f32 v181, v180, v165, v185
v_fma_f32 v180, v180, v164, -v184
v_cvt_pk_bf16_f32 v124, v180, v181
v_mul_f32 v62, v180, v172
v_mul_f32 v63, v180, v173
v_fma_f32 v62, -v181, v173, v62
v_fma_f32 v63, v181, v172, v63
v_cvt_pk_bf16_f32 v125, v62, v63
v_mul_f32 v184, v167, v163
v_mul_f32 v185, v167, v162
v_fma_f32 v167, v166, v163, v185
v_fma_f32 v166, v166, v162, -v184
v_cvt_pk_bf16_f32 v148, v166, -v167
v_mul_f32 v182, v181, v165
v_mul_f32 v183, v181, v164
v_fma_f32 v181, v180, v165, v183
v_fma_f32 v180, v180, v164, -v182
v_cvt_pk_bf16_f32 v126, v180, v181
v_mul_f32 v62, v180, v172
v_mul_f32 v63, v180, v173
v_fma_f32 v62, -v181, v173, v62
v_fma_f32 v63, v181, v172, v63
v_cvt_pk_bf16_f32 v127, v62, v63
v_mul_f32 v182, v167, v163
v_mul_f32 v183, v167, v162
v_fma_f32 v167, v166, v163, v183
v_fma_f32 v166, v166, v162, -v182
v_cvt_pk_bf16_f32 v149, v166, -v167
v_mul_f32 v184, v181, v165
v_mul_f32 v185, v181, v164
v_fma_f32 v181, v180, v165, v185
v_fma_f32 v180, v180, v164, -v184
v_cvt_pk_bf16_f32 v128, v180, v181
v_mul_f32 v62, v180, v172
v_mul_f32 v63, v180, v173
v_fma_f32 v62, -v181, v173, v62
v_fma_f32 v63, v181, v172, v63
v_cvt_pk_bf16_f32 v129, v62, v63
v_mul_f32 v184, v167, v163
v_mul_f32 v185, v167, v162
v_fma_f32 v167, v166, v163, v185
v_fma_f32 v166, v166, v162, -v184
v_cvt_pk_bf16_f32 v150, v166, -v167
v_mul_f32 v182, v181, v165
v_mul_f32 v183, v181, v164
v_fma_f32 v181, v180, v165, v183
v_fma_f32 v180, v180, v164, -v182
v_cvt_pk_bf16_f32 v130, v180, v181
v_mul_f32 v62, v180, v172
v_mul_f32 v63, v180, v173
v_fma_f32 v62, -v181, v173, v62
v_fma_f32 v63, v181, v172, v63
v_cvt_pk_bf16_f32 v131, v62, v63
v_mul_f32 v182, v167, v163
v_mul_f32 v183, v167, v162
v_fma_f32 v167, v166, v163, v183
v_fma_f32 v166, v166, v162, -v182
v_cvt_pk_bf16_f32 v151, v166, -v167
v_mul_f32 v184, v181, v165
v_mul_f32 v185, v181, v164
v_fma_f32 v181, v180, v165, v185
v_fma_f32 v180, v180, v164, -v184
v_cvt_pk_bf16_f32 v132, v180, v181
v_mul_f32 v182, v167, v163
v_mul_f32 v183, v167, v162
v_fma_f32 v167, v166, v163, v183
v_fma_f32 v166, v166, v162, -v182
v_cvt_pk_bf16_f32 v152, v166, -v167
v_mul_f32 v184, v181, v165
v_mul_f32 v185, v181, v164
v_fma_f32 v181, v180, v165, v185
v_fma_f32 v180, v180, v164, -v184
v_cvt_pk_bf16_f32 v133, v180, v181
v_mul_f32 v182, v167, v163
v_mul_f32 v183, v167, v162
v_fma_f32 v167, v166, v163, v183
v_fma_f32 v166, v166, v162, -v182
v_cvt_pk_bf16_f32 v54, v166, -v167
v_mul_f32 v184, v181, v165
v_mul_f32 v185, v181, v164
v_fma_f32 v181, v180, v165, v185
v_fma_f32 v180, v180, v164, -v184
v_cvt_pk_bf16_f32 v134, v180, v181
v_mul_f32 v182, v167, v163
v_mul_f32 v183, v167, v162
v_fma_f32 v167, v166, v163, v183
v_fma_f32 v166, v166, v162, -v182
v_cvt_pk_bf16_f32 v55, v166, -v167
v_mul_f32 v184, v181, v165
v_mul_f32 v185, v181, v164
v_fma_f32 v181, v180, v165, v185
v_fma_f32 v180, v180, v164, -v184
v_cvt_pk_bf16_f32 v135, v180, v181
v_mul_f32 v182, v167, v163
v_mul_f32 v183, v167, v162
v_fma_f32 v167, v166, v163, v183
v_fma_f32 v166, v166, v162, -v182
v_cvt_pk_bf16_f32 v56, v166, -v167
v_mul_f32 v184, v181, v165
v_mul_f32 v185, v181, v164
v_fma_f32 v181, v180, v165, v185
v_fma_f32 v180, v180, v164, -v184
v_cvt_pk_bf16_f32 v136, v180, v181
v_mul_f32 v182, v167, v163
v_mul_f32 v183, v167, v162
v_fma_f32 v167, v166, v163, v183
v_fma_f32 v166, v166, v162, -v182
v_cvt_pk_bf16_f32 v57, v166, -v167
v_mul_f32 v184, v181, v165
v_mul_f32 v185, v181, v164
v_fma_f32 v181, v180, v165, v185
v_fma_f32 v180, v180, v164, -v184
v_cvt_pk_bf16_f32 v137, v180, v181
v_mul_f32 v182, v181, v165
v_mul_f32 v183, v181, v164
v_fma_f32 v181, v180, v165, v183
v_fma_f32 v180, v180, v164, -v182
v_cvt_pk_bf16_f32 v138, v180, v181
v_mul_f32 v184, v181, v165
v_mul_f32 v185, v181, v164
v_fma_f32 v181, v180, v165, v185
v_fma_f32 v180, v180, v164, -v184
v_cvt_pk_bf16_f32 v139, v180, v181
v_mul_f32 v182, v181, v165
v_mul_f32 v183, v181, v164
v_fma_f32 v181, v180, v165, v183
v_fma_f32 v180, v180, v164, -v182
v_cvt_pk_bf16_f32 v140, v180, v181
mega_c2_53:
v_lshrrev_b32 v234, 3, v250
v_and_b32 v235, 7, v250
v_bfe_u32 v236, v250, 4, 1
v_xor_b32 v235, v235, v236
s_lshl_b32 s30, s26, 7
s_lshl_b32 s31, s28, 5
s_add_u32 s30, s30, s31
v_add_u32 v234, s30, v234
v_lshlrev_b32 v234, 12, v234
v_xor_b32 v236, 0, v235
v_lshl_add_u32 v40, v236, 4, v234
v_xor_b32 v236, 2, v235
v_lshl_add_u32 v41, v236, 4, v234
v_add_u32 v41, 32768, v41
v_xor_b32 v236, 4, v235
v_lshl_add_u32 v42, v236, 4, v234
v_add_u32 v42, 65536, v42
v_xor_b32 v236, 6, v235
v_lshl_add_u32 v43, v236, 4, v234
v_add_u32 v43, 98304, v43
s_lshl_b32 s36, s28, 12
s_add_u32 s36, s36, 18688
s_mul_i32 s30, s27, 589824
s_mul_i32 s31, s28, 4608
s_add_u32 s30, s30, s31
v_add_u32 v44, s30, v253
s_add_u32 s37, s31, 35072
s_load_dwordx2 s[10:11], s[0:1], 64
v_lshrrev_b32 v238, 1, v250
v_and_b32 v238, 15, v238
v_and_b32 v239, 1, v250
v_lshlrev_b32 v239, 4, v239
v_lshl_add_u32 v238, v238, 7, v239
s_lshl_b32 s35, s27, 11
s_add_u32 s35, s35, 266240
v_mov_b32 v50, v238
s_mov_b32 s80, s35
s_mov_b64 exec, s[66:67]
buffer_load_dwordx4 v[46:49], v50, s[44:47], s80 offen sc1
s_mov_b64 exec, s[62:63]
s_setprio 0
s_waitcnt lgkmcnt(0)
s_barrier
s_mov_b32 s12, s4
s_and_b32 s13, s5, 0xffff
s_mov_b32 s14, 8388608
s_mov_b32 s15, 0x20000
s_add_u32 s16, s8, 9437184
s_addc_u32 s17, s9, 0
s_and_b32 s17, s17, 0xffff
s_mov_b32 s18, 9437184
s_mov_b32 s19, 0x20000
s_mov_b32 s81, 0
s_add_u32 s32, s81, 0
s_and_b32 s32, s32, 31
s_lshl_b32 s32, s32, 7
s_add_u32 m0, s36, 0
s_nop 0
buffer_load_dwordx4 v40, s[12:15], s32 offen lds
s_add_u32 m0, s36, 1024
s_nop 0
buffer_load_dwordx4 v41, s[12:15], s32 offen lds
s_add_u32 m0, s36, 2048
s_nop 0
buffer_load_dwordx4 v42, s[12:15], s32 offen lds
s_add_u32 m0, s36, 3072
s_nop 0
buffer_load_dwordx4 v43, s[12:15], s32 offen lds
s_lshr_b32 s30, s28, 1
s_mul_i32 s30, s30, 34816
s_and_b32 s31, s29, 1
s_lshl_b32 s31, s31, 8
s_add_u32 s30, s30, s31
s_add_u32 s30, s30, 53504
v_lshl_add_u32 v234, v250, 2, s30
ds_write_b32 v234, v186 offset:0
ds_write_b32 v234, v187 offset:528
ds_write_b32 v234, v188 offset:1056
ds_write_b32 v234, v189 offset:1584
ds_write_b32 v234, v190 offset:2112
ds_write_b32 v234, v191 offset:2640
ds_write_b32 v234, v192 offset:3168
ds_write_b32 v234, v193 offset:3696
ds_write_b32 v234, v194 offset:4224
ds_write_b32 v234, v195 offset:4752
ds_write_b32 v234, v196 offset:5280
ds_write_b32 v234, v197 offset:5808
ds_write_b32 v234, v198 offset:6336
ds_write_b32 v234, v199 offset:6864
ds_write_b32 v234, v200 offset:7392
ds_write_b32 v234, v201 offset:7920
ds_write_b32 v234, v202 offset:8448
ds_write_b32 v234, v203 offset:8976
ds_write_b32 v234, v204 offset:9504
ds_write_b32 v234, v205 offset:10032
ds_write_b32 v234, v206 offset:10560
ds_write_b32 v234, v207 offset:11088
ds_write_b32 v234, v208 offset:11616
ds_write_b32 v234, v209 offset:12144
ds_write_b32 v234, v210 offset:12672
ds_write_b32 v234, v211 offset:13200
ds_write_b32 v234, v212 offset:13728
ds_write_b32 v234, v213 offset:14256
ds_write_b32 v234, v214 offset:14784
ds_write_b32 v234, v215 offset:15312
ds_write_b32 v234, v216 offset:15840
ds_write_b32 v234, v217 offset:16368
ds_write_b32 v234, v218 offset:16896
ds_write_b32 v234, v219 offset:17424
ds_write_b32 v234, v220 offset:17952
ds_write_b32 v234, v221 offset:18480
ds_write_b32 v234, v222 offset:19008
ds_write_b32 v234, v223 offset:19536
ds_write_b32 v234, v224 offset:20064
ds_write_b32 v234, v225 offset:20592
ds_write_b32 v234, v226 offset:21120
ds_write_b32 v234, v227 offset:25344
ds_write_b32 v234, v228 offset:25872
ds_write_b32 v234, v229 offset:26400
ds_write_b32 v234, v230 offset:26928
ds_write_b32 v234, v231 offset:27456
ds_write_b32 v234, v232 offset:27984
ds_write_b32 v234, v233 offset:28512
ds_write_b32 v234, v153 offset:29040
ds_write_b32 v234, v154 offset:29568
ds_write_b32 v234, v155 offset:30096
ds_write_b32 v234, v156 offset:30624
ds_write_b32 v234, v157 offset:31152
ds_write_b32 v234, v158 offset:31680
ds_write_b32 v234, v159 offset:32208
ds_write_b32 v234, v70 offset:32736
ds_write_b32 v234, v71 offset:33264
s_cmp_lt_u32 s58, 64
s_cbranch_scc0 mega_d2_54
v_add_u32 v234, 69632, v234
ds_write_b32 v234, v100 offset:0
ds_write_b32 v234, v101 offset:528
ds_write_b32 v234, v102 offset:1056
ds_write_b32 v234, v103 offset:1584
ds_write_b32 v234, v104 offset:2112
ds_write_b32 v234, v105 offset:2640
ds_write_b32 v234, v106 offset:3168
ds_write_b32 v234, v107 offset:3696
ds_write_b32 v234, v108 offset:4224
ds_write_b32 v234, v109 offset:4752
ds_write_b32 v234, v110 offset:5280
ds_write_b32 v234, v111 offset:5808
ds_write_b32 v234, v112 offset:6336
ds_write_b32 v234, v113 offset:6864
ds_write_b32 v234, v114 offset:7392
ds_write_b32 v234, v115 offset:7920
ds_write_b32 v234, v116 offset:8448
ds_write_b32 v234, v117 offset:8976
ds_write_b32 v234, v118 offset:9504
ds_write_b32 v234, v119 offset:10032
ds_write_b32 v234, v120 offset:10560
ds_write_b32 v234, v121 offset:11088
ds_write_b32 v234, v122 offset:11616
ds_write_b32 v234, v123 offset:12144
ds_write_b32 v234, v124 offset:12672
ds_write_b32 v234, v125 offset:13200
ds_write_b32 v234, v126 offset:13728
ds_write_b32 v234, v127 offset:14256
ds_write_b32 v234, v128 offset:14784
ds_write_b32 v234, v129 offset:15312
ds_write_b32 v234, v130 offset:15840
ds_write_b32 v234, v131 offset:16368
ds_write_b32 v234, v132 offset:16896
ds_write_b32 v234, v133 offset:17424
ds_write_b32 v234, v134 offset:17952
ds_write_b32 v234, v135 offset:18480
ds_write_b32 v234, v136 offset:19008
ds_write_b32 v234, v137 offset:19536
ds_write_b32 v234, v138 offset:20064
ds_write_b32 v234, v139 offset:20592
ds_write_b32 v234, v140 offset:21120
ds_write_b32 v234, v141 offset:25344
ds_write_b32 v234, v142 offset:25872
ds_write_b32 v234, v143 offset:26400
ds_write_b32 v234, v144 offset:26928
ds_write_b32 v234, v145 offset:27456
ds_write_b32 v234, v146 offset:27984
ds_write_b32 v234, v147 offset:28512
ds_write_b32 v234, v148 offset:29040
ds_write_b32 v234, v149 offset:29568
ds_write_b32 v234, v150 offset:30096
ds_write_b32 v234, v151 offset:30624
ds_write_b32 v234, v152 offset:31152
ds_write_b32 v234, v54 offset:31680
ds_write_b32 v234, v55 offset:32208
ds_write_b32 v234, v56 offset:32736
ds_write_b32 v234, v57 offset:33264
mega_d2_54:
s_waitcnt lgkmcnt(0)
s_barrier
s_waitcnt vmcnt(4)
s_mov_b64 exec, s[66:67]
v_min_u32 v51, v46, v47
v_min3_u32 v51, v51, v48, v49
v_cmp_eq_u32 vcc, 0, v51
s_mov_b64 exec, s[62:63]
s_nop 2
s_mov_b64 s[78:79], vcc
s_cbranch_vccnz mega_s3e_55
s_add_u32 s33, s81, 0
s_and_b32 s33, s33, 31
s_mul_i32 s33, s33, 18432
s_add_u32 m0, s37, 0
s_nop 0
buffer_load_dwordx4 v44, s[16:19], s33 offen offset:0 lds
buffer_load_dwordx4 v44, s[16:19], s33 offen offset:1024 lds
buffer_load_dwordx4 v44, s[16:19], s33 offen offset:2048 lds
buffer_load_dwordx4 v44, s[16:19], s33 offen offset:3072 lds
s_add_u32 m0, s37, 4096
s_add_u32 s33, s33, 4096
s_mov_b64 exec, s[66:67]
buffer_load_dwordx4 v44, s[16:19], s33 offen lds
s_mov_b64 exec, s[62:63]
mega_s3e_55:
s_cmp_lt_u32 s2, 64
s_cselect_b32 s30, 3, 2
s_cmp_lt_u32 s28, s30
s_cbranch_scc0 mega_km_57
s_mul_i32 s30, s28, 34816
s_add_u32 s30, s30, 53504
v_mul_u32_u24 v241, 528, v251
v_lshl_add_u32 v241, v252, 4, v241
v_add_u32 v241, s30, v241
v_mov_b32 v136, 0
v_mov_b32 v137, 0
v_mov_b32 v138, 0
v_mov_b32 v139, 0
v_mov_b32 v140, 0
v_mov_b32 v141, 0
v_mov_b32 v142, 0
v_mov_b32 v143, 0
v_mov_b32 v144, 0
v_mov_b32 v145, 0
v_mov_b32 v146, 0
v_mov_b32 v147, 0
ds_read_b128 v[72:75], v241 offset:0
ds_read_b128 v[76:79], v241 offset:8448
ds_read_b128 v[80:83], v241 offset:16896
ds_read_b128 v[84:87], v241 offset:25344
ds_read_b128 v[88:91], v241 offset:64
ds_read_b128 v[92:95], v241 offset:8512
ds_read_b128 v[96:99], v241 offset:16960
ds_read_b128 v[100:103], v241 offset:25408
ds_read_b128 v[104:107], v241 offset:128
ds_read_b128 v[108:111], v241 offset:8576
ds_read_b128 v[112:115], v241 offset:17024
ds_read_b128 v[116:119], v241 offset:25472
ds_read_b128 v[120:123], v241 offset:192
ds_read_b128 v[124:127], v241 offset:8640
ds_read_b128 v[128:131], v241 offset:17088
ds_read_b128 v[132:135], v241 offset:25536
s_waitcnt lgkmcnt(12)
v_mfma_f32_16x16x32_bf16 v[136:139], v[72:75], v[84:87], v[136:139]
v_mfma_f32_16x16x32_bf16 v[140:143], v[76:79], v[84:87], v[140:143]
v_mfma_f32_16x16x32_bf16 v[144:147], v[80:83], v[84:87], v[144:147]
ds_read_b128 v[72:75], v241 offset:256
ds_read_b128 v[76:79], v241 offset:8704
ds_read_b128 v[80:83], v241 offset:17152
ds_read_b128 v[84:87], v241 offset:25600
s_waitcnt lgkmcnt(12)
v_mfma_f32_16x16x32_bf16 v[136:139], v[88:91], v[100:103], v[136:139]
v_mfma_f32_16x16x32_bf16 v[140:143], v[92:95], v[100:103], v[140:143]
v_mfma_f32_16x16x32_bf16 v[144:147], v[96:99], v[100:103], v[144:147]
ds_read_b128 v[88:91], v241 offset:320
ds_read_b128 v[92:95], v241 offset:8768
ds_read_b128 v[96:99], v241 offset:17216
ds_read_b128 v[100:103], v241 offset:25664
s_waitcnt lgkmcnt(12)
v_mfma_f32_16x16x32_bf16 v[136:139], v[104:107], v[116:119], v[136:139]
v_mfma_f32_16x16x32_bf16 v[140:143], v[108:111], v[116:119], v[140:143]
v_mfma_f32_16x16x32_bf16 v[144:147], v[112:115], v[116:119], v[144:147]
ds_read_b128 v[104:107], v241 offset:384
ds_read_b128 v[108:111], v241 offset:8832
ds_read_b128 v[112:115], v241 offset:17280
ds_read_b128 v[116:119], v241 offset:25728
s_waitcnt lgkmcnt(12)
v_mfma_f32_16x16x32_bf16 v[136:139], v[120:123], v[132:135], v[136:139]
v_mfma_f32_16x16x32_bf16 v[140:143], v[124:127], v[132:135], v[140:143]
v_mfma_f32_16x16x32_bf16 v[144:147], v[128:131], v[132:135], v[144:147]
ds_read_b128 v[120:123], v241 offset:448
ds_read_b128 v[124:127], v241 offset:8896
ds_read_b128 v[128:131], v241 offset:17344
ds_read_b128 v[132:135], v241 offset:25792
s_waitcnt lgkmcnt(12)
v_mfma_f32_16x16x32_bf16 v[136:139], v[72:75], v[84:87], v[136:139]
v_mfma_f32_16x16x32_bf16 v[140:143], v[76:79], v[84:87], v[140:143]
v_mfma_f32_16x16x32_bf16 v[144:147], v[80:83], v[84:87], v[144:147]
s_waitcnt lgkmcnt(8)
v_mfma_f32_16x16x32_bf16 v[136:139], v[88:91], v[100:103], v[136:139]
v_mfma_f32_16x16x32_bf16 v[140:143], v[92:95], v[100:103], v[140:143]
v_mfma_f32_16x16x32_bf16 v[144:147], v[96:99], v[100:103], v[144:147]
s_waitcnt lgkmcnt(4)
v_mfma_f32_16x16x32_bf16 v[136:139], v[104:107], v[116:119], v[136:139]
v_mfma_f32_16x16x32_bf16 v[140:143], v[108:111], v[116:119], v[140:143]
v_mfma_f32_16x16x32_bf16 v[144:147], v[112:115], v[116:119], v[144:147]
s_waitcnt lgkmcnt(0)
v_mfma_f32_16x16x32_bf16 v[136:139], v[120:123], v[132:135], v[136:139]
v_mfma_f32_16x16x32_bf16 v[140:143], v[124:127], v[132:135], v[140:143]
v_mfma_f32_16x16x32_bf16 v[144:147], v[128:131], v[132:135], v[144:147]
s_mul_i32 s30, s28, 3328
v_mul_u32_u24 v241, 208, v251
v_lshl_add_u32 v241, v252, 4, v241
v_add_u32 v241, s30, v241
s_nop 1
ds_write_b128 v241, v[136:139] offset:6272
ds_write_b128 v241, v[140:143] offset:6336
ds_write_b128 v241, v[144:147] offset:6400
s_waitcnt lgkmcnt(0)
mega_km_57:
s_cmp_eq_u64 s[78:79], 0
s_cbranch_scc1 mega_s3l_56
s_mov_b32 s39, 100000
s_mov_b64 exec, s[66:67]
buffer_load_dwordx4 v[46:49], v50, s[44:47], s80 offen sc1
s_mov_b64 exec, s[62:63]
s_waitcnt vmcnt(0)
mega_pl_58:
s_mov_b64 exec, s[66:67]
v_min_u32 v51, v46, v47
v_min3_u32 v51, v51, v48, v49
v_cmp_eq_u32 vcc, 0, v51
s_mov_b64 exec, s[62:63]
s_nop 3
s_cbranch_vccz mega_pe_59
s_sub_u32 s39, s39, 1
s_cmp_eq_u32 s39, 0
s_cbranch_scc1 mega_pe_59
s_sleep 2
s_mov_b64 exec, s[66:67]
buffer_load_dwordx4 v[46:49], v50, s[44:47], s80 offen sc1
s_mov_b64 exec, s[62:63]
s_waitcnt vmcnt(0)
s_branch mega_pl_58
mega_pe_59:
s_add_u32 s33, s81, 0
s_and_b32 s33, s33, 31
s_mul_i32 s33, s33, 18432
s_add_u32 m0, s37, 0
s_nop 0
buffer_load_dwordx4 v44, s[16:19], s33 offen offset:0 lds
buffer_load_dwordx4 v44, s[16:19], s33 offen offset:1024 lds
buffer_load_dwordx4 v44, s[16:19], s33 offen offset:2048 lds
buffer_load_dwordx4 v44, s[16:19], s33 offen offset:3072 lds
s_add_u32 m0, s37, 4096
s_add_u32 s33, s33, 4096
s_mov_b64 exec, s[66:67]
buffer_load_dwordx4 v44, s[16:19], s33 offen lds
s_mov_b64 exec, s[62:63]
mega_s3l_56:
s_barrier
s_add_u32 s33, s81, 1
s_and_b32 s33, s33, 31
s_mul_i32 s33, s33, 18432
s_add_u32 m0, s37, 34816
s_nop 0
buffer_load_dwordx4 v44, s[16:19], s33 offen offset:0 lds
buffer_load_dwordx4 v44, s[16:19], s33 offen offset:1024 lds
buffer_load_dwordx4 v44, s[16:19], s33 offen offset:2048 lds
buffer_load_dwordx4 v44, s[16:19], s33 offen offset:3072 lds
s_add_u32 m0, s37, 38912
s_add_u32 s33, s33, 4096
s_mov_b64 exec, s[66:67]
buffer_load_dwordx4 v44, s[16:19], s33 offen lds
s_mov_b64 exec, s[62:63]
s_add_u32 s32, s81, 1
s_and_b32 s32, s32, 31
s_lshl_b32 s32, s32, 7
s_add_u32 m0, s36, 34816
s_nop 0
buffer_load_dwordx4 v40, s[12:15], s32 offen lds
s_add_u32 m0, s36, 35840
s_nop 0
buffer_load_dwordx4 v41, s[12:15], s32 offen lds
s_add_u32 m0, s36, 36864
s_nop 0
buffer_load_dwordx4 v42, s[12:15], s32 offen lds
s_add_u32 m0, s36, 37888
s_nop 0
buffer_load_dwordx4 v43, s[12:15], s32 offen lds
s_waitcnt vmcnt(9)
s_barrier
s_add_u32 s33, s81, 2
s_and_b32 s33, s33, 31
s_mul_i32 s33, s33, 18432
s_add_u32 m0, s37, 69632
s_nop 0
buffer_load_dwordx4 v44, s[16:19], s33 offen offset:0 lds
buffer_load_dwordx4 v44, s[16:19], s33 offen offset:1024 lds
buffer_load_dwordx4 v44, s[16:19], s33 offen offset:2048 lds
buffer_load_dwordx4 v44, s[16:19], s33 offen offset:3072 lds
s_add_u32 m0, s37, 73728
s_add_u32 s33, s33, 4096
s_mov_b64 exec, s[66:67]
buffer_load_dwordx4 v44, s[16:19], s33 offen lds
s_mov_b64 exec, s[62:63]
s_add_u32 s32, s81, 2
s_and_b32 s32, s32, 31
s_lshl_b32 s32, s32, 7
s_add_u32 m0, s36, 69632
s_nop 0
buffer_load_dwordx4 v40, s[12:15], s32 offen lds
s_add_u32 m0, s36, 70656
s_nop 0
buffer_load_dwordx4 v41, s[12:15], s32 offen lds
s_add_u32 m0, s36, 71680
s_nop 0
buffer_load_dwordx4 v42, s[12:15], s32 offen lds
s_add_u32 m0, s36, 72704
s_nop 0
buffer_load_dwordx4 v43, s[12:15], s32 offen lds
s_add_u32 s33, s81, 3
s_and_b32 s33, s33, 31
s_mul_i32 s33, s33, 18432
s_add_u32 m0, s37, 104448
s_nop 0
buffer_load_dwordx4 v44, s[16:19], s33 offen offset:0 lds
buffer_load_dwordx4 v44, s[16:19], s33 offen offset:1024 lds
buffer_load_dwordx4 v44, s[16:19], s33 offen offset:2048 lds
buffer_load_dwordx4 v44, s[16:19], s33 offen offset:3072 lds
s_add_u32 m0, s37, 108544
s_add_u32 s33, s33, 4096
s_mov_b64 exec, s[66:67]
buffer_load_dwordx4 v44, s[16:19], s33 offen lds
s_mov_b64 exec, s[62:63]
s_add_u32 s32, s81, 3
s_and_b32 s32, s32, 31
s_lshl_b32 s32, s32, 7
s_add_u32 m0, s36, 104448
s_nop 0
buffer_load_dwordx4 v40, s[12:15], s32 offen lds
s_add_u32 m0, s36, 105472
s_nop 0
buffer_load_dwordx4 v41, s[12:15], s32 offen lds
s_add_u32 m0, s36, 106496
s_nop 0
buffer_load_dwordx4 v42, s[12:15], s32 offen lds
s_add_u32 m0, s36, 107520
s_nop 0
buffer_load_dwordx4 v43, s[12:15], s32 offen lds
s_setprio 0
s_waitcnt vmcnt(18)
s_barrier
s_add_u32 s33, s81, 4
s_and_b32 s33, s33, 31
s_mul_i32 s33, s33, 18432
s_add_u32 m0, s37, 0
s_nop 0
buffer_load_dwordx4 v44, s[16:19], s33 offen offset:0 lds
buffer_load_dwordx4 v44, s[16:19], s33 offen offset:1024 lds
buffer_load_dwordx4 v44, s[16:19], s33 offen offset:2048 lds
buffer_load_dwordx4 v44, s[16:19], s33 offen offset:3072 lds
s_add_u32 m0, s37, 4096
s_add_u32 s33, s33, 4096
s_mov_b64 exec, s[66:67]
buffer_load_dwordx4 v44, s[16:19], s33 offen lds
s_mov_b64 exec, s[62:63]
s_add_u32 s32, s81, 4
s_and_b32 s32, s32, 31
s_lshl_b32 s32, s32, 7
s_add_u32 m0, s36, 0
s_nop 0
buffer_load_dwordx4 v40, s[12:15], s32 offen lds
s_add_u32 m0, s36, 1024
s_nop 0
buffer_load_dwordx4 v41, s[12:15], s32 offen lds
s_add_u32 m0, s36, 2048
s_nop 0
buffer_load_dwordx4 v42, s[12:15], s32 offen lds
s_add_u32 m0, s36, 3072
s_nop 0
buffer_load_dwordx4 v43, s[12:15], s32 offen lds
s_waitcnt vmcnt(18)
s_barrier
s_add_u32 s33, s81, 5
s_and_b32 s33, s33, 31
s_mul_i32 s33, s33, 18432
s_add_u32 m0, s37, 34816
s_nop 0
buffer_load_dwordx4 v44, s[16:19], s33 offen offset:0 lds
buffer_load_dwordx4 v44, s[16:19], s33 offen offset:1024 lds
buffer_load_dwordx4 v44, s[16:19], s33 offen offset:2048 lds
buffer_load_dwordx4 v44, s[16:19], s33 offen offset:3072 lds
s_add_u32 m0, s37, 38912
s_add_u32 s33, s33, 4096
s_mov_b64 exec, s[66:67]
buffer_load_dwordx4 v44, s[16:19], s33 offen lds
s_mov_b64 exec, s[62:63]
s_add_u32 s32, s81, 5
s_and_b32 s32, s32, 31
s_lshl_b32 s32, s32, 7
s_add_u32 m0, s36, 34816
s_nop 0
buffer_load_dwordx4 v40, s[12:15], s32 offen lds
s_add_u32 m0, s36, 35840
s_nop 0
buffer_load_dwordx4 v41, s[12:15], s32 offen lds
s_add_u32 m0, s36, 36864
s_nop 0
buffer_load_dwordx4 v42, s[12:15], s32 offen lds
s_add_u32 m0, s36, 37888
s_nop 0
buffer_load_dwordx4 v43, s[12:15], s32 offen lds
s_cmp_eq_u32 s29, 7
s_cbranch_scc0 mega_ow_60
v_mov_b32 v234, 2
v_mov_b32 v235, s38
s_mov_b64 exec, 1
buffer_store_dword v234, v235, s[44:47], 0 offen sc1
s_mov_b64 exec, s[62:63]
mega_ow_60:
s_waitcnt vmcnt(18)
s_barrier
s_add_u32 s33, s81, 6
s_and_b32 s33, s33, 31
s_mul_i32 s33, s33, 18432
s_add_u32 m0, s37, 69632
s_nop 0
buffer_load_dwordx4 v44, s[16:19], s33 offen offset:0 lds
buffer_load_dwordx4 v44, s[16:19], s33 offen offset:1024 lds
buffer_load_dwordx4 v44, s[16:19], s33 offen offset:2048 lds
buffer_load_dwordx4 v44, s[16:19], s33 offen offset:3072 lds
s_add_u32 m0, s37, 73728
s_add_u32 s33, s33, 4096
s_mov_b64 exec, s[66:67]
buffer_load_dwordx4 v44, s[16:19], s33 offen lds
s_mov_b64 exec, s[62:63]
s_add_u32 s32, s81, 6
s_and_b32 s32, s32, 31
s_lshl_b32 s32, s32, 7
s_add_u32 m0, s36, 69632
s_nop 0
buffer_load_dwordx4 v40, s[12:15], s32 offen lds
s_add_u32 m0, s36, 70656
s_nop 0
buffer_load_dwordx4 v41, s[12:15], s32 offen lds
s_add_u32 m0, s36, 71680
s_nop 0
buffer_load_dwordx4 v42, s[12:15], s32 offen lds
s_add_u32 m0, s36, 72704
s_nop 0
buffer_load_dwordx4 v43, s[12:15], s32 offen lds
s_waitcnt vmcnt(18)
s_barrier
s_add_u32 s33, s81, 7
s_and_b32 s33, s33, 31
s_mul_i32 s33, s33, 18432
s_add_u32 m0, s37, 104448
s_nop 0
buffer_load_dwordx4 v44, s[16:19], s33 offen offset:0 lds
buffer_load_dwordx4 v44, s[16:19], s33 offen offset:1024 lds
buffer_load_dwordx4 v44, s[16:19], s33 offen offset:2048 lds
buffer_load_dwordx4 v44, s[16:19], s33 offen offset:3072 lds
s_add_u32 m0, s37, 108544
s_add_u32 s33, s33, 4096
s_mov_b64 exec, s[66:67]
buffer_load_dwordx4 v44, s[16:19], s33 offen lds
s_mov_b64 exec, s[62:63]
s_add_u32 s32, s81, 7
s_and_b32 s32, s32, 31
s_lshl_b32 s32, s32, 7
s_add_u32 m0, s36, 104448
s_nop 0
buffer_load_dwordx4 v40, s[12:15], s32 offen lds
s_add_u32 m0, s36, 105472
s_nop 0
buffer_load_dwordx4 v41, s[12:15], s32 offen lds
s_add_u32 m0, s36, 106496
s_nop 0
buffer_load_dwordx4 v42, s[12:15], s32 offen lds
s_add_u32 m0, s36, 107520
s_nop 0
buffer_load_dwordx4 v43, s[12:15], s32 offen lds
s_waitcnt vmcnt(18)
s_barrier
s_add_u32 s33, s81, 8
s_and_b32 s33, s33, 31
s_mul_i32 s33, s33, 18432
s_add_u32 m0, s37, 0
s_nop 0
buffer_load_dwordx4 v44, s[16:19], s33 offen offset:0 lds
buffer_load_dwordx4 v44, s[16:19], s33 offen offset:1024 lds
buffer_load_dwordx4 v44, s[16:19], s33 offen offset:2048 lds
buffer_load_dwordx4 v44, s[16:19], s33 offen offset:3072 lds
s_add_u32 m0, s37, 4096
s_add_u32 s33, s33, 4096
s_mov_b64 exec, s[66:67]
buffer_load_dwordx4 v44, s[16:19], s33 offen lds
s_mov_b64 exec, s[62:63]
s_add_u32 s32, s81, 8
s_and_b32 s32, s32, 31
s_lshl_b32 s32, s32, 7
s_add_u32 m0, s36, 0
s_nop 0
buffer_load_dwordx4 v40, s[12:15], s32 offen lds
s_add_u32 m0, s36, 1024
s_nop 0
buffer_load_dwordx4 v41, s[12:15], s32 offen lds
s_add_u32 m0, s36, 2048
s_nop 0
buffer_load_dwordx4 v42, s[12:15], s32 offen lds
s_add_u32 m0, s36, 3072
s_nop 0
buffer_load_dwordx4 v43, s[12:15], s32 offen lds
s_getpc_b64 s[72:73]
mega_gp:
s_add_u32 s72, s72, mega_gitab-mega_gp
s_addc_u32 s73, s73, 0
v_lshlrev_b32 v234, 3, v255
v_subrev_u32 v234, 2048, v234
global_load_dwordx2 v[210:211], v234, s[72:73] offset:0
global_load_ushort v204, v234, s[72:73] offset:8
global_load_dwordx2 v[214:215], v234, s[72:73] offset:2048
global_load_ushort v209, v234, s[72:73] offset:2056
s_waitcnt vmcnt(22)
s_barrier
s_add_u32 s33, s81, 9
s_and_b32 s33, s33, 31
s_mul_i32 s33, s33, 18432
s_add_u32 m0, s37, 34816
s_nop 0
buffer_load_dwordx4 v44, s[16:19], s33 offen offset:0 lds
buffer_load_dwordx4 v44, s[16:19], s33 offen offset:1024 lds
buffer_load_dwordx4 v44, s[16:19], s33 offen offset:2048 lds
buffer_load_dwordx4 v44, s[16:19], s33 offen offset:3072 lds
s_add_u32 m0, s37, 38912
s_add_u32 s33, s33, 4096
s_mov_b64 exec, s[66:67]
buffer_load_dwordx4 v44, s[16:19], s33 offen lds
s_mov_b64 exec, s[62:63]
s_add_u32 s32, s81, 9
s_and_b32 s32, s32, 31
s_lshl_b32 s32, s32, 7
s_add_u32 m0, s36, 34816
s_nop 0
buffer_load_dwordx4 v40, s[12:15], s32 offen lds
s_add_u32 m0, s36, 35840
s_nop 0
buffer_load_dwordx4 v41, s[12:15], s32 offen lds
s_add_u32 m0, s36, 36864
s_nop 0
buffer_load_dwordx4 v42, s[12:15], s32 offen lds
s_add_u32 m0, s36, 37888
s_nop 0
buffer_load_dwordx4 v43, s[12:15], s32 offen lds
s_waitcnt vmcnt(22)
s_barrier
s_add_u32 s33, s81, 10
s_and_b32 s33, s33, 31
s_mul_i32 s33, s33, 18432
s_add_u32 m0, s37, 69632
s_nop 0
buffer_load_dwordx4 v44, s[16:19], s33 offen offset:0 lds
buffer_load_dwordx4 v44, s[16:19], s33 offen offset:1024 lds
buffer_load_dwordx4 v44, s[16:19], s33 offen offset:2048 lds
buffer_load_dwordx4 v44, s[16:19], s33 offen offset:3072 lds
s_add_u32 m0, s37, 73728
s_add_u32 s33, s33, 4096
s_mov_b64 exec, s[66:67]
buffer_load_dwordx4 v44, s[16:19], s33 offen lds
s_mov_b64 exec, s[62:63]
s_add_u32 s32, s81, 10
s_and_b32 s32, s32, 31
s_lshl_b32 s32, s32, 7
s_add_u32 m0, s36, 69632
s_nop 0
buffer_load_dwordx4 v40, s[12:15], s32 offen lds
s_add_u32 m0, s36, 70656
s_nop 0
buffer_load_dwordx4 v41, s[12:15], s32 offen lds
s_add_u32 m0, s36, 71680
s_nop 0
buffer_load_dwordx4 v42, s[12:15], s32 offen lds
s_add_u32 m0, s36, 72704
s_nop 0
buffer_load_dwordx4 v43, s[12:15], s32 offen lds
s_waitcnt vmcnt(22)
s_barrier
s_add_u32 s33, s81, 11
s_and_b32 s33, s33, 31
s_mul_i32 s33, s33, 18432
s_add_u32 m0, s37, 104448
s_nop 0
buffer_load_dwordx4 v44, s[16:19], s33 offen offset:0 lds
buffer_load_dwordx4 v44, s[16:19], s33 offen offset:1024 lds
buffer_load_dwordx4 v44, s[16:19], s33 offen offset:2048 lds
buffer_load_dwordx4 v44, s[16:19], s33 offen offset:3072 lds
s_add_u32 m0, s37, 108544
s_add_u32 s33, s33, 4096
s_mov_b64 exec, s[66:67]
buffer_load_dwordx4 v44, s[16:19], s33 offen lds
s_mov_b64 exec, s[62:63]
s_add_u32 s32, s81, 11
s_and_b32 s32, s32, 31
s_lshl_b32 s32, s32, 7
s_add_u32 m0, s36, 104448
s_nop 0
buffer_load_dwordx4 v40, s[12:15], s32 offen lds
s_add_u32 m0, s36, 105472
s_nop 0
buffer_load_dwordx4 v41, s[12:15], s32 offen lds
s_add_u32 m0, s36, 106496
s_nop 0
buffer_load_dwordx4 v42, s[12:15], s32 offen lds
s_add_u32 m0, s36, 107520
s_nop 0
buffer_load_dwordx4 v43, s[12:15], s32 offen lds
s_waitcnt vmcnt(18)
s_barrier
s_add_u32 s33, s81, 12
s_and_b32 s33, s33, 31
s_mul_i32 s33, s33, 18432
s_add_u32 m0, s37, 0
s_nop 0
buffer_load_dwordx4 v44, s[16:19], s33 offen offset:0 lds
buffer_load_dwordx4 v44, s[16:19], s33 offen offset:1024 lds
buffer_load_dwordx4 v44, s[16:19], s33 offen offset:2048 lds
buffer_load_dwordx4 v44, s[16:19], s33 offen offset:3072 lds
s_add_u32 m0, s37, 4096
s_add_u32 s33, s33, 4096
s_mov_b64 exec, s[66:67]
buffer_load_dwordx4 v44, s[16:19], s33 offen lds
s_mov_b64 exec, s[62:63]
s_add_u32 s32, s81, 12
s_and_b32 s32, s32, 31
s_lshl_b32 s32, s32, 7
s_add_u32 m0, s36, 0
s_nop 0
buffer_load_dwordx4 v40, s[12:15], s32 offen lds
s_add_u32 m0, s36, 1024
s_nop 0
buffer_load_dwordx4 v41, s[12:15], s32 offen lds
s_add_u32 m0, s36, 2048
s_nop 0
buffer_load_dwordx4 v42, s[12:15], s32 offen lds
s_add_u32 m0, s36, 3072
s_nop 0
buffer_load_dwordx4 v43, s[12:15], s32 offen lds
s_waitcnt vmcnt(18)
s_barrier
s_add_u32 s33, s81, 13
s_and_b32 s33, s33, 31
s_mul_i32 s33, s33, 18432
s_add_u32 m0, s37, 34816
s_nop 0
buffer_load_dwordx4 v44, s[16:19], s33 offen offset:0 lds
buffer_load_dwordx4 v44, s[16:19], s33 offen offset:1024 lds
buffer_load_dwordx4 v44, s[16:19], s33 offen offset:2048 lds
buffer_load_dwordx4 v44, s[16:19], s33 offen offset:3072 lds
s_add_u32 m0, s37, 38912
s_add_u32 s33, s33, 4096
s_mov_b64 exec, s[66:67]
buffer_load_dwordx4 v44, s[16:19], s33 offen lds
s_mov_b64 exec, s[62:63]
s_add_u32 s32, s81, 13
s_and_b32 s32, s32, 31
s_lshl_b32 s32, s32, 7
s_add_u32 m0, s36, 34816
s_nop 0
buffer_load_dwordx4 v40, s[12:15], s32 offen lds
s_add_u32 m0, s36, 35840
s_nop 0
buffer_load_dwordx4 v41, s[12:15], s32 offen lds
s_add_u32 m0, s36, 36864
s_nop 0
buffer_load_dwordx4 v42, s[12:15], s32 offen lds
s_add_u32 m0, s36, 37888
s_nop 0
buffer_load_dwordx4 v43, s[12:15], s32 offen lds
s_waitcnt vmcnt(18)
s_barrier
s_add_u32 s33, s81, 14
s_and_b32 s33, s33, 31
s_mul_i32 s33, s33, 18432
s_add_u32 m0, s37, 69632
s_nop 0
buffer_load_dwordx4 v44, s[16:19], s33 offen offset:0 lds
buffer_load_dwordx4 v44, s[16:19], s33 offen offset:1024 lds
buffer_load_dwordx4 v44, s[16:19], s33 offen offset:2048 lds
buffer_load_dwordx4 v44, s[16:19], s33 offen offset:3072 lds
s_add_u32 m0, s37, 73728
s_add_u32 s33, s33, 4096
s_mov_b64 exec, s[66:67]
buffer_load_dwordx4 v44, s[16:19], s33 offen lds
s_mov_b64 exec, s[62:63]
s_add_u32 s32, s81, 14
s_and_b32 s32, s32, 31
s_lshl_b32 s32, s32, 7
s_add_u32 m0, s36, 69632
s_nop 0
buffer_load_dwordx4 v40, s[12:15], s32 offen lds
s_add_u32 m0, s36, 70656
s_nop 0
buffer_load_dwordx4 v41, s[12:15], s32 offen lds
s_add_u32 m0, s36, 71680
s_nop 0
buffer_load_dwordx4 v42, s[12:15], s32 offen lds
s_add_u32 m0, s36, 72704
s_nop 0
buffer_load_dwordx4 v43, s[12:15], s32 offen lds
s_waitcnt vmcnt(18)
s_barrier
s_add_u32 s33, s81, 15
s_and_b32 s33, s33, 31
s_mul_i32 s33, s33, 18432
s_add_u32 m0, s37, 104448
s_nop 0
buffer_load_dwordx4 v44, s[16:19], s33 offen offset:0 lds
buffer_load_dwordx4 v44, s[16:19], s33 offen offset:1024 lds
buffer_load_dwordx4 v44, s[16:19], s33 offen offset:2048 lds
buffer_load_dwordx4 v44, s[16:19], s33 offen offset:3072 lds
s_add_u32 m0, s37, 108544
s_add_u32 s33, s33, 4096
s_mov_b64 exec, s[66:67]
buffer_load_dwordx4 v44, s[16:19], s33 offen lds
s_mov_b64 exec, s[62:63]
s_add_u32 s32, s81, 15
s_and_b32 s32, s32, 31
s_lshl_b32 s32, s32, 7
s_add_u32 m0, s36, 104448
s_nop 0
buffer_load_dwordx4 v40, s[12:15], s32 offen lds
s_add_u32 m0, s36, 105472
s_nop 0
buffer_load_dwordx4 v41, s[12:15], s32 offen lds
s_add_u32 m0, s36, 106496
s_nop 0
buffer_load_dwordx4 v42, s[12:15], s32 offen lds
s_add_u32 m0, s36, 107520
s_nop 0
buffer_load_dwordx4 v43, s[12:15], s32 offen lds
s_waitcnt vmcnt(18)
s_barrier
s_cmp_eq_u32 s29, 7
s_cbranch_scc0 mega_ow_61
v_lshrrev_b32 v238, 2, v250
v_and_b32 v234, 3, v250
v_lshlrev_b32 v234, 4, v234
v_lshl_add_u32 v238, v238, 7, v234
s_mov_b32 s35, 262144
buffer_load_dwordx4 v[234:237], v238, s[44:47], s35 offen sc1
mega_ow_61:
s_add_u32 s33, s81, 16
s_and_b32 s33, s33, 31
s_mul_i32 s33, s33, 18432
s_add_u32 m0, s37, 0
s_nop 0
buffer_load_dwordx4 v44, s[16:19], s33 offen offset:0 lds
buffer_load_dwordx4 v44, s[16:19], s33 offen offset:1024 lds
buffer_load_dwordx4 v44, s[16:19], s33 offen offset:2048 lds
buffer_load_dwordx4 v44, s[16:19], s33 offen offset:3072 lds
s_add_u32 m0, s37, 4096
s_add_u32 s33, s33, 4096
s_mov_b64 exec, s[66:67]
buffer_load_dwordx4 v44, s[16:19], s33 offen lds
s_mov_b64 exec, s[62:63]
s_add_u32 s32, s81, 16
s_and_b32 s32, s32, 31
s_lshl_b32 s32, s32, 7
s_add_u32 m0, s36, 0
s_nop 0
buffer_load_dwordx4 v40, s[12:15], s32 offen lds
s_add_u32 m0, s36, 1024
s_nop 0
buffer_load_dwordx4 v41, s[12:15], s32 offen lds
s_add_u32 m0, s36, 2048
s_nop 0
buffer_load_dwordx4 v42, s[12:15], s32 offen lds
s_add_u32 m0, s36, 3072
s_nop 0
buffer_load_dwordx4 v43, s[12:15], s32 offen lds
v_and_b32 v200, 0xffff, v210
v_lshrrev_b32 v201, 16, v210
v_and_b32 v202, 0xffff, v211
v_lshrrev_b32 v203, 16, v211
v_and_b32 v205, 0xffff, v214
v_lshrrev_b32 v206, 16, v214
v_and_b32 v207, 0xffff, v215
v_lshrrev_b32 v208, 16, v215
s_waitcnt vmcnt(18)
s_barrier
s_cmp_eq_u32 s29, 7
s_cbranch_scc0 mega_ow_62
s_mov_b32 s39, 100000
s_waitcnt vmcnt(9)
mega_pl_63:
v_min_u32 v234, v234, v235
v_min3_u32 v234, v234, v236, v237
v_cmp_gt_u32 vcc, 2, v234
s_nop 4
s_cbranch_vccz mega_pe_64
s_sub_u32 s39, s39, 1
s_cmp_eq_u32 s39, 0
s_cbranch_scc1 mega_pe_64
s_sleep 8
buffer_load_dwordx4 v[234:237], v238, s[44:47], s35 offen sc1
s_waitcnt vmcnt(0)
s_branch mega_pl_63
mega_pe_64:
mega_ow_62:
s_add_u32 s33, s81, 17
s_and_b32 s33, s33, 31
s_mul_i32 s33, s33, 18432
s_add_u32 m0, s37, 34816
s_nop 0
buffer_load_dwordx4 v44, s[16:19], s33 offen offset:0 lds
buffer_load_dwordx4 v44, s[16:19], s33 offen offset:1024 lds
buffer_load_dwordx4 v44, s[16:19], s33 offen offset:2048 lds
buffer_load_dwordx4 v44, s[16:19], s33 offen offset:3072 lds
s_add_u32 m0, s37, 38912
s_add_u32 s33, s33, 4096
s_mov_b64 exec, s[66:67]
buffer_load_dwordx4 v44, s[16:19], s33 offen lds
s_mov_b64 exec, s[62:63]
s_add_u32 s32, s81, 17
s_and_b32 s32, s32, 31
s_lshl_b32 s32, s32, 7
s_add_u32 m0, s36, 34816
s_nop 0
buffer_load_dwordx4 v40, s[12:15], s32 offen lds
s_add_u32 m0, s36, 35840
s_nop 0
buffer_load_dwordx4 v41, s[12:15], s32 offen lds
s_add_u32 m0, s36, 36864
s_nop 0
buffer_load_dwordx4 v42, s[12:15], s32 offen lds
s_add_u32 m0, s36, 37888
s_nop 0
buffer_load_dwordx4 v43, s[12:15], s32 offen lds
s_waitcnt vmcnt(18)
s_barrier
s_add_u32 s33, s81, 18
s_and_b32 s33, s33, 31
s_mul_i32 s33, s33, 18432
s_add_u32 m0, s37, 69632
s_nop 0
buffer_load_dwordx4 v44, s[16:19], s33 offen offset:0 lds
buffer_load_dwordx4 v44, s[16:19], s33 offen offset:1024 lds
buffer_load_dwordx4 v44, s[16:19], s33 offen offset:2048 lds
buffer_load_dwordx4 v44, s[16:19], s33 offen offset:3072 lds
s_add_u32 m0, s37, 73728
s_add_u32 s33, s33, 4096
s_mov_b64 exec, s[66:67]
buffer_load_dwordx4 v44, s[16:19], s33 offen lds
s_mov_b64 exec, s[62:63]
s_add_u32 s32, s81, 18
s_and_b32 s32, s32, 31
s_lshl_b32 s32, s32, 7
s_add_u32 m0, s36, 69632
s_nop 0
buffer_load_dwordx4 v40, s[12:15], s32 offen lds
s_add_u32 m0, s36, 70656
s_nop 0
buffer_load_dwordx4 v41, s[12:15], s32 offen lds
s_add_u32 m0, s36, 71680
s_nop 0
buffer_load_dwordx4 v42, s[12:15], s32 offen lds
s_add_u32 m0, s36, 72704
s_nop 0
buffer_load_dwordx4 v43, s[12:15], s32 offen lds
s_waitcnt vmcnt(18)
s_barrier
s_add_u32 s33, s81, 19
s_and_b32 s33, s33, 31
s_mul_i32 s33, s33, 18432
s_add_u32 m0, s37, 104448
s_nop 0
buffer_load_dwordx4 v44, s[16:19], s33 offen offset:0 lds
buffer_load_dwordx4 v44, s[16:19], s33 offen offset:1024 lds
buffer_load_dwordx4 v44, s[16:19], s33 offen offset:2048 lds
buffer_load_dwordx4 v44, s[16:19], s33 offen offset:3072 lds
s_add_u32 m0, s37, 108544
s_add_u32 s33, s33, 4096
s_mov_b64 exec, s[66:67]
buffer_load_dwordx4 v44, s[16:19], s33 offen lds
s_mov_b64 exec, s[62:63]
s_add_u32 s32, s81, 19
s_and_b32 s32, s32, 31
s_lshl_b32 s32, s32, 7
s_add_u32 m0, s36, 104448
s_nop 0
buffer_load_dwordx4 v40, s[12:15], s32 offen lds
s_add_u32 m0, s36, 105472
s_nop 0
buffer_load_dwordx4 v41, s[12:15], s32 offen lds
s_add_u32 m0, s36, 106496
s_nop 0
buffer_load_dwordx4 v42, s[12:15], s32 offen lds
s_add_u32 m0, s36, 107520
s_nop 0
buffer_load_dwordx4 v43, s[12:15], s32 offen lds
s_waitcnt vmcnt(18)
s_barrier
s_add_u32 s33, s81, 20
s_and_b32 s33, s33, 31
s_mul_i32 s33, s33, 18432
s_add_u32 m0, s37, 0
s_nop 0
buffer_load_dwordx4 v44, s[16:19], s33 offen offset:0 lds
buffer_load_dwordx4 v44, s[16:19], s33 offen offset:1024 lds
buffer_load_dwordx4 v44, s[16:19], s33 offen offset:2048 lds
buffer_load_dwordx4 v44, s[16:19], s33 offen offset:3072 lds
s_add_u32 m0, s37, 4096
s_add_u32 s33, s33, 4096
s_mov_b64 exec, s[66:67]
buffer_load_dwordx4 v44, s[16:19], s33 offen lds
s_mov_b64 exec, s[62:63]
s_add_u32 s32, s81, 20
s_and_b32 s32, s32, 31
s_lshl_b32 s32, s32, 7
s_add_u32 m0, s36, 0
s_nop 0
buffer_load_dwordx4 v40, s[12:15], s32 offen lds
s_add_u32 m0, s36, 1024
s_nop 0
buffer_load_dwordx4 v41, s[12:15], s32 offen lds
s_add_u32 m0, s36, 2048
s_nop 0
buffer_load_dwordx4 v42, s[12:15], s32 offen lds
s_add_u32 m0, s36, 3072
s_nop 0
buffer_load_dwordx4 v43, s[12:15], s32 offen lds
s_waitcnt vmcnt(18)
s_barrier
s_add_u32 s33, s81, 21
s_and_b32 s33, s33, 31
s_mul_i32 s33, s33, 18432
s_add_u32 m0, s37, 34816
s_nop 0
buffer_load_dwordx4 v44, s[16:19], s33 offen offset:0 lds
buffer_load_dwordx4 v44, s[16:19], s33 offen offset:1024 lds
buffer_load_dwordx4 v44, s[16:19], s33 offen offset:2048 lds
buffer_load_dwordx4 v44, s[16:19], s33 offen offset:3072 lds
s_add_u32 m0, s37, 38912
s_add_u32 s33, s33, 4096
s_mov_b64 exec, s[66:67]
buffer_load_dwordx4 v44, s[16:19], s33 offen lds
s_mov_b64 exec, s[62:63]
s_add_u32 s32, s81, 21
s_and_b32 s32, s32, 31
s_lshl_b32 s32, s32, 7
s_add_u32 m0, s36, 34816
s_nop 0
buffer_load_dwordx4 v40, s[12:15], s32 offen lds
s_add_u32 m0, s36, 35840
s_nop 0
buffer_load_dwordx4 v41, s[12:15], s32 offen lds
s_add_u32 m0, s36, 36864
s_nop 0
buffer_load_dwordx4 v42, s[12:15], s32 offen lds
s_add_u32 m0, s36, 37888
s_nop 0
buffer_load_dwordx4 v43, s[12:15], s32 offen lds
s_waitcnt vmcnt(18)
s_barrier
s_add_u32 s33, s81, 22
s_and_b32 s33, s33, 31
s_mul_i32 s33, s33, 18432
s_add_u32 m0, s37, 69632
s_nop 0
buffer_load_dwordx4 v44, s[16:19], s33 offen offset:0 lds
buffer_load_dwordx4 v44, s[16:19], s33 offen offset:1024 lds
buffer_load_dwordx4 v44, s[16:19], s33 offen offset:2048 lds
buffer_load_dwordx4 v44, s[16:19], s33 offen offset:3072 lds
s_add_u32 m0, s37, 73728
s_add_u32 s33, s33, 4096
s_mov_b64 exec, s[66:67]
buffer_load_dwordx4 v44, s[16:19], s33 offen lds
s_mov_b64 exec, s[62:63]
s_add_u32 s32, s81, 22
s_and_b32 s32, s32, 31
s_lshl_b32 s32, s32, 7
s_add_u32 m0, s36, 69632
s_nop 0
buffer_load_dwordx4 v40, s[12:15], s32 offen lds
s_add_u32 m0, s36, 70656
s_nop 0
buffer_load_dwordx4 v41, s[12:15], s32 offen lds
s_add_u32 m0, s36, 71680
s_nop 0
buffer_load_dwordx4 v42, s[12:15], s32 offen lds
s_add_u32 m0, s36, 72704
s_nop 0
buffer_load_dwordx4 v43, s[12:15], s32 offen lds
s_waitcnt vmcnt(18)
s_barrier
s_add_u32 s33, s81, 23
s_and_b32 s33, s33, 31
s_mul_i32 s33, s33, 18432
s_add_u32 m0, s37, 104448
s_nop 0
buffer_load_dwordx4 v44, s[16:19], s33 offen offset:0 lds
buffer_load_dwordx4 v44, s[16:19], s33 offen offset:1024 lds
buffer_load_dwordx4 v44, s[16:19], s33 offen offset:2048 lds
buffer_load_dwordx4 v44, s[16:19], s33 offen offset:3072 lds
s_add_u32 m0, s37, 108544
s_add_u32 s33, s33, 4096
s_mov_b64 exec, s[66:67]
buffer_load_dwordx4 v44, s[16:19], s33 offen lds
s_mov_b64 exec, s[62:63]
s_add_u32 s32, s81, 23
s_and_b32 s32, s32, 31
s_lshl_b32 s32, s32, 7
s_add_u32 m0, s36, 104448
s_nop 0
buffer_load_dwordx4 v40, s[12:15], s32 offen lds
s_add_u32 m0, s36, 105472
s_nop 0
buffer_load_dwordx4 v41, s[12:15], s32 offen lds
s_add_u32 m0, s36, 106496
s_nop 0
buffer_load_dwordx4 v42, s[12:15], s32 offen lds
s_add_u32 m0, s36, 107520
s_nop 0
buffer_load_dwordx4 v43, s[12:15], s32 offen lds
s_waitcnt vmcnt(18)
s_barrier
s_add_u32 s33, s81, 24
s_and_b32 s33, s33, 31
s_mul_i32 s33, s33, 18432
s_add_u32 m0, s37, 0
s_nop 0
buffer_load_dwordx4 v44, s[16:19], s33 offen offset:0 lds
buffer_load_dwordx4 v44, s[16:19], s33 offen offset:1024 lds
buffer_load_dwordx4 v44, s[16:19], s33 offen offset:2048 lds
buffer_load_dwordx4 v44, s[16:19], s33 offen offset:3072 lds
s_add_u32 m0, s37, 4096
s_add_u32 s33, s33, 4096
s_mov_b64 exec, s[66:67]
buffer_load_dwordx4 v44, s[16:19], s33 offen lds
s_mov_b64 exec, s[62:63]
s_add_u32 s32, s81, 24
s_and_b32 s32, s32, 31
s_lshl_b32 s32, s32, 7
s_add_u32 m0, s36, 0
s_nop 0
buffer_load_dwordx4 v40, s[12:15], s32 offen lds
s_add_u32 m0, s36, 1024
s_nop 0
buffer_load_dwordx4 v41, s[12:15], s32 offen lds
s_add_u32 m0, s36, 2048
s_nop 0
buffer_load_dwordx4 v42, s[12:15], s32 offen lds
s_add_u32 m0, s36, 3072
s_nop 0
buffer_load_dwordx4 v43, s[12:15], s32 offen lds
s_waitcnt vmcnt(18)
s_barrier
s_add_u32 s33, s81, 25
s_and_b32 s33, s33, 31
s_mul_i32 s33, s33, 18432
s_add_u32 m0, s37, 34816
s_nop 0
buffer_load_dwordx4 v44, s[16:19], s33 offen offset:0 lds
buffer_load_dwordx4 v44, s[16:19], s33 offen offset:1024 lds
buffer_load_dwordx4 v44, s[16:19], s33 offen offset:2048 lds
buffer_load_dwordx4 v44, s[16:19], s33 offen offset:3072 lds
s_add_u32 m0, s37, 38912
s_add_u32 s33, s33, 4096
s_mov_b64 exec, s[66:67]
buffer_load_dwordx4 v44, s[16:19], s33 offen lds
s_mov_b64 exec, s[62:63]
s_add_u32 s32, s81, 25
s_and_b32 s32, s32, 31
s_lshl_b32 s32, s32, 7
s_add_u32 m0, s36, 34816
s_nop 0
buffer_load_dwordx4 v40, s[12:15], s32 offen lds
s_add_u32 m0, s36, 35840
s_nop 0
buffer_load_dwordx4 v41, s[12:15], s32 offen lds
s_add_u32 m0, s36, 36864
s_nop 0
buffer_load_dwordx4 v42, s[12:15], s32 offen lds
s_add_u32 m0, s36, 37888
s_nop 0
buffer_load_dwordx4 v43, s[12:15], s32 offen lds
s_waitcnt vmcnt(18)
s_barrier
s_add_u32 s33, s81, 26
s_and_b32 s33, s33, 31
s_mul_i32 s33, s33, 18432
s_add_u32 m0, s37, 69632
s_nop 0
buffer_load_dwordx4 v44, s[16:19], s33 offen offset:0 lds
buffer_load_dwordx4 v44, s[16:19], s33 offen offset:1024 lds
buffer_load_dwordx4 v44, s[16:19], s33 offen offset:2048 lds
buffer_load_dwordx4 v44, s[16:19], s33 offen offset:3072 lds
s_add_u32 m0, s37, 73728
s_add_u32 s33, s33, 4096
s_mov_b64 exec, s[66:67]
buffer_load_dwordx4 v44, s[16:19], s33 offen lds
s_mov_b64 exec, s[62:63]
s_add_u32 s32, s81, 26
s_and_b32 s32, s32, 31
s_lshl_b32 s32, s32, 7
s_add_u32 m0, s36, 69632
s_nop 0
buffer_load_dwordx4 v40, s[12:15], s32 offen lds
s_add_u32 m0, s36, 70656
s_nop 0
buffer_load_dwordx4 v41, s[12:15], s32 offen lds
s_add_u32 m0, s36, 71680
s_nop 0
buffer_load_dwordx4 v42, s[12:15], s32 offen lds
s_add_u32 m0, s36, 72704
s_nop 0
buffer_load_dwordx4 v43, s[12:15], s32 offen lds
s_waitcnt vmcnt(18)
s_barrier
s_add_u32 s33, s81, 27
s_and_b32 s33, s33, 31
s_mul_i32 s33, s33, 18432
s_add_u32 m0, s37, 104448
s_nop 0
buffer_load_dwordx4 v44, s[16:19], s33 offen offset:0 lds
buffer_load_dwordx4 v44, s[16:19], s33 offen offset:1024 lds
buffer_load_dwordx4 v44, s[16:19], s33 offen offset:2048 lds
buffer_load_dwordx4 v44, s[16:19], s33 offen offset:3072 lds
s_add_u32 m0, s37, 108544
s_add_u32 s33, s33, 4096
s_mov_b64 exec, s[66:67]
buffer_load_dwordx4 v44, s[16:19], s33 offen lds
s_mov_b64 exec, s[62:63]
s_add_u32 s32, s81, 27
s_and_b32 s32, s32, 31
s_lshl_b32 s32, s32, 7
s_add_u32 m0, s36, 104448
s_nop 0
buffer_load_dwordx4 v40, s[12:15], s32 offen lds
s_add_u32 m0, s36, 105472
s_nop 0
buffer_load_dwordx4 v41, s[12:15], s32 offen lds
s_add_u32 m0, s36, 106496
s_nop 0
buffer_load_dwordx4 v42, s[12:15], s32 offen lds
s_add_u32 m0, s36, 107520
s_nop 0
buffer_load_dwordx4 v43, s[12:15], s32 offen lds
s_waitcnt vmcnt(18)
s_barrier
s_add_u32 s33, s81, 28
s_and_b32 s33, s33, 31
s_mul_i32 s33, s33, 18432
s_add_u32 m0, s37, 0
s_nop 0
buffer_load_dwordx4 v44, s[16:19], s33 offen offset:0 lds
buffer_load_dwordx4 v44, s[16:19], s33 offen offset:1024 lds
buffer_load_dwordx4 v44, s[16:19], s33 offen offset:2048 lds
buffer_load_dwordx4 v44, s[16:19], s33 offen offset:3072 lds
s_add_u32 m0, s37, 4096
s_add_u32 s33, s33, 4096
s_mov_b64 exec, s[66:67]
buffer_load_dwordx4 v44, s[16:19], s33 offen lds
s_mov_b64 exec, s[62:63]
s_add_u32 s32, s81, 28
s_and_b32 s32, s32, 31
s_lshl_b32 s32, s32, 7
s_add_u32 m0, s36, 0
s_nop 0
buffer_load_dwordx4 v40, s[12:15], s32 offen lds
s_add_u32 m0, s36, 1024
s_nop 0
buffer_load_dwordx4 v41, s[12:15], s32 offen lds
s_add_u32 m0, s36, 2048
s_nop 0
buffer_load_dwordx4 v42, s[12:15], s32 offen lds
s_add_u32 m0, s36, 3072
s_nop 0
buffer_load_dwordx4 v43, s[12:15], s32 offen lds
s_waitcnt vmcnt(18)
s_barrier
s_add_u32 s33, s81, 29
s_and_b32 s33, s33, 31
s_mul_i32 s33, s33, 18432
s_add_u32 m0, s37, 34816
s_nop 0
buffer_load_dwordx4 v44, s[16:19], s33 offen offset:0 lds
buffer_load_dwordx4 v44, s[16:19], s33 offen offset:1024 lds
buffer_load_dwordx4 v44, s[16:19], s33 offen offset:2048 lds
buffer_load_dwordx4 v44, s[16:19], s33 offen offset:3072 lds
s_add_u32 m0, s37, 38912
s_add_u32 s33, s33, 4096
s_mov_b64 exec, s[66:67]
buffer_load_dwordx4 v44, s[16:19], s33 offen lds
s_mov_b64 exec, s[62:63]
s_add_u32 s32, s81, 29
s_and_b32 s32, s32, 31
s_lshl_b32 s32, s32, 7
s_add_u32 m0, s36, 34816
s_nop 0
buffer_load_dwordx4 v40, s[12:15], s32 offen lds
s_add_u32 m0, s36, 35840
s_nop 0
buffer_load_dwordx4 v41, s[12:15], s32 offen lds
s_add_u32 m0, s36, 36864
s_nop 0
buffer_load_dwordx4 v42, s[12:15], s32 offen lds
s_add_u32 m0, s36, 37888
s_nop 0
buffer_load_dwordx4 v43, s[12:15], s32 offen lds
s_waitcnt vmcnt(18)
s_barrier
s_add_u32 s33, s81, 30
s_and_b32 s33, s33, 31
s_mul_i32 s33, s33, 18432
s_add_u32 m0, s37, 69632
s_nop 0
buffer_load_dwordx4 v44, s[16:19], s33 offen offset:0 lds
buffer_load_dwordx4 v44, s[16:19], s33 offen offset:1024 lds
buffer_load_dwordx4 v44, s[16:19], s33 offen offset:2048 lds
buffer_load_dwordx4 v44, s[16:19], s33 offen offset:3072 lds
s_add_u32 m0, s37, 73728
s_add_u32 s33, s33, 4096
s_mov_b64 exec, s[66:67]
buffer_load_dwordx4 v44, s[16:19], s33 offen lds
s_mov_b64 exec, s[62:63]
s_add_u32 s32, s81, 30
s_and_b32 s32, s32, 31
s_lshl_b32 s32, s32, 7
s_add_u32 m0, s36, 69632
s_nop 0
buffer_load_dwordx4 v40, s[12:15], s32 offen lds
s_add_u32 m0, s36, 70656
s_nop 0
buffer_load_dwordx4 v41, s[12:15], s32 offen lds
s_add_u32 m0, s36, 71680
s_nop 0
buffer_load_dwordx4 v42, s[12:15], s32 offen lds
s_add_u32 m0, s36, 72704
s_nop 0
buffer_load_dwordx4 v43, s[12:15], s32 offen lds
s_waitcnt vmcnt(18)
s_barrier
s_add_u32 s33, s81, 31
s_and_b32 s33, s33, 31
s_mul_i32 s33, s33, 18432
s_add_u32 m0, s37, 104448
s_nop 0
buffer_load_dwordx4 v44, s[16:19], s33 offen offset:0 lds
buffer_load_dwordx4 v44, s[16:19], s33 offen offset:1024 lds
buffer_load_dwordx4 v44, s[16:19], s33 offen offset:2048 lds
buffer_load_dwordx4 v44, s[16:19], s33 offen offset:3072 lds
s_add_u32 m0, s37, 108544
s_add_u32 s33, s33, 4096
s_mov_b64 exec, s[66:67]
buffer_load_dwordx4 v44, s[16:19], s33 offen lds
s_mov_b64 exec, s[62:63]
s_add_u32 s32, s81, 31
s_and_b32 s32, s32, 31
s_lshl_b32 s32, s32, 7
s_add_u32 m0, s36, 104448
s_nop 0
buffer_load_dwordx4 v40, s[12:15], s32 offen lds
s_add_u32 m0, s36, 105472
s_nop 0
buffer_load_dwordx4 v41, s[12:15], s32 offen lds
s_add_u32 m0, s36, 106496
s_nop 0
buffer_load_dwordx4 v42, s[12:15], s32 offen lds
s_add_u32 m0, s36, 107520
s_nop 0
buffer_load_dwordx4 v43, s[12:15], s32 offen lds
s_waitcnt vmcnt(18)
s_barrier
s_setprio 3
s_add_u32 s30, s2, 0
s_lshl_b32 s30, s30, 12
s_lshl_b32 s31, s28, 10
s_add_u32 s30, s30, s31
s_add_u32 m0, s31, 27552
s_nop 0
buffer_load_dwordx4 v253, s[52:55], s30 offen lds
ds_read_b32 v0, v200 offset:6272
ds_read_b32 v1, v201 offset:6272
ds_read_b32 v2, v202 offset:6272
ds_read_b32 v3, v203 offset:6272
ds_read_b32 v4, v204 offset:6272
ds_read_b32 v8, v205 offset:6272
ds_read_b32 v9, v206 offset:6272
ds_read_b32 v10, v207 offset:6272
ds_read_b32 v11, v208 offset:6272
ds_read_b32 v12, v209 offset:6272
v_mov_b32 v236, 0
v_mov_b32 v237, 0
ds_read_b32 v16, v236 offset:6272
v_lshlrev_b32 v234, 3, v255
v_add_u32 v234, 16640, v234
s_waitcnt lgkmcnt(6)
v_cvt_pk_bf16_f32 v6, v0, v1
v_cvt_pk_bf16_f32 v7, v2, v3
v_cvt_pk_bf16_f32 v0, v1, v2
v_cvt_pk_bf16_f32 v1, v3, v4
ds_write_b64 v234, v[6:7] offset:0
ds_write_b64 v234, v[0:1] offset:4160
s_waitcnt lgkmcnt(3)
v_cvt_pk_bf16_f32 v14, v8, v9
v_cvt_pk_bf16_f32 v15, v10, v11
v_cvt_pk_bf16_f32 v8, v9, v10
v_cvt_pk_bf16_f32 v9, v11, v12
ds_write_b64 v234, v[14:15] offset:2048
ds_write_b64 v234, v[8:9] offset:6208
v_cmp_gt_u32 vcc, 324, v255
s_nop 3
s_and_saveexec_b64 s[56:57], vcc
s_cbranch_execz mega_tl_65
ds_write_b64 v234, v[236:237] offset:8320
v_cmp_eq_u32 vcc, 256, v255
s_waitcnt lgkmcnt(5)
v_cvt_pk_bf16_f32 v16, v16, v236
v_mov_b32 v17, 0
v_cndmask_b32 v16, v236, v16, vcc
v_cmp_gt_u32 vcc, 264, v255
s_nop 3
s_and_b64 exec, exec, vcc
s_cbranch_execz mega_tl_65
ds_write_b64 v234, v[16:17] offset:4096
ds_write_b64 v234, v[236:237] offset:8256
mega_tl_65:
s_mov_b64 exec, s[62:63]
s_waitcnt vmcnt(10)
s_barrier
s_add_u32 s30, s2, 256
s_lshl_b32 s30, s30, 12
s_lshl_b32 s31, s28, 10
s_add_u32 s30, s30, s31
s_add_u32 m0, s31, 40864
s_nop 0
buffer_load_dwordx4 v253, s[52:55], s30 offen lds
ds_read_b32 v0, v200 offset:9600
ds_read_b32 v1, v201 offset:9600
ds_read_b32 v2, v202 offset:9600
ds_read_b32 v3, v203 offset:9600
ds_read_b32 v4, v204 offset:9600
ds_read_b32 v8, v205 offset:9600
ds_read_b32 v9, v206 offset:9600
ds_read_b32 v10, v207 offset:9600
ds_read_b32 v11, v208 offset:9600
ds_read_b32 v12, v209 offset:9600
v_mov_b32 v236, 0
v_mov_b32 v237, 0
ds_read_b32 v16, v236 offset:9600
v_lshlrev_b32 v234, 3, v255
v_add_u32 v234, 29952, v234
s_waitcnt lgkmcnt(6)
v_cvt_pk_bf16_f32 v6, v0, v1
v_cvt_pk_bf16_f32 v7, v2, v3
v_cvt_pk_bf16_f32 v0, v1, v2
v_cvt_pk_bf16_f32 v1, v3, v4
ds_write_b64 v234, v[6:7] offset:0
ds_write_b64 v234, v[0:1] offset:4160
s_waitcnt lgkmcnt(3)
v_cvt_pk_bf16_f32 v14, v8, v9
v_cvt_pk_bf16_f32 v15, v10, v11
v_cvt_pk_bf16_f32 v8, v9, v10
v_cvt_pk_bf16_f32 v9, v11, v12
ds_write_b64 v234, v[14:15] offset:2048
ds_write_b64 v234, v[8:9] offset:6208
v_cmp_gt_u32 vcc, 324, v255
s_nop 3
s_and_saveexec_b64 s[56:57], vcc
s_cbranch_execz mega_tl_66
ds_write_b64 v234, v[236:237] offset:8320
v_cmp_eq_u32 vcc, 256, v255
s_waitcnt lgkmcnt(5)
v_cvt_pk_bf16_f32 v16, v16, v236
v_mov_b32 v17, 0
v_cndmask_b32 v16, v236, v16, vcc
v_cmp_gt_u32 vcc, 264, v255
s_nop 3
s_and_b64 exec, exec, vcc
s_cbranch_execz mega_tl_66
ds_write_b64 v234, v[16:17] offset:4096
ds_write_b64 v234, v[236:237] offset:8256
mega_tl_66:
s_mov_b64 exec, s[62:63]
s_waitcnt vmcnt(2)
s_barrier
v_mov_b32 v234, 83200
v_lshl_add_u32 v234, v251, 2, v234
v_mov_b32 v235, 0
ds_write_b32 v234, v235
s_cmp_lt_u32 s2, 64
s_cbranch_scc0 mega_c2_67
s_add_u32 s30, s2, 512
s_lshl_b32 s30, s30, 12
s_lshl_b32 s31, s28, 10
s_add_u32 s30, s30, s31
s_add_u32 m0, s31, 62368
s_nop 0
buffer_load_dwordx4 v253, s[52:55], s30 offen lds
ds_read_b32 v0, v200 offset:12928
ds_read_b32 v1, v201 offset:12928
ds_read_b32 v2, v202 offset:12928
ds_read_b32 v3, v203 offset:12928
ds_read_b32 v4, v204 offset:12928
ds_read_b32 v8, v205 offset:12928
ds_read_b32 v9, v206 offset:12928
ds_read_b32 v10, v207 offset:12928
ds_read_b32 v11, v208 offset:12928
ds_read_b32 v12, v209 offset:12928
v_mov_b32 v236, 0
v_mov_b32 v237, 0
ds_read_b32 v16, v236 offset:12928
v_lshlrev_b32 v234, 3, v255
v_add_u32 v234, 51456, v234
s_waitcnt lgkmcnt(6)
v_cvt_pk_bf16_f32 v6, v0, v1
v_cvt_pk_bf16_f32 v7, v2, v3
v_cvt_pk_bf16_f32 v0, v1, v2
v_cvt_pk_bf16_f32 v1, v3, v4
ds_write_b64 v234, v[6:7] offset:0
ds_write_b64 v234, v[0:1] offset:4160
s_waitcnt lgkmcnt(3)
v_cvt_pk_bf16_f32 v14, v8, v9
v_cvt_pk_bf16_f32 v15, v10, v11
v_cvt_pk_bf16_f32 v8, v9, v10
v_cvt_pk_bf16_f32 v9, v11, v12
ds_write_b64 v234, v[14:15] offset:2048
ds_write_b64 v234, v[8:9] offset:6208
v_cmp_gt_u32 vcc, 324, v255
s_nop 3
s_and_saveexec_b64 s[56:57], vcc
s_cbranch_execz mega_tl_68
ds_write_b64 v234, v[236:237] offset:8320
v_cmp_eq_u32 vcc, 256, v255
s_waitcnt lgkmcnt(5)
v_cvt_pk_bf16_f32 v16, v16, v236
v_mov_b32 v17, 0
v_cndmask_b32 v16, v236, v16, vcc
v_cmp_gt_u32 vcc, 264, v255
s_nop 3
s_and_b64 exec, exec, vcc
s_cbranch_execz mega_tl_68
ds_write_b64 v234, v[16:17] offset:4096
ds_write_b64 v234, v[236:237] offset:8256
mega_tl_68:
s_mov_b64 exec, s[62:63]
mega_c2_67:
s_waitcnt vmcnt(0) lgkmcnt(0)
s_barrier
s_mov_b32 s48, s10
s_and_b32 s49, s11, 0xffff
s_mov_b32 s50, 1152
s_mov_b32 s51, 0x20000
s_add_u32 s52, s8, 30932992
s_addc_u32 s53, s9, 0
s_and_b32 s53, s53, 0xffff
s_mov_b32 s54, 2359296
s_mov_b32 s55, 0x20000
s_add_u32 s20, s8, 30932992
s_addc_u32 s21, s9, 0
s_and_b32 s21, s21, 0xffff
s_mov_b32 s22, 2359296
s_mov_b32 s23, 0x20000
s_setprio 3
s_lshr_b32 s30, s28, 1
s_lshl_b32 s70, s30, 8
s_add_u32 s70, s70, s2
s_mul_i32 s71, s30, 13312
s_add_u32 s71, s71, 18688
s_mul_i32 s74, s30, 21504
s_add_u32 s74, s74, 45312
s_lshl_b32 s75, s30, 3
s_add_u32 s75, s75, 83200
s_and_b32 s76, s29, 1
s_lshl_b32 s72, s70, 12
s_lshl_b32 s30, s70, 1
v_mov_b32 v220, s30
buffer_load_ushort v215, v220, s[48:51], 0 offen
s_lshl_b32 s73, s76, 7
s_sub_u32 s73, s71, s73
v_lshlrev_b32 v220, 5, v251
v_lshl_add_u32 v221, v252, 4, v220
s_add_u32 s31, s73, 8576
v_add_u32 v212, s31, v221
v_lshl_add_u32 v214, v252, 3, v220
v_add_u32 v220, 1, v251
v_lshrrev_b32 v220, 1, v220
v_lshlrev_b32 v221, 2, v252
v_sub_u32 v220, v221, v220
v_lshlrev_b32 v220, 2, v220
v_and_b32 v221, 1, v251
v_mul_u32_u24 v221, 4160, v221
v_add_u32 v220, v220, v221
s_add_u32 s31, s73, 3296
v_add_u32 v216, s31, v220
v_subrev_u32 v217, 1024, v216
v_subrev_u32 v218, 2048, v216
v_subrev_u32 v219, 3072, v216
v_mov_b32 v0, 0
v_mov_b32 v1, 0
v_mov_b32 v2, 0
v_mov_b32 v3, 0
v_mov_b32 v4, 0
v_mov_b32 v5, 0
v_mov_b32 v6, 0
v_mov_b32 v7, 0
v_mov_b32 v8, 0
v_mov_b32 v9, 0
v_mov_b32 v10, 0
v_mov_b32 v11, 0
v_mov_b32 v12, 0
v_mov_b32 v13, 0
v_mov_b32 v14, 0
v_mov_b32 v15, 0
v_mov_b32 v16, 0
v_mov_b32 v17, 0
v_mov_b32 v18, 0
v_mov_b32 v19, 0
v_mov_b32 v20, 0
v_mov_b32 v21, 0
v_mov_b32 v22, 0
v_mov_b32 v23, 0
v_mov_b32 v24, 0
v_mov_b32 v25, 0
v_mov_b32 v26, 0
v_mov_b32 v27, 0
v_mov_b32 v28, 0
v_mov_b32 v29, 0
v_mov_b32 v30, 0
v_mov_b32 v31, 0
s_mov_b32 s73, 2
mega_cvl_69:
ds_read2_b32 v[180:181], v216 offset0:192 offset1:193
ds_read2_b32 v[182:183], v216 offset0:194 offset1:195
ds_read_b128 v[120:123], v212 offset:256
ds_read_b128 v[128:131], v212 offset:768
ds_read_b128 v[136:139], v212 offset:1280
ds_read_b128 v[144:147], v212 offset:1792
ds_read_b128 v[152:155], v212 offset:2304
ds_read_b128 v[160:163], v212 offset:2816
ds_read_b128 v[168:171], v212 offset:3328
ds_read_b128 v[176:179], v212 offset:3840
ds_read2_b32 v[184:185], v216 offset0:128 offset1:129
ds_read2_b32 v[186:187], v216 offset0:130 offset1:131
s_waitcnt lgkmcnt(2)
v_mfma_f32_16x16x32_bf16 v[0:3], v[180:183], v[120:123], v[0:3]
ds_read_b128 v[116:119], v212 offset:0
v_mfma_f32_16x16x32_bf16 v[4:7], v[180:183], v[128:131], v[4:7]
ds_read_b128 v[124:127], v212 offset:512
v_mfma_f32_16x16x32_bf16 v[8:11], v[180:183], v[136:139], v[8:11]
ds_read_b128 v[132:135], v212 offset:1024
v_mfma_f32_16x16x32_bf16 v[12:15], v[180:183], v[144:147], v[12:15]
ds_read_b128 v[140:143], v212 offset:1536
v_mfma_f32_16x16x32_bf16 v[16:19], v[180:183], v[152:155], v[16:19]
ds_read_b128 v[148:151], v212 offset:2048
v_mfma_f32_16x16x32_bf16 v[20:23], v[180:183], v[160:163], v[20:23]
ds_read_b128 v[156:159], v212 offset:2560
v_mfma_f32_16x16x32_bf16 v[24:27], v[180:183], v[168:171], v[24:27]
ds_read_b128 v[164:167], v212 offset:3072
v_mfma_f32_16x16x32_bf16 v[28:31], v[180:183], v[176:179], v[28:31]
ds_read_b128 v[172:175], v212 offset:3584
ds_read2_b32 v[188:189], v216 offset0:64 offset1:65
ds_read2_b32 v[190:191], v216 offset0:66 offset1:67
ds_read2_b32 v[192:193], v216 offset0:0 offset1:1
ds_read2_b32 v[194:195], v216 offset0:2 offset1:3
s_waitcnt lgkmcnt(4)
v_mfma_f32_16x16x32_bf16 v[0:3], v[184:187], v[116:119], v[0:3]
ds_read2_b32 v[196:197], v217 offset0:192 offset1:193
ds_read2_b32 v[198:199], v217 offset0:194 offset1:195
v_mfma_f32_16x16x32_bf16 v[4:7], v[184:187], v[124:127], v[4:7]
v_mfma_f32_16x16x32_bf16 v[8:11], v[184:187], v[132:135], v[8:11]
v_mfma_f32_16x16x32_bf16 v[12:15], v[184:187], v[140:143], v[12:15]
v_mfma_f32_16x16x32_bf16 v[16:19], v[184:187], v[148:151], v[16:19]
v_mfma_f32_16x16x32_bf16 v[20:23], v[184:187], v[156:159], v[20:23]
v_mfma_f32_16x16x32_bf16 v[24:27], v[184:187], v[164:167], v[24:27]
v_mfma_f32_16x16x32_bf16 v[28:31], v[184:187], v[172:175], v[28:31]
s_waitcnt lgkmcnt(4)
v_mfma_f32_16x16x32_bf16 v[4:7], v[188:191], v[120:123], v[4:7]
ds_read2_b32 v[200:201], v217 offset0:128 offset1:129
ds_read2_b32 v[202:203], v217 offset0:130 offset1:131
v_mfma_f32_16x16x32_bf16 v[8:11], v[188:191], v[128:131], v[8:11]
v_mfma_f32_16x16x32_bf16 v[12:15], v[188:191], v[136:139], v[12:15]
v_mfma_f32_16x16x32_bf16 v[16:19], v[188:191], v[144:147], v[16:19]
v_mfma_f32_16x16x32_bf16 v[20:23], v[188:191], v[152:155], v[20:23]
v_mfma_f32_16x16x32_bf16 v[24:27], v[188:191], v[160:163], v[24:27]
v_mfma_f32_16x16x32_bf16 v[28:31], v[188:191], v[168:171], v[28:31]
s_waitcnt lgkmcnt(4)
v_mfma_f32_16x16x32_bf16 v[4:7], v[192:195], v[116:119], v[4:7]
ds_read2_b32 v[204:205], v217 offset0:64 offset1:65
ds_read2_b32 v[206:207], v217 offset0:66 offset1:67
v_mfma_f32_16x16x32_bf16 v[8:11], v[192:195], v[124:127], v[8:11]
v_mfma_f32_16x16x32_bf16 v[12:15], v[192:195], v[132:135], v[12:15]
v_mfma_f32_16x16x32_bf16 v[16:19], v[192:195], v[140:143], v[16:19]
v_mfma_f32_16x16x32_bf16 v[20:23], v[192:195], v[148:151], v[20:23]
v_mfma_f32_16x16x32_bf16 v[24:27], v[192:195], v[156:159], v[24:27]
v_mfma_f32_16x16x32_bf16 v[28:31], v[192:195], v[164:167], v[28:31]
s_waitcnt lgkmcnt(4)
v_mfma_f32_16x16x32_bf16 v[8:11], v[196:199], v[120:123], v[8:11]
ds_read2_b32 v[208:209], v217 offset0:0 offset1:1
ds_read2_b32 v[210:211], v217 offset0:2 offset1:3
v_mfma_f32_16x16x32_bf16 v[12:15], v[196:199], v[128:131], v[12:15]
v_mfma_f32_16x16x32_bf16 v[16:19], v[196:199], v[136:139], v[16:19]
v_mfma_f32_16x16x32_bf16 v[20:23], v[196:199], v[144:147], v[20:23]
v_mfma_f32_16x16x32_bf16 v[24:27], v[196:199], v[152:155], v[24:27]
v_mfma_f32_16x16x32_bf16 v[28:31], v[196:199], v[160:163], v[28:31]
s_waitcnt lgkmcnt(4)
v_mfma_f32_16x16x32_bf16 v[8:11], v[200:203], v[116:119], v[8:11]
ds_read2_b32 v[180:181], v218 offset0:192 offset1:193
ds_read2_b32 v[182:183], v218 offset0:194 offset1:195
v_mfma_f32_16x16x32_bf16 v[12:15], v[200:203], v[124:127], v[12:15]
v_mfma_f32_16x16x32_bf16 v[16:19], v[200:203], v[132:135], v[16:19]
v_mfma_f32_16x16x32_bf16 v[20:23], v[200:203], v[140:143], v[20:23]
v_mfma_f32_16x16x32_bf16 v[24:27], v[200:203], v[148:151], v[24:27]
v_mfma_f32_16x16x32_bf16 v[28:31], v[200:203], v[156:159], v[28:31]
s_waitcnt lgkmcnt(4)
v_mfma_f32_16x16x32_bf16 v[12:15], v[204:207], v[120:123], v[12:15]
ds_read2_b32 v[184:185], v218 offset0:128 offset1:129
ds_read2_b32 v[186:187], v218 offset0:130 offset1:131
v_mfma_f32_16x16x32_bf16 v[16:19], v[204:207], v[128:131], v[16:19]
v_mfma_f32_16x16x32_bf16 v[20:23], v[204:207], v[136:139], v[20:23]
v_mfma_f32_16x16x32_bf16 v[24:27], v[204:207], v[144:147], v[24:27]
v_mfma_f32_16x16x32_bf16 v[28:31], v[204:207], v[152:155], v[28:31]
s_waitcnt lgkmcnt(4)
v_mfma_f32_16x16x32_bf16 v[12:15], v[208:211], v[116:119], v[12:15]
ds_read2_b32 v[188:189], v218 offset0:64 offset1:65
ds_read2_b32 v[190:191], v218 offset0:66 offset1:67
v_mfma_f32_16x16x32_bf16 v[16:19], v[208:211], v[124:127], v[16:19]
v_mfma_f32_16x16x32_bf16 v[20:23], v[208:211], v[132:135], v[20:23]
v_mfma_f32_16x16x32_bf16 v[24:27], v[208:211], v[140:143], v[24:27]
v_mfma_f32_16x16x32_bf16 v[28:31], v[208:211], v[148:151], v[28:31]
s_waitcnt lgkmcnt(4)
v_mfma_f32_16x16x32_bf16 v[16:19], v[180:183], v[120:123], v[16:19]
ds_read2_b32 v[192:193], v218 offset0:0 offset1:1
ds_read2_b32 v[194:195], v218 offset0:2 offset1:3
v_mfma_f32_16x16x32_bf16 v[20:23], v[180:183], v[128:131], v[20:23]
v_mfma_f32_16x16x32_bf16 v[24:27], v[180:183], v[136:139], v[24:27]
v_mfma_f32_16x16x32_bf16 v[28:31], v[180:183], v[144:147], v[28:31]
s_waitcnt lgkmcnt(4)
v_mfma_f32_16x16x32_bf16 v[16:19], v[184:187], v[116:119], v[16:19]
ds_read2_b32 v[196:197], v219 offset0:192 offset1:193
ds_read2_b32 v[198:199], v219 offset0:194 offset1:195
v_mfma_f32_16x16x32_bf16 v[20:23], v[184:187], v[124:127], v[20:23]
v_mfma_f32_16x16x32_bf16 v[24:27], v[184:187], v[132:135], v[24:27]
v_mfma_f32_16x16x32_bf16 v[28:31], v[184:187], v[140:143], v[28:31]
s_waitcnt lgkmcnt(4)
v_mfma_f32_16x16x32_bf16 v[20:23], v[188:191], v[120:123], v[20:23]
ds_read2_b32 v[200:201], v219 offset0:128 offset1:129
ds_read2_b32 v[202:203], v219 offset0:130 offset1:131
v_mfma_f32_16x16x32_bf16 v[24:27], v[188:191], v[128:131], v[24:27]
v_mfma_f32_16x16x32_bf16 v[28:31], v[188:191], v[136:139], v[28:31]
s_waitcnt lgkmcnt(4)
v_mfma_f32_16x16x32_bf16 v[20:23], v[192:195], v[116:119], v[20:23]
ds_read2_b32 v[204:205], v219 offset0:64 offset1:65
ds_read2_b32 v[206:207], v219 offset0:66 offset1:67
v_mfma_f32_16x16x32_bf16 v[24:27], v[192:195], v[124:127], v[24:27]
v_mfma_f32_16x16x32_bf16 v[28:31], v[192:195], v[132:135], v[28:31]
s_waitcnt lgkmcnt(4)
v_mfma_f32_16x16x32_bf16 v[24:27], v[196:199], v[120:123], v[24:27]
ds_read2_b32 v[208:209], v219 offset0:0 offset1:1
ds_read2_b32 v[210:211], v219 offset0:2 offset1:3
v_mfma_f32_16x16x32_bf16 v[28:31], v[196:199], v[128:131], v[28:31]
s_waitcnt lgkmcnt(4)
v_mfma_f32_16x16x32_bf16 v[24:27], v[200:203], v[116:119], v[24:27]
v_mfma_f32_16x16x32_bf16 v[28:31], v[200:203], v[124:127], v[28:31]
s_waitcnt lgkmcnt(2)
v_mfma_f32_16x16x32_bf16 v[28:31], v[204:207], v[120:123], v[28:31]
s_waitcnt lgkmcnt(0)
v_mfma_f32_16x16x32_bf16 v[28:31], v[208:211], v[116:119], v[28:31]
v_subrev_u32 v212, 64, v212
v_subrev_u32 v216, 64, v216
v_subrev_u32 v217, 64, v217
v_subrev_u32 v218, 64, v218
v_subrev_u32 v219, 64, v219
s_sub_u32 s73, s73, 1
s_cmp_lg_u32 s73, 0
s_cbranch_scc1 mega_cvl_69
s_lshl_b32 s30, s76, 12
s_add_u32 s31, s74, s30
s_xor_b32 s30, s30, 4096
s_add_u32 s30, s74, s30
v_add_u32 v226, s31, v253
v_add_u32 v227, s30, v253
s_lshl_b32 s30, s76, 11
s_add_u32 s30, s30, s71
s_add_u32 s30, s30, 8864
v_add_u32 v213, s30, v214
v_add_u32 v214, s31, v214
ds_read_b64 v[48:49], v213 offset:0
ds_read_b64 v[50:51], v213 offset:512
ds_read_b64 v[52:53], v213 offset:1024
ds_read_b64 v[54:55], v213 offset:1536
s_cmp_eq_u32 s76, 0
s_cbranch_scc0 mega_x1_70
ds_write_b128 v227, v[16:19] offset:0
ds_write_b128 v227, v[20:23] offset:1024
ds_write_b128 v227, v[24:27] offset:2048
ds_write_b128 v227, v[28:31] offset:3072
s_branch mega_x2_71
mega_x1_70:
s_nop 7
ds_write_b128 v227, v[0:3] offset:0
ds_write_b128 v227, v[4:7] offset:1024
ds_write_b128 v227, v[8:11] offset:2048
ds_write_b128 v227, v[12:15] offset:3072
v_mov_b32 v0, v16
v_mov_b32 v1, v17
v_mov_b32 v2, v18
v_mov_b32 v3, v19
v_mov_b32 v4, v20
v_mov_b32 v5, v21
v_mov_b32 v6, v22
v_mov_b32 v7, v23
v_mov_b32 v8, v24
v_mov_b32 v9, v25
v_mov_b32 v10, v26
v_mov_b32 v11, v27
v_mov_b32 v12, v28
v_mov_b32 v13, v29
v_mov_b32 v14, v30
v_mov_b32 v15, v31
mega_x2_71:
s_lshl_b32 s30, s76, 2
s_add_u32 s31, s75, s30
s_xor_b32 s30, s30, 4
s_add_u32 s30, s75, s30
v_mov_b32 v220, s30
v_mov_b32 v221, s31
v_mov_b32 v222, 1
s_waitcnt lgkmcnt(0)
ds_write_b32 v220, v222
s_mov_b32 s39, 800000
mega_xw_72:
ds_read_b32 v223, v221
s_waitcnt lgkmcnt(0)
v_cmp_eq_u32 vcc, 0, v223
s_nop 4
s_cbranch_vccz mega_xd_73
s_sub_u32 s39, s39, 1
s_cmp_lg_u32 s39, 0
s_cbranch_scc1 mega_xw_72
mega_xd_73:
ds_read_b128 v[32:35], v226 offset:0
ds_read_b128 v[36:39], v226 offset:1024
ds_read_b128 v[40:43], v226 offset:2048
ds_read_b128 v[44:47], v226 offset:3072
s_waitcnt vmcnt(0)
v_lshlrev_b32 v215, 16, v215
s_waitcnt lgkmcnt(0)
v_add_f32 v0, v0, v32
v_add_f32 v1, v1, v33
v_add_f32 v2, v2, v34
v_add_f32 v3, v3, v35
v_add_f32 v4, v4, v36
v_add_f32 v5, v5, v37
v_add_f32 v6, v6, v38
v_add_f32 v7, v7, v39
v_add_f32 v8, v8, v40
v_add_f32 v9, v9, v41
v_add_f32 v10, v10, v42
v_add_f32 v11, v11, v43
v_add_f32 v12, v12, v44
v_add_f32 v13, v13, v45
v_add_f32 v14, v14, v46
v_add_f32 v15, v15, v47
v_lshlrev_b32 v32, 16, v48
v_and_b32 v33, 0xffff0000, v48
v_lshlrev_b32 v34, 16, v49
v_and_b32 v35, 0xffff0000, v49
v_lshlrev_b32 v36, 16, v50
v_and_b32 v37, 0xffff0000, v50
v_lshlrev_b32 v38, 16, v51
v_and_b32 v39, 0xffff0000, v51
v_lshlrev_b32 v40, 16, v52
v_and_b32 v41, 0xffff0000, v52
v_lshlrev_b32 v42, 16, v53
v_and_b32 v43, 0xffff0000, v53
v_lshlrev_b32 v44, 16, v54
v_and_b32 v45, 0xffff0000, v54
v_lshlrev_b32 v46, 16, v55
v_and_b32 v47, 0xffff0000, v55
v_fmac_f32 v0, v32, v215
v_fmac_f32 v1, v33, v215
v_fmac_f32 v2, v34, v215
v_fmac_f32 v3, v35, v215
v_fmac_f32 v4, v36, v215
v_fmac_f32 v5, v37, v215
v_fmac_f32 v6, v38, v215
v_fmac_f32 v7, v39, v215
v_fmac_f32 v8, v40, v215
v_fmac_f32 v9, v41, v215
v_fmac_f32 v10, v42, v215
v_fmac_f32 v11, v43, v215
v_fmac_f32 v12, v44, v215
v_fmac_f32 v13, v45, v215
v_fmac_f32 v14, v46, v215
v_fmac_f32 v15, v47, v215
v_cvt_pk_bf16_f32 v32, v0, v1
v_cvt_pk_bf16_f32 v33, v2, v3
v_cvt_pk_bf16_f32 v34, v4, v5
v_cvt_pk_bf16_f32 v35, v6, v7
v_cvt_pk_bf16_f32 v36, v8, v9
v_cvt_pk_bf16_f32 v37, v10, v11
v_cvt_pk_bf16_f32 v38, v12, v13
v_cvt_pk_bf16_f32 v39, v14, v15
ds_write_b64 v214, v[32:33] offset:0
ds_write_b64 v214, v[34:35] offset:512
ds_write_b64 v214, v[36:37] offset:1024
ds_write_b64 v214, v[38:39] offset:1536
s_lshl_b32 s30, s76, 11
s_add_u32 s72, s72, s30
s_waitcnt lgkmcnt(0)
ds_read_b128 v[40:43], v226 offset:0
ds_read_b128 v[44:47], v226 offset:1024
s_waitcnt lgkmcnt(1)
buffer_store_dwordx4 v[40:43], v253, s[52:55], s72 offen offset:0 sc1
s_waitcnt lgkmcnt(0)
buffer_store_dwordx4 v[44:47], v253, s[52:55], s72 offen offset:1024 sc1
s_mul_i32 s30, s76, 6144
s_lshl_b32 s31, s70, 3
s_add_u32 s30, s30, s31
s_add_u32 s30, s30, 307200
s_waitcnt vmcnt(0)
v_mov_b32 v220, 1
v_mov_b32 v221, s30
s_mov_b64 exec, 1
buffer_store_dword v220, v221, s[44:47], 0 offen sc1
s_mov_b64 exec, s[62:63]
s_setprio 0
s_cmp_eq_u32 s29, 7
s_cbranch_scc0 mega_lend_74
s_and_b32 s24, s2, 7
s_lshr_b32 s25, s2, 3
s_and_b32 s70, s24, 1
s_lshl_b32 s70, s70, 1
s_bfe_u32 s71, s24, 0x10001
s_add_u32 s70, s70, s71
s_lshl_b32 s70, s70, 3
s_and_b32 s71, s25, 7
s_add_u32 s70, s70, s71
s_lshr_b32 s71, s24, 2
s_lshl_b32 s71, s71, 2
s_lshr_b32 s25, s25, 3
s_add_u32 s71, s71, s25
s_mul_i32 s73, s71, 9
s_lshr_b32 s73, s73, 1
v_min_u32 v238, 39, v250
v_lshlrev_b32 v238, 4, v238
s_lshl_b32 s35, s73, 7
s_lshr_b32 s30, s70, 4
s_mul_i32 s30, s30, 6144
s_add_u32 s35, s35, s30
s_add_u32 s35, s35, 307200
v_mov_b32 v242, 83232
s_mov_b32 s39, 800000
mega_yw_75:
ds_read_b32 v243, v242
s_waitcnt lgkmcnt(0)
v_cmp_eq_u32 vcc, 0, v243
s_nop 4
s_cbranch_vccz mega_yd_76
s_sub_u32 s39, s39, 1
s_cmp_lg_u32 s39, 0
s_sleep 4
s_cbranch_scc1 mega_yw_75
mega_yd_76:
s_mov_b32 s39, 100000
buffer_load_dwordx4 v[234:237], v238, s[44:47], s35 offen sc1
s_waitcnt vmcnt(0)
mega_pl_77:
v_min_u32 v234, v234, v236
v_cmp_eq_u32 vcc, 0, v234
s_nop 4
s_cbranch_vccz mega_pe_78
s_sub_u32 s39, s39, 1
s_cmp_eq_u32 s39, 0
s_cbranch_scc1 mega_pe_78
s_sleep 8
buffer_load_dwordx4 v[234:237], v238, s[44:47], s35 offen sc1
s_waitcnt vmcnt(0)
s_branch mega_pl_77
mega_pe_78:
v_lshrrev_b32 v234, 3, v250
v_and_b32 v235, 7, v250
v_lshlrev_b32 v235, 4, v235
v_lshl_add_u32 v234, v234, 12, v235
s_lshl_b32 s34, s73, 16
s_lshl_b32 s35, s70, 7
s_add_u32 s34, s34, s35
s_mov_b32 m0, 149760
s_nop 0
buffer_load_dwordx4 v234, s[20:23], s34 offen lds
s_add_u32 s34, s34, 32768
s_mov_b32 m0, 150784
s_nop 0
buffer_load_dwordx4 v234, s[20:23], s34 offen lds
s_add_u32 s34, s34, 32768
s_mov_b32 m0, 151808
s_nop 0
buffer_load_dwordx4 v234, s[20:23], s34 offen lds
s_add_u32 s34, s34, 32768
s_mov_b32 m0, 152832
s_nop 0
buffer_load_dwordx4 v234, s[20:23], s34 offen lds
s_add_u32 s34, s34, 32768
s_mov_b32 m0, 153856
s_nop 0
buffer_load_dwordx4 v234, s[20:23], s34 offen lds
s_add_u32 s34, s34, 32768
s_mov_b32 m0, 154880
s_nop 0
buffer_load_dwordx4 v234, s[20:23], s34 offen lds
s_add_u32 s34, s34, 32768
s_mov_b32 m0, 155904
s_nop 0
buffer_load_dwordx4 v234, s[20:23], s34 offen lds
s_add_u32 s34, s34, 32768
s_mov_b32 m0, 156928
s_nop 0
buffer_load_dwordx4 v234, s[20:23], s34 offen lds
s_add_u32 s34, s34, 32768
s_mov_b32 m0, 157952
s_nop 0
buffer_load_dwordx4 v234, s[20:23], s34 offen lds
s_add_u32 s34, s34, 32768
s_mov_b32 m0, 158976
s_nop 0
buffer_load_dwordx4 v234, s[20:23], s34 offen lds
s_add_u32 s34, s34, 32768
s_waitcnt vmcnt(0)
mega_lend_74:
s_endpgm
mega_end:
s_endpgm
.p2align 3
mega_gitab:
.short 160, 160, 160, 160, 160, 3276, 3276, 3276
.short 3276, 3276, 3276, 3276, 3068, 3068, 3068, 3068
.short 3068, 3068, 3068, 3068, 3068, 2860, 2860, 2860
.short 2860, 2860, 2860, 2860, 2652, 2652, 2652, 2652
.short 2652, 2652, 2652, 2652, 2652, 2444, 2444, 2444
.short 2444, 2444, 2444, 2444, 2236, 2236, 2236, 2236
.short 2236, 2236, 2236, 2236, 2236, 2028, 2028, 2028
.short 2028, 2028, 2028, 2028, 1820, 1820, 1820, 1820
.short 1820, 1820, 1820, 1820, 1820, 1612, 1612, 1612
.short 1612, 1612, 1612, 1612, 1404, 1404, 1404, 1404
.short 1404, 1404, 1404, 1404, 1404, 1196, 1196, 1196
.short 1196, 1196, 1196, 1196, 988, 988, 988, 988
.short 988, 988, 988, 988, 988, 780, 780, 780
.short 780, 780, 780, 780, 572, 572, 572, 572
.short 572, 572, 572, 572, 572, 364, 364, 364
.short 364, 364, 364, 364, 156, 156, 156, 156
.short 156, 156, 156, 156, 156, 3272, 3272, 3272
.short 3272, 3272, 3272, 3272, 3064, 3064, 3064, 3064
.short 3064, 3064, 3064, 3064, 3064, 2856, 2856, 2856
.short 2856, 2856, 2856, 2856, 2648, 2648, 2648, 2648
.short 2648, 2648, 2648, 2648, 2648, 2440, 2440, 2440
.short 2440, 2440, 2440, 2440, 2232, 2232, 2232, 2232
.short 2232, 2232, 2232, 2232, 2232, 2024, 2024, 2024
.short 2024, 2024, 2024, 2024, 1816, 1816, 1816, 1816
.short 1816, 1816, 1816, 1816, 1816, 1608, 1608, 1608
.short 1608, 1608, 1608, 1608, 1400, 1400, 1400, 1400
.short 1400, 1400, 1400, 1400, 1400, 1192, 1192, 1192
.short 1192, 1192, 1192, 1192, 984, 984, 984, 984
.short 984, 984, 984, 984, 984, 776, 776, 776
.short 776, 776, 776, 776, 568, 568, 568, 568
.short 568, 568, 568, 568, 568, 360, 360, 360
.short 360, 360, 360, 360, 152, 152, 152, 152
.short 152, 152, 152, 152, 152, 3268, 3268, 3268
.short 3268, 3268, 3268, 3268, 3060, 3060, 3060, 3060
.short 3060, 3060, 3060, 3060, 3060, 2852, 2852, 2852
.short 2852, 2852, 2852, 2852, 2644, 2644, 2644, 2644
.short 2644, 2644, 2644, 2644, 2644, 2436, 2436, 2436
.short 2436, 2436, 2436, 2436, 2228, 2228, 2228, 2228
.short 2228, 2228, 2228, 2228, 2228, 2020, 2020, 2020
.short 2020, 2020, 2020, 2020, 1812, 1812, 1812, 1812
.short 1812, 1812, 1812, 1812, 1812, 1604, 1604, 1604
.short 1604, 1604, 1604, 1604, 1396, 1396, 1396, 1396
.short 1396, 1396, 1396, 1396, 1396, 1188, 1188, 1188
.short 1188, 1188, 1188, 1188, 980, 980, 980, 980
.short 980, 980, 980, 980, 980, 772, 772, 772
.short 772, 772, 772, 772, 564, 564, 564, 564
.short 564, 564, 564, 564, 564, 356, 356, 356
.short 356, 356, 356, 356, 148, 148, 148, 148
.short 148, 148, 148, 148, 148, 3264, 3264, 3264
.short 3264, 3264, 3264, 3264, 3056, 3056, 3056, 3056
.short 3056, 3056, 3056, 3056, 3056, 2848, 2848, 2848
.short 2848, 2848, 2848, 2848, 2640, 2640, 2640, 2640
.short 2640, 2640, 2640, 2640, 2640, 2432, 2432, 2432
.short 2432, 2432, 2432, 2432, 2224, 2224, 2224, 2224
.short 2224, 2224, 2224, 2224, 2224, 2016, 2016, 2016
.short 2016, 2016, 2016, 2016, 1808, 1808, 1808, 1808
.short 1808, 1808, 1808, 1808, 1808, 1600, 1600, 1600
.short 1600, 1600, 1600, 1600, 1392, 1392, 1392, 1392
.short 1392, 1392, 1392, 1392, 1392, 1184, 1184, 1184
.short 1184, 1184, 1184, 1184, 976, 976, 976, 976
.short 976, 976, 976, 976, 976, 768, 768, 768
.short 768, 768, 768, 768, 560, 560, 560, 560
.short 560, 560, 560, 560, 560, 352, 352, 352
.short 352, 352, 352, 352, 144, 144, 144, 144
.short 144, 144, 144, 144, 144, 3260, 3260, 3260
.short 3260, 3260, 3260, 3260, 3052, 3052, 3052, 3052
.short 3052, 3052, 3052, 3052, 3052, 2844, 2844, 2844
.short 2844, 2844, 2844, 2844, 2636, 2636, 2636, 2636
.short 2636, 2636, 2636, 2636, 2636, 2428, 2428, 2428
.short 2428, 2428, 2428, 2428, 2220, 2220, 2220, 2220
.short 2220, 2220, 2220, 2220, 2220, 2012, 2012, 2012
.short 2012, 2012, 2012, 2012, 1804, 1804, 1804, 1804
.short 1804, 1804, 1804, 1804, 1804, 1596, 1596, 1596
.short 1596, 1596, 1596, 1596, 1388, 1388, 1388, 1388
.short 1388, 1388, 1388, 1388, 1388, 1180, 1180, 1180
.short 1180, 1180, 1180, 1180, 972, 972, 972, 972
.short 972, 972, 972, 972, 972, 764, 764, 764
.short 764, 764, 764, 764, 556, 556, 556, 556
.short 556, 556, 556, 556, 556, 348, 348, 348
.short 348, 348, 348, 348, 140, 140, 140, 140
.short 140, 140, 140, 140, 140, 3256, 3256, 3256
.short 3256, 3256, 3256, 3256, 3048, 3048, 3048, 3048
.short 3048, 3048, 3048, 3048, 3048, 2840, 2840, 2840
.short 2840, 2840, 2840, 2840, 2632, 2632, 2632, 2632
.short 2632, 2632, 2632, 2632, 2632, 2424, 2424, 2424
.short 2424, 2424, 2424, 2424, 2216, 2216, 2216, 2216
.short 2216, 2216, 2216, 2216, 2216, 2008, 2008, 2008
.short 2008, 2008, 2008, 2008, 1800, 1800, 1800, 1800
.short 1800, 1800, 1800, 1800, 1800, 1592, 1592, 1592
.short 1592, 1592, 1592, 1592, 1384, 1384, 1384, 1384
.short 1384, 1384, 1384, 1384, 1384, 1176, 1176, 1176
.short 1176, 1176, 1176, 1176, 968, 968, 968, 968
.short 968, 968, 968, 968, 968, 760, 760, 760
.short 760, 760, 760, 760, 552, 552, 552, 552
.short 552, 552, 552, 552, 552, 344, 344, 344
.short 344, 344, 344, 344, 136, 136, 136, 136
.short 136, 136, 136, 136, 136, 3252, 3252, 3252
.short 3252, 3252, 3252, 3252, 3044, 3044, 3044, 3044
.short 3044, 3044, 3044, 3044, 3044, 2836, 2836, 2836
.short 2836, 2836, 2836, 2836, 2628, 2628, 2628, 2628
.short 2628, 2628, 2628, 2628, 2628, 2420, 2420, 2420
.short 2420, 2420, 2420, 2420, 2212, 2212, 2212, 2212
.short 2212, 2212, 2212, 2212, 2212, 2004, 2004, 2004
.short 2004, 2004, 2004, 2004, 1796, 1796, 1796, 1796
.short 1796, 1796, 1796, 1796, 1796, 1588, 1588, 1588
.short 1588, 1588, 1588, 1588, 1380, 1380, 1380, 1380
.short 1380, 1380, 1380, 1380, 1380, 1172, 1172, 1172
.short 1172, 1172, 1172, 1172, 964, 964, 964, 964
.short 964, 964, 964, 964, 964, 756, 756, 756
.short 756, 756, 756, 756, 548, 548, 548, 548
.short 548, 548, 548, 548, 548, 340, 340, 340
.short 340, 340, 340, 340, 132, 132, 132, 132
.short 132, 132, 132, 132, 132, 3248, 3248, 3248
.short 3248, 3248, 3248, 3248, 3040, 3040, 3040, 3040
.short 3040, 3040, 3040, 3040, 3040, 2832, 2832, 2832
.short 2832, 2832, 2832, 2832, 2624, 2624, 2624, 2624
.short 2624, 2624, 2624, 2624, 2624, 2416, 2416, 2416
.short 2416, 2416, 2416, 2416, 2208, 2208, 2208, 2208
.short 2208, 2208, 2208, 2208, 2208, 2000, 2000, 2000
.short 2000, 2000, 2000, 2000, 1792, 1792, 1792, 1792
.short 1792, 1792, 1792, 1792, 1792, 1584, 1584, 1584
.short 1584, 1584, 1584, 1584, 1376, 1376, 1376, 1376
.short 1376, 1376, 1376, 1376, 1376, 1168, 1168, 1168
.short 1168, 1168, 1168, 1168, 960, 960, 960, 960
.short 960, 960, 960, 960, 960, 752, 752, 752
.short 752, 752, 752, 752, 544, 544, 544, 544
.short 544, 544, 544, 544, 544, 336, 336, 336
.short 336, 336, 336, 336, 128, 128, 128, 128
.short 128, 128, 128, 3244, 3244, 3244, 3240, 3240
.short 3240, 3240, 3240, 3036, 3036, 3036, 3032, 3032
.short 3032, 3032, 3032, 2828, 2828, 2828, 2824, 2824
.short 2824, 2824, 2824, 2620, 2620, 2620, 2616, 2616
.short 2616, 2616, 2616, 2412, 2412, 2412, 2408, 2408
.short 2408, 2408, 2408, 2204, 2204, 2204, 2200, 2200
.short 2200, 2200, 2200, 1996, 1996, 1996, 1992, 1992
.short 1992, 1992, 1992, 1788, 1788, 1788, 1784, 1784
.short 1784, 1784, 1784, 1580, 1580, 1580, 1576, 1576
.short 1576, 1576, 1576, 1372, 1372, 1372, 1368, 1368
.short 1368, 1368, 1368, 1164, 1164, 1164, 1160, 1160
.short 1160, 1160, 1160, 956, 956, 956, 952, 952
.short 952, 952, 952, 748, 748, 748, 744, 744
.short 744, 744, 744, 540, 540, 540, 536, 536
.short 536, 536, 536, 332, 332, 332, 328, 328
.short 328, 328, 328, 124, 124, 124, 120, 120
.short 120, 120, 120, 3236, 3236, 3236, 3232, 3232
.short 3232, 3232, 3232, 3028, 3028, 3028, 3024, 3024
.short 3024, 3024, 3024, 2820, 2820, 2820, 2816, 2816
.short 2816, 2816, 2816, 2612, 2612, 2612, 2608, 2608
.short 2608, 2608, 2608, 2404, 2404, 2404, 2400, 2400
.short 2400, 2400, 2400, 2196, 2196, 2196, 2192, 2192
.short 2192, 2192, 2192, 1988, 1988, 1988, 1984, 1984
.short 1984, 1984, 1984, 1780, 1780, 1780, 1776, 1776
.short 1776, 1776, 1776, 1572, 1572, 1572, 1568, 1568
.short 1568, 1568, 1568, 1364, 1364, 1364, 1360, 1360
.short 1360, 1360, 1360, 1156, 1156, 1156, 1152, 1152
.short 1152, 1152, 1152, 948, 948, 948, 944, 944
.short 944, 944, 944, 740, 740, 740, 736, 736
.short 736, 736, 736, 532, 532, 532, 528, 528
.short 528, 528, 528, 324, 324, 324, 320, 320
.short 320, 320, 320, 116, 116, 116, 112, 112
.short 112, 112, 112, 3228, 3228, 3228, 3224, 3224
.short 3224, 3224, 3224, 3020, 3020, 3020, 3016, 3016
.short 3016, 3016, 3016, 2812, 2812, 2812, 2808, 2808
.short 2808, 2808, 2808, 2604, 2604, 2604, 2600, 2600
.short 2600, 2600, 2600, 2396, 2396, 2396, 2392, 2392
.short 2392, 2392, 2392, 2188, 2188, 2188, 2184, 2184
.short 2184, 2184, 2184, 1980, 1980, 1980, 1976, 1976
.short 1976, 1976, 1976, 1772, 1772, 1772, 1768, 1768
.short 1768, 1768, 1768, 1564, 1564, 1564, 1560, 1560
.short 1560, 1560, 1560, 1356, 1356, 1356, 1352, 1352
.short 1352, 1352, 1352, 1148, 1148, 1148, 1144, 1144
.short 1144, 1144, 1144, 940, 940, 940, 936, 936
.short 936, 936, 936, 732, 732, 732, 728, 728
.short 728, 728, 728, 524, 524, 524, 520, 520
.short 520, 520, 520, 316, 316, 316, 312, 312
.short 312, 312, 312, 108, 108, 108, 104, 104
.short 104, 104, 104, 3220, 3220, 3220, 3216, 3216
.short 3216, 3216, 3216, 3012, 3012, 3012, 3008, 3008
.short 3008, 3008, 3008, 2804, 2804, 2804, 2800, 2800
.short 2800, 2800, 2800, 2596, 2596, 2596, 2592, 2592
.short 2592, 2592, 2592, 2388, 2388, 2388, 2384, 2384
.short 2384, 2384, 2384, 2180, 2180, 2180, 2176, 2176
.short 2176, 2176, 2176, 1972, 1972, 1972, 1968, 1968
.short 1968, 1968, 1968, 1764, 1764, 1764, 1760, 1760
.short 1760, 1760, 1760, 1556, 1556, 1556, 1552, 1552
.short 1552, 1552, 1552, 1348, 1348, 1348, 1344, 1344
.short 1344, 1344, 1344, 1140, 1140, 1140, 1136, 1136
.short 1136, 1136, 1136, 932, 932, 932, 928, 928
.short 928, 928, 928, 724, 724, 724, 720, 720
.short 720, 720, 720, 516, 516, 516, 512, 512
.short 512, 512, 512, 308, 308, 308, 304, 304
.short 304, 304, 304, 100, 100, 100, 96, 96
.short 96, 96, 3212, 3208, 3208, 3208, 3204, 3200
.short 3200, 3200, 3004, 3000, 3000, 3000, 2996, 2992
.short 2992, 2992, 2796, 2792, 2792, 2792, 2788, 2784
.short 2784, 2784, 2588, 2584, 2584, 2584, 2580, 2576
.short 2576, 2576, 2380, 2376, 2376, 2376, 2372, 2368
.short 2368, 2368, 2172, 2168, 2168, 2168, 2164, 2160
.short 2160, 2160, 1964, 1960, 1960, 1960, 1956, 1952
.short 1952, 1952, 1756, 1752, 1752, 1752, 1748, 1744
.short 1744, 1744, 1548, 1544, 1544, 1544, 1540, 1536
.short 1536, 1536, 1340, 1336, 1336, 1336, 1332, 1328
.short 1328, 1328, 1132, 1128, 1128, 1128, 1124, 1120
.short 1120, 1120, 924, 920, 920, 920, 916, 912
.short 912, 912, 716, 712, 712, 712, 708, 704
.short 704, 704, 508, 504, 504, 504, 500, 496
.short 496, 496, 300, 296, 296, 296, 292, 288
.short 288, 288, 92, 88, 88, 88, 84, 80
.short 80, 80, 3196, 3192, 3192, 3192, 3188, 3184
.short 3184, 3184, 2988, 2984, 2984, 2984, 2980, 2976
.short 2976, 2976, 2780, 2776, 2776, 2776, 2772, 2768
.short 2768, 2768, 2572, 2568, 2568, 2568, 2564, 2560
.short 2560, 2560, 2364, 2360, 2360, 2360, 2356, 2352
.short 2352, 2352, 2156, 2152, 2152, 2152, 2148, 2144
.short 2144, 2144, 1948, 1944, 1944, 1944, 1940, 1936
.short 1936, 1936, 1740, 1736, 1736, 1736, 1732, 1728
.short 1728, 1728, 1532, 1528, 1528, 1528, 1524, 1520
.short 1520, 1520, 1324, 1320, 1320, 1320, 1316, 1312
.short 1312, 1312, 1116, 1112, 1112, 1112, 1108, 1104
.short 1104, 1104, 908, 904, 904, 904, 900, 896
.short 896, 896, 700, 696, 696, 696, 692, 688
.short 688, 688, 492, 488, 488, 488, 484, 480
.short 480, 480, 284, 280, 280, 280, 276, 272
.short 272, 272, 76, 72, 72, 72, 68, 64
.short 64, 3180, 3176, 3172, 3168, 3164, 3160, 3156
.short 3152, 2972, 2968, 2964, 2960, 2956, 2952, 2948
.short 2944, 2764, 2760, 2756, 2752, 2748, 2744, 2740
.short 2736, 2556, 2552, 2548, 2544, 2540, 2536, 2532
.short 2528, 2348, 2344, 2340, 2336, 2332, 2328, 2324
.short 2320, 2140, 2136, 2132, 2128, 2124, 2120, 2116
.short 2112, 1932, 1928, 1924, 1920, 1916, 1912, 1908
.short 1904, 1724, 1720, 1716, 1712, 1708, 1704, 1700
.short 1696, 1516, 1512, 1508, 1504, 1500, 1496, 1492
.short 1488, 1308, 1304, 1300, 1296, 1292, 1288, 1284
.short 1280, 1100, 1096, 1092, 1088, 1084, 1080, 1076
.short 1072, 892, 888, 884, 880, 876, 872, 868
.short 864, 684, 680, 676, 672, 668, 664, 660
.short 656, 476, 472, 468, 464, 460, 456, 452
.short 448, 268, 264, 260, 256, 252, 248, 244
.short 240, 60, 56, 52, 48, 44, 40, 36
.short 32, 3148, 3144, 3140, 3136, 3132, 3128, 3124
.short 3120, 2940, 2936, 2932, 2928, 2924, 2920, 2916
.short 2912, 2732, 2728, 2724, 2720, 2716, 2712, 2708
.short 2704, 2524, 2520, 2516, 2512, 2508, 2504, 2500
.short 2496, 2316, 2312, 2308, 2304, 2300, 2296, 2292
.short 2288, 2108, 2104, 2100, 2096, 2092, 2088, 2084
.short 2080, 1900, 1896, 1892, 1888, 1884, 1880, 1876
.short 1872, 1692, 1688, 1684, 1680, 1676, 1672, 1668
.short 1664, 1484, 1480, 1476, 1472, 1468, 1464, 1460
.short 1456, 1276, 1272, 1268, 1264, 1260, 1256, 1252
.short 1248, 1068, 1064, 1060, 1056, 1052, 1048, 1044
.short 1040, 860, 856, 852, 848, 844, 840, 836
.short 832, 652, 648, 644, 640, 636, 632, 628
.short 624, 444, 440, 436, 432, 428, 424, 420
.short 416, 236, 232, 228, 224, 220, 216, 212
.short 208, 28, 24, 20, 16, 12, 8, 4
.short 0, 0, 0, 0, 0, 0, 0, 0
.section .rodata,"a"
.p2align 6
.amdhsa_kernel mega_kernel
  .amdhsa_next_free_vgpr 256
  .amdhsa_next_free_sgpr 102
  .amdhsa_accum_offset 256
  .amdhsa_group_segment_fixed_size 0
  .amdhsa_kernarg_size 136
  .amdhsa_user_sgpr_count 2
  .amdhsa_user_sgpr_kernarg_segment_ptr 1
  .amdhsa_system_sgpr_workgroup_id_x 1
.end_amdhsa_kernel
```
